```python
import torch

def _softmax(x, axis=-1):
    return torch.softmax(x, dim=axis)

def _gelu(x):
    return torch.nn.functional.gelu(x, approximate='tanh')

def _silu(x):
    return torch.nn.functional.silu(x)

def _sigmoid(x):
    return torch.sigmoid(x)

def _layernorm(x, axis=-1, eps=1e-05):
    m = x.mean(dim=axis, keepdim=True)
    v = x.var(dim=axis, keepdim=True, unbiased=False)
    return (x - m) / torch.sqrt(v + eps)

def _scatter_add(tgt, idx, src, axis=0):
    return tgt.clone().index_add_(axis, idx, src)

def _segment_sum(src, seg, n):
    out = torch.zeros((n,) + src.shape[1:], dtype=src.dtype)
    return out.index_add_(0, seg, src)

def _pad(x, pw):
    flat = tuple((v for pair in reversed(pw) for v in pair))
    return torch.nn.functional.pad(x, flat)
kernel_name = 'gated_mix__linear_attn_block__memory_aug_recurrent_mem_tr__prompt'

def setup_inputs():

    _w = lambda a: (lambda t: t.to(torch.bfloat16) if t.is_floating_point() else t)(torch.as_tensor(a))

    def _A_setup():
        B, S, D = (1, 2048, 640)
        return {'x': _w((lambda *s: torch.randn(*s, dtype=torch.bfloat16) * 0.05)(B, S, D)), 'wqkv': _w((lambda *s: torch.randn(*s, dtype=torch.bfloat16) * 1.6)(D, 3 * D)), 'wo': _w((lambda *s: torch.randn(*s, dtype=torch.bfloat16) * 0.1)(D, D))}
    _A_in = _A_setup()

    def _B_setup():
        B, S, Dm = (1, 2048, 640)
        H, Dh = (32, 192)
        M, seg = (8, 32)
        seg = min(seg, S)
        S = S // seg * seg
        return {'x': _w((lambda *s: torch.randn(*s, dtype=torch.bfloat16) * 0.05)(B, S, Dm)), 'mem0': _w((lambda *s: torch.randn(*s, dtype=torch.bfloat16) * 0.8)(B, M, Dm)), 'Wq': _w((lambda *s: torch.randn(*s, dtype=torch.bfloat16) * 3.2)(Dm, H, Dh) * Dm ** (-0.5)), 'Wk': _w((lambda *s: torch.randn(*s, dtype=torch.bfloat16) * 3.2)(Dm, H, Dh) * Dm ** (-0.5)), 'Wv': _w((lambda *s: torch.randn(*s, dtype=torch.bfloat16) * 0.8)(Dm, H, Dh) * Dm ** (-0.5)), 'Wo': _w((lambda *s: torch.randn(*s, dtype=torch.bfloat16) * 0.8)(H, Dh, Dm) * (H * Dh) ** (-0.5)), 'seg_len': seg}
    _B_in = _B_setup()
    return {'A_x': _A_in['x'], 'A_wqkv': _A_in['wqkv'], 'A_wo': _A_in['wo'], 'B_x': _B_in['x'], 'B_mem0': _B_in['mem0'], 'B_Wq': _B_in['Wq'], 'B_Wk': _B_in['Wk'], 'B_Wv': _B_in['Wv'], 'B_Wo': _B_in['Wo'], 'B_seg_len': _B_in['seg_len'], 'gate_w': _w((lambda *s: torch.randn(*s, dtype=torch.bfloat16) * 0.05)(640) * 16.0)}

def reference(A_x, A_wqkv, A_wo, B_x, B_mem0, B_Wq, B_Wk, B_Wv, B_Wo, B_seg_len, gate_w):

    def _A_ref(x, wqkv, wo):
        B, S, D = x.shape
        H = 32
        Dh = D // H
        qkv = (lambda x, *d: x.permute(*d))((x @ wqkv).reshape(B, S, 3, H, Dh), 2, 0, 3, 1, 4)
        q, k, v = (qkv[0], qkv[1], qkv[2])
        phi = lambda t: torch.where(t > 0, t + 1, torch.exp(t)) + 1e-06
        pq, pk = (phi(q), phi(k))
        kv = torch.einsum('bhsd,bhse->bhde', pk, v)
        z = torch.einsum('bhsd->bhd', pk)
        num = torch.einsum('bhqd,bhde->bhqe', pq, kv)
        den = torch.einsum('bhqd,bhd->bhq', pq, z)[..., None] + 1e-06
        o = num / den
        return (lambda x, *d: x.permute(*d))(o, 0, 2, 1, 3).reshape(B, S, D) @ wo

    def _B_ref(x, mem0, Wq, Wk, Wv, Wo, seg_len):
        B, S, Dm = x.shape
        H, Dh = (Wq.shape[1], Wq.shape[2])
        M = mem0.shape[1]
        scale = Dh ** (-0.5)
        n_seg = S // seg_len
        L = M + seg_len
        idx = torch.arange(L)
        mask = (idx[:, None] < M) | (idx[:, None] >= idx[None, :])
        mem = mem0
        outs = []
        for s in range(n_seg):
            xs = x[:, s * seg_len:(s + 1) * seg_len, :].clone()
            h = torch.concatenate([mem, xs], axis=1)
            q = torch.einsum('btd,dhe->bhte', h, Wq)
            k = torch.einsum('btd,dhe->bhte', h, Wk)
            v = torch.einsum('btd,dhe->bhte', h, Wv)
            scores = torch.einsum('bhqe,bhke->bhqk', q, k) * scale
            scores = torch.where(mask[None, None], scores, -1000000000.0)
            p = _softmax(scores, axis=-1)
            o = torch.einsum('bhqk,bhke->bhqe', p, v)
            o = torch.einsum('bhte,hed->btd', o, Wo)
            mem = o[:, :M, :].clone()
            outs.append(o[:, M:, :])
        return torch.concatenate(outs, axis=1)
    x = A_x
    g = _sigmoid((x * gate_w).sum(-1, keepdims=True))
    a = _A_ref(x, A_wqkv, A_wo)
    b = _B_ref(x, B_mem0, B_Wq, B_Wk, B_Wv, B_Wo, B_seg_len)
    return g * a + (1 - g) * b
```

```asm
; @launch grid=(256,1,1) block=(256,1,1) lds=163840
.amdgcn_target "amdgcn-amd-amdhsa--gfx950"
.text
.globl gated_mix__linear_attn_block__memory_aug_recurrent_mem_tr__prompt_kernel
.p2align 8
.type gated_mix__linear_attn_block__memory_aug_recurrent_mem_tr__prompt_kernel,@function
gated_mix__linear_attn_block__memory_aug_recurrent_mem_tr__prompt_kernel:

    s_cmp_ge_u32 s2, 256
    s_cbranch_scc1 L_end
    s_load_dwordx16 s[64:79], s[0:1], 0
    s_load_dwordx8 s[80:87], s[0:1], 64
    s_load_dwordx4 s[88:91], s[0:1], 96
    s_memrealtime s[92:93]
    s_getreg_b32 s30, hwreg(HW_REG_XCC_ID)
    v_lshrrev_b32 v1, 6, v0
    v_and_b32 v0, 63, v0
    s_mov_b32 s7, 0
    v_readfirstlane_b32 s3, v1
    s_waitcnt lgkmcnt(0)
    s_mov_b32 s8, s90
    s_mov_b32 s9, s91
    s_mov_b32 s10, 268435456
    s_mov_b32 s11, 0x20000
    s_mov_b32 s20, s64
    s_mov_b32 s21, s65
    s_mov_b32 s22, 2621440
    s_mov_b32 s23, 0x20000
    s_mov_b32 s24, s88
    s_mov_b32 s25, s89
    s_mov_b32 s26, 256
    s_mov_b32 s27, 0x20000
    s_mov_b32 s12, s64
    s_mov_b32 s13, s65
    s_mov_b32 s14, 0
    s_mov_b32 s15, 0x20000
    s_mov_b32 s16, s64
    s_mov_b32 s17, s65
    s_mov_b32 s18, 0
    s_mov_b32 s19, 0x20000
    v_mov_b32 v1, 0
    s_or_b32 s31, s2, s3
    s_cmp_eq_u32 s31, 0
    s_cbranch_scc0 L_boot
    s_and_b32 s30, s30, 7
    s_or_b32 s30, s30, 0x100
    v_mov_b32 v2, s30
    v_mov_b32 v3, s92
    buffer_store_dwordx2 v[2:3], v1, s[24:27], 0 offen sc1
L_boot:
    buffer_load_dwordx2 v[2:3], v1, s[24:27], 0 offen sc1
    s_add_u32 s7, s7, 1
    s_bitcmp1_b32 s7, 22
    s_cbranch_scc1 L_abort
    s_waitcnt vmcnt(0)
    v_readfirstlane_b32 s30, v2
    v_readfirstlane_b32 s4, v3
    s_cmp_eq_u32 s30, 0
    s_cbranch_scc1 L_boot
    s_add_u32 s5, s2, s30
    s_and_b32 s5, s5, 7
    s_lshr_b32 s6, s2, 3
    s_cmp_ge_u32 s5, 4
    s_cbranch_scc1 L_disp_hi
    s_cmp_lt_u32 s6, 8
    s_cbranch_scc1 L_a
    s_cmp_lt_u32 s6, 16
    s_cbranch_scc1 L_b
    s_cmp_lt_u32 s6, 26
    s_cbranch_scc1 L_r
    s_cmp_lt_u32 s6, 30
    s_cbranch_scc1 L_f
    s_branch L_a1
L_disp_hi:
    s_cmp_lt_u32 s6, 24
    s_cbranch_scc1 L_kv
    s_branch L_u
L_abort:
    s_mov_b32 s24, s88
    s_mov_b32 s25, s89
    s_mov_b32 s26, 256
    s_mov_b32 s27, 0x20000
    s_mov_b64 exec, -1
    s_waitcnt vmcnt(0) lgkmcnt(0)
    s_lshl_b32 s30, s5, 8
    s_or_b32 s30, s30, s6
    s_or_b32 s30, s30, 0xab0000
    v_mov_b32 v1, 8
    v_mov_b32 v2, s30
    buffer_store_dword v2, v1, s[24:27], 0 offen sc1
L_end:
    s_endpgm
L_a:
    s_lshl_b32 s40, s5, 3
    s_add_u32 s40, s40, s6
    s_sub_u32 s40, s40, 0
    s_mov_b32 s97, 0
    s_mul_i32 s43, s40, 384
    s_mul_i32 s32, s3, 12288
    s_add_u32 s32, s32, 114688
    s_mul_i32 s41, s3, 28672
    s_mov_b32 s12, s74
    s_mov_b32 s13, s75
    s_mov_b32 s14, 7864320
    s_mov_b32 s15, 0x20000
    s_mov_b32 s16, s76
    s_mov_b32 s17, s77
    s_mov_b32 s18, 7864320
    s_mov_b32 s19, 0x20000
    s_mul_i32 s30, s3, 192
    v_add_u32 v1, 0, v0
    v_add_u32 v1, s30, v1
    v_mul_u32_u24 v2, 2731, v1
    v_lshrrev_b32 v2, 16, v2
    v_mul_u32_u24 v3, 24, v2
    v_sub_u32 v3, v1, v3
    v_mul_u32_u24 v2, 12288, v2
    v_lshl_add_u32 v20, v3, 4, v2
    s_mul_i32 s30, s3, 192
    v_add_u32 v1, 64, v0
    v_add_u32 v1, s30, v1
    v_mul_u32_u24 v2, 2731, v1
    v_lshrrev_b32 v2, 16, v2
    v_mul_u32_u24 v3, 24, v2
    v_sub_u32 v3, v1, v3
    v_mul_u32_u24 v2, 12288, v2
    v_lshl_add_u32 v21, v3, 4, v2
    s_mul_i32 s30, s3, 192
    v_add_u32 v1, 128, v0
    v_add_u32 v1, s30, v1
    v_mul_u32_u24 v2, 2731, v1
    v_lshrrev_b32 v2, 16, v2
    v_mul_u32_u24 v3, 24, v2
    v_sub_u32 v3, v1, v3
    v_mul_u32_u24 v2, 12288, v2
    v_lshl_add_u32 v22, v3, 4, v2
    v_lshrrev_b32 v1, 4, v0
    v_lshlrev_b32 v1, 3, v1
    v_bfe_u32 v2, v0, 2, 2
    v_add_u32 v1, v1, v2
    v_mul_u32_u24 v1, 384, v1
    v_and_b32 v2, 3, v0
    v_lshl_add_u32 v1, v2, 3, v1
    s_mul_i32 s30, s3, 96
    s_add_u32 s30, s30, 0
    v_add_u32 v23, s30, v1
    v_bfe_u32 v1, v0, 3, 1
    v_mul_u32_u24 v2, 12288, v1
    v_add_u32 v24, v23, v2
    v_mul_u32_u24 v2, 1536, v1
    v_sub_u32 v25, v24, v2
    v_add_u32 v25, 768, v25
    s_mul_i32 s31, s3, 3072
    s_add_u32 s33, s43, 0
    s_add_u32 m0, s31, 0
    s_nop 0
    buffer_load_dwordx4 v20, s[12:15], s33 offen lds
    s_add_u32 m0, s31, 1024
    s_nop 0
    buffer_load_dwordx4 v21, s[12:15], s33 offen lds
    s_add_u32 m0, s31, 2048
    s_nop 0
    buffer_load_dwordx4 v22, s[12:15], s33 offen lds
    s_add_u32 s33, s43, 0
    s_add_u32 m0, s31, 12288
    s_nop 0
    buffer_load_dwordx4 v20, s[16:19], s33 offen lds
    s_add_u32 m0, s31, 13312
    s_nop 0
    buffer_load_dwordx4 v21, s[16:19], s33 offen lds
    s_add_u32 m0, s31, 14336
    s_nop 0
    buffer_load_dwordx4 v22, s[16:19], s33 offen lds
    s_add_u32 s33, s43, 393216
    s_add_u32 m0, s31, 24576
    s_nop 0
    buffer_load_dwordx4 v20, s[12:15], s33 offen lds
    s_add_u32 m0, s31, 25600
    s_nop 0
    buffer_load_dwordx4 v21, s[12:15], s33 offen lds
    s_add_u32 m0, s31, 26624
    s_nop 0
    buffer_load_dwordx4 v22, s[12:15], s33 offen lds
    s_add_u32 s33, s43, 393216
    s_add_u32 m0, s31, 36864
    s_nop 0
    buffer_load_dwordx4 v20, s[16:19], s33 offen lds
    s_add_u32 m0, s31, 37888
    s_nop 0
    buffer_load_dwordx4 v21, s[16:19], s33 offen lds
    s_add_u32 m0, s31, 38912
    s_nop 0
    buffer_load_dwordx4 v22, s[16:19], s33 offen lds
    s_add_u32 s33, s43, 786432
    s_add_u32 m0, s31, 49152
    s_nop 0
    buffer_load_dwordx4 v20, s[12:15], s33 offen lds
    s_add_u32 m0, s31, 50176
    s_nop 0
    buffer_load_dwordx4 v21, s[12:15], s33 offen lds
    s_add_u32 m0, s31, 51200
    s_nop 0
    buffer_load_dwordx4 v22, s[12:15], s33 offen lds
    s_add_u32 s33, s43, 786432
    s_add_u32 m0, s31, 61440
    s_nop 0
    buffer_load_dwordx4 v20, s[16:19], s33 offen lds
    s_add_u32 m0, s31, 62464
    s_nop 0
    buffer_load_dwordx4 v21, s[16:19], s33 offen lds
    s_add_u32 m0, s31, 63488
    s_nop 0
    buffer_load_dwordx4 v22, s[16:19], s33 offen lds
    s_add_u32 s33, s43, 1179648
    s_add_u32 m0, s31, 73728
    s_nop 0
    buffer_load_dwordx4 v20, s[12:15], s33 offen lds
    s_add_u32 m0, s31, 74752
    s_nop 0
    buffer_load_dwordx4 v21, s[12:15], s33 offen lds
    s_add_u32 m0, s31, 75776
    s_nop 0
    buffer_load_dwordx4 v22, s[12:15], s33 offen lds
    s_add_u32 s33, s43, 1179648
    s_add_u32 m0, s31, 86016
    s_nop 0
    buffer_load_dwordx4 v20, s[16:19], s33 offen lds
    s_add_u32 m0, s31, 87040
    s_nop 0
    buffer_load_dwordx4 v21, s[16:19], s33 offen lds
    s_add_u32 m0, s31, 88064
    s_nop 0
    buffer_load_dwordx4 v22, s[16:19], s33 offen lds
    s_add_u32 s33, s43, 1572864
    s_add_u32 m0, s31, 98304
    s_nop 0
    buffer_load_dwordx4 v20, s[12:15], s33 offen lds
    s_add_u32 m0, s31, 99328
    s_nop 0
    buffer_load_dwordx4 v21, s[12:15], s33 offen lds
    s_add_u32 m0, s31, 100352
    s_nop 0
    buffer_load_dwordx4 v22, s[12:15], s33 offen lds
    s_add_u32 s33, s43, 1572864
    s_add_u32 m0, s31, 110592
    s_nop 0
    buffer_load_dwordx4 v20, s[16:19], s33 offen lds
    s_add_u32 m0, s31, 111616
    s_nop 0
    buffer_load_dwordx4 v21, s[16:19], s33 offen lds
    s_add_u32 m0, s31, 112640
    s_nop 0
    buffer_load_dwordx4 v22, s[16:19], s33 offen lds
    s_add_u32 s33, s43, 1966080
    s_add_u32 m0, s31, 122880
    s_nop 0
    buffer_load_dwordx4 v20, s[12:15], s33 offen lds
    s_add_u32 m0, s31, 123904
    s_nop 0
    buffer_load_dwordx4 v21, s[12:15], s33 offen lds
    s_add_u32 m0, s31, 124928
    s_nop 0
    buffer_load_dwordx4 v22, s[12:15], s33 offen lds
    s_add_u32 s33, s43, 1966080
    s_add_u32 m0, s31, 135168
    s_nop 0
    buffer_load_dwordx4 v20, s[16:19], s33 offen lds
    s_add_u32 m0, s31, 136192
    s_nop 0
    buffer_load_dwordx4 v21, s[16:19], s33 offen lds
    s_add_u32 m0, s31, 137216
    s_nop 0
    buffer_load_dwordx4 v22, s[16:19], s33 offen lds
    s_waitcnt vmcnt(30)
    s_barrier
    ds_read_b64_tr_b16 a[0:1], v24 offset:0
    ds_read_b64_tr_b16 a[2:3], v24 offset:1536
    ds_read_b64_tr_b16 a[16:17], v25 offset:0
    ds_read_b64_tr_b16 a[18:19], v25 offset:1536
    ds_read_b64_tr_b16 a[8:9], v24 offset:32
    ds_read_b64_tr_b16 a[10:11], v24 offset:1568
    ds_read_b64_tr_b16 a[24:25], v25 offset:32
    ds_read_b64_tr_b16 a[26:27], v25 offset:1568
    ds_read_b64_tr_b16 v[32:33], v24 offset:64
    ds_read_b64_tr_b16 v[34:35], v24 offset:1600
    ds_read_b64_tr_b16 a[32:33], v25 offset:64
    ds_read_b64_tr_b16 a[34:35], v25 offset:1600
    s_waitcnt lgkmcnt(0)
    s_waitcnt vmcnt(24)
    s_barrier
    s_add_u32 s33, s43, 2359296
    s_add_u32 m0, s31, 0
    s_nop 0
    buffer_load_dwordx4 v20, s[12:15], s33 offen lds
    s_add_u32 m0, s31, 1024
    s_nop 0
    buffer_load_dwordx4 v21, s[12:15], s33 offen lds
    s_add_u32 m0, s31, 2048
    s_nop 0
    buffer_load_dwordx4 v22, s[12:15], s33 offen lds
    s_add_u32 s33, s43, 2359296
    s_add_u32 m0, s31, 12288
    s_nop 0
    buffer_load_dwordx4 v20, s[16:19], s33 offen lds
    s_add_u32 m0, s31, 13312
    s_nop 0
    buffer_load_dwordx4 v21, s[16:19], s33 offen lds
    s_add_u32 m0, s31, 14336
    s_nop 0
    buffer_load_dwordx4 v22, s[16:19], s33 offen lds
    ds_read_b64_tr_b16 a[4:5], v24 offset:24576
    ds_read_b64_tr_b16 a[6:7], v24 offset:26112
    ds_read_b64_tr_b16 a[20:21], v25 offset:24576
    ds_read_b64_tr_b16 a[22:23], v25 offset:26112
    ds_read_b64_tr_b16 a[12:13], v24 offset:24608
    ds_read_b64_tr_b16 a[14:15], v24 offset:26144
    ds_read_b64_tr_b16 a[28:29], v25 offset:24608
    ds_read_b64_tr_b16 a[30:31], v25 offset:26144
    ds_read_b64_tr_b16 v[36:37], v24 offset:24640
    ds_read_b64_tr_b16 v[38:39], v24 offset:26176
    ds_read_b64_tr_b16 a[36:37], v25 offset:24640
    ds_read_b64_tr_b16 a[38:39], v25 offset:26176
    s_waitcnt lgkmcnt(0)
    s_waitcnt vmcnt(24)
    s_barrier
    s_add_u32 s33, s43, 2752512
    s_add_u32 m0, s31, 24576
    s_nop 0
    buffer_load_dwordx4 v20, s[12:15], s33 offen lds
    s_add_u32 m0, s31, 25600
    s_nop 0
    buffer_load_dwordx4 v21, s[12:15], s33 offen lds
    s_add_u32 m0, s31, 26624
    s_nop 0
    buffer_load_dwordx4 v22, s[12:15], s33 offen lds
    s_add_u32 s33, s43, 2752512
    s_add_u32 m0, s31, 36864
    s_nop 0
    buffer_load_dwordx4 v20, s[16:19], s33 offen lds
    s_add_u32 m0, s31, 37888
    s_nop 0
    buffer_load_dwordx4 v21, s[16:19], s33 offen lds
    s_add_u32 m0, s31, 38912
    s_nop 0
    buffer_load_dwordx4 v22, s[16:19], s33 offen lds
    v_add_u32 v23, 49152, v23
    v_add_u32 v24, 49152, v24
    v_add_u32 v25, 49152, v25
    ds_read_b64_tr_b16 v[40:41], v24 offset:0
    ds_read_b64_tr_b16 v[42:43], v24 offset:1536
    ds_read_b64_tr_b16 a[56:57], v25 offset:0
    ds_read_b64_tr_b16 a[58:59], v25 offset:1536
    ds_read_b64_tr_b16 a[40:41], v24 offset:32
    ds_read_b64_tr_b16 a[42:43], v24 offset:1568
    ds_read_b64_tr_b16 v[48:49], v25 offset:32
    ds_read_b64_tr_b16 v[50:51], v25 offset:1568
    ds_read_b64_tr_b16 a[48:49], v24 offset:64
    ds_read_b64_tr_b16 a[50:51], v24 offset:1600
    ds_read_b64_tr_b16 a[64:65], v25 offset:64
    ds_read_b64_tr_b16 a[66:67], v25 offset:1600
    s_waitcnt lgkmcnt(0)
    s_waitcnt vmcnt(24)
    s_barrier
    s_add_u32 s33, s43, 3145728
    s_add_u32 m0, s31, 49152
    s_nop 0
    buffer_load_dwordx4 v20, s[12:15], s33 offen lds
    s_add_u32 m0, s31, 50176
    s_nop 0
    buffer_load_dwordx4 v21, s[12:15], s33 offen lds
    s_add_u32 m0, s31, 51200
    s_nop 0
    buffer_load_dwordx4 v22, s[12:15], s33 offen lds
    s_add_u32 s33, s43, 3145728
    s_add_u32 m0, s31, 61440
    s_nop 0
    buffer_load_dwordx4 v20, s[16:19], s33 offen lds
    s_add_u32 m0, s31, 62464
    s_nop 0
    buffer_load_dwordx4 v21, s[16:19], s33 offen lds
    s_add_u32 m0, s31, 63488
    s_nop 0
    buffer_load_dwordx4 v22, s[16:19], s33 offen lds
    ds_read_b64_tr_b16 v[44:45], v24 offset:24576
    ds_read_b64_tr_b16 v[46:47], v24 offset:26112
    ds_read_b64_tr_b16 a[60:61], v25 offset:24576
    ds_read_b64_tr_b16 a[62:63], v25 offset:26112
    ds_read_b64_tr_b16 a[44:45], v24 offset:24608
    ds_read_b64_tr_b16 a[46:47], v24 offset:26144
    ds_read_b64_tr_b16 v[52:53], v25 offset:24608
    ds_read_b64_tr_b16 v[54:55], v25 offset:26144
    ds_read_b64_tr_b16 a[52:53], v24 offset:24640
    ds_read_b64_tr_b16 a[54:55], v24 offset:26176
    ds_read_b64_tr_b16 a[68:69], v25 offset:24640
    ds_read_b64_tr_b16 a[70:71], v25 offset:26176
    s_waitcnt lgkmcnt(0)
    s_waitcnt vmcnt(24)
    s_barrier
    s_add_u32 s33, s43, 3538944
    s_add_u32 m0, s31, 73728
    s_nop 0
    buffer_load_dwordx4 v20, s[12:15], s33 offen lds
    s_add_u32 m0, s31, 74752
    s_nop 0
    buffer_load_dwordx4 v21, s[12:15], s33 offen lds
    s_add_u32 m0, s31, 75776
    s_nop 0
    buffer_load_dwordx4 v22, s[12:15], s33 offen lds
    s_add_u32 s33, s43, 3538944
    s_add_u32 m0, s31, 86016
    s_nop 0
    buffer_load_dwordx4 v20, s[16:19], s33 offen lds
    s_add_u32 m0, s31, 87040
    s_nop 0
    buffer_load_dwordx4 v21, s[16:19], s33 offen lds
    s_add_u32 m0, s31, 88064
    s_nop 0
    buffer_load_dwordx4 v22, s[16:19], s33 offen lds
    v_add_u32 v23, 49152, v23
    v_add_u32 v24, 49152, v24
    v_add_u32 v25, 49152, v25
    ds_read_b64_tr_b16 a[72:73], v24 offset:0
    ds_read_b64_tr_b16 a[74:75], v24 offset:1536
    ds_read_b64_tr_b16 a[88:89], v25 offset:0
    ds_read_b64_tr_b16 a[90:91], v25 offset:1536
    ds_read_b64_tr_b16 a[80:81], v24 offset:32
    ds_read_b64_tr_b16 a[82:83], v24 offset:1568
    ds_read_b64_tr_b16 a[96:97], v25 offset:32
    ds_read_b64_tr_b16 a[98:99], v25 offset:1568
    ds_read_b64_tr_b16 v[56:57], v24 offset:64
    ds_read_b64_tr_b16 v[58:59], v24 offset:1600
    ds_read_b64_tr_b16 a[104:105], v25 offset:64
    ds_read_b64_tr_b16 a[106:107], v25 offset:1600
    s_waitcnt lgkmcnt(0)
    s_waitcnt vmcnt(24)
    s_barrier
    s_add_u32 s33, s43, 3932160
    s_add_u32 m0, s31, 98304
    s_nop 0
    buffer_load_dwordx4 v20, s[12:15], s33 offen lds
    s_add_u32 m0, s31, 99328
    s_nop 0
    buffer_load_dwordx4 v21, s[12:15], s33 offen lds
    s_add_u32 m0, s31, 100352
    s_nop 0
    buffer_load_dwordx4 v22, s[12:15], s33 offen lds
    s_add_u32 s33, s43, 3932160
    s_add_u32 m0, s31, 110592
    s_nop 0
    buffer_load_dwordx4 v20, s[16:19], s33 offen lds
    s_add_u32 m0, s31, 111616
    s_nop 0
    buffer_load_dwordx4 v21, s[16:19], s33 offen lds
    s_add_u32 m0, s31, 112640
    s_nop 0
    buffer_load_dwordx4 v22, s[16:19], s33 offen lds
    ds_read_b64_tr_b16 a[76:77], v24 offset:24576
    ds_read_b64_tr_b16 a[78:79], v24 offset:26112
    ds_read_b64_tr_b16 a[92:93], v25 offset:24576
    ds_read_b64_tr_b16 a[94:95], v25 offset:26112
    ds_read_b64_tr_b16 a[84:85], v24 offset:24608
    ds_read_b64_tr_b16 a[86:87], v24 offset:26144
    ds_read_b64_tr_b16 a[100:101], v25 offset:24608
    ds_read_b64_tr_b16 a[102:103], v25 offset:26144
    ds_read_b64_tr_b16 v[60:61], v24 offset:24640
    ds_read_b64_tr_b16 v[62:63], v24 offset:26176
    ds_read_b64_tr_b16 a[108:109], v25 offset:24640
    ds_read_b64_tr_b16 a[110:111], v25 offset:26176
    s_waitcnt lgkmcnt(0)
    s_waitcnt vmcnt(24)
    s_barrier
    s_add_u32 s33, s43, 4325376
    s_add_u32 m0, s31, 122880
    s_nop 0
    buffer_load_dwordx4 v20, s[12:15], s33 offen lds
    s_add_u32 m0, s31, 123904
    s_nop 0
    buffer_load_dwordx4 v21, s[12:15], s33 offen lds
    s_add_u32 m0, s31, 124928
    s_nop 0
    buffer_load_dwordx4 v22, s[12:15], s33 offen lds
    s_add_u32 s33, s43, 4325376
    s_add_u32 m0, s31, 135168
    s_nop 0
    buffer_load_dwordx4 v20, s[16:19], s33 offen lds
    s_add_u32 m0, s31, 136192
    s_nop 0
    buffer_load_dwordx4 v21, s[16:19], s33 offen lds
    s_add_u32 m0, s31, 137216
    s_nop 0
    buffer_load_dwordx4 v22, s[16:19], s33 offen lds
    v_add_u32 v23, 4294868992, v23
    v_add_u32 v24, 4294868992, v24
    v_add_u32 v25, 4294868992, v25
    ds_read_b64_tr_b16 v[64:65], v24 offset:0
    ds_read_b64_tr_b16 v[66:67], v24 offset:1536
    ds_read_b64_tr_b16 a[128:129], v25 offset:0
    ds_read_b64_tr_b16 a[130:131], v25 offset:1536
    ds_read_b64_tr_b16 a[112:113], v24 offset:32
    ds_read_b64_tr_b16 a[114:115], v24 offset:1568
    ds_read_b64_tr_b16 v[72:73], v25 offset:32
    ds_read_b64_tr_b16 v[74:75], v25 offset:1568
    ds_read_b64_tr_b16 a[120:121], v24 offset:64
    ds_read_b64_tr_b16 a[122:123], v24 offset:1600
    ds_read_b64_tr_b16 a[136:137], v25 offset:64
    ds_read_b64_tr_b16 a[138:139], v25 offset:1600
    s_waitcnt lgkmcnt(0)
    s_waitcnt vmcnt(24)
    s_barrier
    s_add_u32 s33, s43, 4718592
    s_add_u32 m0, s31, 0
    s_nop 0
    buffer_load_dwordx4 v20, s[12:15], s33 offen lds
    s_add_u32 m0, s31, 1024
    s_nop 0
    buffer_load_dwordx4 v21, s[12:15], s33 offen lds
    s_add_u32 m0, s31, 2048
    s_nop 0
    buffer_load_dwordx4 v22, s[12:15], s33 offen lds
    s_add_u32 s33, s43, 4718592
    s_add_u32 m0, s31, 12288
    s_nop 0
    buffer_load_dwordx4 v20, s[16:19], s33 offen lds
    s_add_u32 m0, s31, 13312
    s_nop 0
    buffer_load_dwordx4 v21, s[16:19], s33 offen lds
    s_add_u32 m0, s31, 14336
    s_nop 0
    buffer_load_dwordx4 v22, s[16:19], s33 offen lds
    ds_read_b64_tr_b16 v[68:69], v24 offset:24576
    ds_read_b64_tr_b16 v[70:71], v24 offset:26112
    ds_read_b64_tr_b16 a[132:133], v25 offset:24576
    ds_read_b64_tr_b16 a[134:135], v25 offset:26112
    ds_read_b64_tr_b16 a[116:117], v24 offset:24608
    ds_read_b64_tr_b16 a[118:119], v24 offset:26144
    ds_read_b64_tr_b16 v[76:77], v25 offset:24608
    ds_read_b64_tr_b16 v[78:79], v25 offset:26144
    ds_read_b64_tr_b16 a[124:125], v24 offset:24640
    ds_read_b64_tr_b16 a[126:127], v24 offset:26176
    ds_read_b64_tr_b16 a[140:141], v25 offset:24640
    ds_read_b64_tr_b16 a[142:143], v25 offset:26176
    s_waitcnt lgkmcnt(0)
    s_waitcnt vmcnt(24)
    s_barrier
    s_add_u32 s33, s43, 5111808
    s_add_u32 m0, s31, 24576
    s_nop 0
    buffer_load_dwordx4 v20, s[12:15], s33 offen lds
    s_add_u32 m0, s31, 25600
    s_nop 0
    buffer_load_dwordx4 v21, s[12:15], s33 offen lds
    s_add_u32 m0, s31, 26624
    s_nop 0
    buffer_load_dwordx4 v22, s[12:15], s33 offen lds
    s_add_u32 s33, s43, 5111808
    s_add_u32 m0, s31, 36864
    s_nop 0
    buffer_load_dwordx4 v20, s[16:19], s33 offen lds
    s_add_u32 m0, s31, 37888
    s_nop 0
    buffer_load_dwordx4 v21, s[16:19], s33 offen lds
    s_add_u32 m0, s31, 38912
    s_nop 0
    buffer_load_dwordx4 v22, s[16:19], s33 offen lds
    v_add_u32 v23, 49152, v23
    v_add_u32 v24, 49152, v24
    v_add_u32 v25, 49152, v25
    ds_read_b64_tr_b16 a[144:145], v24 offset:0
    ds_read_b64_tr_b16 a[146:147], v24 offset:1536
    ds_read_b64_tr_b16 a[160:161], v25 offset:0
    ds_read_b64_tr_b16 a[162:163], v25 offset:1536
    ds_read_b64_tr_b16 a[152:153], v24 offset:32
    ds_read_b64_tr_b16 a[154:155], v24 offset:1568
    ds_read_b64_tr_b16 a[168:169], v25 offset:32
    ds_read_b64_tr_b16 a[170:171], v25 offset:1568
    ds_read_b64_tr_b16 v[80:81], v24 offset:64
    ds_read_b64_tr_b16 v[82:83], v24 offset:1600
    ds_read_b64_tr_b16 a[176:177], v25 offset:64
    ds_read_b64_tr_b16 a[178:179], v25 offset:1600
    s_waitcnt lgkmcnt(0)
    s_waitcnt vmcnt(24)
    s_barrier
    s_add_u32 s33, s43, 5505024
    s_add_u32 m0, s31, 49152
    s_nop 0
    buffer_load_dwordx4 v20, s[12:15], s33 offen lds
    s_add_u32 m0, s31, 50176
    s_nop 0
    buffer_load_dwordx4 v21, s[12:15], s33 offen lds
    s_add_u32 m0, s31, 51200
    s_nop 0
    buffer_load_dwordx4 v22, s[12:15], s33 offen lds
    s_add_u32 s33, s43, 5505024
    s_add_u32 m0, s31, 61440
    s_nop 0
    buffer_load_dwordx4 v20, s[16:19], s33 offen lds
    s_add_u32 m0, s31, 62464
    s_nop 0
    buffer_load_dwordx4 v21, s[16:19], s33 offen lds
    s_add_u32 m0, s31, 63488
    s_nop 0
    buffer_load_dwordx4 v22, s[16:19], s33 offen lds
    ds_read_b64_tr_b16 a[148:149], v24 offset:24576
    ds_read_b64_tr_b16 a[150:151], v24 offset:26112
    ds_read_b64_tr_b16 a[164:165], v25 offset:24576
    ds_read_b64_tr_b16 a[166:167], v25 offset:26112
    ds_read_b64_tr_b16 a[156:157], v24 offset:24608
    ds_read_b64_tr_b16 a[158:159], v24 offset:26144
    ds_read_b64_tr_b16 a[172:173], v25 offset:24608
    ds_read_b64_tr_b16 a[174:175], v25 offset:26144
    ds_read_b64_tr_b16 v[84:85], v24 offset:24640
    ds_read_b64_tr_b16 v[86:87], v24 offset:26176
    ds_read_b64_tr_b16 a[180:181], v25 offset:24640
    ds_read_b64_tr_b16 a[182:183], v25 offset:26176
    s_waitcnt lgkmcnt(0)
    s_waitcnt vmcnt(24)
    s_barrier
    s_add_u32 s33, s43, 5898240
    s_add_u32 m0, s31, 73728
    s_nop 0
    buffer_load_dwordx4 v20, s[12:15], s33 offen lds
    s_add_u32 m0, s31, 74752
    s_nop 0
    buffer_load_dwordx4 v21, s[12:15], s33 offen lds
    s_add_u32 m0, s31, 75776
    s_nop 0
    buffer_load_dwordx4 v22, s[12:15], s33 offen lds
    s_add_u32 s33, s43, 5898240
    s_add_u32 m0, s31, 86016
    s_nop 0
    buffer_load_dwordx4 v20, s[16:19], s33 offen lds
    s_add_u32 m0, s31, 87040
    s_nop 0
    buffer_load_dwordx4 v21, s[16:19], s33 offen lds
    s_add_u32 m0, s31, 88064
    s_nop 0
    buffer_load_dwordx4 v22, s[16:19], s33 offen lds
    v_add_u32 v23, 49152, v23
    v_add_u32 v24, 49152, v24
    v_add_u32 v25, 49152, v25
    ds_read_b64_tr_b16 v[88:89], v24 offset:0
    ds_read_b64_tr_b16 v[90:91], v24 offset:1536
    ds_read_b64_tr_b16 a[200:201], v25 offset:0
    ds_read_b64_tr_b16 a[202:203], v25 offset:1536
    ds_read_b64_tr_b16 a[184:185], v24 offset:32
    ds_read_b64_tr_b16 a[186:187], v24 offset:1568
    ds_read_b64_tr_b16 v[96:97], v25 offset:32
    ds_read_b64_tr_b16 v[98:99], v25 offset:1568
    ds_read_b64_tr_b16 a[192:193], v24 offset:64
    ds_read_b64_tr_b16 a[194:195], v24 offset:1600
    ds_read_b64_tr_b16 a[208:209], v25 offset:64
    ds_read_b64_tr_b16 a[210:211], v25 offset:1600
    s_waitcnt lgkmcnt(0)
    s_waitcnt vmcnt(24)
    s_barrier
    s_add_u32 s33, s43, 6291456
    s_add_u32 m0, s31, 98304
    s_nop 0
    buffer_load_dwordx4 v20, s[12:15], s33 offen lds
    s_add_u32 m0, s31, 99328
    s_nop 0
    buffer_load_dwordx4 v21, s[12:15], s33 offen lds
    s_add_u32 m0, s31, 100352
    s_nop 0
    buffer_load_dwordx4 v22, s[12:15], s33 offen lds
    s_add_u32 s33, s43, 6291456
    s_add_u32 m0, s31, 110592
    s_nop 0
    buffer_load_dwordx4 v20, s[16:19], s33 offen lds
    s_add_u32 m0, s31, 111616
    s_nop 0
    buffer_load_dwordx4 v21, s[16:19], s33 offen lds
    s_add_u32 m0, s31, 112640
    s_nop 0
    buffer_load_dwordx4 v22, s[16:19], s33 offen lds
    ds_read_b64_tr_b16 v[92:93], v24 offset:24576
    ds_read_b64_tr_b16 v[94:95], v24 offset:26112
    ds_read_b64_tr_b16 a[204:205], v25 offset:24576
    ds_read_b64_tr_b16 a[206:207], v25 offset:26112
    ds_read_b64_tr_b16 a[188:189], v24 offset:24608
    ds_read_b64_tr_b16 a[190:191], v24 offset:26144
    ds_read_b64_tr_b16 v[100:101], v25 offset:24608
    ds_read_b64_tr_b16 v[102:103], v25 offset:26144
    ds_read_b64_tr_b16 a[196:197], v24 offset:24640
    ds_read_b64_tr_b16 a[198:199], v24 offset:26176
    ds_read_b64_tr_b16 a[212:213], v25 offset:24640
    ds_read_b64_tr_b16 a[214:215], v25 offset:26176
    s_waitcnt lgkmcnt(0)
    s_waitcnt vmcnt(24)
    s_barrier
    s_add_u32 s33, s43, 6684672
    s_add_u32 m0, s31, 122880
    s_nop 0
    buffer_load_dwordx4 v20, s[12:15], s33 offen lds
    s_add_u32 m0, s31, 123904
    s_nop 0
    buffer_load_dwordx4 v21, s[12:15], s33 offen lds
    s_add_u32 m0, s31, 124928
    s_nop 0
    buffer_load_dwordx4 v22, s[12:15], s33 offen lds
    s_add_u32 s33, s43, 6684672
    s_add_u32 m0, s31, 135168
    s_nop 0
    buffer_load_dwordx4 v20, s[16:19], s33 offen lds
    s_add_u32 m0, s31, 136192
    s_nop 0
    buffer_load_dwordx4 v21, s[16:19], s33 offen lds
    s_add_u32 m0, s31, 137216
    s_nop 0
    buffer_load_dwordx4 v22, s[16:19], s33 offen lds
    v_add_u32 v23, 4294868992, v23
    v_add_u32 v24, 4294868992, v24
    v_add_u32 v25, 4294868992, v25
    ds_read_b64_tr_b16 a[216:217], v24 offset:0
    ds_read_b64_tr_b16 a[218:219], v24 offset:1536
    ds_read_b64_tr_b16 a[232:233], v25 offset:0
    ds_read_b64_tr_b16 a[234:235], v25 offset:1536
    ds_read_b64_tr_b16 a[224:225], v24 offset:32
    ds_read_b64_tr_b16 a[226:227], v24 offset:1568
    ds_read_b64_tr_b16 a[240:241], v25 offset:32
    ds_read_b64_tr_b16 a[242:243], v25 offset:1568
    ds_read_b64_tr_b16 v[104:105], v24 offset:64
    ds_read_b64_tr_b16 v[106:107], v24 offset:1600
    ds_read_b64_tr_b16 a[248:249], v25 offset:64
    ds_read_b64_tr_b16 a[250:251], v25 offset:1600
    s_waitcnt lgkmcnt(0)
    s_waitcnt vmcnt(24)
    s_barrier
    s_add_u32 s33, s43, 7077888
    s_add_u32 m0, s31, 0
    s_nop 0
    buffer_load_dwordx4 v20, s[12:15], s33 offen lds
    s_add_u32 m0, s31, 1024
    s_nop 0
    buffer_load_dwordx4 v21, s[12:15], s33 offen lds
    s_add_u32 m0, s31, 2048
    s_nop 0
    buffer_load_dwordx4 v22, s[12:15], s33 offen lds
    s_add_u32 s33, s43, 7077888
    s_add_u32 m0, s31, 12288
    s_nop 0
    buffer_load_dwordx4 v20, s[16:19], s33 offen lds
    s_add_u32 m0, s31, 13312
    s_nop 0
    buffer_load_dwordx4 v21, s[16:19], s33 offen lds
    s_add_u32 m0, s31, 14336
    s_nop 0
    buffer_load_dwordx4 v22, s[16:19], s33 offen lds
    ds_read_b64_tr_b16 a[220:221], v24 offset:24576
    ds_read_b64_tr_b16 a[222:223], v24 offset:26112
    ds_read_b64_tr_b16 a[236:237], v25 offset:24576
    ds_read_b64_tr_b16 a[238:239], v25 offset:26112
    ds_read_b64_tr_b16 a[228:229], v24 offset:24608
    ds_read_b64_tr_b16 a[230:231], v24 offset:26144
    ds_read_b64_tr_b16 a[244:245], v25 offset:24608
    ds_read_b64_tr_b16 a[246:247], v25 offset:26144
    ds_read_b64_tr_b16 v[108:109], v24 offset:24640
    ds_read_b64_tr_b16 v[110:111], v24 offset:26176
    ds_read_b64_tr_b16 a[252:253], v25 offset:24640
    ds_read_b64_tr_b16 a[254:255], v25 offset:26176
    s_waitcnt lgkmcnt(0)
    s_waitcnt vmcnt(24)
    s_barrier
    s_add_u32 s33, s43, 7471104
    s_add_u32 m0, s31, 24576
    s_nop 0
    buffer_load_dwordx4 v20, s[12:15], s33 offen lds
    s_add_u32 m0, s31, 25600
    s_nop 0
    buffer_load_dwordx4 v21, s[12:15], s33 offen lds
    s_add_u32 m0, s31, 26624
    s_nop 0
    buffer_load_dwordx4 v22, s[12:15], s33 offen lds
    s_add_u32 s33, s43, 7471104
    s_add_u32 m0, s31, 36864
    s_nop 0
    buffer_load_dwordx4 v20, s[16:19], s33 offen lds
    s_add_u32 m0, s31, 37888
    s_nop 0
    buffer_load_dwordx4 v21, s[16:19], s33 offen lds
    s_add_u32 m0, s31, 38912
    s_nop 0
    buffer_load_dwordx4 v22, s[16:19], s33 offen lds
    v_add_u32 v23, 49152, v23
    v_add_u32 v24, 49152, v24
    v_add_u32 v25, 49152, v25
    ds_read_b64_tr_b16 v[112:113], v24 offset:0
    ds_read_b64_tr_b16 v[114:115], v24 offset:1536
    ds_read_b64_tr_b16 v[160:161], v25 offset:0
    ds_read_b64_tr_b16 v[162:163], v25 offset:1536
    ds_read_b64_tr_b16 v[144:145], v24 offset:32
    ds_read_b64_tr_b16 v[146:147], v24 offset:1568
    ds_read_b64_tr_b16 v[120:121], v25 offset:32
    ds_read_b64_tr_b16 v[122:123], v25 offset:1568
    ds_read_b64_tr_b16 v[152:153], v24 offset:64
    ds_read_b64_tr_b16 v[154:155], v24 offset:1600
    ds_read_b64_tr_b16 v[168:169], v25 offset:64
    ds_read_b64_tr_b16 v[170:171], v25 offset:1600
    s_waitcnt lgkmcnt(0)
    s_waitcnt vmcnt(24)
    s_barrier
    ds_read_b64_tr_b16 v[116:117], v24 offset:24576
    ds_read_b64_tr_b16 v[118:119], v24 offset:26112
    ds_read_b64_tr_b16 v[164:165], v25 offset:24576
    ds_read_b64_tr_b16 v[166:167], v25 offset:26112
    ds_read_b64_tr_b16 v[148:149], v24 offset:24608
    ds_read_b64_tr_b16 v[150:151], v24 offset:26144
    ds_read_b64_tr_b16 v[124:125], v25 offset:24608
    ds_read_b64_tr_b16 v[126:127], v25 offset:26144
    ds_read_b64_tr_b16 v[156:157], v24 offset:24640
    ds_read_b64_tr_b16 v[158:159], v24 offset:26176
    ds_read_b64_tr_b16 v[172:173], v25 offset:24640
    ds_read_b64_tr_b16 v[174:175], v25 offset:26176
    s_waitcnt lgkmcnt(0)
    s_waitcnt vmcnt(18)
    s_barrier
    v_add_u32 v23, 49152, v23
    v_add_u32 v24, 49152, v24
    v_add_u32 v25, 49152, v25
    ds_read_b64_tr_b16 v[176:177], v24 offset:0
    ds_read_b64_tr_b16 v[178:179], v24 offset:1536
    ds_read_b64_tr_b16 v[128:129], v25 offset:0
    ds_read_b64_tr_b16 v[130:131], v25 offset:1536
    ds_read_b64_tr_b16 v[184:185], v24 offset:32
    ds_read_b64_tr_b16 v[186:187], v24 offset:1568
    ds_read_b64_tr_b16 v[192:193], v25 offset:32
    ds_read_b64_tr_b16 v[194:195], v25 offset:1568
    ds_read_b64_tr_b16 v[224:225], v24 offset:64
    ds_read_b64_tr_b16 v[226:227], v24 offset:1600
    ds_read_b64_tr_b16 v[232:233], v25 offset:64
    ds_read_b64_tr_b16 v[234:235], v25 offset:1600
    s_waitcnt lgkmcnt(0)
    s_waitcnt vmcnt(12)
    s_barrier
    ds_read_b64_tr_b16 v[180:181], v24 offset:24576
    ds_read_b64_tr_b16 v[182:183], v24 offset:26112
    ds_read_b64_tr_b16 v[132:133], v25 offset:24576
    ds_read_b64_tr_b16 v[134:135], v25 offset:26112
    ds_read_b64_tr_b16 v[188:189], v24 offset:24608
    ds_read_b64_tr_b16 v[190:191], v24 offset:26144
    ds_read_b64_tr_b16 v[196:197], v25 offset:24608
    ds_read_b64_tr_b16 v[198:199], v25 offset:26144
    ds_read_b64_tr_b16 v[228:229], v24 offset:24640
    ds_read_b64_tr_b16 v[230:231], v24 offset:26176
    ds_read_b64_tr_b16 v[236:237], v25 offset:24640
    ds_read_b64_tr_b16 v[238:239], v25 offset:26176
    s_waitcnt lgkmcnt(0)
    s_waitcnt vmcnt(6)
    s_barrier
    v_add_u32 v23, 4294868992, v23
    v_add_u32 v24, 4294868992, v24
    v_add_u32 v25, 4294868992, v25
    ds_read_b64_tr_b16 v[200:201], v24 offset:0
    ds_read_b64_tr_b16 v[202:203], v24 offset:1536
    ds_read_b64_tr_b16 v[136:137], v25 offset:0
    ds_read_b64_tr_b16 v[138:139], v25 offset:1536
    ds_read_b64_tr_b16 v[208:209], v24 offset:32
    ds_read_b64_tr_b16 v[210:211], v24 offset:1568
    ds_read_b64_tr_b16 v[216:217], v25 offset:32
    ds_read_b64_tr_b16 v[218:219], v25 offset:1568
    ds_read_b64_tr_b16 v[240:241], v24 offset:64
    ds_read_b64_tr_b16 v[242:243], v24 offset:1600
    ds_read_b64_tr_b16 v[248:249], v25 offset:64
    ds_read_b64_tr_b16 v[250:251], v25 offset:1600
    s_waitcnt lgkmcnt(0)
    s_waitcnt vmcnt(0)
    s_barrier
    ds_read_b64_tr_b16 v[204:205], v24 offset:24576
    ds_read_b64_tr_b16 v[206:207], v24 offset:26112
    ds_read_b64_tr_b16 v[140:141], v25 offset:24576
    ds_read_b64_tr_b16 v[142:143], v25 offset:26112
    ds_read_b64_tr_b16 v[212:213], v24 offset:24608
    ds_read_b64_tr_b16 v[214:215], v24 offset:26144
    ds_read_b64_tr_b16 v[220:221], v25 offset:24608
    ds_read_b64_tr_b16 v[222:223], v25 offset:26144
    ds_read_b64_tr_b16 v[244:245], v24 offset:24640
    ds_read_b64_tr_b16 v[246:247], v24 offset:26176
    ds_read_b64_tr_b16 v[252:253], v25 offset:24640
    ds_read_b64_tr_b16 v[254:255], v25 offset:26176
    s_waitcnt lgkmcnt(0)
    s_barrier
    v_lshlrev_b32 v26, 4, v0
    v_add_u32 v26, s41, v26
    ds_write_b128 v26, v[32:35] offset:0
    ds_write_b128 v26, v[36:39] offset:1024
    ds_write_b128 v26, v[40:43] offset:2048
    ds_write_b128 v26, v[44:47] offset:3072
    ds_write_b128 v26, v[48:51] offset:4096
    ds_write_b128 v26, v[52:55] offset:5120
    ds_write_b128 v26, v[56:59] offset:6144
    ds_write_b128 v26, v[60:63] offset:7168
    ds_write_b128 v26, v[64:67] offset:8192
    ds_write_b128 v26, v[68:71] offset:9216
    ds_write_b128 v26, v[72:75] offset:10240
    ds_write_b128 v26, v[76:79] offset:11264
    ds_write_b128 v26, v[80:83] offset:12288
    ds_write_b128 v26, v[84:87] offset:13312
    ds_write_b128 v26, v[88:91] offset:14336
    ds_write_b128 v26, v[92:95] offset:15360
    ds_write_b128 v26, v[96:99] offset:16384
    ds_write_b128 v26, v[100:103] offset:17408
    ds_write_b128 v26, v[104:107] offset:18432
    ds_write_b128 v26, v[108:111] offset:19456
    ds_write_b128 v26, v[112:115] offset:20480
    ds_write_b128 v26, v[116:119] offset:21504
    ds_write_b128 v26, v[120:123] offset:22528
    ds_write_b128 v26, v[124:127] offset:23552
    ds_write_b128 v26, v[128:131] offset:24576
    ds_write_b128 v26, v[132:135] offset:25600
    ds_write_b128 v26, v[136:139] offset:26624
    ds_write_b128 v26, v[140:143] offset:27648
    s_waitcnt lgkmcnt(0)
    v_lshlrev_b32 v4, 4, v0
    v_add_u32 v5, 4096, v4
    v_add_u32 v6, 16384, v4
    v_add_u32 v7, s41, v4
    s_lshl_b32 s31, s5, 9
    s_add_u32 s31, s31, 919936
    v_mov_b32 v9, s31
    v_mov_b32 v1, 0x4444
    v_mov_b32 v2, 0xeeee
    v_and_b32 v3, 2, v0
    v_cmp_eq_u32 vcc, 0, v3
    s_nop 1
    v_cndmask_b32 v8, v2, v1, vcc
    v_and_b32 v1, 15, v0
    v_lshrrev_b32 v2, 4, v0
    v_lshrrev_b32 v34, 2, v1
    v_and_b32 v35, 1, v0
    v_lshl_add_u32 v34, v34, 1, v35
    v_bfe_u32 v35, v0, 1, 1
    v_sub_u32 v27, 0, v35
    v_not_b32 v31, v27
    v_xor_b32 v3, 2, v1
    v_lshlrev_b32 v36, 2, v2
    v_sub_u32 v3, v3, v36
    v_mov_b32 v32, 0x3f80
    v_mov_b32 v33, 0x3f800000
    v_mov_b32 v10, 0
    v_mov_b32 v11, 0
    v_cmp_eq_u32 vcc, 0, v3
    s_nop 1
    v_cndmask_b32 v10, v10, v32, vcc
    v_cmp_eq_u32 vcc, 1, v3
    s_nop 1
    v_cndmask_b32 v10, v10, v33, vcc
    v_cmp_eq_u32 vcc, 2, v3
    s_nop 1
    v_cndmask_b32 v11, v11, v32, vcc
    v_cmp_eq_u32 vcc, 3, v3
    s_nop 1
    v_cndmask_b32 v11, v11, v33, vcc
    s_lshr_b32 s30, s3, 1
    s_mul_i32 s30, s30, 24576
    s_and_b32 s31, s3, 1
    s_lshl_b32 s31, s31, 3
    s_add_u32 s30, s30, s31
    s_add_u32 s48, s30, 120320
    v_mul_u32_u24 v36, 336, v34
    v_add_u32 v36, s48, v36
    v_and_b32 v37, 128, v31
    v_lshl_add_u32 v12, v2, 5, v36
    v_add_u32 v12, v12, v37
    v_and_b32 v37, 8, v31
    v_xor_b32 v12, v12, v37
    v_lshl_add_u32 v28, v2, 4, v36
    v_add_u32 v28, 256, v28
    v_xor_b32 v28, v28, v37
    v_and_b32 v37, 2688, v31
    v_add_u32 v28, v28, v37
    v_cmp_ne_u32 s[60:61], 0, v27
    v_mul_u32_u24 v36, 176, v1
    v_add_u32 v36, s32, v36
    v_lshl_add_u32 v29, v2, 4, v36
    v_lshl_add_u32 v30, v2, 3, v36
    v_lshrrev_b32 v1, 5, v0
    s_lshl_b32 s30, s3, 1
    v_add_u32 v1, s30, v1
    v_and_b32 v2, 31, v0
    v_and_b32 v32, 1, v2
    v_bfe_u32 v33, v2, 1, 1
    v_bfe_u32 v34, v2, 2, 1
    v_bfe_u32 v35, v2, 3, 1
    v_lshlrev_b32 v13, 6, v32
    v_lshl_add_u32 v13, v35, 5, v13
    v_lshl_add_u32 v13, v33, 4, v13
    v_lshl_add_u32 v13, v34, 3, v13
    v_lshlrev_b32 v36, 4, v32
    v_lshl_add_u32 v36, v33, 3, v36
    v_add_u32 v36, 128, v36
    v_mov_b32 v37, 160
    v_cmp_gt_u32 vcc, 16, v2
    v_cmp_gt_u32 s[28:29], 20, v2
    s_nop 1
    v_cndmask_b32 v13, v36, v13, vcc
    v_cndmask_b32 v13, v37, v13, s[28:29]
    v_mul_u32_u24 v36, 336, v1
    v_lshl_add_u32 v13, v13, 1, v36
    v_add_u32 v13, 120320, v13
    v_lshlrev_b32 v14, 8, v35
    v_lshl_add_u32 v14, v34, 5, v14
    v_and_b32 v36, 3, v2
    v_lshl_add_u32 v14, v36, 2, v14
    s_lshl_b32 s30, s40, 9
    s_add_u32 s30, s30, 12288
    s_lshr_b32 s31, s30, 13
    s_lshl_b32 s31, s31, 13
    s_add_u32 s30, s30, s31
    v_add_u32 v14, s30, v14
    v_lshlrev_b32 v36, 5, v33
    v_lshl_add_u32 v36, v32, 2, v36
    s_lshr_b32 s30, s40, 1
    s_lshl_b32 s30, s30, 8
    s_and_b32 s31, s40, 1
    s_lshl_b32 s31, s31, 3
    s_add_u32 s30, s30, s31
    s_add_u32 s30, s30, 53248
    v_add_u32 v36, s30, v36
    v_cndmask_b32 v14, v36, v14, vcc
    v_lshrrev_b32 v36, 5, v0
    v_lshl_add_u32 v14, v36, 4, v14
    s_lshl_b32 s30, s3, 6
    v_add_u32 v14, s30, v14
    v_mov_b32 v37, 2130706432
    v_cndmask_b32 v14, v37, v14, s[28:29]
    s_xor_b32 s30, s3, 0
    s_or_b32 s30, s30, s6
    s_xor_b32 s31, s5, 1
    s_or_b32 s30, s30, s31
    s_lshl_b32 s31, s5, 7
    s_add_u32 s31, s31, 917504
    v_sub_u32 v15, s5, v0
    v_add_u32 v15, 3, v15
    v_and_b32 v15, 3, v15
    v_lshlrev_b32 v15, 9, v15
    v_add_u32 v15, s31, v15
    v_mov_b32 v1, 2130706432
    s_lshl_b32 s31, s30, 6
    v_or_b32 v2, s31, v0
    v_cmp_gt_u32 vcc, 4, v2
    s_nop 1
    v_cndmask_b32 v15, v1, v15, vcc
    v_mov_b32 v3, 933888
    v_cmp_eq_u32 vcc, 4, v2
    s_nop 1
    v_cndmask_b32 v15, v15, v3, vcc
    s_xor_b32 s31, s5, 1
    s_or_b32 s30, s30, s31
    s_lshl_b32 s30, s30, 6
    v_or_b32 v2, s30, v0
    v_cmp_gt_u32 vcc, 4, v2
    v_lshlrev_b32 v31, 7, v0
    v_add_u32 v31, 724992, v31
    v_cndmask_b32 v31, v1, v31, vcc
    v_and_b32 v18, 1, v0
    v_mul_u32_u24 v18, 8192, v18
    s_lshl_b32 s30, s40, 7
    s_lshl_b32 s31, s3, 3
    s_add_u32 s30, s30, s31
    s_add_u32 s30, s30, 3997696
    v_add_u32 v18, s30, v18
    v_lshrrev_b32 v1, 3, v0
    s_lshl_b32 s30, s3, 3
    v_add_u32 v1, s30, v1
    v_and_b32 v32, 1, v0
    v_bfe_u32 v33, v0, 1, 2
    v_and_b32 v34, 7, v0
    v_mul_u32_u24 v35, 176, v1
    v_add_u32 v35, 114688, v35
    v_lshl_add_u32 v20, v32, 6, v35
    v_lshl_add_u32 v20, v33, 4, v20
    v_lshl_add_u32 v21, v34, 2, v35
    v_add_u32 v21, 128, v21
    v_and_b32 v35, 15, v1
    v_lshlrev_b32 v35, 4, v35
    s_lshr_b32 s30, s3, 1
    s_mul_i32 s30, s30, 81920
    s_add_u32 s30, s30, 737280
    v_add_u32 v35, s30, v35
    v_lshl_add_u32 v22, v33, 8, v35
    v_lshl_add_u32 v22, v32, 3, v22
    s_lshl_b32 s30, s40, 10
    s_lshr_b32 s31, s40, 3
    s_lshl_b32 s31, s31, 13
    s_add_u32 s30, s30, s31
    v_add_u32 v22, s30, v22
    v_lshl_add_u32 v23, v33, 2, v35
    s_lshl_b32 s30, s40, 8
    s_add_u32 s30, s30, 65536
    v_add_u32 v23, s30, v23
    v_cmp_eq_u32 vcc, 0, v32
    s_nop 1
    v_cndmask_b32 v23, v37, v23, vcc
    v_lshlrev_b32 v32, 4, v32
    v_lshl_add_u32 v32, v33, 2, v32
    v_add_u32 v33, 0, v32
    v_cmp_le_u32 s[50:51], v33, v1
    v_add_u32 v33, 1, v32
    v_cmp_le_u32 s[52:53], v33, v1
    v_add_u32 v33, 2, v32
    v_cmp_le_u32 s[54:55], v33, v1
    v_add_u32 v33, 3, v32
    v_cmp_le_u32 s[56:57], v33, v1
    v_mov_b32 v25, s4
    s_mov_b32 s58, 1037384597
    s_mov_b32 s59, s58
    v_and_b32 v1, 7, v0
    v_mul_u32_u24 v1, 336, v1
    v_add_u32 v1, s48, v1
    v_mov_b32 v32, 4286578688
    v_mov_b32 v33, 4286578688
    s_barrier
    ds_write_b64 v1, v[32:33] offset:320
    v_mov_b32 v1, 4028416
L_fw_1:
    buffer_load_dwordx2 v[16:17], v1, s[8:11], 0 offen sc1
    s_add_u32 s7, s7, 1
    s_bitcmp1_b32 s7, 22
    s_cbranch_scc1 L_abort
    s_waitcnt vmcnt(0)
    v_cmp_ne_u32 vcc, s4, v17
    v_cmp_gt_u32 s[28:29], 1, v16
    s_or_b64 vcc, vcc, s[28:29]
    s_cbranch_scc1 L_fw_1
L_fe_2:
    v_readfirstlane_b32 s35, v16
    s_sub_u32 s35, s35, 1
    s_mul_i32 s33, s3, 6
    s_add_u32 s33, s33, 0
    s_add_u32 s33, s33, 0
    s_mul_i32 s30, s40, 24
    s_add_u32 s33, s33, s30
    s_lshr_b32 s30, s33, 3
    s_add_u32 s30, s30, 144
    s_lshr_b32 s31, s30, 7
    s_xor_b32 s31, s31, s35
    s_xor_b32 s31, s31, 0
    s_and_b32 s31, s31, 1
    s_lshl_b32 s31, s31, 13
    s_lshl_b32 s76, s30, 14
    s_add_u32 s76, s76, s31
    s_and_b32 s33, s33, 7
    s_lshl_b32 s33, s33, 10
    s_add_u32 s76, s76, s33
    s_mul_i32 s33, s3, 6
    s_add_u32 s33, s33, 0
    s_add_u32 s33, s33, 1
    s_mul_i32 s30, s40, 24
    s_add_u32 s33, s33, s30
    s_lshr_b32 s30, s33, 3
    s_add_u32 s30, s30, 144
    s_lshr_b32 s31, s30, 7
    s_xor_b32 s31, s31, s35
    s_xor_b32 s31, s31, 0
    s_and_b32 s31, s31, 1
    s_lshl_b32 s31, s31, 13
    s_lshl_b32 s77, s30, 14
    s_add_u32 s77, s77, s31
    s_and_b32 s33, s33, 7
    s_lshl_b32 s33, s33, 10
    s_add_u32 s77, s77, s33
    s_mul_i32 s33, s3, 6
    s_add_u32 s33, s33, 0
    s_add_u32 s33, s33, 2
    s_mul_i32 s30, s40, 24
    s_add_u32 s33, s33, s30
    s_lshr_b32 s30, s33, 3
    s_add_u32 s30, s30, 144
    s_lshr_b32 s31, s30, 7
    s_xor_b32 s31, s31, s35
    s_xor_b32 s31, s31, 0
    s_and_b32 s31, s31, 1
    s_lshl_b32 s31, s31, 13
    s_lshl_b32 s78, s30, 14
    s_add_u32 s78, s78, s31
    s_and_b32 s33, s33, 7
    s_lshl_b32 s33, s33, 10
    s_add_u32 s78, s78, s33
    s_mul_i32 s33, s3, 6
    s_add_u32 s33, s33, 0
    s_add_u32 s33, s33, 3
    s_mul_i32 s30, s40, 24
    s_add_u32 s33, s33, s30
    s_lshr_b32 s30, s33, 3
    s_add_u32 s30, s30, 144
    s_lshr_b32 s31, s30, 7
    s_xor_b32 s31, s31, s35
    s_xor_b32 s31, s31, 0
    s_and_b32 s31, s31, 1
    s_lshl_b32 s31, s31, 13
    s_lshl_b32 s79, s30, 14
    s_add_u32 s79, s79, s31
    s_and_b32 s33, s33, 7
    s_lshl_b32 s33, s33, 10
    s_add_u32 s79, s79, s33
    s_mul_i32 s33, s3, 6
    s_add_u32 s33, s33, 0
    s_add_u32 s33, s33, 4
    s_mul_i32 s30, s40, 24
    s_add_u32 s33, s33, s30
    s_lshr_b32 s30, s33, 3
    s_add_u32 s30, s30, 144
    s_lshr_b32 s31, s30, 7
    s_xor_b32 s31, s31, s35
    s_xor_b32 s31, s31, 0
    s_and_b32 s31, s31, 1
    s_lshl_b32 s31, s31, 13
    s_lshl_b32 s80, s30, 14
    s_add_u32 s80, s80, s31
    s_and_b32 s33, s33, 7
    s_lshl_b32 s33, s33, 10
    s_add_u32 s80, s80, s33
    s_mul_i32 s33, s3, 6
    s_add_u32 s33, s33, 0
    s_add_u32 s33, s33, 5
    s_mul_i32 s30, s40, 24
    s_add_u32 s33, s33, s30
    s_lshr_b32 s30, s33, 3
    s_add_u32 s30, s30, 144
    s_lshr_b32 s31, s30, 7
    s_xor_b32 s31, s31, s35
    s_xor_b32 s31, s31, 0
    s_and_b32 s31, s31, 1
    s_lshl_b32 s31, s31, 13
    s_lshl_b32 s81, s30, 14
    s_add_u32 s81, s81, s31
    s_and_b32 s33, s33, 7
    s_lshl_b32 s33, s33, 10
    s_add_u32 s81, s81, s33
    s_mov_b32 s45, 0
    v_min_u32 v1, 39, v0
    v_lshlrev_b32 v1, 7, v1
    v_add_u32 v1, 4022272, v1
L_fw_4:
    buffer_load_dwordx2 v[16:17], v1, s[8:11], 0 offen sc1
    s_add_u32 s7, s7, 1
    s_bitcmp1_b32 s7, 22
    s_cbranch_scc1 L_abort
    s_waitcnt vmcnt(0)
    v_cmp_ne_u32 vcc, s4, v17
    v_cmp_gt_u32 s[28:29], 1, v16
    s_or_b64 vcc, vcc, s[28:29]
    s_cbranch_scc1 L_fw_4
L_fe_5:
L_fw_7:
    buffer_load_dwordx2 v[16:17], v18, s[8:11], 0 offen sc1
    s_add_u32 s7, s7, 1
    s_bitcmp1_b32 s7, 22
    s_cbranch_scc1 L_abort
    s_waitcnt vmcnt(0)
    v_cmp_ne_u32 vcc, s4, v17
    v_cmp_gt_u32 s[28:29], 1, v16
    s_or_b64 vcc, vcc, s[28:29]
    s_cbranch_scc1 L_fw_7
L_fe_8:
    v_mov_b32 v1, v4
    buffer_load_dwordx4 v[120:123], v1, s[8:11], s76 offen sc1
    buffer_load_dwordx4 v[124:127], v1, s[8:11], s77 offen sc1
    buffer_load_dwordx4 v[128:131], v1, s[8:11], s78 offen sc1
    buffer_load_dwordx4 v[132:135], v1, s[8:11], s79 offen sc1
    buffer_load_dwordx4 v[136:139], v1, s[8:11], s80 offen sc1
    buffer_load_dwordx4 v[140:143], v1, s[8:11], s81 offen sc1
    s_add_u32 s45, s45, 4194304
    s_and_b32 s45, s45, 134217727
    s_waitcnt lgkmcnt(0)
    s_barrier
    s_mov_b32 s42, 0
    s_lshl_b32 s49, s35, 13
    s_mov_b32 s36, 2130706432
    s_mov_b32 s47, s36
    s_lshl_b32 s30, s35, 13
    s_lshl_b32 s36, s42, 22
    s_add_u32 s36, s36, s30
    s_and_b32 s36, s36, 134217727
    s_mov_b64 s[38:39], -1
    s_mov_b32 s62, -1
    s_mov_b32 s46, 1006632960
    s_mov_b32 s63, s49
    s_add_u32 s30, s4, s42
    v_mov_b32 v25, s30
    ds_read_b128 v[96:99], v7 offset:0
    ds_read_b128 v[100:103], v7 offset:1024
    ds_read_b128 v[104:107], v7 offset:2048
    ds_read_b128 v[108:111], v7 offset:3072
    ds_read_b128 v[112:115], v7 offset:4096
    ds_read_b128 v[116:119], v7 offset:5120
    v_mov_b32 v72, 0
    v_mov_b32 v73, 0
    v_mov_b32 v74, 0
    v_mov_b32 v75, 0
    v_mov_b32 v76, 0
    v_mov_b32 v77, 0
    v_mov_b32 v78, 0
    v_mov_b32 v79, 0
    v_mov_b32 v80, 0
    v_mov_b32 v81, 0
    v_mov_b32 v82, 0
    v_mov_b32 v83, 0
L_a_go:
    buffer_load_dwordx4 v[32:35], v4, s[8:11], s36 offen offset:0 sc1
    v_mov_b32 v1, 0
    s_nop 3
    v_mov_b32 v1, 0
    s_nop 3
    v_mov_b32 v1, 0
    s_nop 3
    buffer_load_dwordx4 v[36:39], v4, s[8:11], s36 offen offset:1024 sc1
    v_mov_b32 v1, 0
    s_nop 3
    v_mov_b32 v1, 0
    s_nop 3
    v_mov_b32 v1, 0
    s_nop 3
    buffer_load_dwordx4 v[40:43], v4, s[8:11], s36 offen offset:2048 sc1
    v_mov_b32 v1, 0
    s_nop 3
    v_mov_b32 v1, 0
    s_nop 3
    v_mov_b32 v1, 0
    s_nop 3
    buffer_load_dwordx4 v[44:47], v4, s[8:11], s36 offen offset:3072 sc1
    v_mov_b32 v1, 0
    s_nop 3
    v_mov_b32 v1, 0
    s_nop 3
    v_mov_b32 v1, 0
    s_nop 3
    buffer_load_dwordx4 v[48:51], v5, s[8:11], s36 offen offset:0 sc1
    v_mov_b32 v1, 0
    s_nop 3
    v_mov_b32 v1, 0
    s_nop 3
    v_mov_b32 v1, 0
    s_nop 3
    buffer_load_dwordx4 v[52:55], v5, s[8:11], s36 offen offset:1024 sc1
    v_mov_b32 v1, 0
    s_nop 3
    v_mov_b32 v1, 0
    s_nop 3
    v_mov_b32 v1, 0
    s_nop 3
    buffer_load_dwordx4 v[56:59], v5, s[8:11], s36 offen offset:2048 sc1
    s_branch L_a_str
L_a_step:
    s_cmp_lg_u32 s3, 0
    s_cbranch_scc1 L_te_11
    s_mov_b64 exec, 1
    s_add_u32 s31, s4, s42
    s_lshl_b32 s30, s35, 13
    v_mov_b32 v19, s4
    v_add_u32 v19, -1, v19
L_tk_10:
    buffer_load_dword v19, v9, s[8:11], s30 offen sc1
    v_subrev_u32 v1, s31, v19
    v_cmp_lt_u32 vcc, 64, v1
    s_add_u32 s7, s7, 1
    s_bitcmp1_b32 s7, 22
    s_cbranch_scc1 L_abort
    s_waitcnt vmcnt(30)
    s_cbranch_vccnz L_tk_10
    s_mov_b64 exec, -1
L_te_11:
    s_barrier
    buffer_load_dwordx4 v[32:35], v4, s[8:11], s36 offen offset:0 sc1
    v_max3_f32 v90, v84, v85, v86
    v_max3_f32 v90, v87, v88, v90
    s_nop 1
    v_max_f32_dpp v91, v90, v90 quad_perm:[1,0,3,2] row_mask:0xf bank_mask:0xf
    buffer_load_dwordx4 v[36:39], v4, s[8:11], s36 offen offset:1024 sc1
    v_max_f32_dpp v91, v90, v91 quad_perm:[2,3,0,1] row_mask:0xf bank_mask:0xf
    v_max_f32_dpp v91, v90, v91 quad_perm:[3,2,1,0] row_mask:0xf bank_mask:0xf
    s_nop 1
    v_max_f32_dpp v90, v91, v91 row_half_mirror row_mask:0xf bank_mask:0xf
    v_pk_add_f32 v[84:85], v[84:85], v[90:91] op_sel_hi:[1,0] neg_lo:[0,1] neg_hi:[0,1]
    buffer_load_dwordx4 v[40:43], v4, s[8:11], s36 offen offset:2048 sc1
    v_pk_add_f32 v[86:87], v[86:87], v[90:91] op_sel_hi:[1,0] neg_lo:[0,1] neg_hi:[0,1]
    v_pk_add_f32 v[88:89], v[88:89], v[90:91] op_sel_hi:[1,0] neg_lo:[0,1] neg_hi:[0,1]
    v_pk_mul_f32 v[84:85], v[84:85], s[58:59]
    v_pk_mul_f32 v[86:87], v[86:87], s[58:59]
    v_pk_mul_f32 v[88:89], v[88:89], s[58:59]
    v_exp_f32 v84, v84
    v_exp_f32 v85, v85
    v_exp_f32 v86, v86
    v_exp_f32 v87, v87
    buffer_load_dwordx4 v[44:47], v4, s[8:11], s36 offen offset:3072 sc1
    v_exp_f32 v88, v88
    v_pk_add_f32 v[90:91], v[84:85], v[86:87]
    v_add_f32 v90, v90, v88
    v_add_f32 v90, v90, v91
    s_nop 1
    v_add_f32_dpp v91, v90, v90 quad_perm:[1,0,3,2] row_mask:0xf bank_mask:0xf
    v_add_f32_dpp v91, v90, v91 quad_perm:[2,3,0,1] row_mask:0xf bank_mask:0xf
    v_add_f32_dpp v91, v90, v91 quad_perm:[3,2,1,0] row_mask:0xf bank_mask:0xf
    s_nop 1
    buffer_load_dwordx4 v[48:51], v5, s[8:11], s36 offen offset:0 sc1
    v_add_f32_dpp v90, v91, v91 row_half_mirror row_mask:0xf bank_mask:0xf
    v_rcp_f32 v90, v90
    s_nop 0
    v_mul_f32 v88, v88, v90
    v_pk_mul_f32 v[84:85], v[84:85], v[90:91] op_sel_hi:[1,0]
    v_pk_mul_f32 v[86:87], v[86:87], v[90:91] op_sel_hi:[1,0]
    v_mov_b32_dpp v89, v88 quad_perm:[1,0,3,2] row_mask:0xf bank_mask:0xf
    v_cvt_pk_bf16_f32 v26, v84, v85
    v_cvt_pk_bf16_f32 v27, v86, v87
    v_cvt_pk_bf16_f32 v24, v88, v89
    buffer_load_dwordx4 v[52:55], v5, s[8:11], s36 offen offset:1024 sc1
    v_mov_b32 v1, 0
    s_nop 3
    v_mov_b32 v1, 0
    s_nop 3
    v_mov_b32 v1, 0
    s_nop 3
    buffer_load_dwordx4 v[56:59], v5, s[8:11], s36 offen offset:2048 sc1
L_a_str:
    s_waitcnt vmcnt(6)
    v_smfmac_f32_16x16x64_bf16 v[72:75], v[32:35], a[0:7], v8
    buffer_load_dwordx4 v[60:63], v5, s[8:11], s36 offen offset:3072 sc1
    v_mov_b32_dpp v84, v32 quad_perm:[2,3,0,1] row_mask:0xf bank_mask:0xf
    v_mov_b32_dpp v85, v33 quad_perm:[2,3,0,1] row_mask:0xf bank_mask:0xf
    v_smfmac_f32_16x16x64_bf16 v[76:79], v[32:35], a[8:15], v8
    s_waitcnt lgkmcnt(4)
    v_mov_b32_dpp v86, v34 quad_perm:[2,3,0,1] row_mask:0xf bank_mask:0xf
    v_mov_b32_dpp v87, v35 quad_perm:[2,3,0,1] row_mask:0xf bank_mask:0xf
    v_smfmac_f32_16x16x64_bf16 v[80:83], v[32:35], v[96:103], v8
    ds_read_b128 v[96:99], v7 offset:6144
    v_smfmac_f32_16x16x64_bf16 v[72:75], v[84:87], a[16:23], v8
    ds_read_b128 v[100:103], v7 offset:7168
    s_waitcnt vmcnt(6)
    v_mov_b32_dpp v88, v36 quad_perm:[2,3,0,1] row_mask:0xf bank_mask:0xf
    v_smfmac_f32_16x16x64_bf16 v[76:79], v[84:87], a[24:31], v8
    buffer_load_dwordx4 v[64:67], v6, s[8:11], s36 offen offset:0 sc1
    v_mov_b32_dpp v89, v37 quad_perm:[2,3,0,1] row_mask:0xf bank_mask:0xf
    v_smfmac_f32_16x16x64_bf16 v[80:83], v[84:87], a[32:39], v8
    s_waitcnt lgkmcnt(4)
    v_mov_b32_dpp v90, v38 quad_perm:[2,3,0,1] row_mask:0xf bank_mask:0xf
    v_smfmac_f32_16x16x64_bf16 v[72:75], v[36:39], v[104:111], v8
    ds_read_b128 v[104:107], v7 offset:8192
    v_mov_b32_dpp v91, v39 quad_perm:[2,3,0,1] row_mask:0xf bank_mask:0xf
    v_smfmac_f32_16x16x64_bf16 v[76:79], v[36:39], a[40:47], v8
    ds_read_b128 v[108:111], v7 offset:9216
    v_smfmac_f32_16x16x64_bf16 v[80:83], v[36:39], a[48:55], v8
    buffer_load_dwordx4 v[68:71], v6, s[8:11], s36 offen offset:1024 sc1
    v_smfmac_f32_16x16x64_bf16 v[72:75], v[88:91], a[56:63], v8
    s_waitcnt vmcnt(7)
    s_waitcnt lgkmcnt(4)
    v_mov_b32_dpp v92, v40 quad_perm:[2,3,0,1] row_mask:0xf bank_mask:0xf
    v_smfmac_f32_16x16x64_bf16 v[76:79], v[88:91], v[112:119], v8
    ds_read_b128 v[112:115], v7 offset:10240
    v_mov_b32_dpp v93, v41 quad_perm:[2,3,0,1] row_mask:0xf bank_mask:0xf
    v_smfmac_f32_16x16x64_bf16 v[80:83], v[88:91], a[64:71], v8
    ds_read_b128 v[116:119], v7 offset:11264
    v_mov_b32_dpp v94, v42 quad_perm:[2,3,0,1] row_mask:0xf bank_mask:0xf
    v_smfmac_f32_16x16x64_bf16 v[72:75], v[40:43], a[72:79], v8
    v_mov_b32_dpp v95, v43 quad_perm:[2,3,0,1] row_mask:0xf bank_mask:0xf
    v_smfmac_f32_16x16x64_bf16 v[76:79], v[40:43], a[80:87], v8
    s_waitcnt lgkmcnt(4)
    v_smfmac_f32_16x16x64_bf16 v[80:83], v[40:43], v[96:103], v8
    ds_read_b128 v[96:99], v7 offset:12288
    v_smfmac_f32_16x16x64_bf16 v[72:75], v[92:95], a[88:95], v8
    ds_read_b128 v[100:103], v7 offset:13312
    s_waitcnt vmcnt(6)
    v_mov_b32_dpp v84, v44 quad_perm:[2,3,0,1] row_mask:0xf bank_mask:0xf
    v_smfmac_f32_16x16x64_bf16 v[76:79], v[92:95], a[96:103], v8
    v_mov_b32_dpp v85, v45 quad_perm:[2,3,0,1] row_mask:0xf bank_mask:0xf
    v_smfmac_f32_16x16x64_bf16 v[80:83], v[92:95], a[104:111], v8
    s_waitcnt lgkmcnt(4)
    v_mov_b32_dpp v86, v46 quad_perm:[2,3,0,1] row_mask:0xf bank_mask:0xf
    v_smfmac_f32_16x16x64_bf16 v[72:75], v[44:47], v[104:111], v8
    ds_read_b128 v[104:107], v7 offset:14336
    v_mov_b32_dpp v87, v47 quad_perm:[2,3,0,1] row_mask:0xf bank_mask:0xf
    v_smfmac_f32_16x16x64_bf16 v[76:79], v[44:47], a[112:119], v8
    ds_read_b128 v[108:111], v7 offset:15360
    v_cmp_u_f32 vcc, v80, v80
    v_smfmac_f32_16x16x64_bf16 v[80:83], v[44:47], a[120:127], v8
    v_smfmac_f32_16x16x64_bf16 v[72:75], v[84:87], a[128:135], v8
    s_waitcnt vmcnt(5)
    s_waitcnt lgkmcnt(4)
    v_mov_b32_dpp v88, v48 quad_perm:[2,3,0,1] row_mask:0xf bank_mask:0xf
    v_smfmac_f32_16x16x64_bf16 v[76:79], v[84:87], v[112:119], v8
    ds_read_b128 v[112:115], v7 offset:16384
    v_mov_b32_dpp v89, v49 quad_perm:[2,3,0,1] row_mask:0xf bank_mask:0xf
    v_smfmac_f32_16x16x64_bf16 v[80:83], v[84:87], a[136:143], v8
    ds_read_b128 v[116:119], v7 offset:17408
    s_cbranch_vccnz L_a_e
L_a_eb:
    v_mov_b32_dpp v90, v50 quad_perm:[2,3,0,1] row_mask:0xf bank_mask:0xf
    v_smfmac_f32_16x16x64_bf16 v[72:75], v[48:51], a[144:151], v8
    v_mov_b32_dpp v91, v51 quad_perm:[2,3,0,1] row_mask:0xf bank_mask:0xf
    v_smfmac_f32_16x16x64_bf16 v[76:79], v[48:51], a[152:159], v8
    s_waitcnt lgkmcnt(4)
    v_smfmac_f32_16x16x64_bf16 v[80:83], v[48:51], v[96:103], v8
    ds_read_b128 v[96:99], v7 offset:18432
    v_smfmac_f32_16x16x64_bf16 v[72:75], v[88:91], a[160:167], v8
    ds_read_b128 v[100:103], v7 offset:19456
    s_waitcnt vmcnt(4)
    v_mov_b32_dpp v92, v52 quad_perm:[2,3,0,1] row_mask:0xf bank_mask:0xf
    v_smfmac_f32_16x16x64_bf16 v[76:79], v[88:91], a[168:175], v8
    v_mov_b32_dpp v93, v53 quad_perm:[2,3,0,1] row_mask:0xf bank_mask:0xf
    v_smfmac_f32_16x16x64_bf16 v[80:83], v[88:91], a[176:183], v8
    s_waitcnt lgkmcnt(4)
    v_mov_b32_dpp v94, v54 quad_perm:[2,3,0,1] row_mask:0xf bank_mask:0xf
    v_smfmac_f32_16x16x64_bf16 v[72:75], v[52:55], v[104:111], v8
    ds_read_b128 v[104:107], v7 offset:20480
    v_mov_b32_dpp v95, v55 quad_perm:[2,3,0,1] row_mask:0xf bank_mask:0xf
    v_smfmac_f32_16x16x64_bf16 v[76:79], v[52:55], a[184:191], v8
    ds_read_b128 v[108:111], v7 offset:21504
    v_smfmac_f32_16x16x64_bf16 v[80:83], v[52:55], a[192:199], v8
    v_smfmac_f32_16x16x64_bf16 v[72:75], v[92:95], a[200:207], v8
    s_waitcnt vmcnt(3)
    s_waitcnt lgkmcnt(4)
    v_mov_b32_dpp v84, v56 quad_perm:[2,3,0,1] row_mask:0xf bank_mask:0xf
    v_smfmac_f32_16x16x64_bf16 v[76:79], v[92:95], v[112:119], v8
    ds_read_b128 v[112:115], v7 offset:22528
    v_mov_b32_dpp v85, v57 quad_perm:[2,3,0,1] row_mask:0xf bank_mask:0xf
    v_smfmac_f32_16x16x64_bf16 v[80:83], v[92:95], a[208:215], v8
    ds_read_b128 v[116:119], v7 offset:23552
    v_mov_b32_dpp v86, v58 quad_perm:[2,3,0,1] row_mask:0xf bank_mask:0xf
    v_smfmac_f32_16x16x64_bf16 v[72:75], v[56:59], a[216:223], v8
    v_mov_b32_dpp v87, v59 quad_perm:[2,3,0,1] row_mask:0xf bank_mask:0xf
    v_smfmac_f32_16x16x64_bf16 v[76:79], v[56:59], a[224:231], v8
    s_waitcnt lgkmcnt(4)
    v_smfmac_f32_16x16x64_bf16 v[80:83], v[56:59], v[96:103], v8
    ds_read_b128 v[96:99], v7 offset:24576
    v_smfmac_f32_16x16x64_bf16 v[72:75], v[84:87], a[232:239], v8
    ds_read_b128 v[100:103], v7 offset:25600
    s_waitcnt vmcnt(2)
    v_mov_b32_dpp v88, v60 quad_perm:[2,3,0,1] row_mask:0xf bank_mask:0xf
    v_smfmac_f32_16x16x64_bf16 v[76:79], v[84:87], a[240:247], v8
    v_mov_b32_dpp v89, v61 quad_perm:[2,3,0,1] row_mask:0xf bank_mask:0xf
    v_smfmac_f32_16x16x64_bf16 v[80:83], v[84:87], a[248:255], v8
    s_waitcnt lgkmcnt(4)
    v_mov_b32_dpp v90, v62 quad_perm:[2,3,0,1] row_mask:0xf bank_mask:0xf
    v_smfmac_f32_16x16x64_bf16 v[72:75], v[60:63], v[104:111], v8
    ds_read_b128 v[104:107], v7 offset:26624
    v_mov_b32_dpp v91, v63 quad_perm:[2,3,0,1] row_mask:0xf bank_mask:0xf
    v_smfmac_f32_16x16x64_bf16 v[76:79], v[60:63], v[144:151], v8
    ds_read_b128 v[108:111], v7 offset:27648
    v_smfmac_f32_16x16x64_bf16 v[80:83], v[60:63], v[152:159], v8
    s_waitcnt vmcnt(1)
    v_mov_b32_dpp v92, v64 quad_perm:[2,3,0,1] row_mask:0xf bank_mask:0xf
    v_smfmac_f32_16x16x64_bf16 v[72:75], v[88:91], v[160:167], v8
    s_waitcnt lgkmcnt(4)
    v_mov_b32_dpp v93, v65 quad_perm:[2,3,0,1] row_mask:0xf bank_mask:0xf
    v_smfmac_f32_16x16x64_bf16 v[76:79], v[88:91], v[112:119], v8
    v_mov_b32_dpp v94, v66 quad_perm:[2,3,0,1] row_mask:0xf bank_mask:0xf
    v_smfmac_f32_16x16x64_bf16 v[80:83], v[88:91], v[168:175], v8
    v_mov_b32_dpp v95, v67 quad_perm:[2,3,0,1] row_mask:0xf bank_mask:0xf
    v_smfmac_f32_16x16x64_bf16 v[72:75], v[64:67], v[176:183], v8
    v_smfmac_f32_16x16x64_bf16 v[76:79], v[64:67], v[184:191], v8
    s_waitcnt vmcnt(0)
    s_waitcnt lgkmcnt(2)
    v_mov_b32_dpp v84, v68 quad_perm:[2,3,0,1] row_mask:0xf bank_mask:0xf
    v_smfmac_f32_16x16x64_bf16 v[72:75], v[92:95], v[96:103], v8
    v_mov_b32_dpp v85, v69 quad_perm:[2,3,0,1] row_mask:0xf bank_mask:0xf
    v_smfmac_f32_16x16x64_bf16 v[76:79], v[92:95], v[192:199], v8
    v_mov_b32_dpp v86, v70 quad_perm:[2,3,0,1] row_mask:0xf bank_mask:0xf
    v_mov_b32_dpp v87, v71 quad_perm:[2,3,0,1] row_mask:0xf bank_mask:0xf
    v_smfmac_f32_16x16x64_bf16 v[72:75], v[68:71], v[200:207], v8
    v_smfmac_f32_16x16x64_bf16 v[76:79], v[68:71], v[208:215], v8
    s_waitcnt lgkmcnt(0)
    v_smfmac_f32_16x16x64_bf16 v[72:75], v[84:87], v[104:111], v8
    v_smfmac_f32_16x16x64_bf16 v[76:79], v[84:87], v[216:223], v8
    v_smfmac_f32_16x16x64_bf16 v[80:83], v[64:67], v[224:231], v8
    v_smfmac_f32_16x16x64_bf16 v[80:83], v[92:95], v[232:239], v8
    v_cvt_pk_bf16_f32 v32, v72, v73
    v_smfmac_f32_16x16x64_bf16 v[80:83], v[68:71], v[240:247], v8
    v_cvt_pk_bf16_f32 v33, v74, v75
    v_smfmac_f32_16x16x64_bf16 v[80:83], v[84:87], v[248:255], v8
    v_cvt_pk_bf16_f32 v34, v76, v77
    v_cvt_pk_bf16_f32 v35, v78, v79
    v_mfma_f32_16x16x16_bf16 v[72:75], v[32:33], v[10:11], 0
    s_mov_b64 vcc, s[60:61]
    v_mfma_f32_16x16x16_bf16 v[76:79], v[34:35], v[10:11], 0
    s_nop 0
    v_cvt_pk_bf16_f32 v36, v80, v81
    v_cvt_pk_bf16_f32 v37, v82, v83
    s_nop 1
    v_mfma_f32_16x16x16_bf16 v[80:83], v[36:37], v[10:11], 0
    v_cvt_pk_bf16_f32 v40, v72, v73
    v_cvt_pk_bf16_f32 v41, v74, v75
    v_cmp_u_f32 s[28:29], v72, v72
    v_cvt_pk_bf16_f32 v42, v76, v77
    v_cvt_pk_bf16_f32 v43, v78, v79
    s_nop 1
    v_mfma_f32_16x16x32_bf16 v[64:67], v[40:43], v[40:43], 0
    v_cvt_pk_bf16_f32 v44, v80, v81
    v_cvt_pk_bf16_f32 v45, v82, v83
    v_mfma_f32_16x16x32_bf16 v[52:55], v[124:127], v[40:43], 0
    s_and_b64 s[28:29], s[28:29], s[38:39]
    v_mfma_f32_16x16x32_bf16 v[48:51], v[120:123], v[40:43], 0
    s_cbranch_scc1 L_a_slow
    v_mfma_f32_16x16x16_bf16 v[64:67], v[44:45], v[44:45], v[64:67]
    v_mfma_f32_16x16x16_bf16 v[52:55], v[130:131], v[44:45], v[52:55]
    v_mfma_f32_16x16x16_bf16 v[48:51], v[128:129], v[44:45], v[48:51]
    s_nop 0
    ds_write_b64 v28, v[64:65]
    v_mfma_f32_16x16x32_bf16 v[96:99], v[120:123], v[132:135], 0
    s_nop 4
    v_cndmask_b32_dpp v48, v52, v48, vcc quad_perm:[2,3,2,3] row_mask:0xf bank_mask:0xf
    v_cndmask_b32_dpp v49, v53, v49, vcc quad_perm:[2,3,2,3] row_mask:0xf bank_mask:0xf
    v_cndmask_b32_dpp v50, v54, v50, vcc quad_perm:[2,3,2,3] row_mask:0xf bank_mask:0xf
    v_cndmask_b32_dpp v51, v55, v51, vcc quad_perm:[2,3,2,3] row_mask:0xf bank_mask:0xf
    ds_write_b64 v12, v[48:49]
    ds_write_b64 v12, v[50:51] offset:16
    buffer_store_dword v25, v15, s[8:11], s63 offen sc1
    v_mfma_f32_16x16x32_bf16 v[100:103], v[40:43], v[132:135], 0
    v_mfma_f32_16x16x32_bf16 v[104:107], v[120:123], v[136:139], 0
    v_mfma_f32_16x16x32_bf16 v[108:111], v[124:127], v[136:139], 0
    s_waitcnt lgkmcnt(0)
    s_barrier
    ds_read_b128 v[32:35], v13 offset:0
    ds_read_b128 v[36:39], v13 offset:24576
    v_mfma_f32_16x16x32_bf16 v[112:115], v[40:43], v[136:139], 0
    v_mfma_f32_16x16x16_bf16 v[96:99], v[128:129], v[140:141], v[96:99]
    s_waitcnt lgkmcnt(1)
    v_pk_add_f32 v[32:33], v[32:33], v[34:35]
    s_waitcnt lgkmcnt(0)
    v_pk_add_f32 v[36:37], v[36:37], v[38:39]
    v_pk_add_f32 v[32:33], v[32:33], v[36:37]
L_a_exp:
    v_pk_mul_f32 v[38:39], v[32:33], s[58:59]
    v_exp_f32 v38, v38
    v_exp_f32 v39, v39
    s_nop 0
    v_add_f32 v34, v38, v39
    s_nop 1
    v_add_f32_dpp v35, v34, v34 quad_perm:[1,0,3,2] row_mask:0xf bank_mask:0xf
    v_add_f32_dpp v35, v34, v35 quad_perm:[2,3,0,1] row_mask:0xf bank_mask:0xf
    v_add_f32_dpp v35, v34, v35 quad_perm:[3,2,1,0] row_mask:0xf bank_mask:0xf
    s_nop 1
    v_add_f32_dpp v34, v35, v35 row_ror:4 row_mask:0xf bank_mask:0xf
    v_add_f32_dpp v34, v35, v34 row_ror:8 row_mask:0xf bank_mask:0xf
    v_add_f32_dpp v36, v35, v34 row_ror:12 row_mask:0xf bank_mask:0xf
    v_add_f32_dpp v34, v35, v34 row_ror:12 row_mask:0xf bank_mask:0xf
    s_nop 1
    v_permlane16_swap_b32 v34, v36
    v_add_f32 v34, v34, v36
    v_add_u32 v36, 3732930560, v34
    v_cmp_lt_u32 vcc, s46, v36
    v_rcp_f32 v34, v34
    s_nop 0
    v_pk_mul_f32 v[38:39], v[38:39], v[34:35] op_sel_hi:[1,0]
    v_cvt_pk_bf16_f32 v38, v38, v39
    s_cbranch_vccnz L_a_max
    buffer_store_dword v38, v14, s[8:11], s36 offen sc1
    v_mfma_f32_16x16x16_bf16 v[100:103], v[44:45], v[140:141], v[100:103]
    v_mfma_f32_16x16x16_bf16 v[104:107], v[128:129], v[142:143], v[104:107]
    v_mfma_f32_16x16x16_bf16 v[108:111], v[130:131], v[142:143], v[108:111]
    v_mfma_f32_16x16x16_bf16 v[112:115], v[44:45], v[142:143], v[112:115]
    s_or_b32 s30, s42, s3
    s_cbranch_scc1 L_a_d0
    s_add_u32 s30, s40, 31568
    s_lshl_b32 s30, s30, 7
    v_mov_b32 v1, s30
    v_mov_b32 v2, 1
    v_mov_b32 v3, s4
    buffer_store_dwordx2 v[2:3], v1, s[8:11], 0 offen sc1
L_a_d0:
    s_add_u32 s44, s42, 2
    s_min_u32 s44, s44, 64
    v_cmp_ne_u32 vcc, s4, v17
    v_cmp_gt_u32 s[28:29], s44, v16
    s_or_b64 vcc, vcc, s[28:29]
    s_cbranch_scc0 L_fe_13
L_fw_12:
    buffer_load_dwordx2 v[16:17], v18, s[8:11], 0 offen sc1
    s_add_u32 s7, s7, 1
    s_bitcmp1_b32 s7, 22
    s_cbranch_scc1 L_abort
    s_waitcnt vmcnt(0)
    v_cmp_ne_u32 vcc, s4, v17
    v_cmp_gt_u32 s[28:29], s44, v16
    s_or_b64 vcc, vcc, s[28:29]
    s_cbranch_scc1 L_fw_12
L_fe_13:
    v_add_u32 v1, s45, v4
    s_nop 0
    ds_write_b128 v29, v[96:99] offset:0
    buffer_load_dwordx2 v[16:17], v18, s[8:11], 0 offen sc1
    ds_write_b64 v30, v[100:101] offset:128
    buffer_load_dwordx4 v[120:123], v1, s[8:11], s76 offen sc1
    ds_write_b128 v29, v[104:107] offset:2816
    buffer_load_dwordx4 v[124:127], v1, s[8:11], s77 offen sc1
    ds_write_b128 v29, v[108:111] offset:2880
    buffer_load_dwordx4 v[128:131], v1, s[8:11], s78 offen sc1
    ds_write_b64 v30, v[112:113] offset:2944
    buffer_load_dwordx4 v[132:135], v1, s[8:11], s79 offen sc1
    s_cmp_eq_u32 s63, s49
    s_cselect_b32 s63, 2130706432, s49
    s_waitcnt lgkmcnt(0)
    s_barrier
    ds_read_b128 v[40:43], v20 offset:0
    ds_read_b32 v56, v21 offset:0
    ds_read_b128 v[44:47], v20 offset:12288
    ds_read_b32 v57, v21 offset:12288
    ds_read_b128 v[48:51], v20 offset:24576
    ds_read_b32 v58, v21 offset:24576
    ds_read_b128 v[52:55], v20 offset:36864
    ds_read_b32 v59, v21 offset:36864
    buffer_store_dword v25, v15, s[8:11], s63 offen sc1
    buffer_load_dwordx4 v[136:139], v1, s[8:11], s80 offen sc1
    buffer_load_dwordx4 v[140:143], v1, s[8:11], s81 offen sc1
    buffer_store_dwordx2 v[26:27], v22, s[8:11], s47 offen sc1
    buffer_store_dword v24, v23, s[8:11], s47 offen sc1
    buffer_store_dword v25, v31, s[8:11], s47 offen sc1
    s_add_u32 s45, s45, 4194304
    s_and_b32 s45, s45, 134217727
    v_mov_b32 v3, 4286578688
    s_add_u32 s42, s42, 1
    s_mov_b32 s47, s36
    s_lshl_b32 s30, s35, 13
    s_lshl_b32 s36, s42, 22
    s_add_u32 s36, s36, s30
    s_and_b32 s36, s36, 134217727
    s_mov_b64 s[38:39], -1
    s_mov_b32 s62, -1
    s_mov_b32 s46, 1006632960
    s_mov_b32 s63, s49
    s_add_u32 s30, s4, s42
    v_mov_b32 v25, s30
    ds_read_b128 v[96:99], v7 offset:0
    ds_read_b128 v[100:103], v7 offset:1024
    ds_read_b128 v[104:107], v7 offset:2048
    ds_read_b128 v[108:111], v7 offset:3072
    ds_read_b128 v[112:115], v7 offset:4096
    ds_read_b128 v[116:119], v7 offset:5120
    v_mov_b32 v72, 0
    v_mov_b32 v73, 0
    v_mov_b32 v74, 0
    v_mov_b32 v75, 0
    v_mov_b32 v76, 0
    v_mov_b32 v77, 0
    v_mov_b32 v78, 0
    v_mov_b32 v79, 0
    v_mov_b32 v80, 0
    v_mov_b32 v81, 0
    v_mov_b32 v82, 0
    v_mov_b32 v83, 0
    s_waitcnt lgkmcnt(6)
    v_pk_add_f32 v[40:41], v[40:41], v[44:45]
    v_pk_add_f32 v[42:43], v[42:43], v[46:47]
    v_pk_add_f32 v[48:49], v[48:49], v[52:53]
    v_pk_add_f32 v[50:51], v[50:51], v[54:55]
    v_pk_add_f32 v[40:41], v[40:41], v[48:49]
    v_pk_add_f32 v[42:43], v[42:43], v[50:51]
    v_pk_add_f32 v[56:57], v[56:57], v[58:59]
    v_add_f32 v88, v56, v57
    v_cndmask_b32 v84, v3, v40, s[50:51]
    v_cndmask_b32 v85, v3, v41, s[52:53]
    v_cndmask_b32 v86, v3, v42, s[54:55]
    v_cndmask_b32 v87, v3, v43, s[56:57]
    s_cmp_lt_u32 s42, 64
    s_cbranch_scc1 L_a_step
    v_max3_f32 v90, v84, v85, v86
    v_max3_f32 v90, v87, v88, v90
    s_nop 1
    v_max_f32_dpp v91, v90, v90 quad_perm:[1,0,3,2] row_mask:0xf bank_mask:0xf
    v_max_f32_dpp v91, v90, v91 quad_perm:[2,3,0,1] row_mask:0xf bank_mask:0xf
    v_max_f32_dpp v91, v90, v91 quad_perm:[3,2,1,0] row_mask:0xf bank_mask:0xf
    s_nop 1
    v_max_f32_dpp v90, v91, v91 row_half_mirror row_mask:0xf bank_mask:0xf
    v_pk_add_f32 v[84:85], v[84:85], v[90:91] op_sel_hi:[1,0] neg_lo:[0,1] neg_hi:[0,1]
    v_pk_add_f32 v[86:87], v[86:87], v[90:91] op_sel_hi:[1,0] neg_lo:[0,1] neg_hi:[0,1]
    v_pk_add_f32 v[88:89], v[88:89], v[90:91] op_sel_hi:[1,0] neg_lo:[0,1] neg_hi:[0,1]
    v_pk_mul_f32 v[84:85], v[84:85], s[58:59]
    v_pk_mul_f32 v[86:87], v[86:87], s[58:59]
    v_pk_mul_f32 v[88:89], v[88:89], s[58:59]
    v_exp_f32 v84, v84
    v_exp_f32 v85, v85
    v_exp_f32 v86, v86
    v_exp_f32 v87, v87
    v_exp_f32 v88, v88
    v_pk_add_f32 v[90:91], v[84:85], v[86:87]
    v_add_f32 v90, v90, v88
    v_add_f32 v90, v90, v91
    s_nop 1
    v_add_f32_dpp v91, v90, v90 quad_perm:[1,0,3,2] row_mask:0xf bank_mask:0xf
    v_add_f32_dpp v91, v90, v91 quad_perm:[2,3,0,1] row_mask:0xf bank_mask:0xf
    v_add_f32_dpp v91, v90, v91 quad_perm:[3,2,1,0] row_mask:0xf bank_mask:0xf
    s_nop 1
    v_add_f32_dpp v90, v91, v91 row_half_mirror row_mask:0xf bank_mask:0xf
    v_rcp_f32 v90, v90
    s_nop 0
    v_mul_f32 v88, v88, v90
    v_pk_mul_f32 v[84:85], v[84:85], v[90:91] op_sel_hi:[1,0]
    v_pk_mul_f32 v[86:87], v[86:87], v[90:91] op_sel_hi:[1,0]
    v_mov_b32_dpp v89, v88 quad_perm:[1,0,3,2] row_mask:0xf bank_mask:0xf
    v_cvt_pk_bf16_f32 v26, v84, v85
    v_cvt_pk_bf16_f32 v27, v86, v87
    v_cvt_pk_bf16_f32 v24, v88, v89
    buffer_store_dwordx2 v[26:27], v22, s[8:11], s47 offen sc1
    buffer_store_dword v24, v23, s[8:11], s47 offen sc1
    buffer_store_dword v25, v31, s[8:11], s47 offen sc1
    s_endpgm
L_a_max:
    s_mov_b32 s46, -1
    v_max_f32 v34, v32, v33
    s_nop 1
    v_max_f32_dpp v35, v34, v34 quad_perm:[1,0,3,2] row_mask:0xf bank_mask:0xf
    v_max_f32_dpp v35, v34, v35 quad_perm:[2,3,0,1] row_mask:0xf bank_mask:0xf
    v_max_f32_dpp v35, v34, v35 quad_perm:[3,2,1,0] row_mask:0xf bank_mask:0xf
    s_nop 1
    v_max_f32_dpp v34, v35, v35 row_ror:4 row_mask:0xf bank_mask:0xf
    v_max_f32_dpp v34, v35, v34 row_ror:8 row_mask:0xf bank_mask:0xf
    v_max_f32_dpp v36, v35, v34 row_ror:12 row_mask:0xf bank_mask:0xf
    v_max_f32_dpp v34, v35, v34 row_ror:12 row_mask:0xf bank_mask:0xf
    s_nop 1
    v_permlane16_swap_b32 v34, v36
    v_max_f32 v34, v34, v36
    v_pk_add_f32 v[32:33], v[32:33], v[34:35] op_sel_hi:[1,0] neg_lo:[0,1] neg_hi:[0,1]
    s_branch L_a_exp
L_a_e:
    s_cmp_eq_u32 s38, 0
    s_cbranch_scc1 L_a_eb
L_a_slow:
    s_nop 7
    s_waitcnt vmcnt(0) lgkmcnt(0)
    ds_read_b128 v[96:99], v7 offset:0
    ds_read_b128 v[100:103], v7 offset:1024
    ds_read_b128 v[104:107], v7 offset:2048
    ds_read_b128 v[108:111], v7 offset:3072
    ds_read_b128 v[112:115], v7 offset:4096
    ds_read_b128 v[116:119], v7 offset:5120
    v_mov_b32 v72, 0
    v_mov_b32 v73, 0
    v_mov_b32 v74, 0
    v_mov_b32 v75, 0
    v_mov_b32 v76, 0
    v_mov_b32 v77, 0
    v_mov_b32 v78, 0
    v_mov_b32 v79, 0
    v_mov_b32 v80, 0
    v_mov_b32 v81, 0
    v_mov_b32 v82, 0
    v_mov_b32 v83, 0
    s_mov_b32 s63, 2130706432
    s_lshl_b32 s62, s62, 8
    s_cbranch_scc1 L_a_go
L_a_sp:
    buffer_load_dwordx4 v[32:35], v4, s[8:11], s36 offen offset:0 sc1
    buffer_load_dwordx4 v[36:39], v4, s[8:11], s36 offen offset:1024 sc1
    buffer_load_dwordx4 v[40:43], v4, s[8:11], s36 offen offset:2048 sc1
    buffer_load_dwordx4 v[44:47], v4, s[8:11], s36 offen offset:3072 sc1
    buffer_load_dwordx4 v[48:51], v5, s[8:11], s36 offen offset:0 sc1
    buffer_load_dwordx4 v[52:55], v5, s[8:11], s36 offen offset:1024 sc1
    buffer_load_dwordx4 v[56:59], v5, s[8:11], s36 offen offset:2048 sc1
    buffer_load_dwordx4 v[60:63], v5, s[8:11], s36 offen offset:3072 sc1
    buffer_load_dwordx4 v[64:67], v6, s[8:11], s36 offen offset:0 sc1
    buffer_load_dwordx4 v[68:71], v6, s[8:11], s36 offen offset:1024 sc1
    s_add_u32 s7, s7, 1
    s_bitcmp1_b32 s7, 22
    s_cbranch_scc1 L_abort
    s_waitcnt vmcnt(0)
    v_mov_b32 v1, 0
    v_and_b32 v2, 0x7fff7fff, v32
    v_pk_max_u16 v1, v1, v2
    v_and_b32 v2, 0x7fff7fff, v33
    v_pk_max_u16 v1, v1, v2
    v_and_b32 v2, 0x7fff7fff, v34
    v_pk_max_u16 v1, v1, v2
    v_and_b32 v2, 0x7fff7fff, v35
    v_pk_max_u16 v1, v1, v2
    v_and_b32 v2, 0x7fff7fff, v36
    v_pk_max_u16 v1, v1, v2
    v_and_b32 v2, 0x7fff7fff, v37
    v_pk_max_u16 v1, v1, v2
    v_and_b32 v2, 0x7fff7fff, v38
    v_pk_max_u16 v1, v1, v2
    v_and_b32 v2, 0x7fff7fff, v39
    v_pk_max_u16 v1, v1, v2
    v_and_b32 v2, 0x7fff7fff, v40
    v_pk_max_u16 v1, v1, v2
    v_and_b32 v2, 0x7fff7fff, v41
    v_pk_max_u16 v1, v1, v2
    v_and_b32 v2, 0x7fff7fff, v42
    v_pk_max_u16 v1, v1, v2
    v_and_b32 v2, 0x7fff7fff, v43
    v_pk_max_u16 v1, v1, v2
    v_and_b32 v2, 0x7fff7fff, v44
    v_pk_max_u16 v1, v1, v2
    v_and_b32 v2, 0x7fff7fff, v45
    v_pk_max_u16 v1, v1, v2
    v_and_b32 v2, 0x7fff7fff, v46
    v_pk_max_u16 v1, v1, v2
    v_and_b32 v2, 0x7fff7fff, v47
    v_pk_max_u16 v1, v1, v2
    v_and_b32 v2, 0x7fff7fff, v48
    v_pk_max_u16 v1, v1, v2
    v_and_b32 v2, 0x7fff7fff, v49
    v_pk_max_u16 v1, v1, v2
    v_and_b32 v2, 0x7fff7fff, v50
    v_pk_max_u16 v1, v1, v2
    v_and_b32 v2, 0x7fff7fff, v51
    v_pk_max_u16 v1, v1, v2
    v_and_b32 v2, 0x7fff7fff, v52
    v_pk_max_u16 v1, v1, v2
    v_and_b32 v2, 0x7fff7fff, v53
    v_pk_max_u16 v1, v1, v2
    v_and_b32 v2, 0x7fff7fff, v54
    v_pk_max_u16 v1, v1, v2
    v_and_b32 v2, 0x7fff7fff, v55
    v_pk_max_u16 v1, v1, v2
    v_and_b32 v2, 0x7fff7fff, v56
    v_pk_max_u16 v1, v1, v2
    v_and_b32 v2, 0x7fff7fff, v57
    v_pk_max_u16 v1, v1, v2
    v_and_b32 v2, 0x7fff7fff, v58
    v_pk_max_u16 v1, v1, v2
    v_and_b32 v2, 0x7fff7fff, v59
    v_pk_max_u16 v1, v1, v2
    v_and_b32 v2, 0x7fff7fff, v60
    v_pk_max_u16 v1, v1, v2
    v_and_b32 v2, 0x7fff7fff, v61
    v_pk_max_u16 v1, v1, v2
    v_and_b32 v2, 0x7fff7fff, v62
    v_pk_max_u16 v1, v1, v2
    v_and_b32 v2, 0x7fff7fff, v63
    v_pk_max_u16 v1, v1, v2
    v_and_b32 v2, 0x7fff7fff, v64
    v_pk_max_u16 v1, v1, v2
    v_and_b32 v2, 0x7fff7fff, v65
    v_pk_max_u16 v1, v1, v2
    v_and_b32 v2, 0x7fff7fff, v66
    v_pk_max_u16 v1, v1, v2
    v_and_b32 v2, 0x7fff7fff, v67
    v_pk_max_u16 v1, v1, v2
    v_and_b32 v2, 0x7fff7fff, v68
    v_pk_max_u16 v1, v1, v2
    v_and_b32 v2, 0x7fff7fff, v69
    v_pk_max_u16 v1, v1, v2
    v_and_b32 v2, 0x7fff7fff, v70
    v_pk_max_u16 v1, v1, v2
    v_and_b32 v2, 0x7fff7fff, v71
    v_pk_max_u16 v1, v1, v2
    v_lshrrev_b32 v2, 16, v1
    v_and_b32 v1, 0xffff, v1
    v_max_u32 v1, v1, v2
    v_cmp_lt_u32 vcc, 0x7f81, v1
    s_cbranch_vccnz L_a_sp
    s_mov_b64 s[38:39], 0
    s_branch L_a_go
L_b:
    s_lshl_b32 s40, s5, 3
    s_add_u32 s40, s40, s6
    s_sub_u32 s40, s40, 8
    s_mov_b32 s97, 0
    s_mul_i32 s43, s40, 384
    s_mul_i32 s32, s3, 12288
    s_add_u32 s32, s32, 114688
    s_mul_i32 s41, s3, 28672
    s_mov_b32 s12, s78
    s_mov_b32 s13, s79
    s_mov_b32 s14, 7864320
    s_mov_b32 s15, 0x20000
    s_mov_b32 s16, s80
    s_mov_b32 s17, s81
    s_mov_b32 s18, 7864320
    s_mov_b32 s19, 0x20000
    s_mul_i32 s30, s3, 192
    v_add_u32 v1, 0, v0
    v_add_u32 v1, s30, v1
    v_mul_u32_u24 v2, 2731, v1
    v_lshrrev_b32 v2, 16, v2
    v_mul_u32_u24 v3, 24, v2
    v_sub_u32 v3, v1, v3
    v_mul_u32_u24 v2, 12288, v2
    v_lshl_add_u32 v20, v3, 4, v2
    s_mul_i32 s30, s3, 192
    v_add_u32 v1, 64, v0
    v_add_u32 v1, s30, v1
    v_mul_u32_u24 v2, 2731, v1
    v_lshrrev_b32 v2, 16, v2
    v_mul_u32_u24 v3, 24, v2
    v_sub_u32 v3, v1, v3
    v_mul_u32_u24 v2, 12288, v2
    v_lshl_add_u32 v21, v3, 4, v2
    s_mul_i32 s30, s3, 192
    v_add_u32 v1, 128, v0
    v_add_u32 v1, s30, v1
    v_mul_u32_u24 v2, 2731, v1
    v_lshrrev_b32 v2, 16, v2
    v_mul_u32_u24 v3, 24, v2
    v_sub_u32 v3, v1, v3
    v_mul_u32_u24 v2, 12288, v2
    v_lshl_add_u32 v22, v3, 4, v2
    v_lshrrev_b32 v1, 4, v0
    v_lshlrev_b32 v1, 3, v1
    v_bfe_u32 v2, v0, 2, 2
    v_add_u32 v1, v1, v2
    v_mul_u32_u24 v1, 384, v1
    v_and_b32 v2, 3, v0
    v_lshl_add_u32 v1, v2, 3, v1
    s_mul_i32 s30, s3, 96
    s_add_u32 s30, s30, 0
    v_add_u32 v23, s30, v1
    v_bfe_u32 v1, v0, 3, 1
    v_mul_u32_u24 v2, 32, v1
    v_add_u32 v24, v23, v2
    v_mul_u32_u24 v2, 1536, v1
    v_sub_u32 v25, v24, v2
    v_add_u32 v25, 768, v25
    s_mul_i32 s31, s3, 3072
    s_add_u32 s33, s43, 0
    s_add_u32 m0, s31, 0
    s_nop 0
    buffer_load_dwordx4 v20, s[12:15], s33 offen lds
    s_add_u32 m0, s31, 1024
    s_nop 0
    buffer_load_dwordx4 v21, s[12:15], s33 offen lds
    s_add_u32 m0, s31, 2048
    s_nop 0
    buffer_load_dwordx4 v22, s[12:15], s33 offen lds
    s_add_u32 s33, s43, 393216
    s_add_u32 m0, s31, 12288
    s_nop 0
    buffer_load_dwordx4 v20, s[12:15], s33 offen lds
    s_add_u32 m0, s31, 13312
    s_nop 0
    buffer_load_dwordx4 v21, s[12:15], s33 offen lds
    s_add_u32 m0, s31, 14336
    s_nop 0
    buffer_load_dwordx4 v22, s[12:15], s33 offen lds
    s_add_u32 s33, s43, 786432
    s_add_u32 m0, s31, 24576
    s_nop 0
    buffer_load_dwordx4 v20, s[12:15], s33 offen lds
    s_add_u32 m0, s31, 25600
    s_nop 0
    buffer_load_dwordx4 v21, s[12:15], s33 offen lds
    s_add_u32 m0, s31, 26624
    s_nop 0
    buffer_load_dwordx4 v22, s[12:15], s33 offen lds
    s_add_u32 s33, s43, 1179648
    s_add_u32 m0, s31, 36864
    s_nop 0
    buffer_load_dwordx4 v20, s[12:15], s33 offen lds
    s_add_u32 m0, s31, 37888
    s_nop 0
    buffer_load_dwordx4 v21, s[12:15], s33 offen lds
    s_add_u32 m0, s31, 38912
    s_nop 0
    buffer_load_dwordx4 v22, s[12:15], s33 offen lds
    s_add_u32 s33, s43, 1572864
    s_add_u32 m0, s31, 49152
    s_nop 0
    buffer_load_dwordx4 v20, s[12:15], s33 offen lds
    s_add_u32 m0, s31, 50176
    s_nop 0
    buffer_load_dwordx4 v21, s[12:15], s33 offen lds
    s_add_u32 m0, s31, 51200
    s_nop 0
    buffer_load_dwordx4 v22, s[12:15], s33 offen lds
    s_add_u32 s33, s43, 1966080
    s_add_u32 m0, s31, 61440
    s_nop 0
    buffer_load_dwordx4 v20, s[12:15], s33 offen lds
    s_add_u32 m0, s31, 62464
    s_nop 0
    buffer_load_dwordx4 v21, s[12:15], s33 offen lds
    s_add_u32 m0, s31, 63488
    s_nop 0
    buffer_load_dwordx4 v22, s[12:15], s33 offen lds
    s_add_u32 s33, s43, 2359296
    s_add_u32 m0, s31, 73728
    s_nop 0
    buffer_load_dwordx4 v20, s[12:15], s33 offen lds
    s_add_u32 m0, s31, 74752
    s_nop 0
    buffer_load_dwordx4 v21, s[12:15], s33 offen lds
    s_add_u32 m0, s31, 75776
    s_nop 0
    buffer_load_dwordx4 v22, s[12:15], s33 offen lds
    s_add_u32 s33, s43, 2752512
    s_add_u32 m0, s31, 86016
    s_nop 0
    buffer_load_dwordx4 v20, s[12:15], s33 offen lds
    s_add_u32 m0, s31, 87040
    s_nop 0
    buffer_load_dwordx4 v21, s[12:15], s33 offen lds
    s_add_u32 m0, s31, 88064
    s_nop 0
    buffer_load_dwordx4 v22, s[12:15], s33 offen lds
    s_add_u32 s33, s43, 3145728
    s_add_u32 m0, s31, 98304
    s_nop 0
    buffer_load_dwordx4 v20, s[12:15], s33 offen lds
    s_add_u32 m0, s31, 99328
    s_nop 0
    buffer_load_dwordx4 v21, s[12:15], s33 offen lds
    s_add_u32 m0, s31, 100352
    s_nop 0
    buffer_load_dwordx4 v22, s[12:15], s33 offen lds
    s_add_u32 s33, s43, 3538944
    s_add_u32 m0, s31, 110592
    s_nop 0
    buffer_load_dwordx4 v20, s[12:15], s33 offen lds
    s_add_u32 m0, s31, 111616
    s_nop 0
    buffer_load_dwordx4 v21, s[12:15], s33 offen lds
    s_add_u32 m0, s31, 112640
    s_nop 0
    buffer_load_dwordx4 v22, s[12:15], s33 offen lds
    s_add_u32 s33, s43, 3932160
    s_add_u32 m0, s31, 122880
    s_nop 0
    buffer_load_dwordx4 v20, s[12:15], s33 offen lds
    s_add_u32 m0, s31, 123904
    s_nop 0
    buffer_load_dwordx4 v21, s[12:15], s33 offen lds
    s_add_u32 m0, s31, 124928
    s_nop 0
    buffer_load_dwordx4 v22, s[12:15], s33 offen lds
    s_add_u32 s33, s43, 4325376
    s_add_u32 m0, s31, 135168
    s_nop 0
    buffer_load_dwordx4 v20, s[12:15], s33 offen lds
    s_add_u32 m0, s31, 136192
    s_nop 0
    buffer_load_dwordx4 v21, s[12:15], s33 offen lds
    s_add_u32 m0, s31, 137216
    s_nop 0
    buffer_load_dwordx4 v22, s[12:15], s33 offen lds
    s_waitcnt vmcnt(33)
    s_barrier
    ds_read_b64_tr_b16 a[0:1], v24 offset:0
    ds_read_b64_tr_b16 a[2:3], v24 offset:1536
    ds_read_b64_tr_b16 v[40:41], v25 offset:0
    ds_read_b64_tr_b16 v[42:43], v25 offset:1536
    ds_read_b64_tr_b16 v[32:33], v23 offset:64
    ds_read_b64_tr_b16 v[34:35], v23 offset:1600
    s_waitcnt lgkmcnt(0)
    s_waitcnt vmcnt(30)
    s_barrier
    s_add_u32 s33, s43, 4718592
    s_add_u32 m0, s31, 0
    s_nop 0
    buffer_load_dwordx4 v20, s[12:15], s33 offen lds
    s_add_u32 m0, s31, 1024
    s_nop 0
    buffer_load_dwordx4 v21, s[12:15], s33 offen lds
    s_add_u32 m0, s31, 2048
    s_nop 0
    buffer_load_dwordx4 v22, s[12:15], s33 offen lds
    ds_read_b64_tr_b16 a[4:5], v24 offset:12288
    ds_read_b64_tr_b16 a[6:7], v24 offset:13824
    ds_read_b64_tr_b16 v[44:45], v25 offset:12288
    ds_read_b64_tr_b16 v[46:47], v25 offset:13824
    ds_read_b64_tr_b16 v[36:37], v23 offset:12352
    ds_read_b64_tr_b16 v[38:39], v23 offset:13888
    s_waitcnt lgkmcnt(0)
    s_waitcnt vmcnt(30)
    s_barrier
    s_add_u32 s33, s43, 5111808
    s_add_u32 m0, s31, 12288
    s_nop 0
    buffer_load_dwordx4 v20, s[12:15], s33 offen lds
    s_add_u32 m0, s31, 13312
    s_nop 0
    buffer_load_dwordx4 v21, s[12:15], s33 offen lds
    s_add_u32 m0, s31, 14336
    s_nop 0
    buffer_load_dwordx4 v22, s[12:15], s33 offen lds
    ds_read_b64_tr_b16 a[8:9], v24 offset:24576
    ds_read_b64_tr_b16 a[10:11], v24 offset:26112
    ds_read_b64_tr_b16 a[24:25], v25 offset:24576
    ds_read_b64_tr_b16 a[26:27], v25 offset:26112
    ds_read_b64_tr_b16 a[16:17], v23 offset:24640
    ds_read_b64_tr_b16 a[18:19], v23 offset:26176
    s_waitcnt lgkmcnt(0)
    s_waitcnt vmcnt(30)
    s_barrier
    s_add_u32 s33, s43, 5505024
    s_add_u32 m0, s31, 24576
    s_nop 0
    buffer_load_dwordx4 v20, s[12:15], s33 offen lds
    s_add_u32 m0, s31, 25600
    s_nop 0
    buffer_load_dwordx4 v21, s[12:15], s33 offen lds
    s_add_u32 m0, s31, 26624
    s_nop 0
    buffer_load_dwordx4 v22, s[12:15], s33 offen lds
    ds_read_b64_tr_b16 a[12:13], v24 offset:36864
    ds_read_b64_tr_b16 a[14:15], v24 offset:38400
    ds_read_b64_tr_b16 a[28:29], v25 offset:36864
    ds_read_b64_tr_b16 a[30:31], v25 offset:38400
    ds_read_b64_tr_b16 a[20:21], v23 offset:36928
    ds_read_b64_tr_b16 a[22:23], v23 offset:38464
    s_waitcnt lgkmcnt(0)
    s_waitcnt vmcnt(30)
    s_barrier
    s_add_u32 s33, s43, 5898240
    s_add_u32 m0, s31, 36864
    s_nop 0
    buffer_load_dwordx4 v20, s[12:15], s33 offen lds
    s_add_u32 m0, s31, 37888
    s_nop 0
    buffer_load_dwordx4 v21, s[12:15], s33 offen lds
    s_add_u32 m0, s31, 38912
    s_nop 0
    buffer_load_dwordx4 v22, s[12:15], s33 offen lds
    v_add_u32 v23, 49152, v23
    v_add_u32 v24, 49152, v24
    v_add_u32 v25, 49152, v25
    ds_read_b64_tr_b16 v[48:49], v24 offset:0
    ds_read_b64_tr_b16 v[50:51], v24 offset:1536
    ds_read_b64_tr_b16 v[64:65], v25 offset:0
    ds_read_b64_tr_b16 v[66:67], v25 offset:1536
    ds_read_b64_tr_b16 v[56:57], v23 offset:64
    ds_read_b64_tr_b16 v[58:59], v23 offset:1600
    s_waitcnt lgkmcnt(0)
    s_waitcnt vmcnt(30)
    s_barrier
    s_add_u32 s33, s43, 6291456
    s_add_u32 m0, s31, 49152
    s_nop 0
    buffer_load_dwordx4 v20, s[12:15], s33 offen lds
    s_add_u32 m0, s31, 50176
    s_nop 0
    buffer_load_dwordx4 v21, s[12:15], s33 offen lds
    s_add_u32 m0, s31, 51200
    s_nop 0
    buffer_load_dwordx4 v22, s[12:15], s33 offen lds
    ds_read_b64_tr_b16 v[52:53], v24 offset:12288
    ds_read_b64_tr_b16 v[54:55], v24 offset:13824
    ds_read_b64_tr_b16 v[68:69], v25 offset:12288
    ds_read_b64_tr_b16 v[70:71], v25 offset:13824
    ds_read_b64_tr_b16 v[60:61], v23 offset:12352
    ds_read_b64_tr_b16 v[62:63], v23 offset:13888
    s_waitcnt lgkmcnt(0)
    s_waitcnt vmcnt(30)
    s_barrier
    s_add_u32 s33, s43, 6684672
    s_add_u32 m0, s31, 61440
    s_nop 0
    buffer_load_dwordx4 v20, s[12:15], s33 offen lds
    s_add_u32 m0, s31, 62464
    s_nop 0
    buffer_load_dwordx4 v21, s[12:15], s33 offen lds
    s_add_u32 m0, s31, 63488
    s_nop 0
    buffer_load_dwordx4 v22, s[12:15], s33 offen lds
    ds_read_b64_tr_b16 a[32:33], v24 offset:24576
    ds_read_b64_tr_b16 a[34:35], v24 offset:26112
    ds_read_b64_tr_b16 a[48:49], v25 offset:24576
    ds_read_b64_tr_b16 a[50:51], v25 offset:26112
    ds_read_b64_tr_b16 a[40:41], v23 offset:24640
    ds_read_b64_tr_b16 a[42:43], v23 offset:26176
    s_waitcnt lgkmcnt(0)
    s_waitcnt vmcnt(30)
    s_barrier
    s_add_u32 s33, s43, 7077888
    s_add_u32 m0, s31, 73728
    s_nop 0
    buffer_load_dwordx4 v20, s[12:15], s33 offen lds
    s_add_u32 m0, s31, 74752
    s_nop 0
    buffer_load_dwordx4 v21, s[12:15], s33 offen lds
    s_add_u32 m0, s31, 75776
    s_nop 0
    buffer_load_dwordx4 v22, s[12:15], s33 offen lds
    ds_read_b64_tr_b16 a[36:37], v24 offset:36864
    ds_read_b64_tr_b16 a[38:39], v24 offset:38400
    ds_read_b64_tr_b16 a[52:53], v25 offset:36864
    ds_read_b64_tr_b16 a[54:55], v25 offset:38400
    ds_read_b64_tr_b16 a[44:45], v23 offset:36928
    ds_read_b64_tr_b16 a[46:47], v23 offset:38464
    s_waitcnt lgkmcnt(0)
    s_waitcnt vmcnt(30)
    s_barrier
    s_add_u32 s33, s43, 7471104
    s_add_u32 m0, s31, 86016
    s_nop 0
    buffer_load_dwordx4 v20, s[12:15], s33 offen lds
    s_add_u32 m0, s31, 87040
    s_nop 0
    buffer_load_dwordx4 v21, s[12:15], s33 offen lds
    s_add_u32 m0, s31, 88064
    s_nop 0
    buffer_load_dwordx4 v22, s[12:15], s33 offen lds
    v_add_u32 v23, 49152, v23
    v_add_u32 v24, 49152, v24
    v_add_u32 v25, 49152, v25
    ds_read_b64_tr_b16 v[72:73], v24 offset:0
    ds_read_b64_tr_b16 v[74:75], v24 offset:1536
    ds_read_b64_tr_b16 v[88:89], v25 offset:0
    ds_read_b64_tr_b16 v[90:91], v25 offset:1536
    ds_read_b64_tr_b16 v[80:81], v23 offset:64
    ds_read_b64_tr_b16 v[82:83], v23 offset:1600
    s_waitcnt lgkmcnt(0)
    s_waitcnt vmcnt(30)
    s_barrier
    ds_read_b64_tr_b16 v[76:77], v24 offset:12288
    ds_read_b64_tr_b16 v[78:79], v24 offset:13824
    ds_read_b64_tr_b16 v[92:93], v25 offset:12288
    ds_read_b64_tr_b16 v[94:95], v25 offset:13824
    ds_read_b64_tr_b16 v[84:85], v23 offset:12352
    ds_read_b64_tr_b16 v[86:87], v23 offset:13888
    s_waitcnt lgkmcnt(0)
    s_waitcnt vmcnt(27)
    s_barrier
    ds_read_b64_tr_b16 a[56:57], v24 offset:24576
    ds_read_b64_tr_b16 a[58:59], v24 offset:26112
    ds_read_b64_tr_b16 a[72:73], v25 offset:24576
    ds_read_b64_tr_b16 a[74:75], v25 offset:26112
    ds_read_b64_tr_b16 a[64:65], v23 offset:24640
    ds_read_b64_tr_b16 a[66:67], v23 offset:26176
    s_waitcnt lgkmcnt(0)
    s_waitcnt vmcnt(24)
    s_barrier
    ds_read_b64_tr_b16 a[60:61], v24 offset:36864
    ds_read_b64_tr_b16 a[62:63], v24 offset:38400
    ds_read_b64_tr_b16 a[76:77], v25 offset:36864
    ds_read_b64_tr_b16 a[78:79], v25 offset:38400
    ds_read_b64_tr_b16 a[68:69], v23 offset:36928
    ds_read_b64_tr_b16 a[70:71], v23 offset:38464
    s_waitcnt lgkmcnt(0)
    s_waitcnt vmcnt(21)
    s_barrier
    v_add_u32 v23, 4294868992, v23
    v_add_u32 v24, 4294868992, v24
    v_add_u32 v25, 4294868992, v25
    ds_read_b64_tr_b16 v[96:97], v24 offset:0
    ds_read_b64_tr_b16 v[98:99], v24 offset:1536
    ds_read_b64_tr_b16 v[112:113], v25 offset:0
    ds_read_b64_tr_b16 v[114:115], v25 offset:1536
    ds_read_b64_tr_b16 v[104:105], v23 offset:64
    ds_read_b64_tr_b16 v[106:107], v23 offset:1600
    s_waitcnt lgkmcnt(0)
    s_waitcnt vmcnt(18)
    s_barrier
    ds_read_b64_tr_b16 v[100:101], v24 offset:12288
    ds_read_b64_tr_b16 v[102:103], v24 offset:13824
    ds_read_b64_tr_b16 v[116:117], v25 offset:12288
    ds_read_b64_tr_b16 v[118:119], v25 offset:13824
    ds_read_b64_tr_b16 v[108:109], v23 offset:12352
    ds_read_b64_tr_b16 v[110:111], v23 offset:13888
    s_waitcnt lgkmcnt(0)
    s_waitcnt vmcnt(15)
    s_barrier
    ds_read_b64_tr_b16 a[80:81], v24 offset:24576
    ds_read_b64_tr_b16 a[82:83], v24 offset:26112
    ds_read_b64_tr_b16 a[96:97], v25 offset:24576
    ds_read_b64_tr_b16 a[98:99], v25 offset:26112
    ds_read_b64_tr_b16 a[88:89], v23 offset:24640
    ds_read_b64_tr_b16 a[90:91], v23 offset:26176
    s_waitcnt lgkmcnt(0)
    s_waitcnt vmcnt(12)
    s_barrier
    ds_read_b64_tr_b16 a[84:85], v24 offset:36864
    ds_read_b64_tr_b16 a[86:87], v24 offset:38400
    ds_read_b64_tr_b16 a[100:101], v25 offset:36864
    ds_read_b64_tr_b16 a[102:103], v25 offset:38400
    ds_read_b64_tr_b16 a[92:93], v23 offset:36928
    ds_read_b64_tr_b16 a[94:95], v23 offset:38464
    s_waitcnt lgkmcnt(0)
    s_waitcnt vmcnt(9)
    s_barrier
    v_add_u32 v23, 49152, v23
    v_add_u32 v24, 49152, v24
    v_add_u32 v25, 49152, v25
    ds_read_b64_tr_b16 v[120:121], v24 offset:0
    ds_read_b64_tr_b16 v[122:123], v24 offset:1536
    ds_read_b64_tr_b16 v[136:137], v25 offset:0
    ds_read_b64_tr_b16 v[138:139], v25 offset:1536
    ds_read_b64_tr_b16 v[128:129], v23 offset:64
    ds_read_b64_tr_b16 v[130:131], v23 offset:1600
    s_waitcnt lgkmcnt(0)
    s_waitcnt vmcnt(6)
    s_barrier
    ds_read_b64_tr_b16 v[124:125], v24 offset:12288
    ds_read_b64_tr_b16 v[126:127], v24 offset:13824
    ds_read_b64_tr_b16 v[140:141], v25 offset:12288
    ds_read_b64_tr_b16 v[142:143], v25 offset:13824
    ds_read_b64_tr_b16 v[132:133], v23 offset:12352
    ds_read_b64_tr_b16 v[134:135], v23 offset:13888
    s_waitcnt lgkmcnt(0)
    s_waitcnt vmcnt(3)
    s_barrier
    ds_read_b64_tr_b16 a[104:105], v24 offset:24576
    ds_read_b64_tr_b16 a[106:107], v24 offset:26112
    ds_read_b64_tr_b16 a[120:121], v25 offset:24576
    ds_read_b64_tr_b16 a[122:123], v25 offset:26112
    ds_read_b64_tr_b16 a[112:113], v23 offset:24640
    ds_read_b64_tr_b16 a[114:115], v23 offset:26176
    s_waitcnt lgkmcnt(0)
    s_waitcnt vmcnt(0)
    s_barrier
    ds_read_b64_tr_b16 a[108:109], v24 offset:36864
    ds_read_b64_tr_b16 a[110:111], v24 offset:38400
    ds_read_b64_tr_b16 a[124:125], v25 offset:36864
    ds_read_b64_tr_b16 a[126:127], v25 offset:38400
    ds_read_b64_tr_b16 a[116:117], v23 offset:36928
    ds_read_b64_tr_b16 a[118:119], v23 offset:38464
    s_waitcnt lgkmcnt(0)
    s_barrier
    v_lshlrev_b32 v26, 4, v0
    v_add_u32 v26, s41, v26
    v_add_u32 v1, 0, v0
    v_mul_u32_u24 v2, 3277, v1
    v_lshrrev_b32 v2, 16, v2
    v_mul_u32_u24 v3, 20, v2
    v_sub_u32 v3, v1, v3
    v_mul_u32_u24 v2, 1280, v2
    v_lshl_add_u32 v2, v3, 4, v2
    s_mul_i32 s30, s3, 320
    v_add_u32 v20, s30, v2
    v_add_u32 v1, 64, v0
    v_mul_u32_u24 v2, 3277, v1
    v_lshrrev_b32 v2, 16, v2
    v_mul_u32_u24 v3, 20, v2
    v_sub_u32 v3, v1, v3
    v_mul_u32_u24 v2, 1280, v2
    v_lshl_add_u32 v2, v3, 4, v2
    s_mul_i32 s30, s3, 320
    v_add_u32 v21, s30, v2
    v_add_u32 v1, 128, v0
    v_mul_u32_u24 v2, 3277, v1
    v_lshrrev_b32 v2, 16, v2
    v_mul_u32_u24 v3, 20, v2
    v_sub_u32 v3, v1, v3
    v_mul_u32_u24 v2, 1280, v2
    v_lshl_add_u32 v2, v3, 4, v2
    s_mul_i32 s30, s3, 320
    v_add_u32 v22, s30, v2
    v_add_u32 v1, 192, v0
    v_mul_u32_u24 v2, 3277, v1
    v_lshrrev_b32 v2, 16, v2
    v_mul_u32_u24 v3, 20, v2
    v_sub_u32 v3, v1, v3
    v_mul_u32_u24 v2, 1280, v2
    v_lshl_add_u32 v2, v3, 4, v2
    s_mul_i32 s30, s3, 320
    v_add_u32 v23, s30, v2
    v_add_u32 v1, 256, v0
    v_mul_u32_u24 v2, 3277, v1
    v_lshrrev_b32 v2, 16, v2
    v_mul_u32_u24 v3, 20, v2
    v_sub_u32 v3, v1, v3
    v_mul_u32_u24 v2, 1280, v2
    v_lshl_add_u32 v2, v3, 4, v2
    s_mul_i32 s30, s3, 320
    v_add_u32 v24, s30, v2
    v_lshrrev_b32 v1, 2, v0
    v_mul_u32_u24 v1, 320, v1
    v_and_b32 v2, 3, v0
    v_lshl_add_u32 v1, v2, 3, v1
    v_add_u32 v25, s41, v1
    s_mul_i32 s44, s40, 245760
    v_lshrrev_b32 v1, 4, v0
    v_bfe_u32 v2, v0, 2, 1
    v_lshl_add_u32 v1, v1, 1, v2
    v_mul_u32_u24 v1, 320, v1
    v_bfe_u32 v2, v0, 3, 1
    v_lshl_add_u32 v1, v2, 5, v1
    v_and_b32 v2, 3, v0
    v_lshl_add_u32 v1, v2, 3, v1
    v_add_u32 v25, s41, v1
    s_add_u32 s33, s44, 0
    s_add_u32 m0, s41, 0
    s_nop 0
    buffer_load_dwordx4 v20, s[16:19], s33 offen lds
    s_add_u32 m0, s41, 1024
    s_nop 0
    buffer_load_dwordx4 v21, s[16:19], s33 offen lds
    s_add_u32 m0, s41, 2048
    s_nop 0
    buffer_load_dwordx4 v22, s[16:19], s33 offen lds
    s_add_u32 m0, s41, 3072
    s_nop 0
    buffer_load_dwordx4 v23, s[16:19], s33 offen lds
    s_add_u32 m0, s41, 4096
    s_nop 0
    buffer_load_dwordx4 v24, s[16:19], s33 offen lds
    s_add_u32 s33, s44, 20480
    s_add_u32 m0, s41, 5120
    s_nop 0
    buffer_load_dwordx4 v20, s[16:19], s33 offen lds
    s_add_u32 m0, s41, 6144
    s_nop 0
    buffer_load_dwordx4 v21, s[16:19], s33 offen lds
    s_add_u32 m0, s41, 7168
    s_nop 0
    buffer_load_dwordx4 v22, s[16:19], s33 offen lds
    s_add_u32 m0, s41, 8192
    s_nop 0
    buffer_load_dwordx4 v23, s[16:19], s33 offen lds
    s_add_u32 m0, s41, 9216
    s_nop 0
    buffer_load_dwordx4 v24, s[16:19], s33 offen lds
    s_add_u32 s33, s44, 40960
    s_add_u32 m0, s41, 10240
    s_nop 0
    buffer_load_dwordx4 v20, s[16:19], s33 offen lds
    s_add_u32 m0, s41, 11264
    s_nop 0
    buffer_load_dwordx4 v21, s[16:19], s33 offen lds
    s_add_u32 m0, s41, 12288
    s_nop 0
    buffer_load_dwordx4 v22, s[16:19], s33 offen lds
    s_add_u32 m0, s41, 13312
    s_nop 0
    buffer_load_dwordx4 v23, s[16:19], s33 offen lds
    s_add_u32 m0, s41, 14336
    s_nop 0
    buffer_load_dwordx4 v24, s[16:19], s33 offen lds
    s_add_u32 s33, s44, 61440
    s_add_u32 m0, s41, 15360
    s_nop 0
    buffer_load_dwordx4 v20, s[16:19], s33 offen lds
    s_add_u32 m0, s41, 16384
    s_nop 0
    buffer_load_dwordx4 v21, s[16:19], s33 offen lds
    s_add_u32 m0, s41, 17408
    s_nop 0
    buffer_load_dwordx4 v22, s[16:19], s33 offen lds
    s_add_u32 m0, s41, 18432
    s_nop 0
    buffer_load_dwordx4 v23, s[16:19], s33 offen lds
    s_add_u32 m0, s41, 19456
    s_nop 0
    buffer_load_dwordx4 v24, s[16:19], s33 offen lds
    s_add_u32 s33, s44, 81920
    s_add_u32 m0, s41, 20480
    s_nop 0
    buffer_load_dwordx4 v20, s[16:19], s33 offen lds
    s_add_u32 m0, s41, 21504
    s_nop 0
    buffer_load_dwordx4 v21, s[16:19], s33 offen lds
    s_add_u32 m0, s41, 22528
    s_nop 0
    buffer_load_dwordx4 v22, s[16:19], s33 offen lds
    s_add_u32 m0, s41, 23552
    s_nop 0
    buffer_load_dwordx4 v23, s[16:19], s33 offen lds
    s_add_u32 m0, s41, 24576
    s_nop 0
    buffer_load_dwordx4 v24, s[16:19], s33 offen lds
    s_waitcnt vmcnt(20)
    ds_read_b64_tr_b16 a[128:129], v25 offset:0
    ds_read_b64_tr_b16 a[130:131], v25 offset:2560
    ds_read_b64_tr_b16 a[136:137], v25 offset:64
    ds_read_b64_tr_b16 a[138:139], v25 offset:2624
    ds_read_b64_tr_b16 a[224:225], v25 offset:128
    ds_read_b64_tr_b16 a[226:227], v25 offset:2688
    ds_read_b64_tr_b16 v[160:161], v25 offset:192
    ds_read_b64_tr_b16 v[162:163], v25 offset:2752
    ds_read_b64_tr_b16 v[208:209], v25 offset:256
    ds_read_b64_tr_b16 v[210:211], v25 offset:2816
    s_waitcnt lgkmcnt(0)
    s_add_u32 s33, s44, 102400
    s_add_u32 m0, s41, 0
    s_nop 0
    buffer_load_dwordx4 v20, s[16:19], s33 offen lds
    s_add_u32 m0, s41, 1024
    s_nop 0
    buffer_load_dwordx4 v21, s[16:19], s33 offen lds
    s_add_u32 m0, s41, 2048
    s_nop 0
    buffer_load_dwordx4 v22, s[16:19], s33 offen lds
    s_add_u32 m0, s41, 3072
    s_nop 0
    buffer_load_dwordx4 v23, s[16:19], s33 offen lds
    s_add_u32 m0, s41, 4096
    s_nop 0
    buffer_load_dwordx4 v24, s[16:19], s33 offen lds
    s_waitcnt vmcnt(20)
    ds_read_b64_tr_b16 a[132:133], v25 offset:5120
    ds_read_b64_tr_b16 a[134:135], v25 offset:7680
    ds_read_b64_tr_b16 a[140:141], v25 offset:5184
    ds_read_b64_tr_b16 a[142:143], v25 offset:7744
    ds_read_b64_tr_b16 a[228:229], v25 offset:5248
    ds_read_b64_tr_b16 a[230:231], v25 offset:7808
    ds_read_b64_tr_b16 v[164:165], v25 offset:5312
    ds_read_b64_tr_b16 v[166:167], v25 offset:7872
    ds_read_b64_tr_b16 v[212:213], v25 offset:5376
    ds_read_b64_tr_b16 v[214:215], v25 offset:7936
    s_waitcnt lgkmcnt(0)
    s_add_u32 s33, s44, 122880
    s_add_u32 m0, s41, 5120
    s_nop 0
    buffer_load_dwordx4 v20, s[16:19], s33 offen lds
    s_add_u32 m0, s41, 6144
    s_nop 0
    buffer_load_dwordx4 v21, s[16:19], s33 offen lds
    s_add_u32 m0, s41, 7168
    s_nop 0
    buffer_load_dwordx4 v22, s[16:19], s33 offen lds
    s_add_u32 m0, s41, 8192
    s_nop 0
    buffer_load_dwordx4 v23, s[16:19], s33 offen lds
    s_add_u32 m0, s41, 9216
    s_nop 0
    buffer_load_dwordx4 v24, s[16:19], s33 offen lds
    s_waitcnt vmcnt(20)
    ds_read_b64_tr_b16 a[144:145], v25 offset:10240
    ds_read_b64_tr_b16 a[146:147], v25 offset:12800
    ds_read_b64_tr_b16 a[152:153], v25 offset:10304
    ds_read_b64_tr_b16 a[154:155], v25 offset:12864
    ds_read_b64_tr_b16 a[232:233], v25 offset:10368
    ds_read_b64_tr_b16 a[234:235], v25 offset:12928
    ds_read_b64_tr_b16 v[168:169], v25 offset:10432
    ds_read_b64_tr_b16 v[170:171], v25 offset:12992
    ds_read_b64_tr_b16 v[216:217], v25 offset:10496
    ds_read_b64_tr_b16 v[218:219], v25 offset:13056
    s_waitcnt lgkmcnt(0)
    s_add_u32 s33, s44, 143360
    s_add_u32 m0, s41, 10240
    s_nop 0
    buffer_load_dwordx4 v20, s[16:19], s33 offen lds
    s_add_u32 m0, s41, 11264
    s_nop 0
    buffer_load_dwordx4 v21, s[16:19], s33 offen lds
    s_add_u32 m0, s41, 12288
    s_nop 0
    buffer_load_dwordx4 v22, s[16:19], s33 offen lds
    s_add_u32 m0, s41, 13312
    s_nop 0
    buffer_load_dwordx4 v23, s[16:19], s33 offen lds
    s_add_u32 m0, s41, 14336
    s_nop 0
    buffer_load_dwordx4 v24, s[16:19], s33 offen lds
    s_waitcnt vmcnt(20)
    ds_read_b64_tr_b16 a[148:149], v25 offset:15360
    ds_read_b64_tr_b16 a[150:151], v25 offset:17920
    ds_read_b64_tr_b16 a[156:157], v25 offset:15424
    ds_read_b64_tr_b16 a[158:159], v25 offset:17984
    ds_read_b64_tr_b16 a[236:237], v25 offset:15488
    ds_read_b64_tr_b16 a[238:239], v25 offset:18048
    ds_read_b64_tr_b16 v[172:173], v25 offset:15552
    ds_read_b64_tr_b16 v[174:175], v25 offset:18112
    ds_read_b64_tr_b16 v[220:221], v25 offset:15616
    ds_read_b64_tr_b16 v[222:223], v25 offset:18176
    s_waitcnt lgkmcnt(0)
    s_add_u32 s33, s44, 163840
    s_add_u32 m0, s41, 15360
    s_nop 0
    buffer_load_dwordx4 v20, s[16:19], s33 offen lds
    s_add_u32 m0, s41, 16384
    s_nop 0
    buffer_load_dwordx4 v21, s[16:19], s33 offen lds
    s_add_u32 m0, s41, 17408
    s_nop 0
    buffer_load_dwordx4 v22, s[16:19], s33 offen lds
    s_add_u32 m0, s41, 18432
    s_nop 0
    buffer_load_dwordx4 v23, s[16:19], s33 offen lds
    s_add_u32 m0, s41, 19456
    s_nop 0
    buffer_load_dwordx4 v24, s[16:19], s33 offen lds
    s_waitcnt vmcnt(20)
    ds_read_b64_tr_b16 a[160:161], v25 offset:20480
    ds_read_b64_tr_b16 a[162:163], v25 offset:23040
    ds_read_b64_tr_b16 a[168:169], v25 offset:20544
    ds_read_b64_tr_b16 a[170:171], v25 offset:23104
    ds_read_b64_tr_b16 a[240:241], v25 offset:20608
    ds_read_b64_tr_b16 a[242:243], v25 offset:23168
    ds_read_b64_tr_b16 v[176:177], v25 offset:20672
    ds_read_b64_tr_b16 v[178:179], v25 offset:23232
    ds_read_b64_tr_b16 v[224:225], v25 offset:20736
    ds_read_b64_tr_b16 v[226:227], v25 offset:23296
    s_waitcnt lgkmcnt(0)
    s_add_u32 s33, s44, 184320
    s_add_u32 m0, s41, 20480
    s_nop 0
    buffer_load_dwordx4 v20, s[16:19], s33 offen lds
    s_add_u32 m0, s41, 21504
    s_nop 0
    buffer_load_dwordx4 v21, s[16:19], s33 offen lds
    s_add_u32 m0, s41, 22528
    s_nop 0
    buffer_load_dwordx4 v22, s[16:19], s33 offen lds
    s_add_u32 m0, s41, 23552
    s_nop 0
    buffer_load_dwordx4 v23, s[16:19], s33 offen lds
    s_add_u32 m0, s41, 24576
    s_nop 0
    buffer_load_dwordx4 v24, s[16:19], s33 offen lds
    s_waitcnt vmcnt(20)
    ds_read_b64_tr_b16 a[164:165], v25 offset:0
    ds_read_b64_tr_b16 a[166:167], v25 offset:2560
    ds_read_b64_tr_b16 a[172:173], v25 offset:64
    ds_read_b64_tr_b16 a[174:175], v25 offset:2624
    ds_read_b64_tr_b16 a[244:245], v25 offset:128
    ds_read_b64_tr_b16 a[246:247], v25 offset:2688
    ds_read_b64_tr_b16 v[180:181], v25 offset:192
    ds_read_b64_tr_b16 v[182:183], v25 offset:2752
    ds_read_b64_tr_b16 v[228:229], v25 offset:256
    ds_read_b64_tr_b16 v[230:231], v25 offset:2816
    s_waitcnt lgkmcnt(0)
    s_add_u32 s33, s44, 204800
    s_add_u32 m0, s41, 0
    s_nop 0
    buffer_load_dwordx4 v20, s[16:19], s33 offen lds
    s_add_u32 m0, s41, 1024
    s_nop 0
    buffer_load_dwordx4 v21, s[16:19], s33 offen lds
    s_add_u32 m0, s41, 2048
    s_nop 0
    buffer_load_dwordx4 v22, s[16:19], s33 offen lds
    s_add_u32 m0, s41, 3072
    s_nop 0
    buffer_load_dwordx4 v23, s[16:19], s33 offen lds
    s_add_u32 m0, s41, 4096
    s_nop 0
    buffer_load_dwordx4 v24, s[16:19], s33 offen lds
    s_waitcnt vmcnt(20)
    ds_read_b64_tr_b16 a[176:177], v25 offset:5120
    ds_read_b64_tr_b16 a[178:179], v25 offset:7680
    ds_read_b64_tr_b16 a[184:185], v25 offset:5184
    ds_read_b64_tr_b16 a[186:187], v25 offset:7744
    ds_read_b64_tr_b16 a[248:249], v25 offset:5248
    ds_read_b64_tr_b16 a[250:251], v25 offset:7808
    ds_read_b64_tr_b16 v[184:185], v25 offset:5312
    ds_read_b64_tr_b16 v[186:187], v25 offset:7872
    ds_read_b64_tr_b16 v[232:233], v25 offset:5376
    ds_read_b64_tr_b16 v[234:235], v25 offset:7936
    s_waitcnt lgkmcnt(0)
    s_add_u32 s33, s44, 225280
    s_add_u32 m0, s41, 5120
    s_nop 0
    buffer_load_dwordx4 v20, s[16:19], s33 offen lds
    s_add_u32 m0, s41, 6144
    s_nop 0
    buffer_load_dwordx4 v21, s[16:19], s33 offen lds
    s_add_u32 m0, s41, 7168
    s_nop 0
    buffer_load_dwordx4 v22, s[16:19], s33 offen lds
    s_add_u32 m0, s41, 8192
    s_nop 0
    buffer_load_dwordx4 v23, s[16:19], s33 offen lds
    s_add_u32 m0, s41, 9216
    s_nop 0
    buffer_load_dwordx4 v24, s[16:19], s33 offen lds
    s_waitcnt vmcnt(20)
    ds_read_b64_tr_b16 a[180:181], v25 offset:10240
    ds_read_b64_tr_b16 a[182:183], v25 offset:12800
    ds_read_b64_tr_b16 a[188:189], v25 offset:10304
    ds_read_b64_tr_b16 a[190:191], v25 offset:12864
    ds_read_b64_tr_b16 a[252:253], v25 offset:10368
    ds_read_b64_tr_b16 a[254:255], v25 offset:12928
    ds_read_b64_tr_b16 v[188:189], v25 offset:10432
    ds_read_b64_tr_b16 v[190:191], v25 offset:12992
    ds_read_b64_tr_b16 v[236:237], v25 offset:10496
    ds_read_b64_tr_b16 v[238:239], v25 offset:13056
    s_waitcnt lgkmcnt(0)
    s_waitcnt vmcnt(15)
    ds_read_b64_tr_b16 a[192:193], v25 offset:15360
    ds_read_b64_tr_b16 a[194:195], v25 offset:17920
    ds_read_b64_tr_b16 a[200:201], v25 offset:15424
    ds_read_b64_tr_b16 a[202:203], v25 offset:17984
    ds_read_b64_tr_b16 v[144:145], v25 offset:15488
    ds_read_b64_tr_b16 v[146:147], v25 offset:18048
    ds_read_b64_tr_b16 v[192:193], v25 offset:15552
    ds_read_b64_tr_b16 v[194:195], v25 offset:18112
    ds_read_b64_tr_b16 v[240:241], v25 offset:15616
    ds_read_b64_tr_b16 v[242:243], v25 offset:18176
    s_waitcnt lgkmcnt(0)
    s_waitcnt vmcnt(10)
    ds_read_b64_tr_b16 a[196:197], v25 offset:20480
    ds_read_b64_tr_b16 a[198:199], v25 offset:23040
    ds_read_b64_tr_b16 a[204:205], v25 offset:20544
    ds_read_b64_tr_b16 a[206:207], v25 offset:23104
    ds_read_b64_tr_b16 v[148:149], v25 offset:20608
    ds_read_b64_tr_b16 v[150:151], v25 offset:23168
    ds_read_b64_tr_b16 v[196:197], v25 offset:20672
    ds_read_b64_tr_b16 v[198:199], v25 offset:23232
    ds_read_b64_tr_b16 v[244:245], v25 offset:20736
    ds_read_b64_tr_b16 v[246:247], v25 offset:23296
    s_waitcnt lgkmcnt(0)
    s_waitcnt vmcnt(5)
    ds_read_b64_tr_b16 a[208:209], v25 offset:0
    ds_read_b64_tr_b16 a[210:211], v25 offset:2560
    ds_read_b64_tr_b16 a[216:217], v25 offset:64
    ds_read_b64_tr_b16 a[218:219], v25 offset:2624
    ds_read_b64_tr_b16 v[152:153], v25 offset:128
    ds_read_b64_tr_b16 v[154:155], v25 offset:2688
    ds_read_b64_tr_b16 v[200:201], v25 offset:192
    ds_read_b64_tr_b16 v[202:203], v25 offset:2752
    ds_read_b64_tr_b16 v[248:249], v25 offset:256
    ds_read_b64_tr_b16 v[250:251], v25 offset:2816
    s_waitcnt lgkmcnt(0)
    s_waitcnt vmcnt(0)
    ds_read_b64_tr_b16 a[212:213], v25 offset:5120
    ds_read_b64_tr_b16 a[214:215], v25 offset:7680
    ds_read_b64_tr_b16 a[220:221], v25 offset:5184
    ds_read_b64_tr_b16 a[222:223], v25 offset:7744
    ds_read_b64_tr_b16 v[156:157], v25 offset:5248
    ds_read_b64_tr_b16 v[158:159], v25 offset:7808
    ds_read_b64_tr_b16 v[204:205], v25 offset:5312
    ds_read_b64_tr_b16 v[206:207], v25 offset:7872
    ds_read_b64_tr_b16 v[252:253], v25 offset:5376
    ds_read_b64_tr_b16 v[254:255], v25 offset:7936
    s_waitcnt lgkmcnt(0)
    ds_write_b128 v26, v[32:35] offset:0
    ds_write_b128 v26, v[36:39] offset:1024
    ds_write_b128 v26, v[40:43] offset:2048
    ds_write_b128 v26, v[44:47] offset:3072
    ds_write_b128 v26, v[48:51] offset:4096
    ds_write_b128 v26, v[52:55] offset:5120
    ds_write_b128 v26, v[56:59] offset:6144
    ds_write_b128 v26, v[60:63] offset:7168
    ds_write_b128 v26, v[64:67] offset:8192
    ds_write_b128 v26, v[68:71] offset:9216
    ds_write_b128 v26, v[72:75] offset:10240
    ds_write_b128 v26, v[76:79] offset:11264
    ds_write_b128 v26, v[80:83] offset:12288
    ds_write_b128 v26, v[84:87] offset:13312
    ds_write_b128 v26, v[88:91] offset:14336
    ds_write_b128 v26, v[92:95] offset:15360
    ds_write_b128 v26, v[96:99] offset:16384
    ds_write_b128 v26, v[100:103] offset:17408
    ds_write_b128 v26, v[104:107] offset:18432
    ds_write_b128 v26, v[108:111] offset:19456
    ds_write_b128 v26, v[112:115] offset:20480
    ds_write_b128 v26, v[116:119] offset:21504
    ds_write_b128 v26, v[120:123] offset:22528
    ds_write_b128 v26, v[124:127] offset:23552
    ds_write_b128 v26, v[128:131] offset:24576
    ds_write_b128 v26, v[132:135] offset:25600
    ds_write_b128 v26, v[136:139] offset:26624
    ds_write_b128 v26, v[140:143] offset:27648
    s_waitcnt lgkmcnt(0)
    v_lshlrev_b32 v4, 4, v0
    v_add_u32 v5, 4096, v4
    v_add_u32 v6, 16384, v4
    v_add_u32 v7, s41, v4
    s_lshl_b32 s31, s5, 9
    s_add_u32 s31, s31, 919936
    v_mov_b32 v9, s31
    v_mov_b32 v1, 0x4444
    v_mov_b32 v2, 0xeeee
    v_and_b32 v3, 2, v0
    v_cmp_eq_u32 vcc, 0, v3
    s_nop 1
    v_cndmask_b32 v8, v2, v1, vcc
    v_and_b32 v1, 15, v0
    v_lshrrev_b32 v2, 4, v0
    s_mul_i32 s30, s3, 768
    s_add_u32 s30, s30, 114688
    v_lshl_add_u32 v10, v1, 4, s30
    v_lshl_add_u32 v10, v2, 2, v10
    v_and_b32 v3, 1, v2
    v_lshrrev_b32 v2, 1, v2
    v_lshlrev_b32 v13, 4, v1
    v_lshl_add_u32 v13, v3, 3, v13
    s_and_b32 s31, s40, 3
    s_lshl_b32 s31, s31, 8
    s_add_u32 s31, s31, 65536
    v_add_u32 v13, s31, v13
    s_mul_i32 s30, s3, 10
    v_add_u32 v14, s30, v2
    s_lshr_b32 s31, s40, 2
    v_add_u32 v15, s31, v14
    v_and_b32 v15, 7, v15
    v_lshl_add_u32 v15, v15, 10, v13
    v_lshl_add_u32 v128, v14, 14, v15
    v_add_u32 v14, 2, v14
    v_add_u32 v15, s31, v14
    v_and_b32 v15, 7, v15
    v_lshl_add_u32 v15, v15, 10, v13
    v_lshl_add_u32 v129, v14, 14, v15
    v_add_u32 v14, 2, v14
    v_add_u32 v15, s31, v14
    v_and_b32 v15, 7, v15
    v_lshl_add_u32 v15, v15, 10, v13
    v_lshl_add_u32 v130, v14, 14, v15
    v_add_u32 v14, 2, v14
    v_add_u32 v15, s31, v14
    v_and_b32 v15, 7, v15
    v_lshl_add_u32 v15, v15, 10, v13
    v_lshl_add_u32 v131, v14, 14, v15
    v_add_u32 v14, 2, v14
    v_add_u32 v15, s31, v14
    v_and_b32 v15, 7, v15
    v_lshl_add_u32 v15, v15, 10, v13
    v_lshl_add_u32 v132, v14, 14, v15
    v_add_u32 v14, 2, v14
    v_lshlrev_b32 v12, 8, v2
    v_lshl_add_u32 v12, v3, 6, v12
    v_bfe_u32 v1, v0, 3, 1
    v_lshl_add_u32 v12, v1, 7, v12
    v_bfe_u32 v1, v0, 2, 1
    v_lshl_add_u32 v12, v1, 4, v12
    v_and_b32 v1, 1, v0
    v_lshl_add_u32 v12, v1, 3, v12
    v_add_u32 v12, 114688, v12
    v_mov_b32 v1, 0x4444
    v_mov_b32 v2, 0xeeee
    v_and_b32 v3, 8, v0
    v_cmp_eq_u32 vcc, 0, v3
    s_nop 1
    v_cndmask_b32 v11, v2, v1, vcc
    v_mov_b32 v1, 4028416
L_fw_15:
    buffer_load_dwordx2 v[16:17], v1, s[8:11], 0 offen sc1
    s_add_u32 s7, s7, 1
    s_bitcmp1_b32 s7, 22
    s_cbranch_scc1 L_abort
    s_waitcnt vmcnt(0)
    v_cmp_ne_u32 vcc, s4, v17
    v_cmp_gt_u32 s[28:29], 1, v16
    s_or_b64 vcc, vcc, s[28:29]
    s_cbranch_scc1 L_fw_15
L_fe_16:
    v_readfirstlane_b32 s35, v16
    s_sub_u32 s35, s35, 1
    v_min_u32 v1, 39, v0
    v_lshlrev_b32 v1, 7, v1
    v_add_u32 v1, 4022272, v1
L_fw_18:
    buffer_load_dwordx2 v[16:17], v1, s[8:11], 0 offen sc1
    s_add_u32 s7, s7, 1
    s_bitcmp1_b32 s7, 22
    s_cbranch_scc1 L_abort
    s_waitcnt vmcnt(0)
    v_cmp_ne_u32 vcc, s4, v17
    v_cmp_gt_u32 s[28:29], 1, v16
    s_or_b64 vcc, vcc, s[28:29]
    s_cbranch_scc1 L_fw_18
L_fe_19:
    s_barrier
    s_mov_b32 s42, 0
L_b_step:
    s_lshl_b32 s30, s35, 13
    s_lshl_b32 s36, s42, 22
    s_add_u32 s36, s36, s30
    s_and_b32 s36, s36, 134217727
    s_mov_b64 s[38:39], -1
    s_mov_b32 s62, -1
    ds_read_b128 v[96:99], v7 offset:0
    ds_read_b128 v[100:103], v7 offset:1024
    ds_read_b128 v[104:107], v7 offset:2048
    ds_read_b128 v[108:111], v7 offset:3072
    ds_read_b128 v[112:115], v7 offset:4096
    ds_read_b128 v[116:119], v7 offset:5120
    v_mov_b32 v20, 0
    v_mov_b32 v21, 0
    v_mov_b32 v22, 0
    v_mov_b32 v23, 0
    v_mov_b32 v24, 0
    v_mov_b32 v25, 0
    v_mov_b32 v26, 0
    v_mov_b32 v27, 0
    v_mov_b32 v72, 0
    v_mov_b32 v73, 0
    v_mov_b32 v74, 0
    v_mov_b32 v75, 0
    v_mov_b32 v76, 0
    v_mov_b32 v77, 0
    v_mov_b32 v78, 0
    v_mov_b32 v79, 0
    v_mov_b32 v80, 0
    v_mov_b32 v81, 0
    v_mov_b32 v82, 0
    v_mov_b32 v83, 0
    v_mov_b32 v84, 0
    v_mov_b32 v85, 0
    v_mov_b32 v86, 0
    v_mov_b32 v87, 0
    v_mov_b32 v88, 0
    v_mov_b32 v89, 0
    v_mov_b32 v90, 0
    v_mov_b32 v91, 0
    s_cmp_eq_u32 s42, 0
    s_cbranch_scc1 L_b_go
    s_cmp_lg_u32 s3, 0
    s_cbranch_scc1 L_te_22
    s_mov_b64 exec, 1
    s_add_u32 s31, s4, s42
    s_lshl_b32 s30, s35, 13
    v_mov_b32 v19, s4
    v_add_u32 v19, -1, v19
L_tk_21:
    buffer_load_dword v19, v9, s[8:11], s30 offen sc1
    v_subrev_u32 v1, s31, v19
    v_cmp_lt_u32 vcc, 64, v1
    s_add_u32 s7, s7, 1
    s_bitcmp1_b32 s7, 22
    s_cbranch_scc1 L_abort
    s_waitcnt vmcnt(30)
    s_cbranch_vccnz L_tk_21
    s_mov_b64 exec, -1
L_te_22:
    s_barrier
L_b_go:
    buffer_load_dwordx4 v[32:35], v4, s[8:11], s36 offen offset:0 sc1
    v_mov_b32 v1, 0
    s_nop 3
    v_mov_b32 v1, 0
    s_nop 3
    v_mov_b32 v1, 0
    s_nop 3
    buffer_load_dwordx4 v[36:39], v4, s[8:11], s36 offen offset:1024 sc1
    v_mov_b32 v1, 0
    s_nop 3
    v_mov_b32 v1, 0
    s_nop 3
    v_mov_b32 v1, 0
    s_nop 3
    buffer_load_dwordx4 v[40:43], v4, s[8:11], s36 offen offset:2048 sc1
    v_mov_b32 v1, 0
    s_nop 3
    v_mov_b32 v1, 0
    s_nop 3
    v_mov_b32 v1, 0
    s_nop 3
    buffer_load_dwordx4 v[44:47], v4, s[8:11], s36 offen offset:3072 sc1
    v_mov_b32 v1, 0
    s_nop 3
    v_mov_b32 v1, 0
    s_nop 3
    v_mov_b32 v1, 0
    s_nop 3
    buffer_load_dwordx4 v[48:51], v5, s[8:11], s36 offen offset:0 sc1
    v_mov_b32 v1, 0
    s_nop 3
    v_mov_b32 v1, 0
    s_nop 3
    v_mov_b32 v1, 0
    s_nop 3
    buffer_load_dwordx4 v[52:55], v5, s[8:11], s36 offen offset:1024 sc1
    v_mov_b32 v1, 0
    s_nop 3
    v_mov_b32 v1, 0
    s_nop 3
    v_mov_b32 v1, 0
    s_nop 3
    buffer_load_dwordx4 v[56:59], v5, s[8:11], s36 offen offset:2048 sc1
    s_waitcnt vmcnt(6)
    v_smfmac_f32_16x16x64_bf16 v[20:23], v[32:35], a[0:7], v8
    s_waitcnt lgkmcnt(4)
    v_mov_b32_dpp v120, v32 quad_perm:[2,3,0,1] row_mask:0xf bank_mask:0xf
    v_mov_b32_dpp v121, v33 quad_perm:[2,3,0,1] row_mask:0xf bank_mask:0xf
    v_smfmac_f32_16x16x64_bf16 v[24:27], v[32:35], v[96:103], v8
    ds_read_b128 v[96:99], v7 offset:6144
    buffer_load_dwordx4 v[60:63], v5, s[8:11], s36 offen offset:3072 sc1
    v_mov_b32_dpp v122, v34 quad_perm:[2,3,0,1] row_mask:0xf bank_mask:0xf
    v_mov_b32_dpp v123, v35 quad_perm:[2,3,0,1] row_mask:0xf bank_mask:0xf
    s_waitcnt vmcnt(6)
    v_smfmac_f32_16x16x64_bf16 v[20:23], v[36:39], a[8:15], v8
    ds_read_b128 v[100:103], v7 offset:7168
    s_waitcnt lgkmcnt(4)
    v_mov_b32_dpp v124, v36 quad_perm:[2,3,0,1] row_mask:0xf bank_mask:0xf
    v_smfmac_f32_16x16x64_bf16 v[20:23], v[120:123], v[104:111], v8
    ds_read_b128 v[104:107], v7 offset:8192
    v_mov_b32_dpp v125, v37 quad_perm:[2,3,0,1] row_mask:0xf bank_mask:0xf
    v_smfmac_f32_16x16x64_bf16 v[24:27], v[36:39], a[16:23], v8
    ds_read_b128 v[108:111], v7 offset:9216
    buffer_load_dwordx4 v[64:67], v6, s[8:11], s36 offen offset:0 sc1
    s_waitcnt lgkmcnt(4)
    v_mov_b32_dpp v126, v38 quad_perm:[2,3,0,1] row_mask:0xf bank_mask:0xf
    v_mov_b32_dpp v127, v39 quad_perm:[2,3,0,1] row_mask:0xf bank_mask:0xf
    s_waitcnt vmcnt(6)
    v_smfmac_f32_16x16x64_bf16 v[20:23], v[40:43], v[112:119], v8
    ds_read_b128 v[112:115], v7 offset:10240
    v_mov_b32_dpp v120, v40 quad_perm:[2,3,0,1] row_mask:0xf bank_mask:0xf
    v_smfmac_f32_16x16x64_bf16 v[20:23], v[124:127], a[24:31], v8
    ds_read_b128 v[116:119], v7 offset:11264
    s_waitcnt lgkmcnt(4)
    v_mov_b32_dpp v121, v41 quad_perm:[2,3,0,1] row_mask:0xf bank_mask:0xf
    v_smfmac_f32_16x16x64_bf16 v[24:27], v[40:43], v[96:103], v8
    ds_read_b128 v[96:99], v7 offset:12288
    buffer_load_dwordx4 v[68:71], v6, s[8:11], s36 offen offset:1024 sc1
    v_mov_b32_dpp v122, v42 quad_perm:[2,3,0,1] row_mask:0xf bank_mask:0xf
    v_mov_b32_dpp v123, v43 quad_perm:[2,3,0,1] row_mask:0xf bank_mask:0xf
    s_waitcnt vmcnt(6)
    v_smfmac_f32_16x16x64_bf16 v[20:23], v[44:47], a[32:39], v8
    ds_read_b128 v[100:103], v7 offset:13312
    s_waitcnt lgkmcnt(4)
    v_mov_b32_dpp v124, v44 quad_perm:[2,3,0,1] row_mask:0xf bank_mask:0xf
    v_smfmac_f32_16x16x64_bf16 v[20:23], v[120:123], v[104:111], v8
    ds_read_b128 v[104:107], v7 offset:14336
    v_mov_b32_dpp v125, v45 quad_perm:[2,3,0,1] row_mask:0xf bank_mask:0xf
    v_smfmac_f32_16x16x64_bf16 v[24:27], v[44:47], a[40:47], v8
    ds_read_b128 v[108:111], v7 offset:15360
    s_waitcnt lgkmcnt(4)
    v_mov_b32_dpp v126, v46 quad_perm:[2,3,0,1] row_mask:0xf bank_mask:0xf
    v_mov_b32_dpp v127, v47 quad_perm:[2,3,0,1] row_mask:0xf bank_mask:0xf
    s_waitcnt vmcnt(5)
    v_smfmac_f32_16x16x64_bf16 v[20:23], v[48:51], v[112:119], v8
    ds_read_b128 v[112:115], v7 offset:16384
    v_mov_b32_dpp v120, v48 quad_perm:[2,3,0,1] row_mask:0xf bank_mask:0xf
    v_smfmac_f32_16x16x64_bf16 v[20:23], v[124:127], a[48:55], v8
    ds_read_b128 v[116:119], v7 offset:17408
    s_waitcnt lgkmcnt(4)
    v_mov_b32_dpp v121, v49 quad_perm:[2,3,0,1] row_mask:0xf bank_mask:0xf
    v_smfmac_f32_16x16x64_bf16 v[24:27], v[48:51], v[96:103], v8
    ds_read_b128 v[96:99], v7 offset:18432
    v_mov_b32_dpp v122, v50 quad_perm:[2,3,0,1] row_mask:0xf bank_mask:0xf
    v_mov_b32_dpp v123, v51 quad_perm:[2,3,0,1] row_mask:0xf bank_mask:0xf
    s_waitcnt vmcnt(4)
    v_smfmac_f32_16x16x64_bf16 v[20:23], v[52:55], a[56:63], v8
    ds_read_b128 v[100:103], v7 offset:19456
    s_waitcnt lgkmcnt(4)
    v_mov_b32_dpp v124, v52 quad_perm:[2,3,0,1] row_mask:0xf bank_mask:0xf
    v_smfmac_f32_16x16x64_bf16 v[20:23], v[120:123], v[104:111], v8
    ds_read_b128 v[104:107], v7 offset:20480
    v_mov_b32_dpp v125, v53 quad_perm:[2,3,0,1] row_mask:0xf bank_mask:0xf
    v_smfmac_f32_16x16x64_bf16 v[24:27], v[52:55], a[64:71], v8
    ds_read_b128 v[108:111], v7 offset:21504
    s_waitcnt lgkmcnt(4)
    v_mov_b32_dpp v126, v54 quad_perm:[2,3,0,1] row_mask:0xf bank_mask:0xf
    v_mov_b32_dpp v127, v55 quad_perm:[2,3,0,1] row_mask:0xf bank_mask:0xf
    s_waitcnt vmcnt(3)
    v_smfmac_f32_16x16x64_bf16 v[20:23], v[56:59], v[112:119], v8
    ds_read_b128 v[112:115], v7 offset:22528
    v_mov_b32_dpp v120, v56 quad_perm:[2,3,0,1] row_mask:0xf bank_mask:0xf
    v_smfmac_f32_16x16x64_bf16 v[20:23], v[124:127], a[72:79], v8
    ds_read_b128 v[116:119], v7 offset:23552
    s_waitcnt lgkmcnt(4)
    v_mov_b32_dpp v121, v57 quad_perm:[2,3,0,1] row_mask:0xf bank_mask:0xf
    v_smfmac_f32_16x16x64_bf16 v[24:27], v[56:59], v[96:103], v8
    ds_read_b128 v[96:99], v7 offset:24576
    v_mov_b32_dpp v122, v58 quad_perm:[2,3,0,1] row_mask:0xf bank_mask:0xf
    v_mov_b32_dpp v123, v59 quad_perm:[2,3,0,1] row_mask:0xf bank_mask:0xf
    s_waitcnt vmcnt(2)
    v_smfmac_f32_16x16x64_bf16 v[20:23], v[60:63], a[80:87], v8
    ds_read_b128 v[100:103], v7 offset:25600
    s_waitcnt lgkmcnt(4)
    v_mov_b32_dpp v124, v60 quad_perm:[2,3,0,1] row_mask:0xf bank_mask:0xf
    v_smfmac_f32_16x16x64_bf16 v[20:23], v[120:123], v[104:111], v8
    ds_read_b128 v[104:107], v7 offset:26624
    v_mov_b32_dpp v125, v61 quad_perm:[2,3,0,1] row_mask:0xf bank_mask:0xf
    v_smfmac_f32_16x16x64_bf16 v[24:27], v[60:63], a[88:95], v8
    ds_read_b128 v[108:111], v7 offset:27648
    s_waitcnt lgkmcnt(4)
    v_mov_b32_dpp v126, v62 quad_perm:[2,3,0,1] row_mask:0xf bank_mask:0xf
    v_mov_b32_dpp v127, v63 quad_perm:[2,3,0,1] row_mask:0xf bank_mask:0xf
    s_waitcnt vmcnt(1)
    v_smfmac_f32_16x16x64_bf16 v[20:23], v[64:67], v[112:119], v8
    v_mov_b32_dpp v120, v64 quad_perm:[2,3,0,1] row_mask:0xf bank_mask:0xf
    v_smfmac_f32_16x16x64_bf16 v[20:23], v[124:127], a[96:103], v8
    s_waitcnt lgkmcnt(2)
    v_mov_b32_dpp v121, v65 quad_perm:[2,3,0,1] row_mask:0xf bank_mask:0xf
    v_smfmac_f32_16x16x64_bf16 v[24:27], v[64:67], v[96:103], v8
    v_mov_b32_dpp v122, v66 quad_perm:[2,3,0,1] row_mask:0xf bank_mask:0xf
    v_mov_b32_dpp v123, v67 quad_perm:[2,3,0,1] row_mask:0xf bank_mask:0xf
    s_waitcnt vmcnt(0)
    v_smfmac_f32_16x16x64_bf16 v[20:23], v[68:71], a[104:111], v8
    s_waitcnt lgkmcnt(0)
    v_mov_b32_dpp v124, v68 quad_perm:[2,3,0,1] row_mask:0xf bank_mask:0xf
    v_mov_b32_dpp v125, v69 quad_perm:[2,3,0,1] row_mask:0xf bank_mask:0xf
    v_smfmac_f32_16x16x64_bf16 v[20:23], v[120:123], v[104:111], v8
    v_mov_b32_dpp v126, v70 quad_perm:[2,3,0,1] row_mask:0xf bank_mask:0xf
    v_mov_b32_dpp v127, v71 quad_perm:[2,3,0,1] row_mask:0xf bank_mask:0xf
    v_smfmac_f32_16x16x64_bf16 v[24:27], v[68:71], a[112:119], v8
    s_nop 0
    v_smfmac_f32_16x16x64_bf16 v[20:23], v[124:127], a[120:127], v8
    s_nop 4
    v_add_f32 v24, v24, v26
    v_add_f32 v25, v25, v27
    v_cvt_pk_bf16_f32 v26, v24, v25
    ds_write_b32 v10, v26 offset:512
    v_cvt_pk_bf16_f32 v20, v20, v21
    v_cvt_pk_bf16_f32 v21, v22, v23
    ds_write2_b32 v10, v20, v21 offset0:0 offset1:64
    v_cmp_u_f32 vcc, v24, v25
    s_and_b64 vcc, vcc, s[38:39]
    s_cbranch_scc1 L_b_slow
    s_waitcnt lgkmcnt(0)
    s_barrier
    ds_read_b64_tr_b16 v[32:33], v12 offset:0
    ds_read_b64_tr_b16 v[34:35], v12 offset:32
    ds_read_b64_tr_b16 v[36:37], v12 offset:512
    ds_read_b64_tr_b16 v[38:39], v12 offset:544
    ds_read_b64_tr_b16 v[40:41], v12 offset:1024
    ds_read_b64_tr_b16 v[42:43], v12 offset:1056
    ds_read_b64_tr_b16 v[44:45], v12 offset:1536
    ds_read_b64_tr_b16 v[46:47], v12 offset:1568
    ds_read_b64_tr_b16 v[48:49], v12 offset:2048
    ds_read_b64_tr_b16 v[50:51], v12 offset:2080
    ds_read_b64_tr_b16 v[52:53], v12 offset:2560
    ds_read_b64_tr_b16 v[54:55], v12 offset:2592
    s_waitcnt lgkmcnt(10)
    v_smfmac_f32_16x16x64_bf16 v[72:75], v[32:35], a[128:135], v11
    v_smfmac_f32_16x16x64_bf16 v[76:79], v[32:35], a[136:143], v11
    s_waitcnt lgkmcnt(8)
    v_smfmac_f32_16x16x64_bf16 v[72:75], v[36:39], a[144:151], v11
    v_smfmac_f32_16x16x64_bf16 v[76:79], v[36:39], a[152:159], v11
    s_waitcnt lgkmcnt(6)
    v_smfmac_f32_16x16x64_bf16 v[72:75], v[40:43], a[160:167], v11
    v_smfmac_f32_16x16x64_bf16 v[76:79], v[40:43], a[168:175], v11
    s_waitcnt lgkmcnt(4)
    v_smfmac_f32_16x16x64_bf16 v[72:75], v[44:47], a[176:183], v11
    v_smfmac_f32_16x16x64_bf16 v[76:79], v[44:47], a[184:191], v11
    s_waitcnt lgkmcnt(2)
    v_smfmac_f32_16x16x64_bf16 v[72:75], v[48:51], a[192:199], v11
    v_smfmac_f32_16x16x64_bf16 v[76:79], v[48:51], a[200:207], v11
    s_waitcnt lgkmcnt(0)
    v_smfmac_f32_16x16x64_bf16 v[72:75], v[52:55], a[208:215], v11
    v_smfmac_f32_16x16x64_bf16 v[76:79], v[52:55], a[216:223], v11
    v_smfmac_f32_16x16x64_bf16 v[80:83], v[32:35], a[224:231], v11
    v_smfmac_f32_16x16x64_bf16 v[80:83], v[36:39], a[232:239], v11
    v_cvt_pk_bf16_f32 v72, v72, v73
    v_smfmac_f32_16x16x64_bf16 v[80:83], v[40:43], a[240:247], v11
    v_cvt_pk_bf16_f32 v73, v74, v75
    v_smfmac_f32_16x16x64_bf16 v[80:83], v[44:47], a[248:255], v11
    buffer_store_dwordx2 v[72:73], v128, s[8:11], s36 offen sc1
    v_smfmac_f32_16x16x64_bf16 v[80:83], v[48:51], v[144:151], v11
    v_cvt_pk_bf16_f32 v76, v76, v77
    v_smfmac_f32_16x16x64_bf16 v[80:83], v[52:55], v[152:159], v11
    v_cvt_pk_bf16_f32 v77, v78, v79
    v_smfmac_f32_16x16x64_bf16 v[84:87], v[32:35], v[160:167], v11
    buffer_store_dwordx2 v[76:77], v129, s[8:11], s36 offen sc1
    v_smfmac_f32_16x16x64_bf16 v[84:87], v[36:39], v[168:175], v11
    v_smfmac_f32_16x16x64_bf16 v[84:87], v[40:43], v[176:183], v11
    v_cvt_pk_bf16_f32 v80, v80, v81
    v_smfmac_f32_16x16x64_bf16 v[84:87], v[44:47], v[184:191], v11
    v_cvt_pk_bf16_f32 v81, v82, v83
    v_smfmac_f32_16x16x64_bf16 v[84:87], v[48:51], v[192:199], v11
    buffer_store_dwordx2 v[80:81], v130, s[8:11], s36 offen sc1
    v_smfmac_f32_16x16x64_bf16 v[84:87], v[52:55], v[200:207], v11
    v_smfmac_f32_16x16x64_bf16 v[88:91], v[32:35], v[208:215], v11
    v_smfmac_f32_16x16x64_bf16 v[88:91], v[36:39], v[216:223], v11
    v_smfmac_f32_16x16x64_bf16 v[88:91], v[40:43], v[224:231], v11
    v_cvt_pk_bf16_f32 v84, v84, v85
    v_smfmac_f32_16x16x64_bf16 v[88:91], v[44:47], v[232:239], v11
    v_cvt_pk_bf16_f32 v85, v86, v87
    v_smfmac_f32_16x16x64_bf16 v[88:91], v[48:51], v[240:247], v11
    buffer_store_dwordx2 v[84:85], v131, s[8:11], s36 offen sc1
    v_smfmac_f32_16x16x64_bf16 v[88:91], v[52:55], v[248:255], v11
    s_nop 7
    v_cvt_pk_bf16_f32 v88, v88, v89
    v_cvt_pk_bf16_f32 v89, v90, v91
    buffer_store_dwordx2 v[88:89], v132, s[8:11], s36 offen sc1
    s_or_b32 s30, s42, s3
    s_cbranch_scc1 L_b_d0
    s_add_u32 s30, s40, 31600
    s_lshl_b32 s30, s30, 7
    v_mov_b32 v1, s30
    v_mov_b32 v2, 1
    v_mov_b32 v3, s4
    buffer_store_dwordx2 v[2:3], v1, s[8:11], 0 offen sc1
L_b_d0:
    s_add_u32 s42, s42, 1
    s_cmp_lt_u32 s42, 64
    s_cbranch_scc1 L_b_step
    s_endpgm
L_b_slow:
    s_waitcnt vmcnt(0) lgkmcnt(0)
    ds_read_b128 v[96:99], v7 offset:0
    ds_read_b128 v[100:103], v7 offset:1024
    ds_read_b128 v[104:107], v7 offset:2048
    ds_read_b128 v[108:111], v7 offset:3072
    ds_read_b128 v[112:115], v7 offset:4096
    ds_read_b128 v[116:119], v7 offset:5120
    v_mov_b32 v20, 0
    v_mov_b32 v21, 0
    v_mov_b32 v22, 0
    v_mov_b32 v23, 0
    v_mov_b32 v24, 0
    v_mov_b32 v25, 0
    v_mov_b32 v26, 0
    v_mov_b32 v27, 0
    v_mov_b32 v72, 0
    v_mov_b32 v73, 0
    v_mov_b32 v74, 0
    v_mov_b32 v75, 0
    v_mov_b32 v76, 0
    v_mov_b32 v77, 0
    v_mov_b32 v78, 0
    v_mov_b32 v79, 0
    v_mov_b32 v80, 0
    v_mov_b32 v81, 0
    v_mov_b32 v82, 0
    v_mov_b32 v83, 0
    v_mov_b32 v84, 0
    v_mov_b32 v85, 0
    v_mov_b32 v86, 0
    v_mov_b32 v87, 0
    v_mov_b32 v88, 0
    v_mov_b32 v89, 0
    v_mov_b32 v90, 0
    v_mov_b32 v91, 0
    s_lshl_b32 s62, s62, 8
    s_cbranch_scc1 L_b_go
L_b_sp:
    buffer_load_dwordx4 v[32:35], v4, s[8:11], s36 offen offset:0 sc1
    buffer_load_dwordx4 v[36:39], v4, s[8:11], s36 offen offset:1024 sc1
    buffer_load_dwordx4 v[40:43], v4, s[8:11], s36 offen offset:2048 sc1
    buffer_load_dwordx4 v[44:47], v4, s[8:11], s36 offen offset:3072 sc1
    buffer_load_dwordx4 v[48:51], v5, s[8:11], s36 offen offset:0 sc1
    buffer_load_dwordx4 v[52:55], v5, s[8:11], s36 offen offset:1024 sc1
    buffer_load_dwordx4 v[56:59], v5, s[8:11], s36 offen offset:2048 sc1
    buffer_load_dwordx4 v[60:63], v5, s[8:11], s36 offen offset:3072 sc1
    buffer_load_dwordx4 v[64:67], v6, s[8:11], s36 offen offset:0 sc1
    buffer_load_dwordx4 v[68:71], v6, s[8:11], s36 offen offset:1024 sc1
    s_add_u32 s7, s7, 1
    s_bitcmp1_b32 s7, 22
    s_cbranch_scc1 L_abort
    s_waitcnt vmcnt(0)
    v_mov_b32 v1, 0
    v_and_b32 v2, 0x7fff7fff, v32
    v_pk_max_u16 v1, v1, v2
    v_and_b32 v2, 0x7fff7fff, v33
    v_pk_max_u16 v1, v1, v2
    v_and_b32 v2, 0x7fff7fff, v34
    v_pk_max_u16 v1, v1, v2
    v_and_b32 v2, 0x7fff7fff, v35
    v_pk_max_u16 v1, v1, v2
    v_and_b32 v2, 0x7fff7fff, v36
    v_pk_max_u16 v1, v1, v2
    v_and_b32 v2, 0x7fff7fff, v37
    v_pk_max_u16 v1, v1, v2
    v_and_b32 v2, 0x7fff7fff, v38
    v_pk_max_u16 v1, v1, v2
    v_and_b32 v2, 0x7fff7fff, v39
    v_pk_max_u16 v1, v1, v2
    v_and_b32 v2, 0x7fff7fff, v40
    v_pk_max_u16 v1, v1, v2
    v_and_b32 v2, 0x7fff7fff, v41
    v_pk_max_u16 v1, v1, v2
    v_and_b32 v2, 0x7fff7fff, v42
    v_pk_max_u16 v1, v1, v2
    v_and_b32 v2, 0x7fff7fff, v43
    v_pk_max_u16 v1, v1, v2
    v_and_b32 v2, 0x7fff7fff, v44
    v_pk_max_u16 v1, v1, v2
    v_and_b32 v2, 0x7fff7fff, v45
    v_pk_max_u16 v1, v1, v2
    v_and_b32 v2, 0x7fff7fff, v46
    v_pk_max_u16 v1, v1, v2
    v_and_b32 v2, 0x7fff7fff, v47
    v_pk_max_u16 v1, v1, v2
    v_and_b32 v2, 0x7fff7fff, v48
    v_pk_max_u16 v1, v1, v2
    v_and_b32 v2, 0x7fff7fff, v49
    v_pk_max_u16 v1, v1, v2
    v_and_b32 v2, 0x7fff7fff, v50
    v_pk_max_u16 v1, v1, v2
    v_and_b32 v2, 0x7fff7fff, v51
    v_pk_max_u16 v1, v1, v2
    v_and_b32 v2, 0x7fff7fff, v52
    v_pk_max_u16 v1, v1, v2
    v_and_b32 v2, 0x7fff7fff, v53
    v_pk_max_u16 v1, v1, v2
    v_and_b32 v2, 0x7fff7fff, v54
    v_pk_max_u16 v1, v1, v2
    v_and_b32 v2, 0x7fff7fff, v55
    v_pk_max_u16 v1, v1, v2
    v_and_b32 v2, 0x7fff7fff, v56
    v_pk_max_u16 v1, v1, v2
    v_and_b32 v2, 0x7fff7fff, v57
    v_pk_max_u16 v1, v1, v2
    v_and_b32 v2, 0x7fff7fff, v58
    v_pk_max_u16 v1, v1, v2
    v_and_b32 v2, 0x7fff7fff, v59
    v_pk_max_u16 v1, v1, v2
    v_and_b32 v2, 0x7fff7fff, v60
    v_pk_max_u16 v1, v1, v2
    v_and_b32 v2, 0x7fff7fff, v61
    v_pk_max_u16 v1, v1, v2
    v_and_b32 v2, 0x7fff7fff, v62
    v_pk_max_u16 v1, v1, v2
    v_and_b32 v2, 0x7fff7fff, v63
    v_pk_max_u16 v1, v1, v2
    v_and_b32 v2, 0x7fff7fff, v64
    v_pk_max_u16 v1, v1, v2
    v_and_b32 v2, 0x7fff7fff, v65
    v_pk_max_u16 v1, v1, v2
    v_and_b32 v2, 0x7fff7fff, v66
    v_pk_max_u16 v1, v1, v2
    v_and_b32 v2, 0x7fff7fff, v67
    v_pk_max_u16 v1, v1, v2
    v_and_b32 v2, 0x7fff7fff, v68
    v_pk_max_u16 v1, v1, v2
    v_and_b32 v2, 0x7fff7fff, v69
    v_pk_max_u16 v1, v1, v2
    v_and_b32 v2, 0x7fff7fff, v70
    v_pk_max_u16 v1, v1, v2
    v_and_b32 v2, 0x7fff7fff, v71
    v_pk_max_u16 v1, v1, v2
    v_lshrrev_b32 v2, 16, v1
    v_and_b32 v1, 0xffff, v1
    v_max_u32 v1, v1, v2
    v_cmp_lt_u32 vcc, 0x7f81, v1
    s_cbranch_vccnz L_b_sp
    s_mov_b64 s[38:39], 0
    s_branch L_b_go
L_r:
    s_cmp_gt_u32 s3, 1
    s_cbranch_scc1 L_end
    s_mul_i32 s40, s5, 10
    s_add_u32 s40, s40, s6
    s_sub_u32 s40, s40, 16
    s_mov_b32 s97, 0
    v_mov_b32 v25, s4
    s_or_b32 s30, s40, s3
    s_cbranch_scc1 L_r_nop
    v_mov_b32 v1, 4096000
    s_mov_b32 s44, -1
    s_mov_b32 s45, -1
    s_memtime s[46:47]
    s_waitcnt lgkmcnt(0)
    buffer_store_dword v25, v1, s[8:11], 0 offen sc1
    s_waitcnt vmcnt(0)
    s_memtime s[48:49]
    s_waitcnt lgkmcnt(0)
    s_sub_u32 s46, s48, s46
    s_min_u32 s44, s44, s46
    v_xor_b32 v1, 0x2000, v1
    s_memtime s[46:47]
    s_waitcnt lgkmcnt(0)
    buffer_store_dword v25, v1, s[8:11], 0 offen sc1
    s_waitcnt vmcnt(0)
    s_memtime s[48:49]
    s_waitcnt lgkmcnt(0)
    s_sub_u32 s46, s48, s46
    s_min_u32 s45, s45, s46
    v_xor_b32 v1, 0x2000, v1
    s_memtime s[46:47]
    s_waitcnt lgkmcnt(0)
    buffer_store_dword v25, v1, s[8:11], 0 offen sc1
    s_waitcnt vmcnt(0)
    s_memtime s[48:49]
    s_waitcnt lgkmcnt(0)
    s_sub_u32 s46, s48, s46
    s_min_u32 s44, s44, s46
    v_xor_b32 v1, 0x2000, v1
    s_memtime s[46:47]
    s_waitcnt lgkmcnt(0)
    buffer_store_dword v25, v1, s[8:11], 0 offen sc1
    s_waitcnt vmcnt(0)
    s_memtime s[48:49]
    s_waitcnt lgkmcnt(0)
    s_sub_u32 s46, s48, s46
    s_min_u32 s45, s45, s46
    v_xor_b32 v1, 0x2000, v1
    s_memtime s[46:47]
    s_waitcnt lgkmcnt(0)
    buffer_store_dword v25, v1, s[8:11], 0 offen sc1
    s_waitcnt vmcnt(0)
    s_memtime s[48:49]
    s_waitcnt lgkmcnt(0)
    s_sub_u32 s46, s48, s46
    s_min_u32 s44, s44, s46
    v_xor_b32 v1, 0x2000, v1
    s_memtime s[46:47]
    s_waitcnt lgkmcnt(0)
    buffer_store_dword v25, v1, s[8:11], 0 offen sc1
    s_waitcnt vmcnt(0)
    s_memtime s[48:49]
    s_waitcnt lgkmcnt(0)
    s_sub_u32 s46, s48, s46
    s_min_u32 s45, s45, s46
    v_xor_b32 v1, 0x2000, v1
    s_memtime s[46:47]
    s_waitcnt lgkmcnt(0)
    buffer_store_dword v25, v1, s[8:11], 0 offen sc1
    s_waitcnt vmcnt(0)
    s_memtime s[48:49]
    s_waitcnt lgkmcnt(0)
    s_sub_u32 s46, s48, s46
    s_min_u32 s44, s44, s46
    v_xor_b32 v1, 0x2000, v1
    s_memtime s[46:47]
    s_waitcnt lgkmcnt(0)
    buffer_store_dword v25, v1, s[8:11], 0 offen sc1
    s_waitcnt vmcnt(0)
    s_memtime s[48:49]
    s_waitcnt lgkmcnt(0)
    s_sub_u32 s46, s48, s46
    s_min_u32 s45, s45, s46
    v_xor_b32 v1, 0x2000, v1
    s_cmp_lt_u32 s44, s45
    s_cselect_b32 s46, 2, 1
    s_mov_b32 s30, 31472
    s_lshl_b32 s30, s30, 7
    s_lshl_b32 s31, s3, 3
    s_add_u32 s30, s30, s31
    v_mov_b32 v26, s30
    v_mov_b32 v1, 2130706432
    v_cmp_eq_u32 vcc, 0, v0
    s_nop 1
    v_cndmask_b32 v26, v1, v26, vcc
    v_mov_b32 v24, s46
    buffer_store_dwordx2 v[24:25], v26, s[8:11], 0 offen sc1
L_r_nop:
    v_mov_b32 v1, 0x4444
    v_mov_b32 v2, 0xeeee
    v_and_b32 v3, 2, v0
    v_cmp_eq_u32 vcc, 0, v3
    s_nop 1
    v_cndmask_b32 v27, v2, v1, vcc
    v_lshlrev_b32 v2, 4, v0
    v_add_u32 v4, 20480, v2
    v_add_u32 v5, 32768, v2
    v_add_u32 v6, 36864, v2
    v_add_u32 v7, 49152, v2
    v_add_u32 v8, 53248, v2
    s_add_u32 s30, s40, 4
    s_lshl_b32 s30, s30, 14
    v_add_u32 v9, s30, v2
    v_mov_b32 v28, v2
    s_add_u32 s30, s40, 0
    s_and_b32 s30, s30, 7
    s_lshl_b32 s30, s30, 10
    v_add_u32 v148, s30, v28
    s_add_u32 s30, s40, 1
    s_and_b32 s30, s30, 7
    s_lshl_b32 s30, s30, 10
    v_add_u32 v149, s30, v28
    s_add_u32 s30, s40, 2
    s_and_b32 s30, s30, 7
    s_lshl_b32 s30, s30, 10
    v_add_u32 v150, s30, v28
    s_add_u32 s30, s40, 3
    s_and_b32 s30, s30, 7
    s_lshl_b32 s30, s30, 10
    v_add_u32 v151, s30, v28
    s_add_u32 s30, s40, 4
    s_and_b32 s30, s30, 7
    s_lshl_b32 s30, s30, 10
    v_add_u32 v152, s30, v28
    s_add_u32 s30, s40, 5
    s_and_b32 s30, s30, 7
    s_lshl_b32 s30, s30, 10
    v_add_u32 v153, s30, v28
    s_add_u32 s30, s40, 6
    s_and_b32 s30, s30, 7
    s_lshl_b32 s30, s30, 10
    v_add_u32 v154, s30, v28
    s_add_u32 s30, s40, 7
    s_and_b32 s30, s30, 7
    s_lshl_b32 s30, s30, 10
    v_add_u32 v155, s30, v28
    s_add_u32 s30, s40, 0
    s_and_b32 s30, s30, 7
    s_lshl_b32 s30, s30, 10
    v_add_u32 v156, s30, v9
    s_add_u32 s30, s40, 1
    s_and_b32 s30, s30, 7
    s_lshl_b32 s30, s30, 10
    v_add_u32 v157, s30, v9
    s_add_u32 s30, s40, 2
    s_and_b32 s30, s30, 7
    s_lshl_b32 s30, s30, 10
    v_add_u32 v158, s30, v9
    s_add_u32 s30, s40, 3
    s_and_b32 s30, s30, 7
    s_lshl_b32 s30, s30, 10
    v_add_u32 v159, s30, v9
    s_add_u32 s30, s40, 4
    s_and_b32 s30, s30, 7
    s_lshl_b32 s30, s30, 10
    v_add_u32 v160, s30, v9
    s_add_u32 s30, s40, 5
    s_and_b32 s30, s30, 7
    s_lshl_b32 s30, s30, 10
    v_add_u32 v161, s30, v9
    s_add_u32 s30, s40, 6
    s_and_b32 s30, s30, 7
    s_lshl_b32 s30, s30, 10
    v_add_u32 v162, s30, v9
    s_add_u32 s30, s40, 7
    s_and_b32 s30, s30, 7
    s_lshl_b32 s30, s30, 10
    v_add_u32 v163, s30, v9
    v_lshrrev_b32 v1, 4, v0
    v_and_b32 v3, 1, v0
    v_lshlrev_b32 v11, 6, v1
    v_lshl_add_u32 v11, v3, 4, v11
    v_lshl_add_u32 v1, v1, 1, v3
    v_bfe_u32 v2, v0, 1, 3
    v_mul_u32_u24 v18, 1280, v1
    v_lshl_add_u32 v18, v2, 2, v18
    s_lshl_b32 s30, s40, 5
    v_add_u32 v18, s30, v18
    v_and_b32 v3, 1, v2
    v_lshl_add_u32 v11, v3, 5, v11
    v_lshrrev_b32 v2, 1, v2
    v_lshl_add_u32 v11, v2, 2, v11
    s_lshl_b32 s30, s40, 8
    s_lshr_b32 s31, s40, 5
    s_lshl_b32 s31, s31, 13
    s_add_u32 s41, s30, s31
    v_add_u32 v11, s41, v11
    v_mov_b32 v1, 0x01000504
    v_mov_b32 v2, 0x07060302
    v_and_b32 v3, 1, v0
    v_cmp_eq_u32 vcc, 0, v3
    s_nop 1
    v_cndmask_b32 v19, v2, v1, vcc
    s_lshl_b32 s30, s40, 9
    s_add_u32 s30, s30, 12288
    s_lshr_b32 s31, s30, 13
    s_lshl_b32 s31, s31, 13
    s_add_u32 s30, s30, s31
    v_add_u32 v1, s30, v28
    s_sub_u32 s30, s41, 512
    v_add_u32 v2, s30, v28
    v_cmp_gt_u32 vcc, 32, v0
    s_nop 1
    v_cndmask_b32 v29, v2, v1, vcc
    s_lshl_b32 s30, s40, 7
    s_add_u32 s30, s30, 720128
    v_add_u32 v1, s30, v28
    v_cmp_gt_u32 vcc, 48, v0
    s_nop 1
    v_cndmask_b32 v29, v1, v29, vcc
    v_mov_b32 v1, 2130706432
    v_cmp_gt_u32 vcc, 56, v0
    s_nop 1
    v_cndmask_b32 v29, v1, v29, vcc
    v_and_b32 v15, 31, v0
    v_lshlrev_b32 v15, 7, v15
    s_lshl_b32 s30, s5, 3
    s_add_u32 s30, s30, 4009984
    v_add_u32 v15, s30, v15
    s_xor_b32 s30, s6, 16
    s_xor_b32 s31, s5, 3
    s_or_b32 s30, s30, s31
    s_lshl_b32 s31, s5, 7
    s_add_u32 s31, s31, 919552
    v_sub_u32 v14, s5, v0
    v_add_u32 v14, 3, v14
    v_and_b32 v14, 3, v14
    v_lshlrev_b32 v14, 9, v14
    v_add_u32 v14, s31, v14
    v_mov_b32 v1, 2130706432
    s_lshl_b32 s31, s30, 6
    v_or_b32 v2, s31, v0
    v_cmp_gt_u32 vcc, 4, v2
    s_nop 1
    v_cndmask_b32 v14, v1, v14, vcc
    s_lshl_b32 s31, s5, 9
    s_add_u32 s31, s31, 917632
    v_mov_b32 v12, s31
    s_lshl_b32 s31, s5, 9
    s_add_u32 s31, s31, 919936
    v_mov_b32 v13, s31
    s_lshr_b32 s30, s40, 2
    s_lshl_b32 s30, s30, 14
    s_and_b32 s31, s40, 3
    s_lshl_b32 s31, s31, 11
    s_add_u32 s30, s30, s31
    s_add_u32 s30, s30, 737280
    v_add_u32 v120, s30, v28
    v_mov_b32 v112, -1
    v_mov_b32 v113, -1
    v_mov_b32 v114, -1
    v_mov_b32 v115, -1
    v_mov_b32 v1, 4028416
L_fw_23:
    buffer_load_dwordx2 v[16:17], v1, s[8:11], 0 offen sc1
    s_add_u32 s7, s7, 1
    s_bitcmp1_b32 s7, 22
    s_cbranch_scc1 L_abort
    s_waitcnt vmcnt(0)
    v_cmp_ne_u32 vcc, s4, v17
    v_cmp_gt_u32 s[28:29], 1, v16
    s_or_b64 vcc, vcc, s[28:29]
    s_cbranch_scc1 L_fw_23
L_fe_24:
    v_readfirstlane_b32 s35, v16
    s_sub_u32 s35, s35, 1
    s_cmp_eq_u32 s3, 1
    s_cbranch_scc1 L_pf
    s_mov_b32 s12, s72
    s_mov_b32 s13, s73
    s_mov_b32 s14, 10240
    s_mov_b32 s15, 0x20000
    buffer_load_dword v20, v18, s[12:15], 0 offen
    s_mov_b32 s42, 3
    s_lshl_b32 s30, s35, 13
    s_lshl_b32 s36, s42, 22
    s_add_u32 s36, s36, s30
    s_and_b32 s36, s36, 134217727
    buffer_store_dwordx4 v[112:115], v156, s[8:11], s36 offen sc1
    buffer_store_dwordx4 v[112:115], v157, s[8:11], s36 offen sc1
    buffer_store_dwordx4 v[112:115], v158, s[8:11], s36 offen sc1
    buffer_store_dwordx4 v[112:115], v159, s[8:11], s36 offen sc1
    buffer_store_dwordx4 v[112:115], v160, s[8:11], s36 offen sc1
    buffer_store_dwordx4 v[112:115], v161, s[8:11], s36 offen sc1
    buffer_store_dwordx4 v[112:115], v162, s[8:11], s36 offen sc1
    buffer_store_dwordx4 v[112:115], v163, s[8:11], s36 offen sc1
    buffer_store_dwordx4 v[112:115], v120, s[8:11], s36 offen offset:0 sc1
    buffer_store_dwordx4 v[112:115], v120, s[8:11], s36 offen offset:1024 sc1
    buffer_store_dwordx4 v[112:115], v29, s[8:11], s36 offen sc1
    s_mov_b32 s42, 2
    s_lshl_b32 s30, s35, 13
    s_lshl_b32 s36, s42, 22
    s_add_u32 s36, s36, s30
    s_and_b32 s36, s36, 134217727
    buffer_store_dwordx4 v[112:115], v156, s[8:11], s36 offen sc1
    buffer_store_dwordx4 v[112:115], v157, s[8:11], s36 offen sc1
    buffer_store_dwordx4 v[112:115], v158, s[8:11], s36 offen sc1
    buffer_store_dwordx4 v[112:115], v159, s[8:11], s36 offen sc1
    buffer_store_dwordx4 v[112:115], v160, s[8:11], s36 offen sc1
    buffer_store_dwordx4 v[112:115], v161, s[8:11], s36 offen sc1
    buffer_store_dwordx4 v[112:115], v162, s[8:11], s36 offen sc1
    buffer_store_dwordx4 v[112:115], v163, s[8:11], s36 offen sc1
    buffer_store_dwordx4 v[112:115], v120, s[8:11], s36 offen offset:0 sc1
    buffer_store_dwordx4 v[112:115], v120, s[8:11], s36 offen offset:1024 sc1
    buffer_store_dwordx4 v[112:115], v29, s[8:11], s36 offen sc1
    s_mov_b32 s42, 1
    s_lshl_b32 s30, s35, 13
    s_lshl_b32 s36, s42, 22
    s_add_u32 s36, s36, s30
    s_and_b32 s36, s36, 134217727
    buffer_store_dwordx4 v[112:115], v156, s[8:11], s36 offen sc1
    buffer_store_dwordx4 v[112:115], v157, s[8:11], s36 offen sc1
    buffer_store_dwordx4 v[112:115], v158, s[8:11], s36 offen sc1
    buffer_store_dwordx4 v[112:115], v159, s[8:11], s36 offen sc1
    buffer_store_dwordx4 v[112:115], v160, s[8:11], s36 offen sc1
    buffer_store_dwordx4 v[112:115], v161, s[8:11], s36 offen sc1
    buffer_store_dwordx4 v[112:115], v162, s[8:11], s36 offen sc1
    buffer_store_dwordx4 v[112:115], v163, s[8:11], s36 offen sc1
    buffer_store_dwordx4 v[112:115], v120, s[8:11], s36 offen offset:0 sc1
    buffer_store_dwordx4 v[112:115], v120, s[8:11], s36 offen offset:1024 sc1
    buffer_store_dwordx4 v[112:115], v29, s[8:11], s36 offen sc1
    s_mov_b32 s42, 0
    s_lshl_b32 s30, s35, 13
    s_lshl_b32 s36, s42, 22
    s_add_u32 s36, s36, s30
    s_and_b32 s36, s36, 134217727
    buffer_store_dwordx4 v[112:115], v156, s[8:11], s36 offen sc1
    buffer_store_dwordx4 v[112:115], v157, s[8:11], s36 offen sc1
    buffer_store_dwordx4 v[112:115], v158, s[8:11], s36 offen sc1
    buffer_store_dwordx4 v[112:115], v159, s[8:11], s36 offen sc1
    buffer_store_dwordx4 v[112:115], v160, s[8:11], s36 offen sc1
    buffer_store_dwordx4 v[112:115], v161, s[8:11], s36 offen sc1
    buffer_store_dwordx4 v[112:115], v162, s[8:11], s36 offen sc1
    buffer_store_dwordx4 v[112:115], v163, s[8:11], s36 offen sc1
    buffer_store_dwordx4 v[112:115], v120, s[8:11], s36 offen offset:0 sc1
    buffer_store_dwordx4 v[112:115], v120, s[8:11], s36 offen offset:1024 sc1
    buffer_store_dwordx4 v[112:115], v29, s[8:11], s36 offen sc1
    s_waitcnt vmcnt(0)
    v_mov_b32 v1, 0x7f817f81
    v_and_b32 v2, 0x7fff7fff, v20
    v_pk_min_u16 v2, v2, v1
    v_and_b32 v20, 0x80008000, v20
    v_or_b32 v20, v20, v2
    buffer_store_dword v20, v11, s[8:11], s36 offen sc1
    s_add_u32 s30, s40, 31424
    s_lshl_b32 s30, s30, 7
    s_lshl_b32 s31, s3, 3
    s_add_u32 s30, s30, s31
    v_mov_b32 v26, s30
    v_mov_b32 v1, 2130706432
    v_cmp_eq_u32 vcc, 0, v0
    s_nop 1
    v_cndmask_b32 v26, v1, v26, vcc
    s_waitcnt vmcnt(0)
    v_mov_b32 v24, 1
    buffer_store_dwordx2 v[24:25], v26, s[8:11], 0 offen sc1
    v_mov_b32 v16, 0
    s_mov_b32 s43, 0
    s_bfe_u32 s30, s40, 0x10003
    s_xor_b32 s30, s30, 0
    s_lshl_b32 s56, s40, 2
    s_add_u32 s30, s30, s56
    s_lshl_b32 s56, s30, 13
    s_add_u32 s56, s56, 1048576
    s_bfe_u32 s30, s40, 0x10003
    s_xor_b32 s30, s30, 1
    s_lshl_b32 s57, s40, 2
    s_add_u32 s30, s30, s57
    s_lshl_b32 s57, s30, 13
    s_add_u32 s57, s57, 1048576
    s_bfe_u32 s30, s40, 0x10003
    s_xor_b32 s30, s30, 2
    s_lshl_b32 s58, s40, 2
    s_add_u32 s30, s30, s58
    s_lshl_b32 s58, s30, 13
    s_add_u32 s58, s58, 1048576
    s_bfe_u32 s30, s40, 0x10003
    s_xor_b32 s30, s30, 3
    s_lshl_b32 s59, s40, 2
    s_add_u32 s30, s30, s59
    s_lshl_b32 s59, s30, 13
    s_add_u32 s59, s59, 1048576
    s_lshl_b32 s47, s35, 13
    v_min_u32 v1, 39, v0
    v_lshlrev_b32 v1, 7, v1
    v_add_u32 v1, 4022272, v1
L_fw_26:
    buffer_load_dwordx2 v[16:17], v1, s[8:11], 0 offen sc1
    s_add_u32 s7, s7, 1
    s_bitcmp1_b32 s7, 22
    s_cbranch_scc1 L_abort
    s_waitcnt vmcnt(0)
    v_cmp_ne_u32 vcc, s4, v17
    v_cmp_gt_u32 s[28:29], 1, v16
    s_or_b64 vcc, vcc, s[28:29]
    s_cbranch_scc1 L_fw_26
L_fe_27:
L_fw_29:
    buffer_load_dwordx2 v[16:17], v15, s[8:11], 0 offen sc1
    s_add_u32 s7, s7, 1
    s_bitcmp1_b32 s7, 22
    s_cbranch_scc1 L_abort
    s_waitcnt vmcnt(0)
    v_cmp_ne_u32 vcc, s4, v17
    v_cmp_gt_u32 s[28:29], 1, v16
    s_or_b64 vcc, vcc, s[28:29]
    s_cbranch_scc1 L_fw_29
L_fe_30:
    s_add_u32 s46, s43, s56
    buffer_load_dwordx4 a[0:3], v148, s[8:11], s46 offen sc1
    buffer_load_dwordx4 a[4:7], v149, s[8:11], s46 offen sc1
    buffer_load_dwordx4 a[8:11], v150, s[8:11], s46 offen sc1
    buffer_load_dwordx4 a[12:15], v151, s[8:11], s46 offen sc1
    buffer_load_dwordx4 a[16:19], v152, s[8:11], s46 offen sc1
    buffer_load_dwordx4 a[20:23], v153, s[8:11], s46 offen sc1
    buffer_load_dwordx4 a[24:27], v154, s[8:11], s46 offen sc1
    buffer_load_dwordx4 a[28:31], v155, s[8:11], s46 offen sc1
    s_add_u32 s46, s43, s57
    buffer_load_dwordx4 a[32:35], v148, s[8:11], s46 offen sc1
    buffer_load_dwordx4 a[36:39], v149, s[8:11], s46 offen sc1
    buffer_load_dwordx4 a[40:43], v150, s[8:11], s46 offen sc1
    buffer_load_dwordx4 a[44:47], v151, s[8:11], s46 offen sc1
    buffer_load_dwordx4 a[48:51], v152, s[8:11], s46 offen sc1
    buffer_load_dwordx4 a[52:55], v153, s[8:11], s46 offen sc1
    buffer_load_dwordx4 a[56:59], v154, s[8:11], s46 offen sc1
    buffer_load_dwordx4 a[60:63], v155, s[8:11], s46 offen sc1
    s_add_u32 s46, s43, s58
    buffer_load_dwordx4 a[64:67], v148, s[8:11], s46 offen sc1
    buffer_load_dwordx4 a[68:71], v149, s[8:11], s46 offen sc1
    buffer_load_dwordx4 a[72:75], v150, s[8:11], s46 offen sc1
    buffer_load_dwordx4 a[76:79], v151, s[8:11], s46 offen sc1
    buffer_load_dwordx4 a[80:83], v152, s[8:11], s46 offen sc1
    buffer_load_dwordx4 a[84:87], v153, s[8:11], s46 offen sc1
    buffer_load_dwordx4 a[88:91], v154, s[8:11], s46 offen sc1
    buffer_load_dwordx4 a[92:95], v155, s[8:11], s46 offen sc1
    s_add_u32 s46, s43, s59
    buffer_load_dwordx4 a[96:99], v148, s[8:11], s46 offen sc1
    buffer_load_dwordx4 a[100:103], v149, s[8:11], s46 offen sc1
    buffer_load_dwordx4 a[104:107], v150, s[8:11], s46 offen sc1
    buffer_load_dwordx4 a[108:111], v151, s[8:11], s46 offen sc1
    buffer_load_dwordx4 a[112:115], v152, s[8:11], s46 offen sc1
    buffer_load_dwordx4 a[116:119], v153, s[8:11], s46 offen sc1
    buffer_load_dwordx4 a[120:123], v154, s[8:11], s46 offen sc1
    buffer_load_dwordx4 a[124:127], v155, s[8:11], s46 offen sc1
    s_add_u32 s43, s43, 4194304
    s_and_b32 s43, s43, 134217727
L_r_step:
    s_add_u32 s44, s42, 1
    s_lshl_b32 s30, s35, 13
    s_lshl_b32 s37, s44, 22
    s_add_u32 s37, s37, s30
    s_and_b32 s37, s37, 134217727
    s_mov_b64 s[38:39], -1
    s_add_u32 s30, s4, s44
    v_mov_b32 v25, s30
    v_mov_b32 v124, 0
    v_mov_b32 v125, 0
    v_mov_b32 v126, 0
    v_mov_b32 v127, 0
    v_mov_b32 v128, 0
    v_mov_b32 v129, 0
    v_mov_b32 v130, 0
    v_mov_b32 v131, 0
    v_mov_b32 v132, 0
    v_mov_b32 v133, 0
    v_mov_b32 v134, 0
    v_mov_b32 v135, 0
    v_mov_b32 v136, 0
    v_mov_b32 v137, 0
    v_mov_b32 v138, 0
    v_mov_b32 v139, 0
    s_cmp_eq_u32 s42, 0
    s_cbranch_scc1 L_r_first
    s_mov_b64 exec, 1
    s_add_u32 s31, s4, s42
    s_lshl_b32 s30, s35, 13
    v_mov_b32 v30, s4
    v_add_u32 v30, -1, v30
L_tk_32:
    buffer_load_dword v30, v12, s[8:11], s30 offen sc1
    v_subrev_u32 v1, s31, v30
    v_cmp_lt_u32 vcc, 64, v1
    s_add_u32 s7, s7, 1
    s_bitcmp1_b32 s7, 22
    s_cbranch_scc1 L_abort
    s_waitcnt vmcnt(30)
    s_cbranch_vccnz L_tk_32
    s_mov_b64 exec, -1
L_r_go:
    buffer_load_dwordx4 a[136:139], v158, s[8:11], s36 offen sc1
    buffer_load_dwordx4 a[140:143], v159, s[8:11], s36 offen sc1
    buffer_load_dwordx4 a[128:131], v156, s[8:11], s36 offen sc1
    buffer_load_dwordx4 a[132:135], v157, s[8:11], s36 offen sc1
    buffer_load_dwordx4 a[144:147], v160, s[8:11], s36 offen sc1
    buffer_load_dwordx4 a[148:151], v161, s[8:11], s36 offen sc1
    buffer_load_dwordx4 a[152:155], v162, s[8:11], s36 offen sc1
    buffer_load_dwordx4 a[156:159], v163, s[8:11], s36 offen sc1
    buffer_load_dwordx4 v[48:51], v5, s[8:11], s36 offen offset:0 sc1
    buffer_load_dwordx4 v[52:55], v5, s[8:11], s36 offen offset:1024 sc1
    buffer_load_dwordx4 v[56:59], v5, s[8:11], s36 offen offset:2048 sc1
    buffer_load_dwordx4 v[60:63], v5, s[8:11], s36 offen offset:3072 sc1
    buffer_load_dwordx4 v[32:35], v4, s[8:11], s36 offen offset:0 sc1
    buffer_load_dwordx4 v[36:39], v4, s[8:11], s36 offen offset:1024 sc1
    buffer_load_dwordx4 v[40:43], v4, s[8:11], s36 offen offset:2048 sc1
    buffer_load_dwordx4 v[44:47], v4, s[8:11], s36 offen offset:3072 sc1
    buffer_load_dwordx4 v[64:67], v6, s[8:11], s36 offen offset:0 sc1
    buffer_load_dwordx4 v[68:71], v6, s[8:11], s36 offen offset:1024 sc1
    buffer_load_dwordx4 v[100:103], v8, s[8:11], s36 offen offset:1024 sc1
    buffer_load_dwordx4 v[72:75], v6, s[8:11], s36 offen offset:2048 sc1
    buffer_load_dwordx4 v[76:79], v6, s[8:11], s36 offen offset:3072 sc1
    buffer_load_dwordx4 v[96:99], v8, s[8:11], s36 offen offset:0 sc1
    buffer_load_dwordx4 v[80:83], v7, s[8:11], s36 offen offset:0 sc1
    buffer_load_dwordx4 v[84:87], v7, s[8:11], s36 offen offset:1024 sc1
    buffer_load_dwordx4 v[104:107], v8, s[8:11], s36 offen offset:2048 sc1
    buffer_load_dwordx4 v[88:91], v7, s[8:11], s36 offen offset:2048 sc1
    buffer_load_dwordx4 v[92:95], v7, s[8:11], s36 offen offset:3072 sc1
    buffer_load_dwordx4 v[108:111], v8, s[8:11], s36 offen offset:3072 sc1
    s_waitcnt vmcnt(19)
    v_smfmac_f32_16x16x64_bf16 v[128:131], v[48:51], a[32:39], v27
    s_waitcnt vmcnt(18)
    v_smfmac_f32_16x16x64_bf16 v[128:131], v[52:55], a[40:47], v27
    s_waitcnt vmcnt(17)
    v_smfmac_f32_16x16x64_bf16 v[128:131], v[56:59], a[48:55], v27
    s_waitcnt vmcnt(16)
    v_smfmac_f32_16x16x64_bf16 v[128:131], v[60:63], a[56:63], v27
    s_waitcnt vmcnt(15)
    v_smfmac_f32_16x16x64_bf16 v[124:127], v[32:35], a[0:7], v27
    s_waitcnt vmcnt(14)
    v_smfmac_f32_16x16x64_bf16 v[124:127], v[36:39], a[8:15], v27
    s_waitcnt vmcnt(13)
    v_smfmac_f32_16x16x64_bf16 v[124:127], v[40:43], a[16:23], v27
    s_waitcnt vmcnt(12)
    v_smfmac_f32_16x16x64_bf16 v[124:127], v[44:47], a[24:31], v27
    s_waitcnt vmcnt(11)
    v_smfmac_f32_16x16x64_bf16 v[132:135], v[64:67], a[64:71], v27
    buffer_store_dword v25, v14, s[8:11], s47 offen sc1
    s_waitcnt vmcnt(11)
    v_smfmac_f32_16x16x64_bf16 v[132:135], v[68:71], a[72:79], v27
    s_waitcnt vmcnt(10)
    v_smfmac_f32_16x16x64_bf16 v[128:131], v[100:103], a[136:143], v27
    s_waitcnt vmcnt(9)
    v_smfmac_f32_16x16x64_bf16 v[132:135], v[72:75], a[80:87], v27
    s_waitcnt vmcnt(8)
    v_smfmac_f32_16x16x64_bf16 v[132:135], v[76:79], a[88:95], v27
    s_waitcnt vmcnt(7)
    v_smfmac_f32_16x16x64_bf16 v[124:127], v[96:99], a[128:135], v27
    s_waitcnt vmcnt(6)
    v_add_f32 v142, v128, v130
    v_smfmac_f32_16x16x64_bf16 v[136:139], v[80:83], a[96:103], v27
    s_waitcnt vmcnt(5)
    v_add_f32 v143, v129, v131
    v_smfmac_f32_16x16x64_bf16 v[136:139], v[84:87], a[104:111], v27
    s_waitcnt vmcnt(4)
    v_smfmac_f32_16x16x64_bf16 v[132:135], v[104:107], a[144:151], v27
    s_waitcnt vmcnt(3)
    v_add_f32 v140, v124, v126
    v_smfmac_f32_16x16x64_bf16 v[136:139], v[88:91], a[112:119], v27
    s_waitcnt vmcnt(2)
    v_add_f32 v141, v125, v127
    v_smfmac_f32_16x16x64_bf16 v[136:139], v[92:95], a[120:127], v27
    s_waitcnt vmcnt(1)
    v_add_f32 v20, v142, v140
    v_smfmac_f32_16x16x64_bf16 v[136:139], v[108:111], a[152:159], v27
    v_add_f32 v21, v143, v141
    v_add_f32 v144, v132, v134
    v_add_f32 v145, v133, v135
    v_add_f32 v20, v20, v144
    v_add_f32 v21, v21, v145
    s_nop 2
    v_add_f32 v146, v136, v138
    v_add_f32 v147, v137, v139
    v_add_f32 v20, v20, v146
    v_add_f32 v21, v21, v147
L_r_pack:
    v_cvt_pk_bf16_f32 v22, v20, v21
    v_cmp_u_f32 vcc, v20, v21
    s_nop 0
    v_mov_b32_dpp v23, v22 quad_perm:[1,0,3,2] row_mask:0xf bank_mask:0xf
    v_perm_b32 v22, v22, v23, v19
    buffer_store_dword v22, v11, s[8:11], s37 offen sc1
    s_cbranch_vccnz L_r_slow
L_r_ok:
    s_barrier
    s_cmp_eq_u32 s42, 62
    s_cbranch_scc1 L_r_done
    s_add_u32 s45, s42, 2
    v_cmp_ne_u32 vcc, s4, v17
    v_cmp_gt_u32 s[28:29], s45, v16
    s_or_b64 vcc, vcc, s[28:29]
    s_cbranch_scc0 L_fe_35
L_fw_34:
    buffer_load_dwordx2 v[16:17], v15, s[8:11], 0 offen sc1
    s_add_u32 s7, s7, 1
    s_bitcmp1_b32 s7, 22
    s_cbranch_scc1 L_abort
    s_waitcnt vmcnt(0)
    v_cmp_ne_u32 vcc, s4, v17
    v_cmp_gt_u32 s[28:29], s45, v16
    s_or_b64 vcc, vcc, s[28:29]
    s_cbranch_scc1 L_fw_34
L_fe_35:
    buffer_load_dwordx2 v[16:17], v15, s[8:11], 0 offen sc1
    s_add_u32 s46, s43, s56
    buffer_load_dwordx4 a[0:3], v148, s[8:11], s46 offen sc1
    s_nop 9
    buffer_load_dwordx4 a[4:7], v149, s[8:11], s46 offen sc1
    s_nop 9
    buffer_load_dwordx4 a[8:11], v150, s[8:11], s46 offen sc1
    s_nop 9
    buffer_load_dwordx4 a[12:15], v151, s[8:11], s46 offen sc1
    s_nop 9
    buffer_load_dwordx4 a[16:19], v152, s[8:11], s46 offen sc1
    s_nop 9
    buffer_load_dwordx4 a[20:23], v153, s[8:11], s46 offen sc1
    s_nop 9
    buffer_load_dwordx4 a[24:27], v154, s[8:11], s46 offen sc1
    s_nop 9
    buffer_load_dwordx4 a[28:31], v155, s[8:11], s46 offen sc1
    s_nop 9
    s_add_u32 s46, s43, s57
    buffer_load_dwordx4 a[32:35], v148, s[8:11], s46 offen sc1
    s_nop 9
    buffer_load_dwordx4 a[36:39], v149, s[8:11], s46 offen sc1
    s_nop 9
    buffer_load_dwordx4 a[40:43], v150, s[8:11], s46 offen sc1
    s_nop 9
    buffer_load_dwordx4 a[44:47], v151, s[8:11], s46 offen sc1
    s_nop 9
    buffer_load_dwordx4 a[48:51], v152, s[8:11], s46 offen sc1
    s_nop 9
    buffer_load_dwordx4 a[52:55], v153, s[8:11], s46 offen sc1
    s_nop 9
    buffer_load_dwordx4 a[56:59], v154, s[8:11], s46 offen sc1
    s_nop 9
    buffer_load_dwordx4 a[60:63], v155, s[8:11], s46 offen sc1
    s_nop 9
    s_add_u32 s46, s43, s58
    buffer_load_dwordx4 a[64:67], v148, s[8:11], s46 offen sc1
    s_nop 9
    buffer_load_dwordx4 a[68:71], v149, s[8:11], s46 offen sc1
    s_nop 9
    buffer_load_dwordx4 a[72:75], v150, s[8:11], s46 offen sc1
    s_nop 9
    buffer_load_dwordx4 a[76:79], v151, s[8:11], s46 offen sc1
    s_nop 9
    buffer_load_dwordx4 a[80:83], v152, s[8:11], s46 offen sc1
    s_nop 9
    buffer_load_dwordx4 a[84:87], v153, s[8:11], s46 offen sc1
    s_nop 9
    buffer_load_dwordx4 a[88:91], v154, s[8:11], s46 offen sc1
    s_nop 9
    buffer_load_dwordx4 a[92:95], v155, s[8:11], s46 offen sc1
    s_nop 9
    s_add_u32 s46, s43, s59
    buffer_load_dwordx4 a[96:99], v148, s[8:11], s46 offen sc1
    s_nop 9
    buffer_load_dwordx4 a[100:103], v149, s[8:11], s46 offen sc1
    s_nop 9
    buffer_load_dwordx4 a[104:107], v150, s[8:11], s46 offen sc1
    s_nop 9
    buffer_load_dwordx4 a[108:111], v151, s[8:11], s46 offen sc1
    s_nop 9
    buffer_load_dwordx4 a[112:115], v152, s[8:11], s46 offen sc1
    s_nop 9
    buffer_load_dwordx4 a[116:119], v153, s[8:11], s46 offen sc1
    s_nop 9
    buffer_load_dwordx4 a[120:123], v154, s[8:11], s46 offen sc1
    s_nop 9
    buffer_load_dwordx4 a[124:127], v155, s[8:11], s46 offen sc1
    s_nop 9
    s_add_u32 s43, s43, 4194304
    s_and_b32 s43, s43, 134217727
    s_mov_b32 s36, s37
    s_mov_b32 s42, s44
    s_branch L_r_step
L_r_done:
    s_endpgm
L_r_first:
    v_lshlrev_b32 v1, 7, v0
    v_add_u32 v1, 4040704, v1
L_fw_37:
    buffer_load_dwordx2 v[2:3], v1, s[8:11], 0 offen sc1
    s_add_u32 s7, s7, 1
    s_bitcmp1_b32 s7, 22
    s_cbranch_scc1 L_abort
    s_waitcnt vmcnt(0)
    v_cmp_ne_u32 vcc, s4, v3
    v_cmp_gt_u32 s[28:29], 1, v2
    s_or_b64 vcc, vcc, s[28:29]
    s_cbranch_scc1 L_fw_37
L_fe_38:
    s_branch L_r_go
L_r_slow:
    s_cmp_lg_u32 s38, 0
    s_cbranch_scc1 L_r_slow2
    v_mov_b32 v1, 0x7f817f81
    v_and_b32 v2, 0x7fff7fff, v22
    v_pk_min_u16 v2, v2, v1
    v_and_b32 v22, 0x80008000, v22
    v_or_b32 v22, v22, v2
    s_waitcnt vmcnt(0)
    buffer_store_dword v22, v11, s[8:11], s37 offen sc1
    s_branch L_r_ok
L_r_slow2:
    s_lshl_b32 s39, s39, 2
    s_cbranch_scc0 L_r_sp
    v_cmp_u_f32 s[48:49], v140, v141
    v_cmp_u_f32 s[50:51], v142, v143
    v_cmp_u_f32 s[52:53], v144, v145
    v_cmp_u_f32 s[54:55], v146, v147
    s_cmp_eq_u64 s[48:49], 0
    s_cbranch_scc1 L_r_l0
    buffer_load_dwordx4 v[32:35], v4, s[8:11], s36 offen offset:0 sc1
    buffer_load_dwordx4 v[36:39], v4, s[8:11], s36 offen offset:1024 sc1
    buffer_load_dwordx4 v[40:43], v4, s[8:11], s36 offen offset:2048 sc1
    buffer_load_dwordx4 v[44:47], v4, s[8:11], s36 offen offset:3072 sc1
    buffer_load_dwordx4 v[96:99], v8, s[8:11], s36 offen offset:0 sc1
    buffer_load_dwordx4 a[128:131], v156, s[8:11], s36 offen sc1
    buffer_load_dwordx4 a[132:135], v157, s[8:11], s36 offen sc1
    v_mov_b32 v124, 0
    v_mov_b32 v125, 0
    v_mov_b32 v126, 0
    v_mov_b32 v127, 0
L_r_l0:
    s_cmp_eq_u64 s[50:51], 0
    s_cbranch_scc1 L_r_l1
    buffer_load_dwordx4 v[48:51], v5, s[8:11], s36 offen offset:0 sc1
    buffer_load_dwordx4 v[52:55], v5, s[8:11], s36 offen offset:1024 sc1
    buffer_load_dwordx4 v[56:59], v5, s[8:11], s36 offen offset:2048 sc1
    buffer_load_dwordx4 v[60:63], v5, s[8:11], s36 offen offset:3072 sc1
    buffer_load_dwordx4 v[100:103], v8, s[8:11], s36 offen offset:1024 sc1
    buffer_load_dwordx4 a[136:139], v158, s[8:11], s36 offen sc1
    buffer_load_dwordx4 a[140:143], v159, s[8:11], s36 offen sc1
    v_mov_b32 v128, 0
    v_mov_b32 v129, 0
    v_mov_b32 v130, 0
    v_mov_b32 v131, 0
L_r_l1:
    s_cmp_eq_u64 s[52:53], 0
    s_cbranch_scc1 L_r_l2
    buffer_load_dwordx4 v[64:67], v6, s[8:11], s36 offen offset:0 sc1
    buffer_load_dwordx4 v[68:71], v6, s[8:11], s36 offen offset:1024 sc1
    buffer_load_dwordx4 v[72:75], v6, s[8:11], s36 offen offset:2048 sc1
    buffer_load_dwordx4 v[76:79], v6, s[8:11], s36 offen offset:3072 sc1
    buffer_load_dwordx4 v[104:107], v8, s[8:11], s36 offen offset:2048 sc1
    buffer_load_dwordx4 a[144:147], v160, s[8:11], s36 offen sc1
    buffer_load_dwordx4 a[148:151], v161, s[8:11], s36 offen sc1
    v_mov_b32 v132, 0
    v_mov_b32 v133, 0
    v_mov_b32 v134, 0
    v_mov_b32 v135, 0
L_r_l2:
    s_cmp_eq_u64 s[54:55], 0
    s_cbranch_scc1 L_r_l3
    buffer_load_dwordx4 v[80:83], v7, s[8:11], s36 offen offset:0 sc1
    buffer_load_dwordx4 v[84:87], v7, s[8:11], s36 offen offset:1024 sc1
    buffer_load_dwordx4 v[88:91], v7, s[8:11], s36 offen offset:2048 sc1
    buffer_load_dwordx4 v[92:95], v7, s[8:11], s36 offen offset:3072 sc1
    buffer_load_dwordx4 v[108:111], v8, s[8:11], s36 offen offset:3072 sc1
    buffer_load_dwordx4 a[152:155], v162, s[8:11], s36 offen sc1
    buffer_load_dwordx4 a[156:159], v163, s[8:11], s36 offen sc1
    v_mov_b32 v136, 0
    v_mov_b32 v137, 0
    v_mov_b32 v138, 0
    v_mov_b32 v139, 0
L_r_l3:
    s_waitcnt vmcnt(0)
    s_cmp_eq_u64 s[48:49], 0
    s_cbranch_scc1 L_r_m0
    v_smfmac_f32_16x16x64_bf16 v[124:127], v[32:35], a[0:7], v27
    v_smfmac_f32_16x16x64_bf16 v[124:127], v[36:39], a[8:15], v27
    v_smfmac_f32_16x16x64_bf16 v[124:127], v[40:43], a[16:23], v27
    v_smfmac_f32_16x16x64_bf16 v[124:127], v[44:47], a[24:31], v27
    v_smfmac_f32_16x16x64_bf16 v[124:127], v[96:99], a[128:135], v27
L_r_m0:
    s_cmp_eq_u64 s[50:51], 0
    s_cbranch_scc1 L_r_m1
    v_smfmac_f32_16x16x64_bf16 v[128:131], v[48:51], a[32:39], v27
    v_smfmac_f32_16x16x64_bf16 v[128:131], v[52:55], a[40:47], v27
    v_smfmac_f32_16x16x64_bf16 v[128:131], v[56:59], a[48:55], v27
    v_smfmac_f32_16x16x64_bf16 v[128:131], v[60:63], a[56:63], v27
    v_smfmac_f32_16x16x64_bf16 v[128:131], v[100:103], a[136:143], v27
L_r_m1:
    s_cmp_eq_u64 s[52:53], 0
    s_cbranch_scc1 L_r_m2
    v_smfmac_f32_16x16x64_bf16 v[132:135], v[64:67], a[64:71], v27
    v_smfmac_f32_16x16x64_bf16 v[132:135], v[68:71], a[72:79], v27
    v_smfmac_f32_16x16x64_bf16 v[132:135], v[72:75], a[80:87], v27
    v_smfmac_f32_16x16x64_bf16 v[132:135], v[76:79], a[88:95], v27
    v_smfmac_f32_16x16x64_bf16 v[132:135], v[104:107], a[144:151], v27
L_r_m2:
    s_cmp_eq_u64 s[54:55], 0
    s_cbranch_scc1 L_r_m3
    v_smfmac_f32_16x16x64_bf16 v[136:139], v[80:83], a[96:103], v27
    v_smfmac_f32_16x16x64_bf16 v[136:139], v[84:87], a[104:111], v27
    v_smfmac_f32_16x16x64_bf16 v[136:139], v[88:91], a[112:119], v27
    v_smfmac_f32_16x16x64_bf16 v[136:139], v[92:95], a[120:127], v27
    v_smfmac_f32_16x16x64_bf16 v[136:139], v[108:111], a[152:159], v27
L_r_m3:
    s_nop 7
    v_add_f32 v142, v128, v130
    v_add_f32 v143, v129, v131
    v_add_f32 v140, v124, v126
    v_add_f32 v141, v125, v127
    v_add_f32 v20, v142, v140
    v_add_f32 v21, v143, v141
    v_add_f32 v144, v132, v134
    v_add_f32 v145, v133, v135
    v_add_f32 v20, v20, v144
    v_add_f32 v21, v21, v145
    v_add_f32 v146, v136, v138
    v_add_f32 v147, v137, v139
    v_add_f32 v20, v20, v146
    v_add_f32 v21, v21, v147
    s_branch L_r_pack
L_r_sp:
    buffer_load_dwordx4 a[128:131], v156, s[8:11], s36 offen sc1
    buffer_load_dwordx4 a[132:135], v157, s[8:11], s36 offen sc1
    buffer_load_dwordx4 a[136:139], v158, s[8:11], s36 offen sc1
    buffer_load_dwordx4 a[140:143], v159, s[8:11], s36 offen sc1
    buffer_load_dwordx4 a[144:147], v160, s[8:11], s36 offen sc1
    buffer_load_dwordx4 a[148:151], v161, s[8:11], s36 offen sc1
    buffer_load_dwordx4 a[152:155], v162, s[8:11], s36 offen sc1
    buffer_load_dwordx4 a[156:159], v163, s[8:11], s36 offen sc1
    buffer_load_dwordx4 v[32:35], v4, s[8:11], s36 offen offset:0 sc1
    buffer_load_dwordx4 v[36:39], v4, s[8:11], s36 offen offset:1024 sc1
    buffer_load_dwordx4 v[40:43], v4, s[8:11], s36 offen offset:2048 sc1
    buffer_load_dwordx4 v[44:47], v4, s[8:11], s36 offen offset:3072 sc1
    buffer_load_dwordx4 v[48:51], v5, s[8:11], s36 offen offset:0 sc1
    buffer_load_dwordx4 v[52:55], v5, s[8:11], s36 offen offset:1024 sc1
    buffer_load_dwordx4 v[56:59], v5, s[8:11], s36 offen offset:2048 sc1
    buffer_load_dwordx4 v[60:63], v5, s[8:11], s36 offen offset:3072 sc1
    buffer_load_dwordx4 v[64:67], v6, s[8:11], s36 offen offset:0 sc1
    buffer_load_dwordx4 v[68:71], v6, s[8:11], s36 offen offset:1024 sc1
    buffer_load_dwordx4 v[72:75], v6, s[8:11], s36 offen offset:2048 sc1
    buffer_load_dwordx4 v[76:79], v6, s[8:11], s36 offen offset:3072 sc1
    buffer_load_dwordx4 v[80:83], v7, s[8:11], s36 offen offset:0 sc1
    buffer_load_dwordx4 v[84:87], v7, s[8:11], s36 offen offset:1024 sc1
    buffer_load_dwordx4 v[88:91], v7, s[8:11], s36 offen offset:2048 sc1
    buffer_load_dwordx4 v[92:95], v7, s[8:11], s36 offen offset:3072 sc1
    buffer_load_dwordx4 v[96:99], v8, s[8:11], s36 offen offset:0 sc1
    buffer_load_dwordx4 v[100:103], v8, s[8:11], s36 offen offset:1024 sc1
    buffer_load_dwordx4 v[104:107], v8, s[8:11], s36 offen offset:2048 sc1
    buffer_load_dwordx4 v[108:111], v8, s[8:11], s36 offen offset:3072 sc1
    s_add_u32 s7, s7, 1
    s_bitcmp1_b32 s7, 22
    s_cbranch_scc1 L_abort
    s_waitcnt vmcnt(0)
    v_mov_b32 v116, 0
    v_accvgpr_read_b32 v117, a128
    v_max_u32 v116, v116, v117
    v_accvgpr_read_b32 v117, a129
    v_max_u32 v116, v116, v117
    v_accvgpr_read_b32 v117, a130
    v_max_u32 v116, v116, v117
    v_accvgpr_read_b32 v117, a131
    v_max_u32 v116, v116, v117
    v_accvgpr_read_b32 v117, a132
    v_max_u32 v116, v116, v117
    v_accvgpr_read_b32 v117, a133
    v_max_u32 v116, v116, v117
    v_accvgpr_read_b32 v117, a134
    v_max_u32 v116, v116, v117
    v_accvgpr_read_b32 v117, a135
    v_max_u32 v116, v116, v117
    v_accvgpr_read_b32 v117, a136
    v_max_u32 v116, v116, v117
    v_accvgpr_read_b32 v117, a137
    v_max_u32 v116, v116, v117
    v_accvgpr_read_b32 v117, a138
    v_max_u32 v116, v116, v117
    v_accvgpr_read_b32 v117, a139
    v_max_u32 v116, v116, v117
    v_accvgpr_read_b32 v117, a140
    v_max_u32 v116, v116, v117
    v_accvgpr_read_b32 v117, a141
    v_max_u32 v116, v116, v117
    v_accvgpr_read_b32 v117, a142
    v_max_u32 v116, v116, v117
    v_accvgpr_read_b32 v117, a143
    v_max_u32 v116, v116, v117
    v_accvgpr_read_b32 v117, a144
    v_max_u32 v116, v116, v117
    v_accvgpr_read_b32 v117, a145
    v_max_u32 v116, v116, v117
    v_accvgpr_read_b32 v117, a146
    v_max_u32 v116, v116, v117
    v_accvgpr_read_b32 v117, a147
    v_max_u32 v116, v116, v117
    v_accvgpr_read_b32 v117, a148
    v_max_u32 v116, v116, v117
    v_accvgpr_read_b32 v117, a149
    v_max_u32 v116, v116, v117
    v_accvgpr_read_b32 v117, a150
    v_max_u32 v116, v116, v117
    v_accvgpr_read_b32 v117, a151
    v_max_u32 v116, v116, v117
    v_accvgpr_read_b32 v117, a152
    v_max_u32 v116, v116, v117
    v_accvgpr_read_b32 v117, a153
    v_max_u32 v116, v116, v117
    v_accvgpr_read_b32 v117, a154
    v_max_u32 v116, v116, v117
    v_accvgpr_read_b32 v117, a155
    v_max_u32 v116, v116, v117
    v_accvgpr_read_b32 v117, a156
    v_max_u32 v116, v116, v117
    v_accvgpr_read_b32 v117, a157
    v_max_u32 v116, v116, v117
    v_accvgpr_read_b32 v117, a158
    v_max_u32 v116, v116, v117
    v_accvgpr_read_b32 v117, a159
    v_max_u32 v116, v116, v117
    v_max_u32 v116, v116, v32
    v_max_u32 v116, v116, v33
    v_max_u32 v116, v116, v34
    v_max_u32 v116, v116, v35
    v_max_u32 v116, v116, v36
    v_max_u32 v116, v116, v37
    v_max_u32 v116, v116, v38
    v_max_u32 v116, v116, v39
    v_max_u32 v116, v116, v40
    v_max_u32 v116, v116, v41
    v_max_u32 v116, v116, v42
    v_max_u32 v116, v116, v43
    v_max_u32 v116, v116, v44
    v_max_u32 v116, v116, v45
    v_max_u32 v116, v116, v46
    v_max_u32 v116, v116, v47
    v_max_u32 v116, v116, v48
    v_max_u32 v116, v116, v49
    v_max_u32 v116, v116, v50
    v_max_u32 v116, v116, v51
    v_max_u32 v116, v116, v52
    v_max_u32 v116, v116, v53
    v_max_u32 v116, v116, v54
    v_max_u32 v116, v116, v55
    v_max_u32 v116, v116, v56
    v_max_u32 v116, v116, v57
    v_max_u32 v116, v116, v58
    v_max_u32 v116, v116, v59
    v_max_u32 v116, v116, v60
    v_max_u32 v116, v116, v61
    v_max_u32 v116, v116, v62
    v_max_u32 v116, v116, v63
    v_max_u32 v116, v116, v64
    v_max_u32 v116, v116, v65
    v_max_u32 v116, v116, v66
    v_max_u32 v116, v116, v67
    v_max_u32 v116, v116, v68
    v_max_u32 v116, v116, v69
    v_max_u32 v116, v116, v70
    v_max_u32 v116, v116, v71
    v_max_u32 v116, v116, v72
    v_max_u32 v116, v116, v73
    v_max_u32 v116, v116, v74
    v_max_u32 v116, v116, v75
    v_max_u32 v116, v116, v76
    v_max_u32 v116, v116, v77
    v_max_u32 v116, v116, v78
    v_max_u32 v116, v116, v79
    v_max_u32 v116, v116, v80
    v_max_u32 v116, v116, v81
    v_max_u32 v116, v116, v82
    v_max_u32 v116, v116, v83
    v_max_u32 v116, v116, v84
    v_max_u32 v116, v116, v85
    v_max_u32 v116, v116, v86
    v_max_u32 v116, v116, v87
    v_max_u32 v116, v116, v88
    v_max_u32 v116, v116, v89
    v_max_u32 v116, v116, v90
    v_max_u32 v116, v116, v91
    v_max_u32 v116, v116, v92
    v_max_u32 v116, v116, v93
    v_max_u32 v116, v116, v94
    v_max_u32 v116, v116, v95
    v_max_u32 v116, v116, v96
    v_max_u32 v116, v116, v97
    v_max_u32 v116, v116, v98
    v_max_u32 v116, v116, v99
    v_max_u32 v116, v116, v100
    v_max_u32 v116, v116, v101
    v_max_u32 v116, v116, v102
    v_max_u32 v116, v116, v103
    v_max_u32 v116, v116, v104
    v_max_u32 v116, v116, v105
    v_max_u32 v116, v116, v106
    v_max_u32 v116, v116, v107
    v_max_u32 v116, v116, v108
    v_max_u32 v116, v116, v109
    v_max_u32 v116, v116, v110
    v_max_u32 v116, v116, v111
    v_cmp_eq_u32 vcc, -1, v116
    s_cbranch_vccnz L_r_sp
    s_mov_b64 s[38:39], 0
    v_mov_b32 v124, 0
    v_mov_b32 v125, 0
    v_mov_b32 v126, 0
    v_mov_b32 v127, 0
    v_mov_b32 v128, 0
    v_mov_b32 v129, 0
    v_mov_b32 v130, 0
    v_mov_b32 v131, 0
    v_mov_b32 v132, 0
    v_mov_b32 v133, 0
    v_mov_b32 v134, 0
    v_mov_b32 v135, 0
    v_mov_b32 v136, 0
    v_mov_b32 v137, 0
    v_mov_b32 v138, 0
    v_mov_b32 v139, 0
    s_branch L_r_go
L_pf:
    s_sub_u32 s40, s6, 16
    s_mul_i32 s30, s40, 13
    s_lshr_b32 s30, s30, 2
    s_min_u32 s30, s30, 28
    s_lshl_b32 s43, s5, 5
    s_add_u32 s30, s30, s43
    s_add_u32 s30, s30, 144
    s_lshr_b32 s31, s30, 7
    s_xor_b32 s31, s31, s35
    s_xor_b32 s31, s31, 0
    s_and_b32 s31, s31, 1
    s_lshl_b32 s31, s31, 13
    s_lshl_b32 s43, s30, 14
    s_add_u32 s43, s43, s31
    s_add_u32 s43, s43, 8388608
    s_lshl_b32 s47, s40, 14
    s_add_u32 s47, s47, 737280
    v_lshlrev_b32 v4, 4, v0
    v_add_u32 v5, 4096, v4
    v_add_u32 v6, 8192, v4
    s_mov_b32 s42, 0
L_pf_step:
    s_add_u32 s45, s43, 16384
    s_add_u32 s48, s43, 32768
    s_add_u32 s49, s43, 49152
    s_add_u32 s46, s42, 4
    s_lshl_b32 s30, s35, 13
    s_lshl_b32 s44, s42, 22
    s_add_u32 s44, s44, s30
    s_and_b32 s44, s44, 134217727
    s_add_u32 s44, s44, s47
    s_lshl_b32 s30, s35, 13
    s_lshl_b32 s36, s46, 22
    s_add_u32 s36, s36, s30
    s_and_b32 s36, s36, 134217727
    s_cmp_gt_u32 s46, 63
    s_cselect_b32 s36, 2130706432, s36
    s_waitcnt vmcnt(0)
    s_barrier
    buffer_store_dwordx4 v[112:115], v156, s[8:11], s36 offen sc1
    s_nop 4
    buffer_store_dwordx4 v[112:115], v157, s[8:11], s36 offen sc1
    s_nop 4
    buffer_store_dwordx4 v[112:115], v158, s[8:11], s36 offen sc1
    s_nop 4
    buffer_store_dwordx4 v[112:115], v159, s[8:11], s36 offen sc1
    s_nop 4
    buffer_store_dwordx4 v[112:115], v160, s[8:11], s36 offen sc1
    s_nop 4
    buffer_store_dwordx4 v[112:115], v161, s[8:11], s36 offen sc1
    s_nop 4
    buffer_store_dwordx4 v[112:115], v162, s[8:11], s36 offen sc1
    s_nop 4
    buffer_store_dwordx4 v[112:115], v163, s[8:11], s36 offen sc1
    s_nop 4
    buffer_store_dwordx4 v[112:115], v120, s[8:11], s36 offen offset:0 sc1
    s_nop 4
    buffer_store_dwordx4 v[112:115], v120, s[8:11], s36 offen offset:1024 sc1
    s_nop 4
    buffer_store_dwordx4 v[112:115], v29, s[8:11], s36 offen sc1
    s_add_u32 s43, s43, 4194304
    s_and_b32 s43, s43, 134217727
    s_add_u32 s42, s42, 1
    s_cmp_lt_u32 s42, 63
    s_cbranch_scc1 L_pf_step
    s_endpgm
L_kv:
    s_sub_u32 s40, s5, 4
    s_lshl_b32 s40, s40, 3
    s_and_b32 s30, s6, 7
    s_add_u32 s40, s40, s30
    s_lshr_b32 s41, s6, 3
    s_cmp_eq_u32 s41, 0
    s_cselect_b32 s12, s76, s78
    s_cselect_b32 s13, s77, s79
    s_cmp_eq_u32 s41, 2
    s_cselect_b32 s12, s74, s12
    s_cselect_b32 s13, s75, s13
    s_mov_b32 s14, 7864320
    s_mov_b32 s15, 0x20000
    s_mul_i32 s43, s40, 384
    v_lshlrev_b32 v10, 4, v0
    s_sub_u32 s54, s5, 4
    s_lshr_b32 s55, s41, 1
    s_lshl_b32 s55, s55, 3
    s_and_b32 s30, s6, 7
    s_add_u32 s55, s55, s30
    s_cmp_eq_u32 s41, 1
    s_cbranch_scc1 L_kv_nt
    s_cmp_lg_u32 s3, 3
    s_cbranch_scc1 L_kv_nt
    s_lshl_b32 s98, s55, 6
    v_add_u32 v40, s98, v0
    v_mul_u32_u24 v41, 2731, v40
    v_lshrrev_b32 v41, 16, v41
    v_mul_u32_u24 v42, 24, v41
    v_sub_u32 v42, v40, v42
    v_mul_u32_u24 v41, 12288, v41
    v_lshl_add_u32 v41, v42, 7, v41
    s_mul_i32 s98, s54, 3072
    v_add_u32 v41, s98, v41
    s_and_b32 s98, s55, 7
    s_lshl_b32 s96, s54, 3
    s_add_u32 s98, s98, s96
    s_mul_i32 s98, s98, 245760
    s_lshr_b32 s96, s55, 3
    s_lshl_b32 s96, s96, 13
    s_add_u32 s98, s98, s96
    v_lshlrev_b32 v42, 7, v0
    v_add_u32 v42, s98, v42
    s_mov_b32 s92, s78
    s_mov_b32 s93, s79
    s_mov_b32 s94, 7864320
    s_mov_b32 s95, 0x20000
    s_mov_b32 s96, 0
    buffer_load_dword v44, v41, s[92:95], s96 offen
    s_waitcnt vmcnt(8)
    s_mov_b32 s96, 786432
    buffer_load_dword v45, v41, s[92:95], s96 offen
    s_waitcnt vmcnt(8)
    s_mov_b32 s96, 1572864
    buffer_load_dword v46, v41, s[92:95], s96 offen
    s_waitcnt vmcnt(8)
    s_mov_b32 s96, 2359296
    buffer_load_dword v47, v41, s[92:95], s96 offen
    s_waitcnt vmcnt(8)
    s_mov_b32 s96, 3145728
    buffer_load_dword v48, v41, s[92:95], s96 offen
    s_waitcnt vmcnt(8)
    s_mov_b32 s96, 3932160
    buffer_load_dword v49, v41, s[92:95], s96 offen
    s_waitcnt vmcnt(8)
    s_mov_b32 s96, 4718592
    buffer_load_dword v50, v41, s[92:95], s96 offen
    s_waitcnt vmcnt(8)
    s_mov_b32 s96, 5505024
    buffer_load_dword v51, v41, s[92:95], s96 offen
    s_waitcnt vmcnt(8)
    s_mov_b32 s96, 6291456
    buffer_load_dword v44, v41, s[92:95], s96 offen
    s_waitcnt vmcnt(8)
    s_mov_b32 s96, 7077888
    buffer_load_dword v45, v41, s[92:95], s96 offen
    s_waitcnt vmcnt(8)
L_kv_nt:
    s_barrier
    s_mul_i32 s30, s3, 192
    v_add_u32 v1, 0, v0
    v_add_u32 v1, s30, v1
    v_mul_u32_u24 v2, 2731, v1
    v_lshrrev_b32 v2, 16, v2
    v_mul_u32_u24 v3, 24, v2
    v_sub_u32 v3, v1, v3
    v_mul_u32_u24 v2, 12288, v2
    v_lshl_add_u32 v4, v3, 4, v2
    s_mul_i32 s30, s3, 192
    v_add_u32 v1, 64, v0
    v_add_u32 v1, s30, v1
    v_mul_u32_u24 v2, 2731, v1
    v_lshrrev_b32 v2, 16, v2
    v_mul_u32_u24 v3, 24, v2
    v_sub_u32 v3, v1, v3
    v_mul_u32_u24 v2, 12288, v2
    v_lshl_add_u32 v5, v3, 4, v2
    s_mul_i32 s30, s3, 192
    v_add_u32 v1, 128, v0
    v_add_u32 v1, s30, v1
    v_mul_u32_u24 v2, 2731, v1
    v_lshrrev_b32 v2, 16, v2
    v_mul_u32_u24 v3, 24, v2
    v_sub_u32 v3, v1, v3
    v_mul_u32_u24 v2, 12288, v2
    v_lshl_add_u32 v6, v3, 4, v2
    v_lshrrev_b32 v1, 4, v0
    v_lshlrev_b32 v1, 3, v1
    v_bfe_u32 v2, v0, 2, 2
    v_add_u32 v1, v1, v2
    v_mul_u32_u24 v1, 384, v1
    v_and_b32 v2, 3, v0
    v_lshl_add_u32 v1, v2, 3, v1
    s_mul_i32 s30, s3, 96
    s_add_u32 s30, s30, 81920
    v_add_u32 v24, s30, v1
    v_bfe_u32 v1, v0, 3, 1
    v_mul_u32_u24 v2, 0, v1
    v_add_u32 v25, v24, v2
    v_mul_u32_u24 v2, 1536, v1
    v_sub_u32 v26, v25, v2
    v_add_u32 v26, 768, v26
    s_mul_i32 s31, s3, 3072
    s_add_u32 s33, s43, 0
    s_add_u32 m0, s31, 81920
    s_nop 0
    buffer_load_dwordx4 v4, s[12:15], s33 offen lds
    s_add_u32 m0, s31, 82944
    s_nop 0
    buffer_load_dwordx4 v5, s[12:15], s33 offen lds
    s_add_u32 m0, s31, 83968
    s_nop 0
    buffer_load_dwordx4 v6, s[12:15], s33 offen lds
    s_add_u32 s33, s43, 393216
    s_add_u32 m0, s31, 94208
    s_nop 0
    buffer_load_dwordx4 v4, s[12:15], s33 offen lds
    s_add_u32 m0, s31, 95232
    s_nop 0
    buffer_load_dwordx4 v5, s[12:15], s33 offen lds
    s_add_u32 m0, s31, 96256
    s_nop 0
    buffer_load_dwordx4 v6, s[12:15], s33 offen lds
    s_add_u32 s33, s43, 786432
    s_add_u32 m0, s31, 106496
    s_nop 0
    buffer_load_dwordx4 v4, s[12:15], s33 offen lds
    s_add_u32 m0, s31, 107520
    s_nop 0
    buffer_load_dwordx4 v5, s[12:15], s33 offen lds
    s_add_u32 m0, s31, 108544
    s_nop 0
    buffer_load_dwordx4 v6, s[12:15], s33 offen lds
    s_add_u32 s33, s43, 1179648
    s_add_u32 m0, s31, 118784
    s_nop 0
    buffer_load_dwordx4 v4, s[12:15], s33 offen lds
    s_add_u32 m0, s31, 119808
    s_nop 0
    buffer_load_dwordx4 v5, s[12:15], s33 offen lds
    s_add_u32 m0, s31, 120832
    s_nop 0
    buffer_load_dwordx4 v6, s[12:15], s33 offen lds
    s_add_u32 s33, s43, 1572864
    s_add_u32 m0, s31, 131072
    s_nop 0
    buffer_load_dwordx4 v4, s[12:15], s33 offen lds
    s_add_u32 m0, s31, 132096
    s_nop 0
    buffer_load_dwordx4 v5, s[12:15], s33 offen lds
    s_add_u32 m0, s31, 133120
    s_nop 0
    buffer_load_dwordx4 v6, s[12:15], s33 offen lds
    s_add_u32 s33, s43, 1966080
    s_add_u32 m0, s31, 143360
    s_nop 0
    buffer_load_dwordx4 v4, s[12:15], s33 offen lds
    s_add_u32 m0, s31, 144384
    s_nop 0
    buffer_load_dwordx4 v5, s[12:15], s33 offen lds
    s_add_u32 m0, s31, 145408
    s_nop 0
    buffer_load_dwordx4 v6, s[12:15], s33 offen lds
    s_waitcnt vmcnt(15)
    s_barrier
    ds_read_b64_tr_b16 a[0:1], v24 offset:0
    ds_read_b64_tr_b16 a[2:3], v24 offset:1536
    ds_read_b64_tr_b16 a[4:5], v24 offset:32
    ds_read_b64_tr_b16 a[6:7], v24 offset:1568
    ds_read_b64_tr_b16 a[8:9], v24 offset:64
    ds_read_b64_tr_b16 a[10:11], v24 offset:1600
    s_waitcnt lgkmcnt(0)
    s_waitcnt vmcnt(12)
    s_barrier
    s_add_u32 s33, s43, 2359296
    s_add_u32 m0, s31, 81920
    s_nop 0
    buffer_load_dwordx4 v4, s[12:15], s33 offen lds
    s_add_u32 m0, s31, 82944
    s_nop 0
    buffer_load_dwordx4 v5, s[12:15], s33 offen lds
    s_add_u32 m0, s31, 83968
    s_nop 0
    buffer_load_dwordx4 v6, s[12:15], s33 offen lds
    ds_read_b64_tr_b16 a[12:13], v24 offset:12288
    ds_read_b64_tr_b16 a[14:15], v24 offset:13824
    ds_read_b64_tr_b16 a[16:17], v24 offset:12320
    ds_read_b64_tr_b16 a[18:19], v24 offset:13856
    ds_read_b64_tr_b16 a[20:21], v24 offset:12352
    ds_read_b64_tr_b16 a[22:23], v24 offset:13888
    s_waitcnt lgkmcnt(0)
    s_waitcnt vmcnt(12)
    s_barrier
    s_add_u32 s33, s43, 2752512
    s_add_u32 m0, s31, 94208
    s_nop 0
    buffer_load_dwordx4 v4, s[12:15], s33 offen lds
    s_add_u32 m0, s31, 95232
    s_nop 0
    buffer_load_dwordx4 v5, s[12:15], s33 offen lds
    s_add_u32 m0, s31, 96256
    s_nop 0
    buffer_load_dwordx4 v6, s[12:15], s33 offen lds
    ds_read_b64_tr_b16 a[24:25], v24 offset:24576
    ds_read_b64_tr_b16 a[26:27], v24 offset:26112
    ds_read_b64_tr_b16 a[28:29], v24 offset:24608
    ds_read_b64_tr_b16 a[30:31], v24 offset:26144
    ds_read_b64_tr_b16 a[32:33], v24 offset:24640
    ds_read_b64_tr_b16 a[34:35], v24 offset:26176
    s_waitcnt lgkmcnt(0)
    s_waitcnt vmcnt(12)
    s_barrier
    s_add_u32 s33, s43, 3145728
    s_add_u32 m0, s31, 106496
    s_nop 0
    buffer_load_dwordx4 v4, s[12:15], s33 offen lds
    s_add_u32 m0, s31, 107520
    s_nop 0
    buffer_load_dwordx4 v5, s[12:15], s33 offen lds
    s_add_u32 m0, s31, 108544
    s_nop 0
    buffer_load_dwordx4 v6, s[12:15], s33 offen lds
    ds_read_b64_tr_b16 a[36:37], v24 offset:36864
    ds_read_b64_tr_b16 a[38:39], v24 offset:38400
    ds_read_b64_tr_b16 a[40:41], v24 offset:36896
    ds_read_b64_tr_b16 a[42:43], v24 offset:38432
    ds_read_b64_tr_b16 a[44:45], v24 offset:36928
    ds_read_b64_tr_b16 a[46:47], v24 offset:38464
    s_waitcnt lgkmcnt(0)
    s_waitcnt vmcnt(12)
    s_barrier
    s_add_u32 s33, s43, 3538944
    s_add_u32 m0, s31, 118784
    s_nop 0
    buffer_load_dwordx4 v4, s[12:15], s33 offen lds
    s_add_u32 m0, s31, 119808
    s_nop 0
    buffer_load_dwordx4 v5, s[12:15], s33 offen lds
    s_add_u32 m0, s31, 120832
    s_nop 0
    buffer_load_dwordx4 v6, s[12:15], s33 offen lds
    v_add_u32 v24, 49152, v24
    v_add_u32 v25, 49152, v25
    v_add_u32 v26, 49152, v26
    ds_read_b64_tr_b16 a[48:49], v24 offset:0
    ds_read_b64_tr_b16 a[50:51], v24 offset:1536
    ds_read_b64_tr_b16 a[52:53], v24 offset:32
    ds_read_b64_tr_b16 a[54:55], v24 offset:1568
    ds_read_b64_tr_b16 a[56:57], v24 offset:64
    ds_read_b64_tr_b16 a[58:59], v24 offset:1600
    s_waitcnt lgkmcnt(0)
    s_waitcnt vmcnt(12)
    s_barrier
    s_add_u32 s33, s43, 3932160
    s_add_u32 m0, s31, 131072
    s_nop 0
    buffer_load_dwordx4 v4, s[12:15], s33 offen lds
    s_add_u32 m0, s31, 132096
    s_nop 0
    buffer_load_dwordx4 v5, s[12:15], s33 offen lds
    s_add_u32 m0, s31, 133120
    s_nop 0
    buffer_load_dwordx4 v6, s[12:15], s33 offen lds
    ds_read_b64_tr_b16 a[60:61], v24 offset:12288
    ds_read_b64_tr_b16 a[62:63], v24 offset:13824
    ds_read_b64_tr_b16 a[64:65], v24 offset:12320
    ds_read_b64_tr_b16 a[66:67], v24 offset:13856
    ds_read_b64_tr_b16 a[68:69], v24 offset:12352
    ds_read_b64_tr_b16 a[70:71], v24 offset:13888
    s_waitcnt lgkmcnt(0)
    s_waitcnt vmcnt(12)
    s_barrier
    s_add_u32 s33, s43, 4325376
    s_add_u32 m0, s31, 143360
    s_nop 0
    buffer_load_dwordx4 v4, s[12:15], s33 offen lds
    s_add_u32 m0, s31, 144384
    s_nop 0
    buffer_load_dwordx4 v5, s[12:15], s33 offen lds
    s_add_u32 m0, s31, 145408
    s_nop 0
    buffer_load_dwordx4 v6, s[12:15], s33 offen lds
    v_add_u32 v24, 4294918144, v24
    v_add_u32 v25, 4294918144, v25
    v_add_u32 v26, 4294918144, v26
    ds_read_b64_tr_b16 a[72:73], v24 offset:0
    ds_read_b64_tr_b16 a[74:75], v24 offset:1536
    ds_read_b64_tr_b16 a[76:77], v24 offset:32
    ds_read_b64_tr_b16 a[78:79], v24 offset:1568
    ds_read_b64_tr_b16 a[80:81], v24 offset:64
    ds_read_b64_tr_b16 a[82:83], v24 offset:1600
    s_waitcnt lgkmcnt(0)
    s_waitcnt vmcnt(12)
    s_barrier
    s_add_u32 s33, s43, 4718592
    s_add_u32 m0, s31, 81920
    s_nop 0
    buffer_load_dwordx4 v4, s[12:15], s33 offen lds
    s_add_u32 m0, s31, 82944
    s_nop 0
    buffer_load_dwordx4 v5, s[12:15], s33 offen lds
    s_add_u32 m0, s31, 83968
    s_nop 0
    buffer_load_dwordx4 v6, s[12:15], s33 offen lds
    ds_read_b64_tr_b16 a[84:85], v24 offset:12288
    ds_read_b64_tr_b16 a[86:87], v24 offset:13824
    ds_read_b64_tr_b16 a[88:89], v24 offset:12320
    ds_read_b64_tr_b16 a[90:91], v24 offset:13856
    ds_read_b64_tr_b16 a[92:93], v24 offset:12352
    ds_read_b64_tr_b16 a[94:95], v24 offset:13888
    s_waitcnt lgkmcnt(0)
    s_waitcnt vmcnt(12)
    s_barrier
    s_add_u32 s33, s43, 5111808
    s_add_u32 m0, s31, 94208
    s_nop 0
    buffer_load_dwordx4 v4, s[12:15], s33 offen lds
    s_add_u32 m0, s31, 95232
    s_nop 0
    buffer_load_dwordx4 v5, s[12:15], s33 offen lds
    s_add_u32 m0, s31, 96256
    s_nop 0
    buffer_load_dwordx4 v6, s[12:15], s33 offen lds
    ds_read_b64_tr_b16 a[96:97], v24 offset:24576
    ds_read_b64_tr_b16 a[98:99], v24 offset:26112
    ds_read_b64_tr_b16 a[100:101], v24 offset:24608
    ds_read_b64_tr_b16 a[102:103], v24 offset:26144
    ds_read_b64_tr_b16 a[104:105], v24 offset:24640
    ds_read_b64_tr_b16 a[106:107], v24 offset:26176
    s_waitcnt lgkmcnt(0)
    s_waitcnt vmcnt(12)
    s_barrier
    s_add_u32 s33, s43, 5505024
    s_add_u32 m0, s31, 106496
    s_nop 0
    buffer_load_dwordx4 v4, s[12:15], s33 offen lds
    s_add_u32 m0, s31, 107520
    s_nop 0
    buffer_load_dwordx4 v5, s[12:15], s33 offen lds
    s_add_u32 m0, s31, 108544
    s_nop 0
    buffer_load_dwordx4 v6, s[12:15], s33 offen lds
    ds_read_b64_tr_b16 a[108:109], v24 offset:36864
    ds_read_b64_tr_b16 a[110:111], v24 offset:38400
    ds_read_b64_tr_b16 a[112:113], v24 offset:36896
    ds_read_b64_tr_b16 a[114:115], v24 offset:38432
    ds_read_b64_tr_b16 a[116:117], v24 offset:36928
    ds_read_b64_tr_b16 a[118:119], v24 offset:38464
    s_waitcnt lgkmcnt(0)
    s_waitcnt vmcnt(12)
    s_barrier
    s_add_u32 s33, s43, 5898240
    s_add_u32 m0, s31, 118784
    s_nop 0
    buffer_load_dwordx4 v4, s[12:15], s33 offen lds
    s_add_u32 m0, s31, 119808
    s_nop 0
    buffer_load_dwordx4 v5, s[12:15], s33 offen lds
    s_add_u32 m0, s31, 120832
    s_nop 0
    buffer_load_dwordx4 v6, s[12:15], s33 offen lds
    v_add_u32 v24, 49152, v24
    v_add_u32 v25, 49152, v25
    v_add_u32 v26, 49152, v26
    ds_read_b64_tr_b16 a[120:121], v24 offset:0
    ds_read_b64_tr_b16 a[122:123], v24 offset:1536
    ds_read_b64_tr_b16 a[124:125], v24 offset:32
    ds_read_b64_tr_b16 a[126:127], v24 offset:1568
    ds_read_b64_tr_b16 a[128:129], v24 offset:64
    ds_read_b64_tr_b16 a[130:131], v24 offset:1600
    s_waitcnt lgkmcnt(0)
    s_waitcnt vmcnt(12)
    s_barrier
    s_add_u32 s33, s43, 6291456
    s_add_u32 m0, s31, 131072
    s_nop 0
    buffer_load_dwordx4 v4, s[12:15], s33 offen lds
    s_add_u32 m0, s31, 132096
    s_nop 0
    buffer_load_dwordx4 v5, s[12:15], s33 offen lds
    s_add_u32 m0, s31, 133120
    s_nop 0
    buffer_load_dwordx4 v6, s[12:15], s33 offen lds
    ds_read_b64_tr_b16 a[132:133], v24 offset:12288
    ds_read_b64_tr_b16 a[134:135], v24 offset:13824
    ds_read_b64_tr_b16 a[136:137], v24 offset:12320
    ds_read_b64_tr_b16 a[138:139], v24 offset:13856
    ds_read_b64_tr_b16 a[140:141], v24 offset:12352
    ds_read_b64_tr_b16 a[142:143], v24 offset:13888
    s_waitcnt lgkmcnt(0)
    s_waitcnt vmcnt(12)
    s_barrier
    s_add_u32 s33, s43, 6684672
    s_add_u32 m0, s31, 143360
    s_nop 0
    buffer_load_dwordx4 v4, s[12:15], s33 offen lds
    s_add_u32 m0, s31, 144384
    s_nop 0
    buffer_load_dwordx4 v5, s[12:15], s33 offen lds
    s_add_u32 m0, s31, 145408
    s_nop 0
    buffer_load_dwordx4 v6, s[12:15], s33 offen lds
    v_add_u32 v24, 4294918144, v24
    v_add_u32 v25, 4294918144, v25
    v_add_u32 v26, 4294918144, v26
    ds_read_b64_tr_b16 a[144:145], v24 offset:0
    ds_read_b64_tr_b16 a[146:147], v24 offset:1536
    ds_read_b64_tr_b16 a[148:149], v24 offset:32
    ds_read_b64_tr_b16 a[150:151], v24 offset:1568
    ds_read_b64_tr_b16 a[152:153], v24 offset:64
    ds_read_b64_tr_b16 a[154:155], v24 offset:1600
    s_waitcnt lgkmcnt(0)
    s_waitcnt vmcnt(12)
    s_barrier
    s_add_u32 s33, s43, 7077888
    s_add_u32 m0, s31, 81920
    s_nop 0
    buffer_load_dwordx4 v4, s[12:15], s33 offen lds
    s_add_u32 m0, s31, 82944
    s_nop 0
    buffer_load_dwordx4 v5, s[12:15], s33 offen lds
    s_add_u32 m0, s31, 83968
    s_nop 0
    buffer_load_dwordx4 v6, s[12:15], s33 offen lds
    ds_read_b64_tr_b16 a[156:157], v24 offset:12288
    ds_read_b64_tr_b16 a[158:159], v24 offset:13824
    ds_read_b64_tr_b16 a[160:161], v24 offset:12320
    ds_read_b64_tr_b16 a[162:163], v24 offset:13856
    ds_read_b64_tr_b16 a[164:165], v24 offset:12352
    ds_read_b64_tr_b16 a[166:167], v24 offset:13888
    s_waitcnt lgkmcnt(0)
    s_waitcnt vmcnt(12)
    s_barrier
    s_add_u32 s33, s43, 7471104
    s_add_u32 m0, s31, 94208
    s_nop 0
    buffer_load_dwordx4 v4, s[12:15], s33 offen lds
    s_add_u32 m0, s31, 95232
    s_nop 0
    buffer_load_dwordx4 v5, s[12:15], s33 offen lds
    s_add_u32 m0, s31, 96256
    s_nop 0
    buffer_load_dwordx4 v6, s[12:15], s33 offen lds
    v_lshrrev_b32 v1, 3, v0
    s_lshl_b32 s30, s3, 3
    v_add_u32 v1, s30, v1
    v_bfe_u32 v2, v1, 1, 3
    v_and_b32 v3, 7, v0
    v_xor_b32 v2, v2, v3
    v_mul_u32_u24 v1, 1280, v1
    v_lshl_add_u32 v8, v2, 4, v1
    v_and_b32 v1, 15, v0
    v_lshrrev_b32 v2, 1, v1
    v_lshrrev_b32 v3, 4, v0
    v_xor_b32 v2, v2, v3
    v_lshlrev_b32 v1, 7, v1
    v_lshl_add_u32 v16, v2, 4, v1
    v_xor_b32 v17, 64, v16
    s_lshl_b32 s34, s3, 10
    s_mov_b32 s44, 0
    s_mov_b32 s48, s34
    s_add_u32 m0, s48, 0
    s_nop 0
    buffer_load_dwordx4 v8, s[20:23], s44 offen offset:0 lds
    s_add_u32 m0, s48, 3968
    s_nop 0
    buffer_load_dwordx4 v8, s[20:23], s44 offen offset:128 lds
    s_add_u32 m0, s48, 7936
    s_nop 0
    buffer_load_dwordx4 v8, s[20:23], s44 offen offset:256 lds
    s_add_u32 m0, s48, 11904
    s_nop 0
    buffer_load_dwordx4 v8, s[20:23], s44 offen offset:384 lds
    s_add_u32 m0, s48, 15872
    s_nop 0
    buffer_load_dwordx4 v8, s[20:23], s44 offen offset:512 lds
    s_add_u32 m0, s48, 19840
    s_nop 0
    buffer_load_dwordx4 v8, s[20:23], s44 offen offset:640 lds
    s_add_u32 m0, s48, 23808
    s_nop 0
    buffer_load_dwordx4 v8, s[20:23], s44 offen offset:768 lds
    s_add_u32 m0, s48, 27776
    s_nop 0
    buffer_load_dwordx4 v8, s[20:23], s44 offen offset:896 lds
    s_add_u32 m0, s48, 31744
    s_nop 0
    buffer_load_dwordx4 v8, s[20:23], s44 offen offset:1024 lds
    s_add_u32 m0, s48, 35712
    s_nop 0
    buffer_load_dwordx4 v8, s[20:23], s44 offen offset:1152 lds
    s_add_u32 s44, s44, 40960
    s_add_u32 s48, s48, 40960
    s_add_u32 m0, s48, 0
    s_nop 0
    buffer_load_dwordx4 v8, s[20:23], s44 offen offset:0 lds
    s_add_u32 m0, s48, 3968
    s_nop 0
    buffer_load_dwordx4 v8, s[20:23], s44 offen offset:128 lds
    s_add_u32 m0, s48, 7936
    s_nop 0
    buffer_load_dwordx4 v8, s[20:23], s44 offen offset:256 lds
    s_add_u32 m0, s48, 11904
    s_nop 0
    buffer_load_dwordx4 v8, s[20:23], s44 offen offset:384 lds
    s_add_u32 m0, s48, 15872
    s_nop 0
    buffer_load_dwordx4 v8, s[20:23], s44 offen offset:512 lds
    s_add_u32 m0, s48, 19840
    s_nop 0
    buffer_load_dwordx4 v8, s[20:23], s44 offen offset:640 lds
    s_add_u32 m0, s48, 23808
    s_nop 0
    buffer_load_dwordx4 v8, s[20:23], s44 offen offset:768 lds
    s_add_u32 m0, s48, 27776
    s_nop 0
    buffer_load_dwordx4 v8, s[20:23], s44 offen offset:896 lds
    s_add_u32 m0, s48, 31744
    s_nop 0
    buffer_load_dwordx4 v8, s[20:23], s44 offen offset:1024 lds
    s_add_u32 m0, s48, 35712
    s_nop 0
    buffer_load_dwordx4 v8, s[20:23], s44 offen offset:1152 lds
    v_mov_b32 v12, 4028416
    buffer_load_dwordx2 v[14:15], v12, s[8:11], 0 offen sc1
    v_lshlrev_b32 v1, 7, v0
    s_lshl_b32 s30, s6, 13
    s_add_u32 s30, s30, 81920
    buffer_load_dword v13, v1, s[20:23], s30 offen
    ds_read_b64_tr_b16 a[168:169], v24 offset:24576
    ds_read_b64_tr_b16 a[170:171], v24 offset:26112
    ds_read_b64_tr_b16 a[172:173], v24 offset:24608
    ds_read_b64_tr_b16 a[174:175], v24 offset:26144
    ds_read_b64_tr_b16 a[176:177], v24 offset:24640
    ds_read_b64_tr_b16 a[178:179], v24 offset:26176
    s_waitcnt lgkmcnt(0)
    s_waitcnt vmcnt(34)
    s_barrier
    ds_read_b64_tr_b16 a[180:181], v24 offset:36864
    ds_read_b64_tr_b16 a[182:183], v24 offset:38400
    ds_read_b64_tr_b16 a[184:185], v24 offset:36896
    ds_read_b64_tr_b16 a[186:187], v24 offset:38432
    ds_read_b64_tr_b16 a[188:189], v24 offset:36928
    ds_read_b64_tr_b16 a[190:191], v24 offset:38464
    s_waitcnt lgkmcnt(0)
    s_waitcnt vmcnt(31)
    s_barrier
    v_add_u32 v24, 49152, v24
    v_add_u32 v25, 49152, v25
    v_add_u32 v26, 49152, v26
    ds_read_b64_tr_b16 a[192:193], v24 offset:0
    ds_read_b64_tr_b16 a[194:195], v24 offset:1536
    ds_read_b64_tr_b16 a[196:197], v24 offset:32
    ds_read_b64_tr_b16 a[198:199], v24 offset:1568
    ds_read_b64_tr_b16 a[200:201], v24 offset:64
    ds_read_b64_tr_b16 a[202:203], v24 offset:1600
    s_waitcnt lgkmcnt(0)
    s_waitcnt vmcnt(28)
    s_barrier
    ds_read_b64_tr_b16 a[204:205], v24 offset:12288
    ds_read_b64_tr_b16 a[206:207], v24 offset:13824
    ds_read_b64_tr_b16 a[208:209], v24 offset:12320
    ds_read_b64_tr_b16 a[210:211], v24 offset:13856
    ds_read_b64_tr_b16 a[212:213], v24 offset:12352
    ds_read_b64_tr_b16 a[214:215], v24 offset:13888
    s_waitcnt lgkmcnt(0)
    s_waitcnt vmcnt(25)
    s_barrier
    v_add_u32 v24, 4294918144, v24
    v_add_u32 v25, 4294918144, v25
    v_add_u32 v26, 4294918144, v26
    ds_read_b64_tr_b16 a[216:217], v24 offset:0
    ds_read_b64_tr_b16 a[218:219], v24 offset:1536
    ds_read_b64_tr_b16 a[220:221], v24 offset:32
    ds_read_b64_tr_b16 a[222:223], v24 offset:1568
    ds_read_b64_tr_b16 a[224:225], v24 offset:64
    ds_read_b64_tr_b16 a[226:227], v24 offset:1600
    s_waitcnt lgkmcnt(0)
    s_waitcnt vmcnt(22)
    s_barrier
    ds_read_b64_tr_b16 a[228:229], v24 offset:12288
    ds_read_b64_tr_b16 a[230:231], v24 offset:13824
    ds_read_b64_tr_b16 a[232:233], v24 offset:12320
    ds_read_b64_tr_b16 a[234:235], v24 offset:13856
    ds_read_b64_tr_b16 a[236:237], v24 offset:12352
    ds_read_b64_tr_b16 a[238:239], v24 offset:13888
    s_waitcnt lgkmcnt(0)
    s_barrier
    s_waitcnt vmcnt(0)
    v_mov_b32 v12, 4028416
    v_cmp_ne_u32 vcc, s4, v15
    v_cmp_gt_u32 s[28:29], 1, v14
    s_or_b64 vcc, vcc, s[28:29]
    s_cbranch_scc0 L_fe_41
L_fw_40:
    buffer_load_dwordx2 v[14:15], v12, s[8:11], 0 offen sc1
    s_add_u32 s7, s7, 1
    s_bitcmp1_b32 s7, 22
    s_cbranch_scc1 L_abort
    s_waitcnt vmcnt(0)
    v_cmp_ne_u32 vcc, s4, v15
    v_cmp_gt_u32 s[28:29], 1, v14
    s_or_b64 vcc, vcc, s[28:29]
    s_cbranch_scc1 L_fw_40
L_fe_41:
    v_readfirstlane_b32 s35, v14
    s_sub_u32 s35, s35, 1
    s_lshr_b32 s45, s41, 1
    s_mul_i32 s45, s45, 3
    s_mul_i32 s33, s3, 6
    s_add_u32 s33, s33, s45
    s_add_u32 s33, s33, 0
    s_mul_i32 s30, s40, 24
    s_add_u32 s33, s33, s30
    s_lshr_b32 s30, s33, 3
    s_add_u32 s30, s30, 144
    s_lshr_b32 s31, s30, 7
    s_xor_b32 s31, s31, s35
    s_xor_b32 s31, s31, 0
    s_and_b32 s31, s31, 1
    s_lshl_b32 s31, s31, 13
    s_lshl_b32 s56, s30, 14
    s_add_u32 s56, s56, s31
    s_and_b32 s33, s33, 7
    s_lshl_b32 s33, s33, 10
    s_add_u32 s56, s56, s33
    s_mul_i32 s33, s3, 6
    s_add_u32 s33, s33, s45
    s_add_u32 s33, s33, 1
    s_mul_i32 s30, s40, 24
    s_add_u32 s33, s33, s30
    s_lshr_b32 s30, s33, 3
    s_add_u32 s30, s30, 144
    s_lshr_b32 s31, s30, 7
    s_xor_b32 s31, s31, s35
    s_xor_b32 s31, s31, 0
    s_and_b32 s31, s31, 1
    s_lshl_b32 s31, s31, 13
    s_lshl_b32 s57, s30, 14
    s_add_u32 s57, s57, s31
    s_and_b32 s33, s33, 7
    s_lshl_b32 s33, s33, 10
    s_add_u32 s57, s57, s33
    s_mul_i32 s33, s3, 6
    s_add_u32 s33, s33, s45
    s_add_u32 s33, s33, 2
    s_mul_i32 s30, s40, 24
    s_add_u32 s33, s33, s30
    s_lshr_b32 s30, s33, 3
    s_add_u32 s30, s30, 144
    s_lshr_b32 s31, s30, 7
    s_xor_b32 s31, s31, s35
    s_xor_b32 s31, s31, 0
    s_and_b32 s31, s31, 1
    s_lshl_b32 s31, s31, 13
    s_lshl_b32 s58, s30, 14
    s_add_u32 s58, s58, s31
    s_and_b32 s33, s33, 7
    s_lshl_b32 s33, s33, 10
    s_add_u32 s58, s58, s33
    s_lshl_b32 s30, s40, 1
    s_lshr_b32 s42, s3, 1
    s_add_u32 s30, s30, s42
    s_lshr_b32 s31, s30, 7
    s_xor_b32 s31, s31, s35
    s_xor_b32 s31, s31, 1
    s_and_b32 s31, s31, 1
    s_lshl_b32 s31, s31, 13
    s_lshl_b32 s42, s30, 14
    s_add_u32 s42, s42, s31
    s_and_b32 s30, s3, 1
    s_mul_i32 s30, s30, 3072
    s_add_u32 s42, s42, s30
    s_add_u32 s30, s42, 0
    s_cmp_eq_u32 s41, 1
    s_cselect_b32 s56, s30, s56
    s_add_u32 s30, s42, 1024
    s_cmp_eq_u32 s41, 1
    s_cselect_b32 s57, s30, s57
    s_add_u32 s30, s42, 2048
    s_cmp_eq_u32 s41, 1
    s_cselect_b32 s58, s30, s58
    s_mov_b32 s45, 0
    v_mov_b32 v11, 2130706432
    s_lshl_b32 s30, s41, 5
    s_add_u32 s30, s30, s40
    s_add_u32 s30, s30, 31232
    s_lshl_b32 s30, s30, 7
    s_lshl_b32 s31, s3, 3
    s_add_u32 s30, s30, s31
    v_mov_b32 v12, s30
    v_mov_b32 v1, 2130706432
    v_cmp_eq_u32 vcc, 0, v0
    s_nop 1
    v_cndmask_b32 v12, v1, v12, vcc
    v_mov_b32 v15, s4
    s_mov_b32 s46, 0
    s_mov_b32 s47, 2130706432
    s_mov_b32 s50, 0
    v_lshrrev_b32 v22, 2, v0
    v_lshlrev_b32 v22, 7, v22
    v_and_b32 v1, 3, v0
    v_lshl_add_u32 v22, v1, 3, v22
    v_add_u32 v22, 4018176, v22
    s_waitcnt vmcnt(0)
    s_barrier
    v_mov_b32 v18, v16
    v_mov_b32 v19, v17
    s_mov_b32 s49, 40960
    ds_read_b128 v[96:99], v18 offset:0
    ds_read_b128 v[100:103], v18 offset:2048
    ds_read_b128 v[104:107], v19 offset:0
    ds_read_b128 v[108:111], v19 offset:2048
L_kv_loop:
    s_waitcnt lgkmcnt(2)
    v_mfma_f32_16x16x32_bf16 v[32:35], a[0:3], v[96:99], 0
    ds_read_b128 v[112:115], v18 offset:4096
    v_mfma_f32_16x16x32_bf16 v[40:43], a[4:7], v[96:99], 0
    s_add_u32 m0, s48, 15872
    v_mfma_f32_16x16x32_bf16 v[48:51], a[8:11], v[96:99], 0
    buffer_load_dwordx4 v8, s[20:23], s44 offen offset:512 lds
    v_mfma_f32_16x16x32_bf16 v[36:39], a[0:3], v[100:103], 0
    ds_read_b128 v[116:119], v18 offset:6144
    v_mfma_f32_16x16x32_bf16 v[44:47], a[4:7], v[100:103], 0
    v_mfma_f32_16x16x32_bf16 v[52:55], a[8:11], v[100:103], 0
    s_add_u32 m0, s48, 19840
    s_waitcnt lgkmcnt(2)
    v_mfma_f32_16x16x32_bf16 v[32:35], a[12:15], v[104:107], v[32:35]
    ds_read_b128 v[120:123], v19 offset:4096
    buffer_load_dwordx4 v8, s[20:23], s44 offen offset:640 lds
    v_mfma_f32_16x16x32_bf16 v[40:43], a[16:19], v[104:107], v[40:43]
    buffer_load_dwordx2 v[24:25], v22, s[8:11], 0 offen sc1
    v_mfma_f32_16x16x32_bf16 v[48:51], a[20:23], v[104:107], v[48:51]
    v_mfma_f32_16x16x32_bf16 v[36:39], a[12:15], v[108:111], v[36:39]
    ds_read_b128 v[124:127], v19 offset:6144
    s_add_u32 m0, s48, 23808
    v_mfma_f32_16x16x32_bf16 v[44:47], a[16:19], v[108:111], v[44:47]
    buffer_load_dwordx4 v8, s[20:23], s44 offen offset:768 lds
    v_mfma_f32_16x16x32_bf16 v[52:55], a[20:23], v[108:111], v[52:55]
    s_waitcnt lgkmcnt(2)
    v_mfma_f32_16x16x32_bf16 v[32:35], a[24:27], v[112:115], v[32:35]
    ds_read_b128 v[96:99], v18 offset:8192
    v_mfma_f32_16x16x32_bf16 v[40:43], a[28:31], v[112:115], v[40:43]
    s_add_u32 m0, s48, 27776
    v_mfma_f32_16x16x32_bf16 v[48:51], a[32:35], v[112:115], v[48:51]
    buffer_load_dwordx4 v8, s[20:23], s44 offen offset:896 lds
    v_mfma_f32_16x16x32_bf16 v[36:39], a[24:27], v[116:119], v[36:39]
    ds_read_b128 v[100:103], v18 offset:10240
    v_mfma_f32_16x16x32_bf16 v[44:47], a[28:31], v[116:119], v[44:47]
    v_mfma_f32_16x16x32_bf16 v[52:55], a[32:35], v[116:119], v[52:55]
    s_add_u32 m0, s48, 31744
    s_waitcnt lgkmcnt(2)
    v_mfma_f32_16x16x32_bf16 v[32:35], a[36:39], v[120:123], v[32:35]
    ds_read_b128 v[104:107], v19 offset:8192
    buffer_load_dwordx4 v8, s[20:23], s44 offen offset:1024 lds
    v_mfma_f32_16x16x32_bf16 v[40:43], a[40:43], v[120:123], v[40:43]
    v_mfma_f32_16x16x32_bf16 v[48:51], a[44:47], v[120:123], v[48:51]
    v_mfma_f32_16x16x32_bf16 v[36:39], a[36:39], v[124:127], v[36:39]
    ds_read_b128 v[108:111], v19 offset:10240
    s_add_u32 m0, s48, 35712
    v_mfma_f32_16x16x32_bf16 v[44:47], a[40:43], v[124:127], v[44:47]
    buffer_load_dwordx4 v8, s[20:23], s44 offen offset:1152 lds
    v_mfma_f32_16x16x32_bf16 v[52:55], a[44:47], v[124:127], v[52:55]
    s_waitcnt lgkmcnt(2)
    v_mfma_f32_16x16x32_bf16 v[32:35], a[48:51], v[96:99], v[32:35]
    ds_read_b128 v[112:115], v18 offset:12288
    v_mfma_f32_16x16x32_bf16 v[40:43], a[52:55], v[96:99], v[40:43]
    v_mfma_f32_16x16x32_bf16 v[48:51], a[56:59], v[96:99], v[48:51]
    v_cvt_pk_bf16_f32 v80, v56, v57
    v_mfma_f32_16x16x32_bf16 v[36:39], a[48:51], v[100:103], v[36:39]
    ds_read_b128 v[116:119], v18 offset:14336
    v_cvt_pk_bf16_f32 v81, v58, v59
    v_mfma_f32_16x16x32_bf16 v[44:47], a[52:55], v[100:103], v[44:47]
    v_mfma_f32_16x16x32_bf16 v[52:55], a[56:59], v[100:103], v[52:55]
    v_cvt_pk_bf16_f32 v82, v64, v65
    s_waitcnt lgkmcnt(2)
    v_mfma_f32_16x16x32_bf16 v[32:35], a[60:63], v[104:107], v[32:35]
    ds_read_b128 v[120:123], v19 offset:12288
    v_cvt_pk_bf16_f32 v83, v66, v67
    v_mfma_f32_16x16x32_bf16 v[40:43], a[64:67], v[104:107], v[40:43]
    v_mfma_f32_16x16x32_bf16 v[48:51], a[68:71], v[104:107], v[48:51]
    v_cvt_pk_bf16_f32 v84, v60, v61
    v_mfma_f32_16x16x32_bf16 v[36:39], a[60:63], v[108:111], v[36:39]
    ds_read_b128 v[124:127], v19 offset:14336
    v_cvt_pk_bf16_f32 v85, v62, v63
    v_mfma_f32_16x16x32_bf16 v[44:47], a[64:67], v[108:111], v[44:47]
    v_mfma_f32_16x16x32_bf16 v[52:55], a[68:71], v[108:111], v[52:55]
    v_cvt_pk_bf16_f32 v86, v68, v69
    s_waitcnt lgkmcnt(2)
    v_mfma_f32_16x16x32_bf16 v[32:35], a[72:75], v[112:115], v[32:35]
    ds_read_b128 v[96:99], v18 offset:16384
    v_cvt_pk_bf16_f32 v87, v70, v71
    v_mfma_f32_16x16x32_bf16 v[40:43], a[76:79], v[112:115], v[40:43]
    v_mfma_f32_16x16x32_bf16 v[48:51], a[80:83], v[112:115], v[48:51]
    v_cvt_pk_bf16_f32 v88, v72, v73
    v_mfma_f32_16x16x32_bf16 v[36:39], a[72:75], v[116:119], v[36:39]
    ds_read_b128 v[100:103], v18 offset:18432
    v_cvt_pk_bf16_f32 v89, v74, v75
    v_mfma_f32_16x16x32_bf16 v[44:47], a[76:79], v[116:119], v[44:47]
    v_mfma_f32_16x16x32_bf16 v[52:55], a[80:83], v[116:119], v[52:55]
    v_cvt_pk_bf16_f32 v90, v76, v77
    s_waitcnt lgkmcnt(2)
    v_mfma_f32_16x16x32_bf16 v[32:35], a[84:87], v[120:123], v[32:35]
    ds_read_b128 v[104:107], v19 offset:16384
    v_cvt_pk_bf16_f32 v91, v78, v79
    v_mfma_f32_16x16x32_bf16 v[40:43], a[88:91], v[120:123], v[40:43]
    v_mfma_f32_16x16x32_bf16 v[48:51], a[92:95], v[120:123], v[48:51]
    v_mfma_f32_16x16x32_bf16 v[36:39], a[84:87], v[124:127], v[36:39]
    ds_read_b128 v[108:111], v19 offset:18432
    v_mfma_f32_16x16x32_bf16 v[44:47], a[88:91], v[124:127], v[44:47]
    buffer_store_dwordx4 v[80:83], v11, s[8:11], s56 offen sc1
    v_mfma_f32_16x16x32_bf16 v[52:55], a[92:95], v[124:127], v[52:55]
    s_waitcnt lgkmcnt(2)
    v_mfma_f32_16x16x32_bf16 v[32:35], a[96:99], v[96:99], v[32:35]
    ds_read_b128 v[112:115], v18 offset:20480
    v_mfma_f32_16x16x32_bf16 v[40:43], a[100:103], v[96:99], v[40:43]
    v_mfma_f32_16x16x32_bf16 v[48:51], a[104:107], v[96:99], v[48:51]
    buffer_store_dwordx4 v[84:87], v11, s[8:11], s57 offen sc1
    v_mfma_f32_16x16x32_bf16 v[36:39], a[96:99], v[100:103], v[36:39]
    ds_read_b128 v[116:119], v18 offset:22528
    v_mfma_f32_16x16x32_bf16 v[44:47], a[100:103], v[100:103], v[44:47]
    v_mfma_f32_16x16x32_bf16 v[52:55], a[104:107], v[100:103], v[52:55]
    s_waitcnt lgkmcnt(2)
    v_mfma_f32_16x16x32_bf16 v[32:35], a[108:111], v[104:107], v[32:35]
    ds_read_b128 v[120:123], v19 offset:20480
    buffer_store_dwordx4 v[88:91], v11, s[8:11], s58 offen sc1
    v_mfma_f32_16x16x32_bf16 v[40:43], a[112:115], v[104:107], v[40:43]
    v_mfma_f32_16x16x32_bf16 v[48:51], a[116:119], v[104:107], v[48:51]
    v_mfma_f32_16x16x32_bf16 v[36:39], a[108:111], v[108:111], v[36:39]
    ds_read_b128 v[124:127], v19 offset:22528
    v_mfma_f32_16x16x32_bf16 v[44:47], a[112:115], v[108:111], v[44:47]
    v_mfma_f32_16x16x32_bf16 v[52:55], a[116:119], v[108:111], v[52:55]
    s_waitcnt lgkmcnt(2)
    v_mfma_f32_16x16x32_bf16 v[32:35], a[120:123], v[112:115], v[32:35]
    ds_read_b128 v[96:99], v18 offset:24576
    v_mfma_f32_16x16x32_bf16 v[40:43], a[124:127], v[112:115], v[40:43]
    v_mfma_f32_16x16x32_bf16 v[48:51], a[128:131], v[112:115], v[48:51]
    v_add_u32 v11, s45, v10
    s_add_u32 s45, s45, 4194304
    v_mfma_f32_16x16x32_bf16 v[36:39], a[120:123], v[116:119], v[36:39]
    ds_read_b128 v[100:103], v18 offset:26624
    v_mfma_f32_16x16x32_bf16 v[44:47], a[124:127], v[116:119], v[44:47]
    v_mov_b32 v14, s50
    s_max_u32 s50, s50, s46
    v_mfma_f32_16x16x32_bf16 v[52:55], a[128:131], v[116:119], v[52:55]
    s_add_u32 s46, s46, 1
    s_waitcnt lgkmcnt(2)
    v_mfma_f32_16x16x32_bf16 v[32:35], a[132:135], v[120:123], v[32:35]
    ds_read_b128 v[104:107], v19 offset:24576
    v_mfma_f32_16x16x32_bf16 v[40:43], a[136:139], v[120:123], v[40:43]
    s_and_b32 s45, s45, 134217727
    v_mfma_f32_16x16x32_bf16 v[48:51], a[140:143], v[120:123], v[48:51]
    s_sub_u32 s51, s46, 28
    s_cmp_gt_i32 s51, 0
    v_mfma_f32_16x16x32_bf16 v[36:39], a[132:135], v[124:127], v[36:39]
    ds_read_b128 v[108:111], v19 offset:26624
    v_mfma_f32_16x16x32_bf16 v[44:47], a[136:139], v[124:127], v[44:47]
    s_cselect_b64 s[52:53], -1, 0
    v_mfma_f32_16x16x32_bf16 v[52:55], a[140:143], v[124:127], v[52:55]
    s_waitcnt lgkmcnt(2)
    v_mfma_f32_16x16x32_bf16 v[32:35], a[144:147], v[96:99], v[32:35]
    ds_read_b128 v[112:115], v18 offset:28672
    v_mfma_f32_16x16x32_bf16 v[40:43], a[148:151], v[96:99], v[40:43]
    v_mfma_f32_16x16x32_bf16 v[48:51], a[152:155], v[96:99], v[48:51]
    v_mfma_f32_16x16x32_bf16 v[36:39], a[144:147], v[100:103], v[36:39]
    ds_read_b128 v[116:119], v18 offset:30720
    v_mfma_f32_16x16x32_bf16 v[44:47], a[148:151], v[100:103], v[44:47]
    v_mfma_f32_16x16x32_bf16 v[52:55], a[152:155], v[100:103], v[52:55]
    s_waitcnt lgkmcnt(2)
    v_mfma_f32_16x16x32_bf16 v[32:35], a[156:159], v[104:107], v[32:35]
    ds_read_b128 v[120:123], v19 offset:28672
    v_mfma_f32_16x16x32_bf16 v[40:43], a[160:163], v[104:107], v[40:43]
    v_mfma_f32_16x16x32_bf16 v[48:51], a[164:167], v[104:107], v[48:51]
    v_mfma_f32_16x16x32_bf16 v[36:39], a[156:159], v[108:111], v[36:39]
    ds_read_b128 v[124:127], v19 offset:30720
    v_mfma_f32_16x16x32_bf16 v[44:47], a[160:163], v[108:111], v[44:47]
    v_mfma_f32_16x16x32_bf16 v[52:55], a[164:167], v[108:111], v[52:55]
    s_waitcnt lgkmcnt(2)
    v_mfma_f32_16x16x32_bf16 v[32:35], a[168:171], v[112:115], v[32:35]
    ds_read_b128 v[96:99], v18 offset:32768
    v_mfma_f32_16x16x32_bf16 v[40:43], a[172:175], v[112:115], v[40:43]
    v_mfma_f32_16x16x32_bf16 v[48:51], a[176:179], v[112:115], v[48:51]
    s_sub_u32 s54, s46, 3
    v_mfma_f32_16x16x32_bf16 v[36:39], a[168:171], v[116:119], v[36:39]
    ds_read_b128 v[100:103], v18 offset:34816
    v_mfma_f32_16x16x32_bf16 v[44:47], a[172:175], v[116:119], v[44:47]
    s_cmp_le_u32 s54, 9
    s_cbranch_scc1 L_kv_tight0
L_kv_loose0:
    v_mfma_f32_16x16x32_bf16 v[52:55], a[176:179], v[116:119], v[52:55]
    s_waitcnt lgkmcnt(2)
    v_mfma_f32_16x16x32_bf16 v[32:35], a[180:183], v[120:123], v[32:35]
    ds_read_b128 v[104:107], v19 offset:32768
    v_mfma_f32_16x16x32_bf16 v[40:43], a[184:187], v[120:123], v[40:43]
    v_mfma_f32_16x16x32_bf16 v[48:51], a[188:191], v[120:123], v[48:51]
    v_mfma_f32_16x16x32_bf16 v[36:39], a[180:183], v[124:127], v[36:39]
    ds_read_b128 v[108:111], v19 offset:34816
    v_mfma_f32_16x16x32_bf16 v[44:47], a[184:187], v[124:127], v[44:47]
    v_mfma_f32_16x16x32_bf16 v[52:55], a[188:191], v[124:127], v[52:55]
    s_waitcnt lgkmcnt(2)
    v_mfma_f32_16x16x32_bf16 v[32:35], a[192:195], v[96:99], v[32:35]
    ds_read_b128 v[112:115], v18 offset:36864
    v_mfma_f32_16x16x32_bf16 v[40:43], a[196:199], v[96:99], v[40:43]
    v_mfma_f32_16x16x32_bf16 v[48:51], a[200:203], v[96:99], v[48:51]
    v_add_u32 v20, s49, v16
    v_add_u32 v21, s49, v17
    v_mfma_f32_16x16x32_bf16 v[36:39], a[192:195], v[100:103], v[36:39]
    ds_read_b128 v[116:119], v18 offset:38912
    s_add_u32 s49, s49, 40960
    s_cmp_eq_u32 s49, 122880
    v_mfma_f32_16x16x32_bf16 v[44:47], a[196:199], v[100:103], v[44:47]
    s_cselect_b32 s49, 0, s49
    v_mfma_f32_16x16x32_bf16 v[52:55], a[200:203], v[100:103], v[52:55]
    s_add_u32 s48, s49, s34
    s_add_u32 s44, s44, 40960
    s_waitcnt lgkmcnt(2)
    v_mfma_f32_16x16x32_bf16 v[32:35], a[204:207], v[104:107], v[32:35]
    ds_read_b128 v[120:123], v19 offset:36864
    v_mfma_f32_16x16x32_bf16 v[40:43], a[208:211], v[104:107], v[40:43]
    v_mfma_f32_16x16x32_bf16 v[48:51], a[212:215], v[104:107], v[48:51]
    s_waitcnt vmcnt(3)
    s_barrier
    buffer_store_dwordx2 v[14:15], v12, s[8:11], 0 offen sc1
    v_mfma_f32_16x16x32_bf16 v[36:39], a[204:207], v[108:111], v[36:39]
    ds_read_b128 v[124:127], v19 offset:38912
    s_add_u32 m0, s48, 0
    v_mfma_f32_16x16x32_bf16 v[44:47], a[208:211], v[108:111], v[44:47]
    buffer_load_dwordx4 v8, s[20:23], s44 offen offset:0 lds
    v_mfma_f32_16x16x32_bf16 v[52:55], a[212:215], v[108:111], v[52:55]
    v_cmp_ne_u32 vcc, s4, v25
    v_cmp_gt_u32 s[28:29], s51, v24
    s_waitcnt lgkmcnt(2)
    v_mfma_f32_16x16x32_bf16 v[32:35], a[216:219], v[112:115], v[32:35]
    ds_read_b128 v[96:99], v20 offset:0
    v_mfma_f32_16x16x32_bf16 v[40:43], a[220:223], v[112:115], v[40:43]
    s_add_u32 m0, s48, 3968
    v_mfma_f32_16x16x32_bf16 v[48:51], a[224:227], v[112:115], v[48:51]
    buffer_load_dwordx4 v8, s[20:23], s44 offen offset:128 lds
    v_mfma_f32_16x16x32_bf16 v[36:39], a[216:219], v[116:119], v[36:39]
    ds_read_b128 v[100:103], v20 offset:2048
    v_mfma_f32_16x16x32_bf16 v[44:47], a[220:223], v[116:119], v[44:47]
    s_or_b64 vcc, vcc, s[28:29]
    s_and_b64 vcc, vcc, s[52:53]
    s_cbranch_scc1 L_kv_hold0
L_kv_free0:
    v_mfma_f32_16x16x32_bf16 v[52:55], a[224:227], v[116:119], v[52:55]
    s_add_u32 m0, s48, 7936
    s_waitcnt lgkmcnt(2)
    v_mfma_f32_16x16x32_bf16 v[32:35], a[228:231], v[120:123], v[32:35]
    ds_read_b128 v[104:107], v21 offset:0
    buffer_load_dwordx4 v8, s[20:23], s44 offen offset:256 lds
    v_mfma_f32_16x16x32_bf16 v[40:43], a[232:235], v[120:123], v[40:43]
    v_mfma_f32_16x16x32_bf16 v[48:51], a[236:239], v[120:123], v[48:51]
    v_mfma_f32_16x16x32_bf16 v[36:39], a[228:231], v[124:127], v[36:39]
    ds_read_b128 v[108:111], v21 offset:2048
    s_add_u32 m0, s48, 11904
    v_mfma_f32_16x16x32_bf16 v[44:47], a[232:235], v[124:127], v[44:47]
    buffer_load_dwordx4 v8, s[20:23], s44 offen offset:384 lds
    v_mfma_f32_16x16x32_bf16 v[52:55], a[236:239], v[124:127], v[52:55]
    s_cmp_le_u32 s46, 1
    s_cbranch_scc1 L_kv_early0
L_kv_back0:
    s_waitcnt lgkmcnt(2)
    v_mfma_f32_16x16x32_bf16 v[56:59], a[0:3], v[96:99], 0
    ds_read_b128 v[112:115], v20 offset:4096
    v_mfma_f32_16x16x32_bf16 v[64:67], a[4:7], v[96:99], 0
    s_add_u32 m0, s48, 15872
    v_mfma_f32_16x16x32_bf16 v[72:75], a[8:11], v[96:99], 0
    buffer_load_dwordx4 v8, s[20:23], s44 offen offset:512 lds
    v_mfma_f32_16x16x32_bf16 v[60:63], a[0:3], v[100:103], 0
    ds_read_b128 v[116:119], v20 offset:6144
    v_mfma_f32_16x16x32_bf16 v[68:71], a[4:7], v[100:103], 0
    v_mfma_f32_16x16x32_bf16 v[76:79], a[8:11], v[100:103], 0
    s_add_u32 m0, s48, 19840
    s_waitcnt lgkmcnt(2)
    v_mfma_f32_16x16x32_bf16 v[56:59], a[12:15], v[104:107], v[56:59]
    ds_read_b128 v[120:123], v21 offset:4096
    buffer_load_dwordx4 v8, s[20:23], s44 offen offset:640 lds
    v_mfma_f32_16x16x32_bf16 v[64:67], a[16:19], v[104:107], v[64:67]
    buffer_load_dwordx2 v[24:25], v22, s[8:11], 0 offen sc1
    v_mfma_f32_16x16x32_bf16 v[72:75], a[20:23], v[104:107], v[72:75]
    v_mfma_f32_16x16x32_bf16 v[60:63], a[12:15], v[108:111], v[60:63]
    ds_read_b128 v[124:127], v21 offset:6144
    s_add_u32 m0, s48, 23808
    v_mfma_f32_16x16x32_bf16 v[68:71], a[16:19], v[108:111], v[68:71]
    buffer_load_dwordx4 v8, s[20:23], s44 offen offset:768 lds
    v_mfma_f32_16x16x32_bf16 v[76:79], a[20:23], v[108:111], v[76:79]
    s_waitcnt lgkmcnt(2)
    v_mfma_f32_16x16x32_bf16 v[56:59], a[24:27], v[112:115], v[56:59]
    ds_read_b128 v[96:99], v20 offset:8192
    v_mfma_f32_16x16x32_bf16 v[64:67], a[28:31], v[112:115], v[64:67]
    s_add_u32 m0, s48, 27776
    v_mfma_f32_16x16x32_bf16 v[72:75], a[32:35], v[112:115], v[72:75]
    buffer_load_dwordx4 v8, s[20:23], s44 offen offset:896 lds
    v_mfma_f32_16x16x32_bf16 v[60:63], a[24:27], v[116:119], v[60:63]
    ds_read_b128 v[100:103], v20 offset:10240
    v_mfma_f32_16x16x32_bf16 v[68:71], a[28:31], v[116:119], v[68:71]
    v_mfma_f32_16x16x32_bf16 v[76:79], a[32:35], v[116:119], v[76:79]
    s_add_u32 m0, s48, 31744
    s_waitcnt lgkmcnt(2)
    v_mfma_f32_16x16x32_bf16 v[56:59], a[36:39], v[120:123], v[56:59]
    ds_read_b128 v[104:107], v21 offset:8192
    buffer_load_dwordx4 v8, s[20:23], s44 offen offset:1024 lds
    v_mfma_f32_16x16x32_bf16 v[64:67], a[40:43], v[120:123], v[64:67]
    v_mfma_f32_16x16x32_bf16 v[72:75], a[44:47], v[120:123], v[72:75]
    v_mfma_f32_16x16x32_bf16 v[60:63], a[36:39], v[124:127], v[60:63]
    ds_read_b128 v[108:111], v21 offset:10240
    s_add_u32 m0, s48, 35712
    v_mfma_f32_16x16x32_bf16 v[68:71], a[40:43], v[124:127], v[68:71]
    buffer_load_dwordx4 v8, s[20:23], s44 offen offset:1152 lds
    v_mfma_f32_16x16x32_bf16 v[76:79], a[44:47], v[124:127], v[76:79]
    s_waitcnt lgkmcnt(2)
    v_mfma_f32_16x16x32_bf16 v[56:59], a[48:51], v[96:99], v[56:59]
    ds_read_b128 v[112:115], v20 offset:12288
    v_mfma_f32_16x16x32_bf16 v[64:67], a[52:55], v[96:99], v[64:67]
    v_mfma_f32_16x16x32_bf16 v[72:75], a[56:59], v[96:99], v[72:75]
    v_cvt_pk_bf16_f32 v80, v32, v33
    v_mfma_f32_16x16x32_bf16 v[60:63], a[48:51], v[100:103], v[60:63]
    ds_read_b128 v[116:119], v20 offset:14336
    v_cvt_pk_bf16_f32 v81, v34, v35
    v_mfma_f32_16x16x32_bf16 v[68:71], a[52:55], v[100:103], v[68:71]
    v_mfma_f32_16x16x32_bf16 v[76:79], a[56:59], v[100:103], v[76:79]
    v_cvt_pk_bf16_f32 v82, v40, v41
    s_waitcnt lgkmcnt(2)
    v_mfma_f32_16x16x32_bf16 v[56:59], a[60:63], v[104:107], v[56:59]
    ds_read_b128 v[120:123], v21 offset:12288
    v_cvt_pk_bf16_f32 v83, v42, v43
    v_mfma_f32_16x16x32_bf16 v[64:67], a[64:67], v[104:107], v[64:67]
    v_mfma_f32_16x16x32_bf16 v[72:75], a[68:71], v[104:107], v[72:75]
    v_cvt_pk_bf16_f32 v84, v36, v37
    v_mfma_f32_16x16x32_bf16 v[60:63], a[60:63], v[108:111], v[60:63]
    ds_read_b128 v[124:127], v21 offset:14336
    v_cvt_pk_bf16_f32 v85, v38, v39
    v_mfma_f32_16x16x32_bf16 v[68:71], a[64:67], v[108:111], v[68:71]
    v_mfma_f32_16x16x32_bf16 v[76:79], a[68:71], v[108:111], v[76:79]
    v_cvt_pk_bf16_f32 v86, v44, v45
    s_waitcnt lgkmcnt(2)
    v_mfma_f32_16x16x32_bf16 v[56:59], a[72:75], v[112:115], v[56:59]
    ds_read_b128 v[96:99], v20 offset:16384
    v_cvt_pk_bf16_f32 v87, v46, v47
    v_mfma_f32_16x16x32_bf16 v[64:67], a[76:79], v[112:115], v[64:67]
    v_mfma_f32_16x16x32_bf16 v[72:75], a[80:83], v[112:115], v[72:75]
    v_cvt_pk_bf16_f32 v88, v48, v49
    v_mfma_f32_16x16x32_bf16 v[60:63], a[72:75], v[116:119], v[60:63]
    ds_read_b128 v[100:103], v20 offset:18432
    v_cvt_pk_bf16_f32 v89, v50, v51
    v_mfma_f32_16x16x32_bf16 v[68:71], a[76:79], v[116:119], v[68:71]
    v_mfma_f32_16x16x32_bf16 v[76:79], a[80:83], v[116:119], v[76:79]
    v_cvt_pk_bf16_f32 v90, v52, v53
    s_waitcnt lgkmcnt(2)
    v_mfma_f32_16x16x32_bf16 v[56:59], a[84:87], v[120:123], v[56:59]
    ds_read_b128 v[104:107], v21 offset:16384
    v_cvt_pk_bf16_f32 v91, v54, v55
    v_mfma_f32_16x16x32_bf16 v[64:67], a[88:91], v[120:123], v[64:67]
    v_mfma_f32_16x16x32_bf16 v[72:75], a[92:95], v[120:123], v[72:75]
    v_mfma_f32_16x16x32_bf16 v[60:63], a[84:87], v[124:127], v[60:63]
    ds_read_b128 v[108:111], v21 offset:18432
    v_mfma_f32_16x16x32_bf16 v[68:71], a[88:91], v[124:127], v[68:71]
    buffer_store_dwordx4 v[80:83], v11, s[8:11], s56 offen sc1
    v_mfma_f32_16x16x32_bf16 v[76:79], a[92:95], v[124:127], v[76:79]
    s_waitcnt lgkmcnt(2)
    v_mfma_f32_16x16x32_bf16 v[56:59], a[96:99], v[96:99], v[56:59]
    ds_read_b128 v[112:115], v20 offset:20480
    v_mfma_f32_16x16x32_bf16 v[64:67], a[100:103], v[96:99], v[64:67]
    v_mfma_f32_16x16x32_bf16 v[72:75], a[104:107], v[96:99], v[72:75]
    buffer_store_dwordx4 v[84:87], v11, s[8:11], s57 offen sc1
    v_mfma_f32_16x16x32_bf16 v[60:63], a[96:99], v[100:103], v[60:63]
    ds_read_b128 v[116:119], v20 offset:22528
    v_mfma_f32_16x16x32_bf16 v[68:71], a[100:103], v[100:103], v[68:71]
    v_mfma_f32_16x16x32_bf16 v[76:79], a[104:107], v[100:103], v[76:79]
    s_waitcnt lgkmcnt(2)
    v_mfma_f32_16x16x32_bf16 v[56:59], a[108:111], v[104:107], v[56:59]
    ds_read_b128 v[120:123], v21 offset:20480
    buffer_store_dwordx4 v[88:91], v11, s[8:11], s58 offen sc1
    v_mfma_f32_16x16x32_bf16 v[64:67], a[112:115], v[104:107], v[64:67]
    v_mfma_f32_16x16x32_bf16 v[72:75], a[116:119], v[104:107], v[72:75]
    v_mfma_f32_16x16x32_bf16 v[60:63], a[108:111], v[108:111], v[60:63]
    ds_read_b128 v[124:127], v21 offset:22528
    v_mfma_f32_16x16x32_bf16 v[68:71], a[112:115], v[108:111], v[68:71]
    v_mfma_f32_16x16x32_bf16 v[76:79], a[116:119], v[108:111], v[76:79]
    s_waitcnt lgkmcnt(2)
    v_mfma_f32_16x16x32_bf16 v[56:59], a[120:123], v[112:115], v[56:59]
    ds_read_b128 v[96:99], v20 offset:24576
    v_mfma_f32_16x16x32_bf16 v[64:67], a[124:127], v[112:115], v[64:67]
    v_mfma_f32_16x16x32_bf16 v[72:75], a[128:131], v[112:115], v[72:75]
    v_add_u32 v11, s45, v10
    s_add_u32 s45, s45, 4194304
    v_mfma_f32_16x16x32_bf16 v[60:63], a[120:123], v[116:119], v[60:63]
    ds_read_b128 v[100:103], v20 offset:26624
    v_mfma_f32_16x16x32_bf16 v[68:71], a[124:127], v[116:119], v[68:71]
    v_mov_b32 v14, s50
    s_max_u32 s50, s50, s46
    v_mfma_f32_16x16x32_bf16 v[76:79], a[128:131], v[116:119], v[76:79]
    s_add_u32 s46, s46, 1
    s_waitcnt lgkmcnt(2)
    v_mfma_f32_16x16x32_bf16 v[56:59], a[132:135], v[120:123], v[56:59]
    ds_read_b128 v[104:107], v21 offset:24576
    v_mfma_f32_16x16x32_bf16 v[64:67], a[136:139], v[120:123], v[64:67]
    s_and_b32 s45, s45, 134217727
    v_mfma_f32_16x16x32_bf16 v[72:75], a[140:143], v[120:123], v[72:75]
    s_sub_u32 s51, s46, 28
    s_cmp_gt_i32 s51, 0
    v_mfma_f32_16x16x32_bf16 v[60:63], a[132:135], v[124:127], v[60:63]
    ds_read_b128 v[108:111], v21 offset:26624
    v_mfma_f32_16x16x32_bf16 v[68:71], a[136:139], v[124:127], v[68:71]
    s_cselect_b64 s[52:53], -1, 0
    v_mfma_f32_16x16x32_bf16 v[76:79], a[140:143], v[124:127], v[76:79]
    s_waitcnt lgkmcnt(2)
    v_mfma_f32_16x16x32_bf16 v[56:59], a[144:147], v[96:99], v[56:59]
    ds_read_b128 v[112:115], v20 offset:28672
    v_mfma_f32_16x16x32_bf16 v[64:67], a[148:151], v[96:99], v[64:67]
    v_mfma_f32_16x16x32_bf16 v[72:75], a[152:155], v[96:99], v[72:75]
    v_mfma_f32_16x16x32_bf16 v[60:63], a[144:147], v[100:103], v[60:63]
    ds_read_b128 v[116:119], v20 offset:30720
    v_mfma_f32_16x16x32_bf16 v[68:71], a[148:151], v[100:103], v[68:71]
    v_mfma_f32_16x16x32_bf16 v[76:79], a[152:155], v[100:103], v[76:79]
    s_waitcnt lgkmcnt(2)
    v_mfma_f32_16x16x32_bf16 v[56:59], a[156:159], v[104:107], v[56:59]
    ds_read_b128 v[120:123], v21 offset:28672
    v_mfma_f32_16x16x32_bf16 v[64:67], a[160:163], v[104:107], v[64:67]
    v_mfma_f32_16x16x32_bf16 v[72:75], a[164:167], v[104:107], v[72:75]
    v_mfma_f32_16x16x32_bf16 v[60:63], a[156:159], v[108:111], v[60:63]
    ds_read_b128 v[124:127], v21 offset:30720
    v_mfma_f32_16x16x32_bf16 v[68:71], a[160:163], v[108:111], v[68:71]
    v_mfma_f32_16x16x32_bf16 v[76:79], a[164:167], v[108:111], v[76:79]
    s_waitcnt lgkmcnt(2)
    v_mfma_f32_16x16x32_bf16 v[56:59], a[168:171], v[112:115], v[56:59]
    ds_read_b128 v[96:99], v20 offset:32768
    v_mfma_f32_16x16x32_bf16 v[64:67], a[172:175], v[112:115], v[64:67]
    v_mfma_f32_16x16x32_bf16 v[72:75], a[176:179], v[112:115], v[72:75]
    s_sub_u32 s54, s46, 3
    v_mfma_f32_16x16x32_bf16 v[60:63], a[168:171], v[116:119], v[60:63]
    ds_read_b128 v[100:103], v20 offset:34816
    v_mfma_f32_16x16x32_bf16 v[68:71], a[172:175], v[116:119], v[68:71]
    s_cmp_le_u32 s54, 9
    s_cbranch_scc1 L_kv_tight1
L_kv_loose1:
    v_mfma_f32_16x16x32_bf16 v[76:79], a[176:179], v[116:119], v[76:79]
    s_waitcnt lgkmcnt(2)
    v_mfma_f32_16x16x32_bf16 v[56:59], a[180:183], v[120:123], v[56:59]
    ds_read_b128 v[104:107], v21 offset:32768
    v_mfma_f32_16x16x32_bf16 v[64:67], a[184:187], v[120:123], v[64:67]
    v_mfma_f32_16x16x32_bf16 v[72:75], a[188:191], v[120:123], v[72:75]
    v_mfma_f32_16x16x32_bf16 v[60:63], a[180:183], v[124:127], v[60:63]
    ds_read_b128 v[108:111], v21 offset:34816
    v_mfma_f32_16x16x32_bf16 v[68:71], a[184:187], v[124:127], v[68:71]
    v_mfma_f32_16x16x32_bf16 v[76:79], a[188:191], v[124:127], v[76:79]
    s_waitcnt lgkmcnt(2)
    v_mfma_f32_16x16x32_bf16 v[56:59], a[192:195], v[96:99], v[56:59]
    ds_read_b128 v[112:115], v20 offset:36864
    v_mfma_f32_16x16x32_bf16 v[64:67], a[196:199], v[96:99], v[64:67]
    v_mfma_f32_16x16x32_bf16 v[72:75], a[200:203], v[96:99], v[72:75]
    v_add_u32 v18, s49, v16
    v_add_u32 v19, s49, v17
    v_mfma_f32_16x16x32_bf16 v[60:63], a[192:195], v[100:103], v[60:63]
    ds_read_b128 v[116:119], v20 offset:38912
    s_add_u32 s49, s49, 40960
    s_cmp_eq_u32 s49, 122880
    v_mfma_f32_16x16x32_bf16 v[68:71], a[196:199], v[100:103], v[68:71]
    s_cselect_b32 s49, 0, s49
    v_mfma_f32_16x16x32_bf16 v[76:79], a[200:203], v[100:103], v[76:79]
    s_add_u32 s48, s49, s34
    s_add_u32 s44, s44, 40960
    s_waitcnt lgkmcnt(2)
    v_mfma_f32_16x16x32_bf16 v[56:59], a[204:207], v[104:107], v[56:59]
    ds_read_b128 v[120:123], v21 offset:36864
    v_mfma_f32_16x16x32_bf16 v[64:67], a[208:211], v[104:107], v[64:67]
    v_mfma_f32_16x16x32_bf16 v[72:75], a[212:215], v[104:107], v[72:75]
    s_waitcnt vmcnt(3)
    s_barrier
    buffer_store_dwordx2 v[14:15], v12, s[8:11], 0 offen sc1
    v_mfma_f32_16x16x32_bf16 v[60:63], a[204:207], v[108:111], v[60:63]
    ds_read_b128 v[124:127], v21 offset:38912
    s_add_u32 m0, s48, 0
    v_mfma_f32_16x16x32_bf16 v[68:71], a[208:211], v[108:111], v[68:71]
    buffer_load_dwordx4 v8, s[20:23], s44 offen offset:0 lds
    v_mfma_f32_16x16x32_bf16 v[76:79], a[212:215], v[108:111], v[76:79]
    v_cmp_ne_u32 vcc, s4, v25
    v_cmp_gt_u32 s[28:29], s51, v24
    s_waitcnt lgkmcnt(2)
    v_mfma_f32_16x16x32_bf16 v[56:59], a[216:219], v[112:115], v[56:59]
    ds_read_b128 v[96:99], v18 offset:0
    v_mfma_f32_16x16x32_bf16 v[64:67], a[220:223], v[112:115], v[64:67]
    s_add_u32 m0, s48, 3968
    v_mfma_f32_16x16x32_bf16 v[72:75], a[224:227], v[112:115], v[72:75]
    buffer_load_dwordx4 v8, s[20:23], s44 offen offset:128 lds
    v_mfma_f32_16x16x32_bf16 v[60:63], a[216:219], v[116:119], v[60:63]
    ds_read_b128 v[100:103], v18 offset:2048
    v_mfma_f32_16x16x32_bf16 v[68:71], a[220:223], v[116:119], v[68:71]
    s_or_b64 vcc, vcc, s[28:29]
    s_and_b64 vcc, vcc, s[52:53]
    s_cbranch_scc1 L_kv_hold1
L_kv_free1:
    v_mfma_f32_16x16x32_bf16 v[76:79], a[224:227], v[116:119], v[76:79]
    s_add_u32 m0, s48, 7936
    s_waitcnt lgkmcnt(2)
    v_mfma_f32_16x16x32_bf16 v[56:59], a[228:231], v[120:123], v[56:59]
    ds_read_b128 v[104:107], v19 offset:0
    buffer_load_dwordx4 v8, s[20:23], s44 offen offset:256 lds
    v_mfma_f32_16x16x32_bf16 v[64:67], a[232:235], v[120:123], v[64:67]
    v_mfma_f32_16x16x32_bf16 v[72:75], a[236:239], v[120:123], v[72:75]
    v_mfma_f32_16x16x32_bf16 v[60:63], a[228:231], v[124:127], v[60:63]
    ds_read_b128 v[108:111], v19 offset:2048
    s_add_u32 m0, s48, 11904
    v_mfma_f32_16x16x32_bf16 v[68:71], a[232:235], v[124:127], v[68:71]
    buffer_load_dwordx4 v8, s[20:23], s44 offen offset:384 lds
    v_mfma_f32_16x16x32_bf16 v[76:79], a[236:239], v[124:127], v[76:79]
    s_cmp_le_u32 s46, 1
    s_cbranch_scc1 L_kv_early1
L_kv_back1:
    s_cmp_lt_u32 s46, 64
    s_cbranch_scc1 L_kv_loop
    s_nop 4
    v_cvt_pk_bf16_f32 v80, v56, v57
    v_cvt_pk_bf16_f32 v81, v58, v59
    v_cvt_pk_bf16_f32 v82, v64, v65
    v_cvt_pk_bf16_f32 v83, v66, v67
    v_cvt_pk_bf16_f32 v84, v60, v61
    v_cvt_pk_bf16_f32 v85, v62, v63
    v_cvt_pk_bf16_f32 v86, v68, v69
    v_cvt_pk_bf16_f32 v87, v70, v71
    v_cvt_pk_bf16_f32 v88, v72, v73
    v_cvt_pk_bf16_f32 v89, v74, v75
    v_cvt_pk_bf16_f32 v90, v76, v77
    v_cvt_pk_bf16_f32 v91, v78, v79
    buffer_store_dwordx4 v[80:83], v11, s[8:11], s56 offen sc1
    buffer_store_dwordx4 v[84:87], v11, s[8:11], s57 offen sc1
    buffer_store_dwordx4 v[88:91], v11, s[8:11], s58 offen sc1
    s_waitcnt vmcnt(0) lgkmcnt(0)
    v_mov_b32 v14, 64
    buffer_store_dwordx2 v[14:15], v12, s[8:11], 0 offen sc1
    s_branch L_kv_done
L_kv_early0:
    s_nop 6
    v_cvt_pk_bf16_f32 v80, v32, v33
    v_cvt_pk_bf16_f32 v81, v34, v35
    v_cvt_pk_bf16_f32 v82, v40, v41
    v_cvt_pk_bf16_f32 v83, v42, v43
    v_cvt_pk_bf16_f32 v84, v36, v37
    v_cvt_pk_bf16_f32 v85, v38, v39
    v_cvt_pk_bf16_f32 v86, v44, v45
    v_cvt_pk_bf16_f32 v87, v46, v47
    v_cvt_pk_bf16_f32 v88, v48, v49
    v_cvt_pk_bf16_f32 v89, v50, v51
    v_cvt_pk_bf16_f32 v90, v52, v53
    v_cvt_pk_bf16_f32 v91, v54, v55
    buffer_store_dwordx4 v[80:83], v11, s[8:11], s56 offen sc1
    buffer_store_dwordx4 v[84:87], v11, s[8:11], s57 offen sc1
    buffer_store_dwordx4 v[88:91], v11, s[8:11], s58 offen sc1
    s_mov_b32 s50, s46
    s_waitcnt vmcnt(0)
    v_mov_b32 v14, s50
    buffer_store_dwordx2 v[14:15], v12, s[8:11], 0 offen sc1
    s_branch L_kv_back0
L_kv_early1:
    s_nop 6
    v_cvt_pk_bf16_f32 v80, v56, v57
    v_cvt_pk_bf16_f32 v81, v58, v59
    v_cvt_pk_bf16_f32 v82, v64, v65
    v_cvt_pk_bf16_f32 v83, v66, v67
    v_cvt_pk_bf16_f32 v84, v60, v61
    v_cvt_pk_bf16_f32 v85, v62, v63
    v_cvt_pk_bf16_f32 v86, v68, v69
    v_cvt_pk_bf16_f32 v87, v70, v71
    v_cvt_pk_bf16_f32 v88, v72, v73
    v_cvt_pk_bf16_f32 v89, v74, v75
    v_cvt_pk_bf16_f32 v90, v76, v77
    v_cvt_pk_bf16_f32 v91, v78, v79
    buffer_store_dwordx4 v[80:83], v11, s[8:11], s56 offen sc1
    buffer_store_dwordx4 v[84:87], v11, s[8:11], s57 offen sc1
    buffer_store_dwordx4 v[88:91], v11, s[8:11], s58 offen sc1
    s_mov_b32 s50, s46
    s_waitcnt vmcnt(0)
    v_mov_b32 v14, s50
    buffer_store_dwordx2 v[14:15], v12, s[8:11], 0 offen sc1
    s_branch L_kv_back1
L_kv_tight0:
    s_waitcnt vmcnt(0)
    v_mov_b32 v14, s50
    buffer_store_dwordx2 v[14:15], v12, s[8:11], 0 offen sc1
    s_branch L_kv_loose0
L_kv_tight1:
    s_waitcnt vmcnt(0)
    v_mov_b32 v14, s50
    buffer_store_dwordx2 v[14:15], v12, s[8:11], 0 offen sc1
    s_branch L_kv_loose1
L_kv_hold0:
    s_branch L_fm_45
L_fw_43:
    s_sleep 8
L_fm_45:
    buffer_load_dwordx2 v[24:25], v22, s[8:11], 0 offen sc1
    s_add_u32 s7, s7, 1
    s_bitcmp1_b32 s7, 22
    s_cbranch_scc1 L_abort
    s_waitcnt vmcnt(0)
    v_cmp_ne_u32 vcc, s4, v25
    v_cmp_gt_u32 s[28:29], s51, v24
    s_or_b64 vcc, vcc, s[28:29]
    s_cbranch_scc1 L_fw_43
L_fe_44:
    s_branch L_kv_free0
L_kv_hold1:
    s_branch L_fm_48
L_fw_46:
    s_sleep 8
L_fm_48:
    buffer_load_dwordx2 v[24:25], v22, s[8:11], 0 offen sc1
    s_add_u32 s7, s7, 1
    s_bitcmp1_b32 s7, 22
    s_cbranch_scc1 L_abort
    s_waitcnt vmcnt(0)
    v_cmp_ne_u32 vcc, s4, v25
    v_cmp_gt_u32 s[28:29], s51, v24
    s_or_b64 vcc, vcc, s[28:29]
    s_cbranch_scc1 L_fw_46
L_fe_47:
    s_branch L_kv_free1
L_kv_done:
    s_cmp_eq_u32 s41, 2
    s_cbranch_scc1 L_g
    s_branch L_a3
L_u:
    s_sub_u32 s40, s5, 4
    s_lshl_b32 s40, s40, 3
    s_and_b32 s30, s6, 7
    s_add_u32 s40, s40, s30
    s_mul_i32 s43, s40, 245760
    s_mov_b32 s12, s80
    s_mov_b32 s13, s81
    s_mov_b32 s14, 7864320
    s_mov_b32 s15, 0x20000
    s_mul_i32 s32, s3, 15360
    s_add_u32 s32, s32, 32768
    v_add_u32 v1, 0, v0
    v_mul_u32_u24 v2, 3277, v1
    v_lshrrev_b32 v2, 16, v2
    v_mul_u32_u24 v3, 20, v2
    v_sub_u32 v3, v1, v3
    v_mul_u32_u24 v2, 1280, v2
    v_lshl_add_u32 v2, v3, 4, v2
    s_mul_i32 s30, s3, 320
    v_add_u32 v4, s30, v2
    v_add_u32 v1, 64, v0
    v_mul_u32_u24 v2, 3277, v1
    v_lshrrev_b32 v2, 16, v2
    v_mul_u32_u24 v3, 20, v2
    v_sub_u32 v3, v1, v3
    v_mul_u32_u24 v2, 1280, v2
    v_lshl_add_u32 v2, v3, 4, v2
    s_mul_i32 s30, s3, 320
    v_add_u32 v5, s30, v2
    v_add_u32 v1, 128, v0
    v_mul_u32_u24 v2, 3277, v1
    v_lshrrev_b32 v2, 16, v2
    v_mul_u32_u24 v3, 20, v2
    v_sub_u32 v3, v1, v3
    v_mul_u32_u24 v2, 1280, v2
    v_lshl_add_u32 v2, v3, 4, v2
    s_mul_i32 s30, s3, 320
    v_add_u32 v6, s30, v2
    v_add_u32 v1, 192, v0
    v_mul_u32_u24 v2, 3277, v1
    v_lshrrev_b32 v2, 16, v2
    v_mul_u32_u24 v3, 20, v2
    v_sub_u32 v3, v1, v3
    v_mul_u32_u24 v2, 1280, v2
    v_lshl_add_u32 v2, v3, 4, v2
    s_mul_i32 s30, s3, 320
    v_add_u32 v7, s30, v2
    v_add_u32 v1, 256, v0
    v_mul_u32_u24 v2, 3277, v1
    v_lshrrev_b32 v2, 16, v2
    v_mul_u32_u24 v3, 20, v2
    v_sub_u32 v3, v1, v3
    v_mul_u32_u24 v2, 1280, v2
    v_lshl_add_u32 v2, v3, 4, v2
    s_mul_i32 s30, s3, 320
    v_add_u32 v8, s30, v2
    v_lshrrev_b32 v1, 2, v0
    v_mul_u32_u24 v1, 320, v1
    v_and_b32 v2, 3, v0
    v_lshl_add_u32 v1, v2, 3, v1
    v_add_u32 v9, s32, v1
    s_sub_u32 s54, s5, 4
    s_sub_u32 s55, s6, 8
    s_cmp_lg_u32 s3, 3
    s_cbranch_scc1 L_u_nt
    s_lshl_b32 s98, s55, 6
    v_add_u32 v40, s98, v0
    v_mul_u32_u24 v41, 2731, v40
    v_lshrrev_b32 v41, 16, v41
    v_mul_u32_u24 v42, 24, v41
    v_sub_u32 v42, v40, v42
    v_mul_u32_u24 v41, 12288, v41
    v_lshl_add_u32 v41, v42, 7, v41
    s_mul_i32 s98, s54, 3072
    v_add_u32 v41, s98, v41
    s_and_b32 s98, s55, 7
    s_lshl_b32 s96, s54, 3
    s_add_u32 s98, s98, s96
    s_mul_i32 s98, s98, 245760
    s_lshr_b32 s96, s55, 3
    s_lshl_b32 s96, s96, 13
    s_add_u32 s98, s98, s96
    v_lshlrev_b32 v42, 7, v0
    v_add_u32 v42, s98, v42
    s_mov_b32 s92, s78
    s_mov_b32 s93, s79
    s_mov_b32 s94, 7864320
    s_mov_b32 s95, 0x20000
    s_mov_b32 s96, 0
    buffer_load_dword v44, v41, s[92:95], s96 offen
    s_waitcnt vmcnt(8)
    s_mov_b32 s96, 786432
    buffer_load_dword v45, v41, s[92:95], s96 offen
    s_waitcnt vmcnt(8)
    s_mov_b32 s96, 1572864
    buffer_load_dword v46, v41, s[92:95], s96 offen
    s_waitcnt vmcnt(8)
    s_mov_b32 s96, 2359296
    buffer_load_dword v47, v41, s[92:95], s96 offen
    s_waitcnt vmcnt(8)
    s_mov_b32 s96, 3145728
    buffer_load_dword v48, v41, s[92:95], s96 offen
    s_waitcnt vmcnt(8)
    s_mov_b32 s96, 3932160
    buffer_load_dword v49, v41, s[92:95], s96 offen
    s_waitcnt vmcnt(8)
    s_mov_b32 s96, 4718592
    buffer_load_dword v50, v41, s[92:95], s96 offen
    s_waitcnt vmcnt(8)
    s_mov_b32 s96, 5505024
    buffer_load_dword v51, v41, s[92:95], s96 offen
    s_waitcnt vmcnt(8)
    s_mov_b32 s96, 6291456
    buffer_load_dword v44, v41, s[92:95], s96 offen
    s_waitcnt vmcnt(8)
    s_mov_b32 s96, 7077888
    buffer_load_dword v45, v41, s[92:95], s96 offen
    s_waitcnt vmcnt(8)
L_u_nt:
    s_barrier
    s_add_u32 s33, s43, 0
    s_add_u32 m0, s32, 0
    s_nop 0
    buffer_load_dwordx4 v4, s[12:15], s33 offen lds
    s_add_u32 m0, s32, 1024
    s_nop 0
    buffer_load_dwordx4 v5, s[12:15], s33 offen lds
    s_add_u32 m0, s32, 2048
    s_nop 0
    buffer_load_dwordx4 v6, s[12:15], s33 offen lds
    s_add_u32 m0, s32, 3072
    s_nop 0
    buffer_load_dwordx4 v7, s[12:15], s33 offen lds
    s_add_u32 m0, s32, 4096
    s_nop 0
    buffer_load_dwordx4 v8, s[12:15], s33 offen lds
    s_add_u32 s33, s43, 20480
    s_add_u32 m0, s32, 5120
    s_nop 0
    buffer_load_dwordx4 v4, s[12:15], s33 offen lds
    s_add_u32 m0, s32, 6144
    s_nop 0
    buffer_load_dwordx4 v5, s[12:15], s33 offen lds
    s_add_u32 m0, s32, 7168
    s_nop 0
    buffer_load_dwordx4 v6, s[12:15], s33 offen lds
    s_add_u32 m0, s32, 8192
    s_nop 0
    buffer_load_dwordx4 v7, s[12:15], s33 offen lds
    s_add_u32 m0, s32, 9216
    s_nop 0
    buffer_load_dwordx4 v8, s[12:15], s33 offen lds
    s_add_u32 s33, s43, 40960
    s_add_u32 m0, s32, 10240
    s_nop 0
    buffer_load_dwordx4 v4, s[12:15], s33 offen lds
    s_add_u32 m0, s32, 11264
    s_nop 0
    buffer_load_dwordx4 v5, s[12:15], s33 offen lds
    s_add_u32 m0, s32, 12288
    s_nop 0
    buffer_load_dwordx4 v6, s[12:15], s33 offen lds
    s_add_u32 m0, s32, 13312
    s_nop 0
    buffer_load_dwordx4 v7, s[12:15], s33 offen lds
    s_add_u32 m0, s32, 14336
    s_nop 0
    buffer_load_dwordx4 v8, s[12:15], s33 offen lds
    s_waitcnt vmcnt(10)
    ds_read_b64_tr_b16 a[0:1], v9 offset:0
    ds_read_b64_tr_b16 a[24:25], v9 offset:32
    ds_read_b64_tr_b16 a[48:49], v9 offset:64
    ds_read_b64_tr_b16 a[72:73], v9 offset:96
    ds_read_b64_tr_b16 a[96:97], v9 offset:128
    ds_read_b64_tr_b16 a[120:121], v9 offset:160
    ds_read_b64_tr_b16 a[144:145], v9 offset:192
    ds_read_b64_tr_b16 a[168:169], v9 offset:224
    ds_read_b64_tr_b16 a[192:193], v9 offset:256
    ds_read_b64_tr_b16 a[216:217], v9 offset:288
    s_waitcnt lgkmcnt(0)
    s_add_u32 s33, s43, 61440
    s_add_u32 m0, s32, 0
    s_nop 0
    buffer_load_dwordx4 v4, s[12:15], s33 offen lds
    s_add_u32 m0, s32, 1024
    s_nop 0
    buffer_load_dwordx4 v5, s[12:15], s33 offen lds
    s_add_u32 m0, s32, 2048
    s_nop 0
    buffer_load_dwordx4 v6, s[12:15], s33 offen lds
    s_add_u32 m0, s32, 3072
    s_nop 0
    buffer_load_dwordx4 v7, s[12:15], s33 offen lds
    s_add_u32 m0, s32, 4096
    s_nop 0
    buffer_load_dwordx4 v8, s[12:15], s33 offen lds
    s_waitcnt vmcnt(10)
    ds_read_b64_tr_b16 a[2:3], v9 offset:5120
    ds_read_b64_tr_b16 a[26:27], v9 offset:5152
    ds_read_b64_tr_b16 a[50:51], v9 offset:5184
    ds_read_b64_tr_b16 a[74:75], v9 offset:5216
    ds_read_b64_tr_b16 a[98:99], v9 offset:5248
    ds_read_b64_tr_b16 a[122:123], v9 offset:5280
    ds_read_b64_tr_b16 a[146:147], v9 offset:5312
    ds_read_b64_tr_b16 a[170:171], v9 offset:5344
    ds_read_b64_tr_b16 a[194:195], v9 offset:5376
    ds_read_b64_tr_b16 a[218:219], v9 offset:5408
    s_waitcnt lgkmcnt(0)
    s_add_u32 s33, s43, 81920
    s_add_u32 m0, s32, 5120
    s_nop 0
    buffer_load_dwordx4 v4, s[12:15], s33 offen lds
    s_add_u32 m0, s32, 6144
    s_nop 0
    buffer_load_dwordx4 v5, s[12:15], s33 offen lds
    s_add_u32 m0, s32, 7168
    s_nop 0
    buffer_load_dwordx4 v6, s[12:15], s33 offen lds
    s_add_u32 m0, s32, 8192
    s_nop 0
    buffer_load_dwordx4 v7, s[12:15], s33 offen lds
    s_add_u32 m0, s32, 9216
    s_nop 0
    buffer_load_dwordx4 v8, s[12:15], s33 offen lds
    s_waitcnt vmcnt(10)
    ds_read_b64_tr_b16 a[16:17], v9 offset:10240
    ds_read_b64_tr_b16 a[40:41], v9 offset:10272
    ds_read_b64_tr_b16 a[64:65], v9 offset:10304
    ds_read_b64_tr_b16 a[88:89], v9 offset:10336
    ds_read_b64_tr_b16 a[112:113], v9 offset:10368
    ds_read_b64_tr_b16 a[136:137], v9 offset:10400
    ds_read_b64_tr_b16 a[160:161], v9 offset:10432
    ds_read_b64_tr_b16 a[184:185], v9 offset:10464
    ds_read_b64_tr_b16 a[208:209], v9 offset:10496
    ds_read_b64_tr_b16 a[232:233], v9 offset:10528
    s_waitcnt lgkmcnt(0)
    s_add_u32 s33, s43, 102400
    s_add_u32 m0, s32, 10240
    s_nop 0
    buffer_load_dwordx4 v4, s[12:15], s33 offen lds
    s_add_u32 m0, s32, 11264
    s_nop 0
    buffer_load_dwordx4 v5, s[12:15], s33 offen lds
    s_add_u32 m0, s32, 12288
    s_nop 0
    buffer_load_dwordx4 v6, s[12:15], s33 offen lds
    s_add_u32 m0, s32, 13312
    s_nop 0
    buffer_load_dwordx4 v7, s[12:15], s33 offen lds
    s_add_u32 m0, s32, 14336
    s_nop 0
    buffer_load_dwordx4 v8, s[12:15], s33 offen lds
    s_waitcnt vmcnt(10)
    ds_read_b64_tr_b16 a[4:5], v9 offset:0
    ds_read_b64_tr_b16 a[28:29], v9 offset:32
    ds_read_b64_tr_b16 a[52:53], v9 offset:64
    ds_read_b64_tr_b16 a[76:77], v9 offset:96
    ds_read_b64_tr_b16 a[100:101], v9 offset:128
    ds_read_b64_tr_b16 a[124:125], v9 offset:160
    ds_read_b64_tr_b16 a[148:149], v9 offset:192
    ds_read_b64_tr_b16 a[172:173], v9 offset:224
    ds_read_b64_tr_b16 a[196:197], v9 offset:256
    ds_read_b64_tr_b16 a[220:221], v9 offset:288
    s_waitcnt lgkmcnt(0)
    s_add_u32 s33, s43, 122880
    s_add_u32 m0, s32, 0
    s_nop 0
    buffer_load_dwordx4 v4, s[12:15], s33 offen lds
    s_add_u32 m0, s32, 1024
    s_nop 0
    buffer_load_dwordx4 v5, s[12:15], s33 offen lds
    s_add_u32 m0, s32, 2048
    s_nop 0
    buffer_load_dwordx4 v6, s[12:15], s33 offen lds
    s_add_u32 m0, s32, 3072
    s_nop 0
    buffer_load_dwordx4 v7, s[12:15], s33 offen lds
    s_add_u32 m0, s32, 4096
    s_nop 0
    buffer_load_dwordx4 v8, s[12:15], s33 offen lds
    s_waitcnt vmcnt(10)
    ds_read_b64_tr_b16 a[6:7], v9 offset:5120
    ds_read_b64_tr_b16 a[30:31], v9 offset:5152
    ds_read_b64_tr_b16 a[54:55], v9 offset:5184
    ds_read_b64_tr_b16 a[78:79], v9 offset:5216
    ds_read_b64_tr_b16 a[102:103], v9 offset:5248
    ds_read_b64_tr_b16 a[126:127], v9 offset:5280
    ds_read_b64_tr_b16 a[150:151], v9 offset:5312
    ds_read_b64_tr_b16 a[174:175], v9 offset:5344
    ds_read_b64_tr_b16 a[198:199], v9 offset:5376
    ds_read_b64_tr_b16 a[222:223], v9 offset:5408
    s_waitcnt lgkmcnt(0)
    s_add_u32 s33, s43, 143360
    s_add_u32 m0, s32, 5120
    s_nop 0
    buffer_load_dwordx4 v4, s[12:15], s33 offen lds
    s_add_u32 m0, s32, 6144
    s_nop 0
    buffer_load_dwordx4 v5, s[12:15], s33 offen lds
    s_add_u32 m0, s32, 7168
    s_nop 0
    buffer_load_dwordx4 v6, s[12:15], s33 offen lds
    s_add_u32 m0, s32, 8192
    s_nop 0
    buffer_load_dwordx4 v7, s[12:15], s33 offen lds
    s_add_u32 m0, s32, 9216
    s_nop 0
    buffer_load_dwordx4 v8, s[12:15], s33 offen lds
    s_waitcnt vmcnt(10)
    ds_read_b64_tr_b16 a[18:19], v9 offset:10240
    ds_read_b64_tr_b16 a[42:43], v9 offset:10272
    ds_read_b64_tr_b16 a[66:67], v9 offset:10304
    ds_read_b64_tr_b16 a[90:91], v9 offset:10336
    ds_read_b64_tr_b16 a[114:115], v9 offset:10368
    ds_read_b64_tr_b16 a[138:139], v9 offset:10400
    ds_read_b64_tr_b16 a[162:163], v9 offset:10432
    ds_read_b64_tr_b16 a[186:187], v9 offset:10464
    ds_read_b64_tr_b16 a[210:211], v9 offset:10496
    ds_read_b64_tr_b16 a[234:235], v9 offset:10528
    s_waitcnt lgkmcnt(0)
    s_add_u32 s33, s43, 163840
    s_add_u32 m0, s32, 10240
    s_nop 0
    buffer_load_dwordx4 v4, s[12:15], s33 offen lds
    s_add_u32 m0, s32, 11264
    s_nop 0
    buffer_load_dwordx4 v5, s[12:15], s33 offen lds
    s_add_u32 m0, s32, 12288
    s_nop 0
    buffer_load_dwordx4 v6, s[12:15], s33 offen lds
    s_add_u32 m0, s32, 13312
    s_nop 0
    buffer_load_dwordx4 v7, s[12:15], s33 offen lds
    s_add_u32 m0, s32, 14336
    s_nop 0
    buffer_load_dwordx4 v8, s[12:15], s33 offen lds
    s_waitcnt vmcnt(10)
    ds_read_b64_tr_b16 a[8:9], v9 offset:0
    ds_read_b64_tr_b16 a[32:33], v9 offset:32
    ds_read_b64_tr_b16 a[56:57], v9 offset:64
    ds_read_b64_tr_b16 a[80:81], v9 offset:96
    ds_read_b64_tr_b16 a[104:105], v9 offset:128
    ds_read_b64_tr_b16 a[128:129], v9 offset:160
    ds_read_b64_tr_b16 a[152:153], v9 offset:192
    ds_read_b64_tr_b16 a[176:177], v9 offset:224
    ds_read_b64_tr_b16 a[200:201], v9 offset:256
    ds_read_b64_tr_b16 a[224:225], v9 offset:288
    s_waitcnt lgkmcnt(0)
    s_add_u32 s33, s43, 184320
    s_add_u32 m0, s32, 0
    s_nop 0
    buffer_load_dwordx4 v4, s[12:15], s33 offen lds
    s_add_u32 m0, s32, 1024
    s_nop 0
    buffer_load_dwordx4 v5, s[12:15], s33 offen lds
    s_add_u32 m0, s32, 2048
    s_nop 0
    buffer_load_dwordx4 v6, s[12:15], s33 offen lds
    s_add_u32 m0, s32, 3072
    s_nop 0
    buffer_load_dwordx4 v7, s[12:15], s33 offen lds
    s_add_u32 m0, s32, 4096
    s_nop 0
    buffer_load_dwordx4 v8, s[12:15], s33 offen lds
    s_waitcnt vmcnt(10)
    ds_read_b64_tr_b16 a[10:11], v9 offset:5120
    ds_read_b64_tr_b16 a[34:35], v9 offset:5152
    ds_read_b64_tr_b16 a[58:59], v9 offset:5184
    ds_read_b64_tr_b16 a[82:83], v9 offset:5216
    ds_read_b64_tr_b16 a[106:107], v9 offset:5248
    ds_read_b64_tr_b16 a[130:131], v9 offset:5280
    ds_read_b64_tr_b16 a[154:155], v9 offset:5312
    ds_read_b64_tr_b16 a[178:179], v9 offset:5344
    ds_read_b64_tr_b16 a[202:203], v9 offset:5376
    ds_read_b64_tr_b16 a[226:227], v9 offset:5408
    s_waitcnt lgkmcnt(0)
    s_add_u32 s33, s43, 204800
    s_add_u32 m0, s32, 5120
    s_nop 0
    buffer_load_dwordx4 v4, s[12:15], s33 offen lds
    s_add_u32 m0, s32, 6144
    s_nop 0
    buffer_load_dwordx4 v5, s[12:15], s33 offen lds
    s_add_u32 m0, s32, 7168
    s_nop 0
    buffer_load_dwordx4 v6, s[12:15], s33 offen lds
    s_add_u32 m0, s32, 8192
    s_nop 0
    buffer_load_dwordx4 v7, s[12:15], s33 offen lds
    s_add_u32 m0, s32, 9216
    s_nop 0
    buffer_load_dwordx4 v8, s[12:15], s33 offen lds
    s_waitcnt vmcnt(10)
    ds_read_b64_tr_b16 a[20:21], v9 offset:10240
    ds_read_b64_tr_b16 a[44:45], v9 offset:10272
    ds_read_b64_tr_b16 a[68:69], v9 offset:10304
    ds_read_b64_tr_b16 a[92:93], v9 offset:10336
    ds_read_b64_tr_b16 a[116:117], v9 offset:10368
    ds_read_b64_tr_b16 a[140:141], v9 offset:10400
    ds_read_b64_tr_b16 a[164:165], v9 offset:10432
    ds_read_b64_tr_b16 a[188:189], v9 offset:10464
    ds_read_b64_tr_b16 a[212:213], v9 offset:10496
    ds_read_b64_tr_b16 a[236:237], v9 offset:10528
    s_waitcnt lgkmcnt(0)
    s_add_u32 s33, s43, 225280
    s_add_u32 m0, s32, 10240
    s_nop 0
    buffer_load_dwordx4 v4, s[12:15], s33 offen lds
    s_add_u32 m0, s32, 11264
    s_nop 0
    buffer_load_dwordx4 v5, s[12:15], s33 offen lds
    s_add_u32 m0, s32, 12288
    s_nop 0
    buffer_load_dwordx4 v6, s[12:15], s33 offen lds
    s_add_u32 m0, s32, 13312
    s_nop 0
    buffer_load_dwordx4 v7, s[12:15], s33 offen lds
    s_add_u32 m0, s32, 14336
    s_nop 0
    buffer_load_dwordx4 v8, s[12:15], s33 offen lds
    s_waitcnt vmcnt(10)
    ds_read_b64_tr_b16 a[12:13], v9 offset:0
    ds_read_b64_tr_b16 a[36:37], v9 offset:32
    ds_read_b64_tr_b16 a[60:61], v9 offset:64
    ds_read_b64_tr_b16 a[84:85], v9 offset:96
    ds_read_b64_tr_b16 a[108:109], v9 offset:128
    ds_read_b64_tr_b16 a[132:133], v9 offset:160
    ds_read_b64_tr_b16 a[156:157], v9 offset:192
    ds_read_b64_tr_b16 a[180:181], v9 offset:224
    ds_read_b64_tr_b16 a[204:205], v9 offset:256
    ds_read_b64_tr_b16 a[228:229], v9 offset:288
    s_waitcnt lgkmcnt(0)
    s_waitcnt vmcnt(5)
    ds_read_b64_tr_b16 a[14:15], v9 offset:5120
    ds_read_b64_tr_b16 a[38:39], v9 offset:5152
    ds_read_b64_tr_b16 a[62:63], v9 offset:5184
    ds_read_b64_tr_b16 a[86:87], v9 offset:5216
    ds_read_b64_tr_b16 a[110:111], v9 offset:5248
    ds_read_b64_tr_b16 a[134:135], v9 offset:5280
    ds_read_b64_tr_b16 a[158:159], v9 offset:5312
    ds_read_b64_tr_b16 a[182:183], v9 offset:5344
    ds_read_b64_tr_b16 a[206:207], v9 offset:5376
    ds_read_b64_tr_b16 a[230:231], v9 offset:5408
    s_waitcnt lgkmcnt(0)
    s_waitcnt vmcnt(0)
    ds_read_b64_tr_b16 a[22:23], v9 offset:10240
    ds_read_b64_tr_b16 a[46:47], v9 offset:10272
    ds_read_b64_tr_b16 a[70:71], v9 offset:10304
    ds_read_b64_tr_b16 a[94:95], v9 offset:10336
    ds_read_b64_tr_b16 a[118:119], v9 offset:10368
    ds_read_b64_tr_b16 a[142:143], v9 offset:10400
    ds_read_b64_tr_b16 a[166:167], v9 offset:10432
    ds_read_b64_tr_b16 a[190:191], v9 offset:10464
    ds_read_b64_tr_b16 a[214:215], v9 offset:10496
    ds_read_b64_tr_b16 a[238:239], v9 offset:10528
    s_waitcnt lgkmcnt(0)
    v_lshlrev_b32 v10, 4, v0
    v_and_b32 v11, 3, v0
    v_lshlrev_b32 v11, 3, v11
    s_add_u32 s30, s40, 31264
    s_lshl_b32 s30, s30, 7
    v_add_u32 v11, s30, v11
    s_add_u32 s30, s40, 31328
    s_lshl_b32 s30, s30, 7
    s_lshl_b32 s31, s3, 3
    s_add_u32 s30, s30, s31
    v_mov_b32 v12, s30
    v_mov_b32 v1, 2130706432
    v_cmp_eq_u32 vcc, 0, v0
    s_nop 1
    v_cndmask_b32 v12, v1, v12, vcc
    v_mov_b32 v1, 4028416
L_fw_49:
    buffer_load_dwordx2 v[16:17], v1, s[8:11], 0 offen sc1
    s_add_u32 s7, s7, 1
    s_bitcmp1_b32 s7, 22
    s_cbranch_scc1 L_abort
    s_waitcnt vmcnt(0)
    v_cmp_ne_u32 vcc, s4, v17
    v_cmp_gt_u32 s[28:29], 1, v16
    s_or_b64 vcc, vcc, s[28:29]
    s_cbranch_scc1 L_fw_49
L_fe_50:
    v_readfirstlane_b32 s35, v16
    s_sub_u32 s35, s35, 1
    s_lshl_b32 s30, s40, 1
    s_lshr_b32 s44, s3, 1
    s_add_u32 s30, s30, s44
    s_lshr_b32 s31, s30, 7
    s_xor_b32 s31, s31, s35
    s_xor_b32 s31, s31, 1
    s_and_b32 s31, s31, 1
    s_lshl_b32 s31, s31, 13
    s_lshl_b32 s44, s30, 14
    s_add_u32 s44, s44, s31
    v_mov_b32 v15, s4
    s_mul_i32 s34, s3, 3072
    s_and_b32 s30, s3, 1
    s_mul_i32 s30, s30, 3072
    s_add_u32 s44, s44, s30
    s_mul_i32 s50, s3, 10
    s_lshr_b32 s51, s40, 3
    s_add_u32 s45, s50, s40
    s_add_u32 s30, s45, 0
    s_and_b32 s30, s30, 7
    s_lshl_b32 s30, s30, 10
    v_add_u32 v20, s30, v10
    s_add_u32 s30, s45, 1
    s_and_b32 s30, s30, 7
    s_lshl_b32 s30, s30, 10
    v_add_u32 v21, s30, v10
    s_add_u32 s30, s45, 2
    s_and_b32 s30, s30, 7
    s_lshl_b32 s30, s30, 10
    v_add_u32 v22, s30, v10
    s_add_u32 s30, s45, 3
    s_and_b32 s30, s30, 7
    s_lshl_b32 s30, s30, 10
    v_add_u32 v23, s30, v10
    s_add_u32 s30, s45, 4
    s_and_b32 s30, s30, 7
    s_lshl_b32 s30, s30, 10
    v_add_u32 v24, s30, v10
    s_add_u32 s30, s45, 5
    s_and_b32 s30, s30, 7
    s_lshl_b32 s30, s30, 10
    v_add_u32 v25, s30, v10
    s_add_u32 s30, s45, 6
    s_and_b32 s30, s30, 7
    s_lshl_b32 s30, s30, 10
    v_add_u32 v26, s30, v10
    s_add_u32 s30, s45, 7
    s_and_b32 s30, s30, 7
    s_lshl_b32 s30, s30, 10
    v_add_u32 v27, s30, v10
    s_bfe_u32 s30, s50, 0x10003
    s_xor_b32 s30, s30, s51
    s_lshl_b32 s64, s50, 2
    s_add_u32 s30, s30, s64
    s_lshl_b32 s64, s30, 13
    s_add_u32 s64, s64, 1048576
    s_add_u32 s50, s50, 1
    s_bfe_u32 s30, s50, 0x10003
    s_xor_b32 s30, s30, s51
    s_lshl_b32 s65, s50, 2
    s_add_u32 s30, s30, s65
    s_lshl_b32 s65, s30, 13
    s_add_u32 s65, s65, 1048576
    s_add_u32 s50, s50, 1
    s_bfe_u32 s30, s50, 0x10003
    s_xor_b32 s30, s30, s51
    s_lshl_b32 s66, s50, 2
    s_add_u32 s30, s30, s66
    s_lshl_b32 s66, s30, 13
    s_add_u32 s66, s66, 1048576
    s_add_u32 s50, s50, 1
    s_bfe_u32 s30, s50, 0x10003
    s_xor_b32 s30, s30, s51
    s_lshl_b32 s67, s50, 2
    s_add_u32 s30, s30, s67
    s_lshl_b32 s67, s30, 13
    s_add_u32 s67, s67, 1048576
    s_add_u32 s50, s50, 1
    s_bfe_u32 s30, s50, 0x10003
    s_xor_b32 s30, s30, s51
    s_lshl_b32 s68, s50, 2
    s_add_u32 s30, s30, s68
    s_lshl_b32 s68, s30, 13
    s_add_u32 s68, s68, 1048576
    s_add_u32 s50, s50, 1
    s_bfe_u32 s30, s50, 0x10003
    s_xor_b32 s30, s30, s51
    s_lshl_b32 s69, s50, 2
    s_add_u32 s30, s30, s69
    s_lshl_b32 s69, s30, 13
    s_add_u32 s69, s69, 1048576
    s_add_u32 s50, s50, 1
    s_bfe_u32 s30, s50, 0x10003
    s_xor_b32 s30, s30, s51
    s_lshl_b32 s70, s50, 2
    s_add_u32 s30, s30, s70
    s_lshl_b32 s70, s30, 13
    s_add_u32 s70, s70, 1048576
    s_add_u32 s50, s50, 1
    s_bfe_u32 s30, s50, 0x10003
    s_xor_b32 s30, s30, s51
    s_lshl_b32 s71, s50, 2
    s_add_u32 s30, s30, s71
    s_lshl_b32 s71, s30, 13
    s_add_u32 s71, s71, 1048576
    s_add_u32 s50, s50, 1
    s_bfe_u32 s30, s50, 0x10003
    s_xor_b32 s30, s30, s51
    s_lshl_b32 s72, s50, 2
    s_add_u32 s30, s30, s72
    s_lshl_b32 s72, s30, 13
    s_add_u32 s72, s72, 1048576
    s_add_u32 s50, s50, 1
    s_bfe_u32 s30, s50, 0x10003
    s_xor_b32 s30, s30, s51
    s_lshl_b32 s73, s50, 2
    s_add_u32 s30, s30, s73
    s_lshl_b32 s73, s30, 13
    s_add_u32 s73, s73, 1048576
    s_add_u32 s50, s50, 1
    s_mov_b32 s46, 0
    s_mov_b32 s45, 0
L_fw_52:
    buffer_load_dwordx2 v[16:17], v11, s[8:11], 0 offen sc1
    s_add_u32 s7, s7, 1
    s_bitcmp1_b32 s7, 22
    s_cbranch_scc1 L_abort
    s_waitcnt vmcnt(0)
    v_cmp_ne_u32 vcc, s4, v17
    v_cmp_gt_u32 s[28:29], 1, v16
    s_or_b64 vcc, vcc, s[28:29]
    s_cbranch_scc1 L_fw_52
L_fe_53:
    s_add_u32 m0, s34, 0
    s_nop 0
    buffer_load_dwordx4 v10, s[8:11], s44 offen offset:0 sc1 lds
    buffer_load_dwordx4 v10, s[8:11], s44 offen offset:1024 sc1 lds
    buffer_load_dwordx4 v10, s[8:11], s44 offen offset:2048 sc1 lds
    s_waitcnt vmcnt(0)
    s_barrier
L_u_solo:
    ds_read_b128 v[32:35], v10 offset:0
    ds_read_b128 v[56:59], v10 offset:1024
    ds_read_b128 v[36:39], v10 offset:3072
    ds_read_b128 v[60:63], v10 offset:4096
    ds_read_b128 v[40:43], v10 offset:6144
    ds_read_b128 v[64:67], v10 offset:7168
    ds_read_b128 v[44:47], v10 offset:9216
    ds_read_b128 v[68:71], v10 offset:10240
    ds_read_b64 v[48:49], v10 offset:2048
    ds_read_b64 v[50:51], v10 offset:5120
    ds_read_b64 v[72:73], v10 offset:2056
    ds_read_b64 v[74:75], v10 offset:5128
    ds_read_b64 v[52:53], v10 offset:8192
    ds_read_b64 v[54:55], v10 offset:11264
    ds_read_b64 v[76:77], v10 offset:8200
    ds_read_b64 v[78:79], v10 offset:11272
    s_add_u32 s47, s46, 2
    s_add_u32 s44, s44, 4194304
    s_mov_b32 s52, 0
    s_waitcnt lgkmcnt(0)
    v_mfma_f32_16x16x32_bf16 v[128:131], v[32:35], a[0:3], 0
    v_mfma_f32_16x16x32_bf16 v[132:135], v[56:59], a[0:3], 0
    v_mfma_f32_16x16x32_bf16 v[128:131], v[36:39], a[4:7], v[128:131]
    v_mfma_f32_16x16x32_bf16 v[132:135], v[60:63], a[4:7], v[132:135]
    v_mfma_f32_16x16x32_bf16 v[128:131], v[40:43], a[8:11], v[128:131]
    v_mfma_f32_16x16x32_bf16 v[132:135], v[64:67], a[8:11], v[132:135]
    v_mfma_f32_16x16x32_bf16 v[128:131], v[44:47], a[12:15], v[128:131]
    v_mfma_f32_16x16x32_bf16 v[132:135], v[68:71], a[12:15], v[132:135]
    v_mfma_f32_16x16x32_bf16 v[128:131], v[48:51], a[16:19], v[128:131]
    v_mfma_f32_16x16x32_bf16 v[132:135], v[72:75], a[16:19], v[132:135]
    v_mfma_f32_16x16x32_bf16 v[128:131], v[52:55], a[20:23], v[128:131]
    s_barrier
    v_mfma_f32_16x16x32_bf16 v[132:135], v[76:79], a[20:23], v[132:135]
    v_mfma_f32_16x16x32_bf16 v[136:139], v[32:35], a[24:27], 0
    v_mfma_f32_16x16x32_bf16 v[140:143], v[56:59], a[24:27], 0
    v_mfma_f32_16x16x32_bf16 v[136:139], v[36:39], a[28:31], v[136:139]
    v_mfma_f32_16x16x32_bf16 v[140:143], v[60:63], a[28:31], v[140:143]
    v_mfma_f32_16x16x32_bf16 v[136:139], v[40:43], a[32:35], v[136:139]
    v_cvt_pk_bf16_f32 v144, v128, v129
    v_mfma_f32_16x16x32_bf16 v[140:143], v[64:67], a[32:35], v[140:143]
    v_cvt_pk_bf16_f32 v145, v130, v131
    v_mfma_f32_16x16x32_bf16 v[136:139], v[44:47], a[36:39], v[136:139]
    v_cvt_pk_bf16_f32 v146, v132, v133
    v_mfma_f32_16x16x32_bf16 v[140:143], v[68:71], a[36:39], v[140:143]
    v_cvt_pk_bf16_f32 v147, v134, v135
    v_mfma_f32_16x16x32_bf16 v[136:139], v[48:51], a[40:43], v[136:139]
    s_add_u32 s49, s45, s64
    v_mfma_f32_16x16x32_bf16 v[140:143], v[72:75], a[40:43], v[140:143]
    buffer_store_dwordx4 v[144:147], v20, s[8:11], s49 offen sc1
    v_mfma_f32_16x16x32_bf16 v[136:139], v[52:55], a[44:47], v[136:139]
    v_mfma_f32_16x16x32_bf16 v[140:143], v[76:79], a[44:47], v[140:143]
    v_mfma_f32_16x16x32_bf16 v[128:131], v[32:35], a[48:51], 0
    v_mfma_f32_16x16x32_bf16 v[132:135], v[56:59], a[48:51], 0
    v_mfma_f32_16x16x32_bf16 v[128:131], v[36:39], a[52:55], v[128:131]
    v_mfma_f32_16x16x32_bf16 v[132:135], v[60:63], a[52:55], v[132:135]
    v_mfma_f32_16x16x32_bf16 v[128:131], v[40:43], a[56:59], v[128:131]
    v_cvt_pk_bf16_f32 v148, v136, v137
    v_mfma_f32_16x16x32_bf16 v[132:135], v[64:67], a[56:59], v[132:135]
    v_cvt_pk_bf16_f32 v149, v138, v139
    v_mfma_f32_16x16x32_bf16 v[128:131], v[44:47], a[60:63], v[128:131]
    v_cvt_pk_bf16_f32 v150, v140, v141
    v_mfma_f32_16x16x32_bf16 v[132:135], v[68:71], a[60:63], v[132:135]
    v_cvt_pk_bf16_f32 v151, v142, v143
    v_mfma_f32_16x16x32_bf16 v[128:131], v[48:51], a[64:67], v[128:131]
    s_add_u32 s49, s45, s65
    v_mfma_f32_16x16x32_bf16 v[132:135], v[72:75], a[64:67], v[132:135]
    buffer_store_dwordx4 v[148:151], v21, s[8:11], s49 offen sc1
    v_mfma_f32_16x16x32_bf16 v[128:131], v[52:55], a[68:71], v[128:131]
    v_mfma_f32_16x16x32_bf16 v[132:135], v[76:79], a[68:71], v[132:135]
    v_mfma_f32_16x16x32_bf16 v[136:139], v[32:35], a[72:75], 0
    v_mfma_f32_16x16x32_bf16 v[140:143], v[56:59], a[72:75], 0
    v_mfma_f32_16x16x32_bf16 v[136:139], v[36:39], a[76:79], v[136:139]
    v_mfma_f32_16x16x32_bf16 v[140:143], v[60:63], a[76:79], v[140:143]
    v_mfma_f32_16x16x32_bf16 v[136:139], v[40:43], a[80:83], v[136:139]
    v_cvt_pk_bf16_f32 v144, v128, v129
    v_mfma_f32_16x16x32_bf16 v[140:143], v[64:67], a[80:83], v[140:143]
    v_cvt_pk_bf16_f32 v145, v130, v131
    v_mfma_f32_16x16x32_bf16 v[136:139], v[44:47], a[84:87], v[136:139]
    v_cvt_pk_bf16_f32 v146, v132, v133
    v_mfma_f32_16x16x32_bf16 v[140:143], v[68:71], a[84:87], v[140:143]
    v_cvt_pk_bf16_f32 v147, v134, v135
    v_mfma_f32_16x16x32_bf16 v[136:139], v[48:51], a[88:91], v[136:139]
    s_add_u32 s49, s45, s66
    v_mfma_f32_16x16x32_bf16 v[140:143], v[72:75], a[88:91], v[140:143]
    buffer_store_dwordx4 v[144:147], v22, s[8:11], s49 offen sc1
    v_mfma_f32_16x16x32_bf16 v[136:139], v[52:55], a[92:95], v[136:139]
    v_mfma_f32_16x16x32_bf16 v[140:143], v[76:79], a[92:95], v[140:143]
    v_mfma_f32_16x16x32_bf16 v[128:131], v[32:35], a[96:99], 0
    v_mfma_f32_16x16x32_bf16 v[132:135], v[56:59], a[96:99], 0
    v_mfma_f32_16x16x32_bf16 v[128:131], v[36:39], a[100:103], v[128:131]
    v_mfma_f32_16x16x32_bf16 v[132:135], v[60:63], a[100:103], v[132:135]
    v_mfma_f32_16x16x32_bf16 v[128:131], v[40:43], a[104:107], v[128:131]
    v_cvt_pk_bf16_f32 v148, v136, v137
    v_mfma_f32_16x16x32_bf16 v[132:135], v[64:67], a[104:107], v[132:135]
    v_cvt_pk_bf16_f32 v149, v138, v139
    v_mfma_f32_16x16x32_bf16 v[128:131], v[44:47], a[108:111], v[128:131]
    v_cvt_pk_bf16_f32 v150, v140, v141
    v_mfma_f32_16x16x32_bf16 v[132:135], v[68:71], a[108:111], v[132:135]
    v_cvt_pk_bf16_f32 v151, v142, v143
    v_mfma_f32_16x16x32_bf16 v[128:131], v[48:51], a[112:115], v[128:131]
    s_add_u32 s49, s45, s67
    v_mfma_f32_16x16x32_bf16 v[132:135], v[72:75], a[112:115], v[132:135]
    buffer_store_dwordx4 v[148:151], v23, s[8:11], s49 offen sc1
    v_mfma_f32_16x16x32_bf16 v[128:131], v[52:55], a[116:119], v[128:131]
    v_mfma_f32_16x16x32_bf16 v[132:135], v[76:79], a[116:119], v[132:135]
    v_mfma_f32_16x16x32_bf16 v[136:139], v[32:35], a[120:123], 0
    v_mfma_f32_16x16x32_bf16 v[140:143], v[56:59], a[120:123], 0
    v_mfma_f32_16x16x32_bf16 v[136:139], v[36:39], a[124:127], v[136:139]
    v_mfma_f32_16x16x32_bf16 v[140:143], v[60:63], a[124:127], v[140:143]
    v_mfma_f32_16x16x32_bf16 v[136:139], v[40:43], a[128:131], v[136:139]
    v_cvt_pk_bf16_f32 v144, v128, v129
    v_mfma_f32_16x16x32_bf16 v[140:143], v[64:67], a[128:131], v[140:143]
    v_cvt_pk_bf16_f32 v145, v130, v131
    v_mfma_f32_16x16x32_bf16 v[136:139], v[44:47], a[132:135], v[136:139]
    v_cvt_pk_bf16_f32 v146, v132, v133
    v_mfma_f32_16x16x32_bf16 v[140:143], v[68:71], a[132:135], v[140:143]
    v_cvt_pk_bf16_f32 v147, v134, v135
    v_mfma_f32_16x16x32_bf16 v[136:139], v[48:51], a[136:139], v[136:139]
    s_add_u32 s49, s45, s68
    v_mfma_f32_16x16x32_bf16 v[140:143], v[72:75], a[136:139], v[140:143]
    buffer_store_dwordx4 v[144:147], v24, s[8:11], s49 offen sc1
    v_mfma_f32_16x16x32_bf16 v[136:139], v[52:55], a[140:143], v[136:139]
    v_mfma_f32_16x16x32_bf16 v[140:143], v[76:79], a[140:143], v[140:143]
    buffer_load_dwordx2 v[16:17], v11, s[8:11], 0 offen sc1
    v_mfma_f32_16x16x32_bf16 v[128:131], v[32:35], a[144:147], 0
    v_mfma_f32_16x16x32_bf16 v[132:135], v[56:59], a[144:147], 0
    v_mfma_f32_16x16x32_bf16 v[128:131], v[36:39], a[148:151], v[128:131]
    v_mfma_f32_16x16x32_bf16 v[132:135], v[60:63], a[148:151], v[132:135]
    v_mfma_f32_16x16x32_bf16 v[128:131], v[40:43], a[152:155], v[128:131]
    v_cvt_pk_bf16_f32 v148, v136, v137
    v_mfma_f32_16x16x32_bf16 v[132:135], v[64:67], a[152:155], v[132:135]
    v_cvt_pk_bf16_f32 v149, v138, v139
    v_mfma_f32_16x16x32_bf16 v[128:131], v[44:47], a[156:159], v[128:131]
    v_cvt_pk_bf16_f32 v150, v140, v141
    v_mfma_f32_16x16x32_bf16 v[132:135], v[68:71], a[156:159], v[132:135]
    v_cvt_pk_bf16_f32 v151, v142, v143
    v_mfma_f32_16x16x32_bf16 v[128:131], v[48:51], a[160:163], v[128:131]
    s_add_u32 s49, s45, s69
    v_mfma_f32_16x16x32_bf16 v[132:135], v[72:75], a[160:163], v[132:135]
    buffer_store_dwordx4 v[148:151], v25, s[8:11], s49 offen sc1
    v_mfma_f32_16x16x32_bf16 v[128:131], v[52:55], a[164:167], v[128:131]
    v_mfma_f32_16x16x32_bf16 v[132:135], v[76:79], a[164:167], v[132:135]
    v_mfma_f32_16x16x32_bf16 v[136:139], v[32:35], a[168:171], 0
    v_mfma_f32_16x16x32_bf16 v[140:143], v[56:59], a[168:171], 0
    v_mfma_f32_16x16x32_bf16 v[136:139], v[36:39], a[172:175], v[136:139]
    v_mfma_f32_16x16x32_bf16 v[140:143], v[60:63], a[172:175], v[140:143]
    v_mfma_f32_16x16x32_bf16 v[136:139], v[40:43], a[176:179], v[136:139]
    v_cvt_pk_bf16_f32 v144, v128, v129
    v_mfma_f32_16x16x32_bf16 v[140:143], v[64:67], a[176:179], v[140:143]
    v_cvt_pk_bf16_f32 v145, v130, v131
    v_mfma_f32_16x16x32_bf16 v[136:139], v[44:47], a[180:183], v[136:139]
    v_cvt_pk_bf16_f32 v146, v132, v133
    v_mfma_f32_16x16x32_bf16 v[140:143], v[68:71], a[180:183], v[140:143]
    v_cvt_pk_bf16_f32 v147, v134, v135
    v_mfma_f32_16x16x32_bf16 v[136:139], v[48:51], a[184:187], v[136:139]
    s_add_u32 s49, s45, s70
    v_mfma_f32_16x16x32_bf16 v[140:143], v[72:75], a[184:187], v[140:143]
    buffer_store_dwordx4 v[144:147], v26, s[8:11], s49 offen sc1
    v_mfma_f32_16x16x32_bf16 v[136:139], v[52:55], a[188:191], v[136:139]
    v_mfma_f32_16x16x32_bf16 v[140:143], v[76:79], a[188:191], v[140:143]
    v_mfma_f32_16x16x32_bf16 v[128:131], v[32:35], a[192:195], 0
    v_mfma_f32_16x16x32_bf16 v[132:135], v[56:59], a[192:195], 0
    v_mfma_f32_16x16x32_bf16 v[128:131], v[36:39], a[196:199], v[128:131]
    v_mfma_f32_16x16x32_bf16 v[132:135], v[60:63], a[196:199], v[132:135]
    v_mfma_f32_16x16x32_bf16 v[128:131], v[40:43], a[200:203], v[128:131]
    v_cvt_pk_bf16_f32 v148, v136, v137
    v_mfma_f32_16x16x32_bf16 v[132:135], v[64:67], a[200:203], v[132:135]
    v_cvt_pk_bf16_f32 v149, v138, v139
    v_mfma_f32_16x16x32_bf16 v[128:131], v[44:47], a[204:207], v[128:131]
    v_cvt_pk_bf16_f32 v150, v140, v141
    v_mfma_f32_16x16x32_bf16 v[132:135], v[68:71], a[204:207], v[132:135]
    v_cvt_pk_bf16_f32 v151, v142, v143
    v_mfma_f32_16x16x32_bf16 v[128:131], v[48:51], a[208:211], v[128:131]
    s_add_u32 s49, s45, s71
    v_mfma_f32_16x16x32_bf16 v[132:135], v[72:75], a[208:211], v[132:135]
    buffer_store_dwordx4 v[148:151], v27, s[8:11], s49 offen sc1
    v_mfma_f32_16x16x32_bf16 v[128:131], v[52:55], a[212:215], v[128:131]
    s_waitcnt vmcnt(3)
    v_cmp_ne_u32 vcc, s4, v17
    v_cmp_gt_u32 s[28:29], s47, v16
    v_mfma_f32_16x16x32_bf16 v[132:135], v[76:79], a[212:215], v[132:135]
    v_mfma_f32_16x16x32_bf16 v[136:139], v[32:35], a[216:219], 0
    s_add_u32 m0, s34, 0
    s_or_b64 vcc, vcc, s[28:29]
    s_cbranch_scc1 L_u_nodma
    buffer_load_dwordx4 v10, s[8:11], s44 offen offset:0 sc1 lds
    buffer_load_dwordx4 v10, s[8:11], s44 offen offset:1024 sc1 lds
    buffer_load_dwordx4 v10, s[8:11], s44 offen offset:2048 sc1 lds
L_u_nodma_back:
    v_mfma_f32_16x16x32_bf16 v[140:143], v[56:59], a[216:219], 0
    v_mfma_f32_16x16x32_bf16 v[136:139], v[36:39], a[220:223], v[136:139]
    v_mfma_f32_16x16x32_bf16 v[140:143], v[60:63], a[220:223], v[140:143]
    v_mfma_f32_16x16x32_bf16 v[136:139], v[40:43], a[224:227], v[136:139]
    v_cvt_pk_bf16_f32 v144, v128, v129
    v_mfma_f32_16x16x32_bf16 v[140:143], v[64:67], a[224:227], v[140:143]
    v_cvt_pk_bf16_f32 v145, v130, v131
    v_mfma_f32_16x16x32_bf16 v[136:139], v[44:47], a[228:231], v[136:139]
    v_cvt_pk_bf16_f32 v146, v132, v133
    v_mfma_f32_16x16x32_bf16 v[140:143], v[68:71], a[228:231], v[140:143]
    v_cvt_pk_bf16_f32 v147, v134, v135
    v_mfma_f32_16x16x32_bf16 v[136:139], v[48:51], a[232:235], v[136:139]
    s_add_u32 s49, s45, s72
    v_mfma_f32_16x16x32_bf16 v[140:143], v[72:75], a[232:235], v[140:143]
    buffer_store_dwordx4 v[144:147], v20, s[8:11], s49 offen sc1
    v_mfma_f32_16x16x32_bf16 v[136:139], v[52:55], a[236:239], v[136:139]
    v_mfma_f32_16x16x32_bf16 v[140:143], v[76:79], a[236:239], v[140:143]
    s_mov_b32 s48, s45
    s_add_u32 s45, s45, 4194304
    s_add_u32 s46, s46, 1
    s_nop 4
    v_cvt_pk_bf16_f32 v148, v136, v137
    v_cvt_pk_bf16_f32 v149, v138, v139
    v_cvt_pk_bf16_f32 v150, v140, v141
    v_cvt_pk_bf16_f32 v151, v142, v143
    s_add_u32 s49, s48, s73
    buffer_store_dwordx4 v[148:151], v21, s[8:11], s49 offen sc1
    s_waitcnt vmcnt(0)
    v_mov_b32 v14, s46
    buffer_store_dwordx2 v[14:15], v12, s[8:11], 0 offen sc1
    s_cmp_eq_u32 s52, 0
    s_cbranch_scc1 L_u_have
L_fw_55:
    buffer_load_dwordx2 v[16:17], v11, s[8:11], 0 offen sc1
    s_add_u32 s7, s7, 1
    s_bitcmp1_b32 s7, 22
    s_cbranch_scc1 L_abort
    s_waitcnt vmcnt(0)
    v_cmp_ne_u32 vcc, s4, v17
    v_cmp_gt_u32 s[28:29], s47, v16
    s_or_b64 vcc, vcc, s[28:29]
    s_cbranch_scc1 L_fw_55
L_fe_56:
    buffer_load_dwordx4 v10, s[8:11], s44 offen offset:0 sc1 lds
    buffer_load_dwordx4 v10, s[8:11], s44 offen offset:1024 sc1 lds
    buffer_load_dwordx4 v10, s[8:11], s44 offen offset:2048 sc1 lds
    s_waitcnt vmcnt(0)
L_u_have:
    s_barrier
    s_cmp_lt_u32 s46, 4
    s_cbranch_scc1 L_u_solo
    ds_read_b128 v[32:35], v10 offset:0
    ds_read_b128 v[56:59], v10 offset:1024
    ds_read_b128 v[36:39], v10 offset:3072
    ds_read_b128 v[60:63], v10 offset:4096
    ds_read_b128 v[40:43], v10 offset:6144
    ds_read_b128 v[64:67], v10 offset:7168
    ds_read_b128 v[44:47], v10 offset:9216
    ds_read_b128 v[68:71], v10 offset:10240
    ds_read_b64 v[48:49], v10 offset:2048
    ds_read_b64 v[50:51], v10 offset:5120
    ds_read_b64 v[72:73], v10 offset:2056
    ds_read_b64 v[74:75], v10 offset:5128
    ds_read_b64 v[52:53], v10 offset:8192
    ds_read_b64 v[54:55], v10 offset:11264
    ds_read_b64 v[76:77], v10 offset:8200
    ds_read_b64 v[78:79], v10 offset:11272
    s_add_u32 s44, s44, 4194304
    s_mov_b32 s48, 2130706432
L_fw_58:
    buffer_load_dwordx2 v[16:17], v11, s[8:11], 0 offen sc1
    s_add_u32 s7, s7, 1
    s_bitcmp1_b32 s7, 22
    s_cbranch_scc1 L_abort
    s_waitcnt vmcnt(0)
    v_cmp_ne_u32 vcc, s4, v17
    v_cmp_gt_u32 s[28:29], 6, v16
    s_or_b64 vcc, vcc, s[28:29]
    s_cbranch_scc1 L_fw_58
L_fe_59:
    s_add_u32 m0, s34, 12288
    s_nop 0
    buffer_load_dwordx4 v10, s[8:11], s44 offen offset:0 sc1 lds
    buffer_load_dwordx4 v10, s[8:11], s44 offen offset:1024 sc1 lds
    buffer_load_dwordx4 v10, s[8:11], s44 offen offset:2048 sc1 lds
L_u_loop:
    s_waitcnt lgkmcnt(0)
    v_mfma_f32_16x16x32_bf16 v[128:131], v[32:35], a[0:3], 0
    v_mfma_f32_16x16x32_bf16 v[132:135], v[56:59], a[0:3], 0
    v_mfma_f32_16x16x32_bf16 v[128:131], v[36:39], a[4:7], v[128:131]
    v_mfma_f32_16x16x32_bf16 v[132:135], v[60:63], a[4:7], v[132:135]
    v_mfma_f32_16x16x32_bf16 v[128:131], v[40:43], a[8:11], v[128:131]
    v_cvt_pk_bf16_f32 v148, v136, v137
    v_mfma_f32_16x16x32_bf16 v[132:135], v[64:67], a[8:11], v[132:135]
    v_cvt_pk_bf16_f32 v149, v138, v139
    v_mfma_f32_16x16x32_bf16 v[128:131], v[44:47], a[12:15], v[128:131]
    v_cvt_pk_bf16_f32 v150, v140, v141
    v_mfma_f32_16x16x32_bf16 v[132:135], v[68:71], a[12:15], v[132:135]
    v_cvt_pk_bf16_f32 v151, v142, v143
    v_mfma_f32_16x16x32_bf16 v[128:131], v[48:51], a[16:19], v[128:131]
    s_add_u32 s49, s48, s73
    v_mfma_f32_16x16x32_bf16 v[132:135], v[72:75], a[16:19], v[132:135]
    buffer_store_dwordx4 v[148:151], v21, s[8:11], s49 offen sc1
    v_mfma_f32_16x16x32_bf16 v[128:131], v[52:55], a[20:23], v[128:131]
    buffer_load_dwordx2 v[16:17], v11, s[8:11], 0 offen sc1
    v_mfma_f32_16x16x32_bf16 v[132:135], v[76:79], a[20:23], v[132:135]
    v_mfma_f32_16x16x32_bf16 v[136:139], v[32:35], a[24:27], 0
    s_add_u32 s47, s46, 3
    s_min_u32 s47, s47, 64
    v_mfma_f32_16x16x32_bf16 v[140:143], v[56:59], a[24:27], 0
    s_add_u32 s44, s44, 4194304
    v_mov_b32 v14, s46
    v_mfma_f32_16x16x32_bf16 v[136:139], v[36:39], a[28:31], v[136:139]
    s_and_b32 s44, s44, 134217727
    v_mfma_f32_16x16x32_bf16 v[140:143], v[60:63], a[28:31], v[140:143]
    v_mfma_f32_16x16x32_bf16 v[136:139], v[40:43], a[32:35], v[136:139]
    v_cvt_pk_bf16_f32 v144, v128, v129
    v_mfma_f32_16x16x32_bf16 v[140:143], v[64:67], a[32:35], v[140:143]
    v_cvt_pk_bf16_f32 v145, v130, v131
    v_mfma_f32_16x16x32_bf16 v[136:139], v[44:47], a[36:39], v[136:139]
    v_cvt_pk_bf16_f32 v146, v132, v133
    v_mfma_f32_16x16x32_bf16 v[140:143], v[68:71], a[36:39], v[140:143]
    v_cvt_pk_bf16_f32 v147, v134, v135
    v_mfma_f32_16x16x32_bf16 v[136:139], v[48:51], a[40:43], v[136:139]
    s_add_u32 s49, s45, s64
    v_mfma_f32_16x16x32_bf16 v[140:143], v[72:75], a[40:43], v[140:143]
    buffer_store_dwordx4 v[144:147], v20, s[8:11], s49 offen sc1
    v_mfma_f32_16x16x32_bf16 v[136:139], v[52:55], a[44:47], v[136:139]
    v_mfma_f32_16x16x32_bf16 v[140:143], v[76:79], a[44:47], v[140:143]
    v_mfma_f32_16x16x32_bf16 v[128:131], v[32:35], a[48:51], 0
    v_mfma_f32_16x16x32_bf16 v[132:135], v[56:59], a[48:51], 0
    v_mfma_f32_16x16x32_bf16 v[128:131], v[36:39], a[52:55], v[128:131]
    v_mfma_f32_16x16x32_bf16 v[132:135], v[60:63], a[52:55], v[132:135]
    v_mfma_f32_16x16x32_bf16 v[128:131], v[40:43], a[56:59], v[128:131]
    v_cvt_pk_bf16_f32 v148, v136, v137
    v_mfma_f32_16x16x32_bf16 v[132:135], v[64:67], a[56:59], v[132:135]
    v_cvt_pk_bf16_f32 v149, v138, v139
    v_mfma_f32_16x16x32_bf16 v[128:131], v[44:47], a[60:63], v[128:131]
    v_cvt_pk_bf16_f32 v150, v140, v141
    v_mfma_f32_16x16x32_bf16 v[132:135], v[68:71], a[60:63], v[132:135]
    v_cvt_pk_bf16_f32 v151, v142, v143
    v_mfma_f32_16x16x32_bf16 v[128:131], v[48:51], a[64:67], v[128:131]
    s_add_u32 s49, s45, s65
    v_mfma_f32_16x16x32_bf16 v[132:135], v[72:75], a[64:67], v[132:135]
    buffer_store_dwordx4 v[148:151], v21, s[8:11], s49 offen sc1
    v_mfma_f32_16x16x32_bf16 v[128:131], v[52:55], a[68:71], v[128:131]
    v_mfma_f32_16x16x32_bf16 v[132:135], v[76:79], a[68:71], v[132:135]
    v_mfma_f32_16x16x32_bf16 v[136:139], v[32:35], a[72:75], 0
    v_mfma_f32_16x16x32_bf16 v[140:143], v[56:59], a[72:75], 0
    v_mfma_f32_16x16x32_bf16 v[136:139], v[36:39], a[76:79], v[136:139]
    v_mfma_f32_16x16x32_bf16 v[140:143], v[60:63], a[76:79], v[140:143]
    v_mfma_f32_16x16x32_bf16 v[136:139], v[40:43], a[80:83], v[136:139]
    v_cvt_pk_bf16_f32 v144, v128, v129
    v_mfma_f32_16x16x32_bf16 v[140:143], v[64:67], a[80:83], v[140:143]
    v_cvt_pk_bf16_f32 v145, v130, v131
    v_mfma_f32_16x16x32_bf16 v[136:139], v[44:47], a[84:87], v[136:139]
    v_cvt_pk_bf16_f32 v146, v132, v133
    v_mfma_f32_16x16x32_bf16 v[140:143], v[68:71], a[84:87], v[140:143]
    v_cvt_pk_bf16_f32 v147, v134, v135
    v_mfma_f32_16x16x32_bf16 v[136:139], v[48:51], a[88:91], v[136:139]
    s_add_u32 s49, s45, s66
    v_mfma_f32_16x16x32_bf16 v[140:143], v[72:75], a[88:91], v[140:143]
    buffer_store_dwordx4 v[144:147], v22, s[8:11], s49 offen sc1
    v_mfma_f32_16x16x32_bf16 v[136:139], v[52:55], a[92:95], v[136:139]
    v_mfma_f32_16x16x32_bf16 v[140:143], v[76:79], a[92:95], v[140:143]
    v_mfma_f32_16x16x32_bf16 v[128:131], v[32:35], a[96:99], 0
    v_mfma_f32_16x16x32_bf16 v[132:135], v[56:59], a[96:99], 0
    v_mfma_f32_16x16x32_bf16 v[128:131], v[36:39], a[100:103], v[128:131]
    v_mfma_f32_16x16x32_bf16 v[132:135], v[60:63], a[100:103], v[132:135]
    v_mfma_f32_16x16x32_bf16 v[128:131], v[40:43], a[104:107], v[128:131]
    v_cvt_pk_bf16_f32 v148, v136, v137
    v_mfma_f32_16x16x32_bf16 v[132:135], v[64:67], a[104:107], v[132:135]
    v_cvt_pk_bf16_f32 v149, v138, v139
    v_mfma_f32_16x16x32_bf16 v[128:131], v[44:47], a[108:111], v[128:131]
    v_cvt_pk_bf16_f32 v150, v140, v141
    v_mfma_f32_16x16x32_bf16 v[132:135], v[68:71], a[108:111], v[132:135]
    v_cvt_pk_bf16_f32 v151, v142, v143
    v_mfma_f32_16x16x32_bf16 v[128:131], v[48:51], a[112:115], v[128:131]
    s_add_u32 s49, s45, s67
    v_mfma_f32_16x16x32_bf16 v[132:135], v[72:75], a[112:115], v[132:135]
    buffer_store_dwordx4 v[148:151], v23, s[8:11], s49 offen sc1
    v_mfma_f32_16x16x32_bf16 v[128:131], v[52:55], a[116:119], v[128:131]
    s_waitcnt vmcnt(4)
    s_barrier
    v_mfma_f32_16x16x32_bf16 v[132:135], v[76:79], a[116:119], v[132:135]
    buffer_store_dwordx2 v[14:15], v12, s[8:11], 0 offen sc1
    v_cmp_ne_u32 vcc, s4, v17
    v_mfma_f32_16x16x32_bf16 v[136:139], v[32:35], a[120:123], 0
    v_cmp_gt_u32 s[28:29], s47, v16
    s_or_b64 vcc, vcc, s[28:29]
    s_cbranch_scc1 L_u_slow0
L_u_back0:
    v_mfma_f32_16x16x32_bf16 v[140:143], v[56:59], a[120:123], 0
    s_add_u32 m0, s34, 0
    v_mfma_f32_16x16x32_bf16 v[136:139], v[36:39], a[124:127], v[136:139]
    buffer_load_dwordx4 v10, s[8:11], s44 offen offset:0 sc1 lds
    v_mfma_f32_16x16x32_bf16 v[140:143], v[60:63], a[124:127], v[140:143]
    v_mfma_f32_16x16x32_bf16 v[136:139], v[40:43], a[128:131], v[136:139]
    v_cvt_pk_bf16_f32 v144, v128, v129
    v_mfma_f32_16x16x32_bf16 v[140:143], v[64:67], a[128:131], v[140:143]
    v_cvt_pk_bf16_f32 v145, v130, v131
    v_mfma_f32_16x16x32_bf16 v[136:139], v[44:47], a[132:135], v[136:139]
    v_cvt_pk_bf16_f32 v146, v132, v133
    v_mfma_f32_16x16x32_bf16 v[140:143], v[68:71], a[132:135], v[140:143]
    v_cvt_pk_bf16_f32 v147, v134, v135
    v_mfma_f32_16x16x32_bf16 v[136:139], v[48:51], a[136:139], v[136:139]
    s_add_u32 s49, s45, s68
    v_mfma_f32_16x16x32_bf16 v[140:143], v[72:75], a[136:139], v[140:143]
    buffer_store_dwordx4 v[144:147], v24, s[8:11], s49 offen sc1
    v_mfma_f32_16x16x32_bf16 v[136:139], v[52:55], a[140:143], v[136:139]
    v_mfma_f32_16x16x32_bf16 v[140:143], v[76:79], a[140:143], v[140:143]
    buffer_load_dwordx4 v10, s[8:11], s44 offen offset:1024 sc1 lds
    v_mfma_f32_16x16x32_bf16 v[128:131], v[32:35], a[144:147], 0
    v_mfma_f32_16x16x32_bf16 v[132:135], v[56:59], a[144:147], 0
    v_mfma_f32_16x16x32_bf16 v[128:131], v[36:39], a[148:151], v[128:131]
    buffer_load_dwordx4 v10, s[8:11], s44 offen offset:2048 sc1 lds
    v_mfma_f32_16x16x32_bf16 v[132:135], v[60:63], a[148:151], v[132:135]
    ds_read_b128 v[80:83], v10 offset:12288
    v_mfma_f32_16x16x32_bf16 v[128:131], v[40:43], a[152:155], v[128:131]
    v_cvt_pk_bf16_f32 v148, v136, v137
    v_mfma_f32_16x16x32_bf16 v[132:135], v[64:67], a[152:155], v[132:135]
    v_cvt_pk_bf16_f32 v149, v138, v139
    v_mfma_f32_16x16x32_bf16 v[128:131], v[44:47], a[156:159], v[128:131]
    v_cvt_pk_bf16_f32 v150, v140, v141
    v_mfma_f32_16x16x32_bf16 v[132:135], v[68:71], a[156:159], v[132:135]
    v_cvt_pk_bf16_f32 v151, v142, v143
    v_mfma_f32_16x16x32_bf16 v[128:131], v[48:51], a[160:163], v[128:131]
    s_add_u32 s49, s45, s69
    v_mfma_f32_16x16x32_bf16 v[132:135], v[72:75], a[160:163], v[132:135]
    buffer_store_dwordx4 v[148:151], v25, s[8:11], s49 offen sc1
    v_mfma_f32_16x16x32_bf16 v[128:131], v[52:55], a[164:167], v[128:131]
    ds_read_b128 v[104:107], v10 offset:13312
    v_mfma_f32_16x16x32_bf16 v[132:135], v[76:79], a[164:167], v[132:135]
    ds_read_b128 v[84:87], v10 offset:15360
    v_mfma_f32_16x16x32_bf16 v[136:139], v[32:35], a[168:171], 0
    ds_read_b128 v[108:111], v10 offset:16384
    v_mfma_f32_16x16x32_bf16 v[140:143], v[56:59], a[168:171], 0
    ds_read_b128 v[88:91], v10 offset:18432
    v_mfma_f32_16x16x32_bf16 v[136:139], v[36:39], a[172:175], v[136:139]
    ds_read_b128 v[112:115], v10 offset:19456
    v_mfma_f32_16x16x32_bf16 v[140:143], v[60:63], a[172:175], v[140:143]
    ds_read_b128 v[92:95], v10 offset:21504
    v_mfma_f32_16x16x32_bf16 v[136:139], v[40:43], a[176:179], v[136:139]
    v_cvt_pk_bf16_f32 v144, v128, v129
    v_mfma_f32_16x16x32_bf16 v[140:143], v[64:67], a[176:179], v[140:143]
    v_cvt_pk_bf16_f32 v145, v130, v131
    v_mfma_f32_16x16x32_bf16 v[136:139], v[44:47], a[180:183], v[136:139]
    v_cvt_pk_bf16_f32 v146, v132, v133
    v_mfma_f32_16x16x32_bf16 v[140:143], v[68:71], a[180:183], v[140:143]
    v_cvt_pk_bf16_f32 v147, v134, v135
    v_mfma_f32_16x16x32_bf16 v[136:139], v[48:51], a[184:187], v[136:139]
    s_add_u32 s49, s45, s70
    v_mfma_f32_16x16x32_bf16 v[140:143], v[72:75], a[184:187], v[140:143]
    buffer_store_dwordx4 v[144:147], v26, s[8:11], s49 offen sc1
    v_mfma_f32_16x16x32_bf16 v[136:139], v[52:55], a[188:191], v[136:139]
    ds_read_b128 v[116:119], v10 offset:22528
    v_mfma_f32_16x16x32_bf16 v[140:143], v[76:79], a[188:191], v[140:143]
    ds_read_b64 v[96:97], v10 offset:14336
    v_mfma_f32_16x16x32_bf16 v[128:131], v[32:35], a[192:195], 0
    ds_read_b64 v[98:99], v10 offset:17408
    v_mfma_f32_16x16x32_bf16 v[132:135], v[56:59], a[192:195], 0
    ds_read_b64 v[120:121], v10 offset:14344
    v_mfma_f32_16x16x32_bf16 v[128:131], v[36:39], a[196:199], v[128:131]
    ds_read_b64 v[122:123], v10 offset:17416
    v_mfma_f32_16x16x32_bf16 v[132:135], v[60:63], a[196:199], v[132:135]
    ds_read_b64 v[100:101], v10 offset:20480
    v_mfma_f32_16x16x32_bf16 v[128:131], v[40:43], a[200:203], v[128:131]
    v_cvt_pk_bf16_f32 v148, v136, v137
    v_mfma_f32_16x16x32_bf16 v[132:135], v[64:67], a[200:203], v[132:135]
    v_cvt_pk_bf16_f32 v149, v138, v139
    v_mfma_f32_16x16x32_bf16 v[128:131], v[44:47], a[204:207], v[128:131]
    v_cvt_pk_bf16_f32 v150, v140, v141
    v_mfma_f32_16x16x32_bf16 v[132:135], v[68:71], a[204:207], v[132:135]
    v_cvt_pk_bf16_f32 v151, v142, v143
    v_mfma_f32_16x16x32_bf16 v[128:131], v[48:51], a[208:211], v[128:131]
    s_add_u32 s49, s45, s71
    v_mfma_f32_16x16x32_bf16 v[132:135], v[72:75], a[208:211], v[132:135]
    buffer_store_dwordx4 v[148:151], v27, s[8:11], s49 offen sc1
    v_mfma_f32_16x16x32_bf16 v[128:131], v[52:55], a[212:215], v[128:131]
    ds_read_b64 v[102:103], v10 offset:23552
    v_mfma_f32_16x16x32_bf16 v[132:135], v[76:79], a[212:215], v[132:135]
    ds_read_b64 v[124:125], v10 offset:20488
    v_mfma_f32_16x16x32_bf16 v[136:139], v[32:35], a[216:219], 0
    ds_read_b64 v[126:127], v10 offset:23560
    v_mfma_f32_16x16x32_bf16 v[140:143], v[56:59], a[216:219], 0
    v_mfma_f32_16x16x32_bf16 v[136:139], v[36:39], a[220:223], v[136:139]
    v_mfma_f32_16x16x32_bf16 v[140:143], v[60:63], a[220:223], v[140:143]
    v_mfma_f32_16x16x32_bf16 v[136:139], v[40:43], a[224:227], v[136:139]
    v_cvt_pk_bf16_f32 v144, v128, v129
    v_mfma_f32_16x16x32_bf16 v[140:143], v[64:67], a[224:227], v[140:143]
    v_cvt_pk_bf16_f32 v145, v130, v131
    v_mfma_f32_16x16x32_bf16 v[136:139], v[44:47], a[228:231], v[136:139]
    v_cvt_pk_bf16_f32 v146, v132, v133
    v_mfma_f32_16x16x32_bf16 v[140:143], v[68:71], a[228:231], v[140:143]
    v_cvt_pk_bf16_f32 v147, v134, v135
    v_mfma_f32_16x16x32_bf16 v[136:139], v[48:51], a[232:235], v[136:139]
    s_add_u32 s49, s45, s72
    v_mfma_f32_16x16x32_bf16 v[140:143], v[72:75], a[232:235], v[140:143]
    buffer_store_dwordx4 v[144:147], v20, s[8:11], s49 offen sc1
    v_mfma_f32_16x16x32_bf16 v[136:139], v[52:55], a[236:239], v[136:139]
    s_mov_b32 s48, s45
    s_add_u32 s45, s45, 4194304
    v_mfma_f32_16x16x32_bf16 v[140:143], v[76:79], a[236:239], v[140:143]
    s_add_u32 s46, s46, 1
    s_and_b32 s45, s45, 134217727
    s_waitcnt lgkmcnt(0)
    v_mfma_f32_16x16x32_bf16 v[128:131], v[80:83], a[0:3], 0
    v_mfma_f32_16x16x32_bf16 v[132:135], v[104:107], a[0:3], 0
    v_mfma_f32_16x16x32_bf16 v[128:131], v[84:87], a[4:7], v[128:131]
    v_mfma_f32_16x16x32_bf16 v[132:135], v[108:111], a[4:7], v[132:135]
    v_mfma_f32_16x16x32_bf16 v[128:131], v[88:91], a[8:11], v[128:131]
    v_cvt_pk_bf16_f32 v148, v136, v137
    v_mfma_f32_16x16x32_bf16 v[132:135], v[112:115], a[8:11], v[132:135]
    v_cvt_pk_bf16_f32 v149, v138, v139
    v_mfma_f32_16x16x32_bf16 v[128:131], v[92:95], a[12:15], v[128:131]
    v_cvt_pk_bf16_f32 v150, v140, v141
    v_mfma_f32_16x16x32_bf16 v[132:135], v[116:119], a[12:15], v[132:135]
    v_cvt_pk_bf16_f32 v151, v142, v143
    v_mfma_f32_16x16x32_bf16 v[128:131], v[96:99], a[16:19], v[128:131]
    s_add_u32 s49, s48, s73
    v_mfma_f32_16x16x32_bf16 v[132:135], v[120:123], a[16:19], v[132:135]
    buffer_store_dwordx4 v[148:151], v21, s[8:11], s49 offen sc1
    v_mfma_f32_16x16x32_bf16 v[128:131], v[100:103], a[20:23], v[128:131]
    buffer_load_dwordx2 v[16:17], v11, s[8:11], 0 offen sc1
    v_mfma_f32_16x16x32_bf16 v[132:135], v[124:127], a[20:23], v[132:135]
    v_mfma_f32_16x16x32_bf16 v[136:139], v[80:83], a[24:27], 0
    s_add_u32 s47, s46, 3
    s_min_u32 s47, s47, 64
    v_mfma_f32_16x16x32_bf16 v[140:143], v[104:107], a[24:27], 0
    s_add_u32 s44, s44, 4194304
    v_mov_b32 v14, s46
    v_mfma_f32_16x16x32_bf16 v[136:139], v[84:87], a[28:31], v[136:139]
    s_and_b32 s44, s44, 134217727
    v_mfma_f32_16x16x32_bf16 v[140:143], v[108:111], a[28:31], v[140:143]
    v_mfma_f32_16x16x32_bf16 v[136:139], v[88:91], a[32:35], v[136:139]
    v_cvt_pk_bf16_f32 v144, v128, v129
    v_mfma_f32_16x16x32_bf16 v[140:143], v[112:115], a[32:35], v[140:143]
    v_cvt_pk_bf16_f32 v145, v130, v131
    v_mfma_f32_16x16x32_bf16 v[136:139], v[92:95], a[36:39], v[136:139]
    v_cvt_pk_bf16_f32 v146, v132, v133
    v_mfma_f32_16x16x32_bf16 v[140:143], v[116:119], a[36:39], v[140:143]
    v_cvt_pk_bf16_f32 v147, v134, v135
    v_mfma_f32_16x16x32_bf16 v[136:139], v[96:99], a[40:43], v[136:139]
    s_add_u32 s49, s45, s64
    v_mfma_f32_16x16x32_bf16 v[140:143], v[120:123], a[40:43], v[140:143]
    buffer_store_dwordx4 v[144:147], v20, s[8:11], s49 offen sc1
    v_mfma_f32_16x16x32_bf16 v[136:139], v[100:103], a[44:47], v[136:139]
    v_mfma_f32_16x16x32_bf16 v[140:143], v[124:127], a[44:47], v[140:143]
    v_mfma_f32_16x16x32_bf16 v[128:131], v[80:83], a[48:51], 0
    v_mfma_f32_16x16x32_bf16 v[132:135], v[104:107], a[48:51], 0
    v_mfma_f32_16x16x32_bf16 v[128:131], v[84:87], a[52:55], v[128:131]
    v_mfma_f32_16x16x32_bf16 v[132:135], v[108:111], a[52:55], v[132:135]
    v_mfma_f32_16x16x32_bf16 v[128:131], v[88:91], a[56:59], v[128:131]
    v_cvt_pk_bf16_f32 v148, v136, v137
    v_mfma_f32_16x16x32_bf16 v[132:135], v[112:115], a[56:59], v[132:135]
    v_cvt_pk_bf16_f32 v149, v138, v139
    v_mfma_f32_16x16x32_bf16 v[128:131], v[92:95], a[60:63], v[128:131]
    v_cvt_pk_bf16_f32 v150, v140, v141
    v_mfma_f32_16x16x32_bf16 v[132:135], v[116:119], a[60:63], v[132:135]
    v_cvt_pk_bf16_f32 v151, v142, v143
    v_mfma_f32_16x16x32_bf16 v[128:131], v[96:99], a[64:67], v[128:131]
    s_add_u32 s49, s45, s65
    v_mfma_f32_16x16x32_bf16 v[132:135], v[120:123], a[64:67], v[132:135]
    buffer_store_dwordx4 v[148:151], v21, s[8:11], s49 offen sc1
    v_mfma_f32_16x16x32_bf16 v[128:131], v[100:103], a[68:71], v[128:131]
    v_mfma_f32_16x16x32_bf16 v[132:135], v[124:127], a[68:71], v[132:135]
    v_mfma_f32_16x16x32_bf16 v[136:139], v[80:83], a[72:75], 0
    v_mfma_f32_16x16x32_bf16 v[140:143], v[104:107], a[72:75], 0
    v_mfma_f32_16x16x32_bf16 v[136:139], v[84:87], a[76:79], v[136:139]
    v_mfma_f32_16x16x32_bf16 v[140:143], v[108:111], a[76:79], v[140:143]
    v_mfma_f32_16x16x32_bf16 v[136:139], v[88:91], a[80:83], v[136:139]
    v_cvt_pk_bf16_f32 v144, v128, v129
    v_mfma_f32_16x16x32_bf16 v[140:143], v[112:115], a[80:83], v[140:143]
    v_cvt_pk_bf16_f32 v145, v130, v131
    v_mfma_f32_16x16x32_bf16 v[136:139], v[92:95], a[84:87], v[136:139]
    v_cvt_pk_bf16_f32 v146, v132, v133
    v_mfma_f32_16x16x32_bf16 v[140:143], v[116:119], a[84:87], v[140:143]
    v_cvt_pk_bf16_f32 v147, v134, v135
    v_mfma_f32_16x16x32_bf16 v[136:139], v[96:99], a[88:91], v[136:139]
    s_add_u32 s49, s45, s66
    v_mfma_f32_16x16x32_bf16 v[140:143], v[120:123], a[88:91], v[140:143]
    buffer_store_dwordx4 v[144:147], v22, s[8:11], s49 offen sc1
    v_mfma_f32_16x16x32_bf16 v[136:139], v[100:103], a[92:95], v[136:139]
    v_mfma_f32_16x16x32_bf16 v[140:143], v[124:127], a[92:95], v[140:143]
    v_mfma_f32_16x16x32_bf16 v[128:131], v[80:83], a[96:99], 0
    v_mfma_f32_16x16x32_bf16 v[132:135], v[104:107], a[96:99], 0
    v_mfma_f32_16x16x32_bf16 v[128:131], v[84:87], a[100:103], v[128:131]
    v_mfma_f32_16x16x32_bf16 v[132:135], v[108:111], a[100:103], v[132:135]
    v_mfma_f32_16x16x32_bf16 v[128:131], v[88:91], a[104:107], v[128:131]
    v_cvt_pk_bf16_f32 v148, v136, v137
    v_mfma_f32_16x16x32_bf16 v[132:135], v[112:115], a[104:107], v[132:135]
    v_cvt_pk_bf16_f32 v149, v138, v139
    v_mfma_f32_16x16x32_bf16 v[128:131], v[92:95], a[108:111], v[128:131]
    v_cvt_pk_bf16_f32 v150, v140, v141
    v_mfma_f32_16x16x32_bf16 v[132:135], v[116:119], a[108:111], v[132:135]
    v_cvt_pk_bf16_f32 v151, v142, v143
    v_mfma_f32_16x16x32_bf16 v[128:131], v[96:99], a[112:115], v[128:131]
    s_add_u32 s49, s45, s67
    v_mfma_f32_16x16x32_bf16 v[132:135], v[120:123], a[112:115], v[132:135]
    buffer_store_dwordx4 v[148:151], v23, s[8:11], s49 offen sc1
    v_mfma_f32_16x16x32_bf16 v[128:131], v[100:103], a[116:119], v[128:131]
    s_waitcnt vmcnt(4)
    s_barrier
    v_mfma_f32_16x16x32_bf16 v[132:135], v[124:127], a[116:119], v[132:135]
    buffer_store_dwordx2 v[14:15], v12, s[8:11], 0 offen sc1
    v_cmp_ne_u32 vcc, s4, v17
    v_mfma_f32_16x16x32_bf16 v[136:139], v[80:83], a[120:123], 0
    v_cmp_gt_u32 s[28:29], s47, v16
    s_or_b64 vcc, vcc, s[28:29]
    s_cbranch_scc1 L_u_slow1
L_u_back1:
    v_mfma_f32_16x16x32_bf16 v[140:143], v[104:107], a[120:123], 0
    s_add_u32 m0, s34, 12288
    v_mfma_f32_16x16x32_bf16 v[136:139], v[84:87], a[124:127], v[136:139]
    buffer_load_dwordx4 v10, s[8:11], s44 offen offset:0 sc1 lds
    v_mfma_f32_16x16x32_bf16 v[140:143], v[108:111], a[124:127], v[140:143]
    v_mfma_f32_16x16x32_bf16 v[136:139], v[88:91], a[128:131], v[136:139]
    v_cvt_pk_bf16_f32 v144, v128, v129
    v_mfma_f32_16x16x32_bf16 v[140:143], v[112:115], a[128:131], v[140:143]
    v_cvt_pk_bf16_f32 v145, v130, v131
    v_mfma_f32_16x16x32_bf16 v[136:139], v[92:95], a[132:135], v[136:139]
    v_cvt_pk_bf16_f32 v146, v132, v133
    v_mfma_f32_16x16x32_bf16 v[140:143], v[116:119], a[132:135], v[140:143]
    v_cvt_pk_bf16_f32 v147, v134, v135
    v_mfma_f32_16x16x32_bf16 v[136:139], v[96:99], a[136:139], v[136:139]
    s_add_u32 s49, s45, s68
    v_mfma_f32_16x16x32_bf16 v[140:143], v[120:123], a[136:139], v[140:143]
    buffer_store_dwordx4 v[144:147], v24, s[8:11], s49 offen sc1
    v_mfma_f32_16x16x32_bf16 v[136:139], v[100:103], a[140:143], v[136:139]
    v_mfma_f32_16x16x32_bf16 v[140:143], v[124:127], a[140:143], v[140:143]
    buffer_load_dwordx4 v10, s[8:11], s44 offen offset:1024 sc1 lds
    v_mfma_f32_16x16x32_bf16 v[128:131], v[80:83], a[144:147], 0
    v_mfma_f32_16x16x32_bf16 v[132:135], v[104:107], a[144:147], 0
    v_mfma_f32_16x16x32_bf16 v[128:131], v[84:87], a[148:151], v[128:131]
    buffer_load_dwordx4 v10, s[8:11], s44 offen offset:2048 sc1 lds
    v_mfma_f32_16x16x32_bf16 v[132:135], v[108:111], a[148:151], v[132:135]
    ds_read_b128 v[32:35], v10 offset:0
    v_mfma_f32_16x16x32_bf16 v[128:131], v[88:91], a[152:155], v[128:131]
    v_cvt_pk_bf16_f32 v148, v136, v137
    v_mfma_f32_16x16x32_bf16 v[132:135], v[112:115], a[152:155], v[132:135]
    v_cvt_pk_bf16_f32 v149, v138, v139
    v_mfma_f32_16x16x32_bf16 v[128:131], v[92:95], a[156:159], v[128:131]
    v_cvt_pk_bf16_f32 v150, v140, v141
    v_mfma_f32_16x16x32_bf16 v[132:135], v[116:119], a[156:159], v[132:135]
    v_cvt_pk_bf16_f32 v151, v142, v143
    v_mfma_f32_16x16x32_bf16 v[128:131], v[96:99], a[160:163], v[128:131]
    s_add_u32 s49, s45, s69
    v_mfma_f32_16x16x32_bf16 v[132:135], v[120:123], a[160:163], v[132:135]
    buffer_store_dwordx4 v[148:151], v25, s[8:11], s49 offen sc1
    v_mfma_f32_16x16x32_bf16 v[128:131], v[100:103], a[164:167], v[128:131]
    ds_read_b128 v[56:59], v10 offset:1024
    v_mfma_f32_16x16x32_bf16 v[132:135], v[124:127], a[164:167], v[132:135]
    ds_read_b128 v[36:39], v10 offset:3072
    v_mfma_f32_16x16x32_bf16 v[136:139], v[80:83], a[168:171], 0
    ds_read_b128 v[60:63], v10 offset:4096
    v_mfma_f32_16x16x32_bf16 v[140:143], v[104:107], a[168:171], 0
    ds_read_b128 v[40:43], v10 offset:6144
    v_mfma_f32_16x16x32_bf16 v[136:139], v[84:87], a[172:175], v[136:139]
    ds_read_b128 v[64:67], v10 offset:7168
    v_mfma_f32_16x16x32_bf16 v[140:143], v[108:111], a[172:175], v[140:143]
    ds_read_b128 v[44:47], v10 offset:9216
    v_mfma_f32_16x16x32_bf16 v[136:139], v[88:91], a[176:179], v[136:139]
    v_cvt_pk_bf16_f32 v144, v128, v129
    v_mfma_f32_16x16x32_bf16 v[140:143], v[112:115], a[176:179], v[140:143]
    v_cvt_pk_bf16_f32 v145, v130, v131
    v_mfma_f32_16x16x32_bf16 v[136:139], v[92:95], a[180:183], v[136:139]
    v_cvt_pk_bf16_f32 v146, v132, v133
    v_mfma_f32_16x16x32_bf16 v[140:143], v[116:119], a[180:183], v[140:143]
    v_cvt_pk_bf16_f32 v147, v134, v135
    v_mfma_f32_16x16x32_bf16 v[136:139], v[96:99], a[184:187], v[136:139]
    s_add_u32 s49, s45, s70
    v_mfma_f32_16x16x32_bf16 v[140:143], v[120:123], a[184:187], v[140:143]
    buffer_store_dwordx4 v[144:147], v26, s[8:11], s49 offen sc1
    v_mfma_f32_16x16x32_bf16 v[136:139], v[100:103], a[188:191], v[136:139]
    ds_read_b128 v[68:71], v10 offset:10240
    v_mfma_f32_16x16x32_bf16 v[140:143], v[124:127], a[188:191], v[140:143]
    ds_read_b64 v[48:49], v10 offset:2048
    v_mfma_f32_16x16x32_bf16 v[128:131], v[80:83], a[192:195], 0
    ds_read_b64 v[50:51], v10 offset:5120
    v_mfma_f32_16x16x32_bf16 v[132:135], v[104:107], a[192:195], 0
    ds_read_b64 v[72:73], v10 offset:2056
    v_mfma_f32_16x16x32_bf16 v[128:131], v[84:87], a[196:199], v[128:131]
    ds_read_b64 v[74:75], v10 offset:5128
    v_mfma_f32_16x16x32_bf16 v[132:135], v[108:111], a[196:199], v[132:135]
    ds_read_b64 v[52:53], v10 offset:8192
    v_mfma_f32_16x16x32_bf16 v[128:131], v[88:91], a[200:203], v[128:131]
    v_cvt_pk_bf16_f32 v148, v136, v137
    v_mfma_f32_16x16x32_bf16 v[132:135], v[112:115], a[200:203], v[132:135]
    v_cvt_pk_bf16_f32 v149, v138, v139
    v_mfma_f32_16x16x32_bf16 v[128:131], v[92:95], a[204:207], v[128:131]
    v_cvt_pk_bf16_f32 v150, v140, v141
    v_mfma_f32_16x16x32_bf16 v[132:135], v[116:119], a[204:207], v[132:135]
    v_cvt_pk_bf16_f32 v151, v142, v143
    v_mfma_f32_16x16x32_bf16 v[128:131], v[96:99], a[208:211], v[128:131]
    s_add_u32 s49, s45, s71
    v_mfma_f32_16x16x32_bf16 v[132:135], v[120:123], a[208:211], v[132:135]
    buffer_store_dwordx4 v[148:151], v27, s[8:11], s49 offen sc1
    v_mfma_f32_16x16x32_bf16 v[128:131], v[100:103], a[212:215], v[128:131]
    ds_read_b64 v[54:55], v10 offset:11264
    v_mfma_f32_16x16x32_bf16 v[132:135], v[124:127], a[212:215], v[132:135]
    ds_read_b64 v[76:77], v10 offset:8200
    v_mfma_f32_16x16x32_bf16 v[136:139], v[80:83], a[216:219], 0
    ds_read_b64 v[78:79], v10 offset:11272
    v_mfma_f32_16x16x32_bf16 v[140:143], v[104:107], a[216:219], 0
    v_mfma_f32_16x16x32_bf16 v[136:139], v[84:87], a[220:223], v[136:139]
    v_mfma_f32_16x16x32_bf16 v[140:143], v[108:111], a[220:223], v[140:143]
    v_mfma_f32_16x16x32_bf16 v[136:139], v[88:91], a[224:227], v[136:139]
    v_cvt_pk_bf16_f32 v144, v128, v129
    v_mfma_f32_16x16x32_bf16 v[140:143], v[112:115], a[224:227], v[140:143]
    v_cvt_pk_bf16_f32 v145, v130, v131
    v_mfma_f32_16x16x32_bf16 v[136:139], v[92:95], a[228:231], v[136:139]
    v_cvt_pk_bf16_f32 v146, v132, v133
    v_mfma_f32_16x16x32_bf16 v[140:143], v[116:119], a[228:231], v[140:143]
    v_cvt_pk_bf16_f32 v147, v134, v135
    v_mfma_f32_16x16x32_bf16 v[136:139], v[96:99], a[232:235], v[136:139]
    s_add_u32 s49, s45, s72
    v_mfma_f32_16x16x32_bf16 v[140:143], v[120:123], a[232:235], v[140:143]
    buffer_store_dwordx4 v[144:147], v20, s[8:11], s49 offen sc1
    v_mfma_f32_16x16x32_bf16 v[136:139], v[100:103], a[236:239], v[136:139]
    s_mov_b32 s48, s45
    s_add_u32 s45, s45, 4194304
    v_mfma_f32_16x16x32_bf16 v[140:143], v[124:127], a[236:239], v[140:143]
    s_add_u32 s46, s46, 1
    s_and_b32 s45, s45, 134217727
    s_cmp_lt_u32 s46, 64
    s_cbranch_scc1 L_u_loop
    s_nop 5
    v_cvt_pk_bf16_f32 v148, v136, v137
    v_cvt_pk_bf16_f32 v149, v138, v139
    v_cvt_pk_bf16_f32 v150, v140, v141
    v_cvt_pk_bf16_f32 v151, v142, v143
    s_add_u32 s49, s48, s73
    buffer_store_dwordx4 v[148:151], v21, s[8:11], s49 offen sc1
    s_waitcnt vmcnt(0) lgkmcnt(0)
    v_mov_b32 v14, 64
    buffer_store_dwordx2 v[14:15], v12, s[8:11], 0 offen sc1
    s_branch L_g
L_u_nodma:
    s_mov_b32 s52, 1
    s_branch L_u_nodma_back
L_u_slow0:
L_fw_61:
    buffer_load_dwordx2 v[16:17], v11, s[8:11], 0 offen sc1
    s_add_u32 s7, s7, 1
    s_bitcmp1_b32 s7, 22
    s_cbranch_scc1 L_abort
    s_waitcnt vmcnt(0)
    v_cmp_ne_u32 vcc, s4, v17
    v_cmp_gt_u32 s[28:29], s47, v16
    s_or_b64 vcc, vcc, s[28:29]
    s_cbranch_scc1 L_fw_61
L_fe_62:
    s_branch L_u_back0
L_u_slow1:
L_fw_64:
    buffer_load_dwordx2 v[16:17], v11, s[8:11], 0 offen sc1
    s_add_u32 s7, s7, 1
    s_bitcmp1_b32 s7, 22
    s_cbranch_scc1 L_abort
    s_waitcnt vmcnt(0)
    v_cmp_ne_u32 vcc, s4, v17
    v_cmp_gt_u32 s[28:29], s47, v16
    s_or_b64 vcc, vcc, s[28:29]
    s_cbranch_scc1 L_fw_64
L_fe_65:
    s_branch L_u_back1
L_f:
    s_and_b32 s30, s6, 1
    s_mul_i32 s30, s30, 5
    s_mul_i32 s40, s5, 10
    s_add_u32 s40, s40, s30
    s_bfe_u32 s42, s6, 0x10001
    s_xor_b32 s42, s42, 1
    s_mov_b32 s97, 0
    v_lshlrev_b32 v4, 4, v0
    v_add_u32 v5, 4096, v4
    v_and_b32 v1, 7, v0
    s_lshl_b32 s30, s3, 3
    v_add_u32 v1, s30, v1
    v_lshlrev_b32 v1, 7, v1
    s_lshl_b32 s30, s5, 3
    s_add_u32 s30, s30, 4009984
    v_add_u32 v6, s30, v1
    s_lshl_b32 s30, s5, 2
    s_add_u32 s30, s30, s6
    s_add_u32 s30, s30, 31366
    s_lshl_b32 s30, s30, 7
    s_lshl_b32 s31, s3, 3
    s_add_u32 s30, s30, s31
    v_mov_b32 v8, s30
    v_mov_b32 v1, 2130706432
    v_cmp_eq_u32 vcc, 0, v0
    s_nop 1
    v_cndmask_b32 v8, v1, v8, vcc
    s_lshl_b32 s30, s5, 7
    s_add_u32 s30, s30, 724992
    v_mov_b32 v7, s30
    v_mov_b32 v15, s4
    s_mul_i32 s30, s3, 10240
    v_add_u32 v9, s30, v4
    s_lshl_b32 s30, s3, 10
    v_add_u32 v10, s30, v4
    v_lshlrev_b32 v11, 3, v0
    s_lshl_b32 s30, s3, 9
    v_add_u32 v11, s30, v11
    v_mov_b32 v12, 0
    v_mov_b32 v13, 0
    s_mov_b32 s58, 2130706432
    s_sleep 100
    s_sleep 100
    s_sleep 100
    s_sleep 75
    s_lshl_b32 s30, s5, 2
    s_add_u32 s30, s30, s6
    s_sub_u32 s30, s30, 26
    s_lshl_b32 s30, s30, 2
    s_add_u32 s30, s30, s3
    s_lshl_b32 s30, s30, 13
    v_lshlrev_b32 v1, 7, v0
    buffer_load_dword v20, v1, s[20:23], s30 offen
    s_add_u32 s30, s30, 524288
    buffer_load_dword v21, v1, s[20:23], s30 offen
    s_add_u32 s30, s30, 524288
    buffer_load_dword v22, v1, s[20:23], s30 offen
    s_add_u32 s30, s30, 524288
    buffer_load_dword v23, v1, s[20:23], s30 offen
    s_add_u32 s30, s30, 524288
    buffer_load_dword v24, v1, s[20:23], s30 offen
    s_add_u32 s30, s30, 524288
    s_mov_b32 s12, s66
    s_mov_b32 s13, s67
    s_mov_b32 s14, 2457600
    s_mov_b32 s15, 0x20000
    s_and_b32 s30, s30, 524287
    buffer_load_dword v25, v1, s[12:15], s30 offen
    s_add_u32 s30, s30, 524288
    buffer_load_dword v26, v1, s[12:15], s30 offen
    s_add_u32 s30, s30, 524288
    buffer_load_dword v27, v1, s[12:15], s30 offen
    s_add_u32 s30, s30, 524288
    buffer_load_dword v28, v1, s[12:15], s30 offen
    s_add_u32 s30, s30, 524288
    buffer_load_dword v29, v1, s[12:15], s30 offen
    s_add_u32 s30, s30, 524288
    s_mov_b32 s12, s68
    s_mov_b32 s13, s69
    s_mov_b32 s14, 819200
    s_mov_b32 s15, 0x20000
    s_and_b32 s30, s30, 524287
    buffer_load_dword v25, v1, s[12:15], s30 offen
    s_add_u32 s30, s30, 524288
    buffer_load_dword v26, v1, s[12:15], s30 offen
    s_add_u32 s30, s30, 524288
    s_waitcnt vmcnt(0)
    v_mov_b32 v1, 4028416
L_fw_67:
    buffer_load_dwordx2 v[16:17], v1, s[8:11], 0 offen sc1
    s_add_u32 s7, s7, 1
    s_bitcmp1_b32 s7, 22
    s_cbranch_scc1 L_abort
    s_waitcnt vmcnt(0)
    v_cmp_ne_u32 vcc, s4, v17
    v_cmp_gt_u32 s[28:29], 1, v16
    s_or_b64 vcc, vcc, s[28:29]
    s_cbranch_scc1 L_fw_67
L_fe_68:
    v_readfirstlane_b32 s35, v16
    s_sub_u32 s35, s35, 1
    s_add_u32 s45, s40, 0
    s_bfe_u32 s30, s45, 0x10003
    s_xor_b32 s30, s30, s3
    s_lshl_b32 s76, s45, 2
    s_add_u32 s30, s30, s76
    s_lshl_b32 s76, s30, 13
    s_add_u32 s76, s76, 1048576
    s_add_u32 s45, s40, 1
    s_bfe_u32 s30, s45, 0x10003
    s_xor_b32 s30, s30, s3
    s_lshl_b32 s77, s45, 2
    s_add_u32 s30, s30, s77
    s_lshl_b32 s77, s30, 13
    s_add_u32 s77, s77, 1048576
    s_add_u32 s45, s40, 2
    s_bfe_u32 s30, s45, 0x10003
    s_xor_b32 s30, s30, s3
    s_lshl_b32 s78, s45, 2
    s_add_u32 s30, s30, s78
    s_lshl_b32 s78, s30, 13
    s_add_u32 s78, s78, 1048576
    s_add_u32 s45, s40, 3
    s_bfe_u32 s30, s45, 0x10003
    s_xor_b32 s30, s30, s3
    s_lshl_b32 s79, s45, 2
    s_add_u32 s30, s30, s79
    s_lshl_b32 s79, s30, 13
    s_add_u32 s79, s79, 1048576
    s_add_u32 s45, s40, 4
    s_bfe_u32 s30, s45, 0x10003
    s_xor_b32 s30, s30, s3
    s_lshl_b32 s80, s45, 2
    s_add_u32 s30, s30, s80
    s_lshl_b32 s80, s30, 13
    s_add_u32 s80, s80, 1048576
    s_add_u32 s30, s40, 0
    s_and_b32 s30, s30, 7
    s_lshl_b32 s30, s30, 10
    v_add_u32 v18, s30, v4
    s_add_u32 s30, s40, 1
    s_and_b32 s30, s30, 7
    s_lshl_b32 s30, s30, 10
    v_add_u32 v19, s30, v4
    s_add_u32 s30, s40, 2
    s_and_b32 s30, s30, 7
    s_lshl_b32 s30, s30, 10
    v_add_u32 v20, s30, v4
    s_add_u32 s30, s40, 3
    s_and_b32 s30, s30, 7
    s_lshl_b32 s30, s30, 10
    v_add_u32 v21, s30, v4
    s_add_u32 s30, s40, 4
    s_and_b32 s30, s30, 7
    s_lshl_b32 s30, s30, 10
    v_add_u32 v22, s30, v4
    s_add_u32 s30, s40, 5
    s_and_b32 s30, s30, 7
    s_lshl_b32 s30, s30, 10
    v_add_u32 v23, s30, v4
    s_add_u32 s30, s40, 6
    s_and_b32 s30, s30, 7
    s_lshl_b32 s30, s30, 10
    v_add_u32 v24, s30, v4
    s_add_u32 s30, s40, 7
    s_and_b32 s30, s30, 7
    s_lshl_b32 s30, s30, 10
    v_add_u32 v25, s30, v4
    s_lshl_b32 s45, s3, 1
    s_add_u32 s45, s45, s40
    s_add_u32 s30, s45, 0
    s_and_b32 s30, s30, 7
    s_lshl_b32 s30, s30, 10
    v_add_u32 v152, s30, v4
    s_add_u32 s30, s45, 1
    s_and_b32 s30, s30, 7
    s_lshl_b32 s30, s30, 10
    v_add_u32 v153, s30, v4
    s_add_u32 s30, s45, 2
    s_and_b32 s30, s30, 7
    s_lshl_b32 s30, s30, 10
    v_add_u32 v154, s30, v4
    s_add_u32 s30, s45, 3
    s_and_b32 s30, s30, 7
    s_lshl_b32 s30, s30, 10
    v_add_u32 v155, s30, v4
    s_add_u32 s30, s45, 4
    s_and_b32 s30, s30, 7
    s_lshl_b32 s30, s30, 10
    v_add_u32 v156, s30, v4
    s_add_u32 s30, s45, 5
    s_and_b32 s30, s30, 7
    s_lshl_b32 s30, s30, 10
    v_add_u32 v157, s30, v4
    s_add_u32 s30, s45, 6
    s_and_b32 s30, s30, 7
    s_lshl_b32 s30, s30, 10
    v_add_u32 v158, s30, v4
    s_add_u32 s30, s45, 7
    s_and_b32 s30, s30, 7
    s_lshl_b32 s30, s30, 10
    v_add_u32 v159, s30, v4
    s_add_u32 s45, s42, 1
L_fw_70:
    buffer_load_dwordx2 v[12:13], v6, s[8:11], 0 offen sc1
    s_add_u32 s7, s7, 1
    s_bitcmp1_b32 s7, 22
    s_cbranch_scc1 L_abort
    s_waitcnt vmcnt(0)
    v_cmp_ne_u32 vcc, s4, v13
    v_cmp_gt_u32 s[28:29], s45, v12
    s_or_b64 vcc, vcc, s[28:29]
    s_cbranch_scc1 L_fw_70
L_fe_71:
    s_lshl_b32 s43, s42, 22
    s_and_b32 s43, s43, 134217727
    s_cmp_gt_u32 s42, 60
    s_cselect_b32 s43, 2130706432, s43
    s_add_u32 s81, s43, s76
    s_add_u32 s82, s43, s77
    s_add_u32 s83, s43, s78
    s_add_u32 s84, s43, s79
    s_add_u32 s85, s43, s80
    buffer_load_dwordx4 a[0:3], v18, s[8:11], s81 offen sc1
    buffer_load_dwordx4 a[4:7], v19, s[8:11], s81 offen sc1
    buffer_load_dwordx4 a[8:11], v20, s[8:11], s81 offen sc1
    buffer_load_dwordx4 a[12:15], v21, s[8:11], s81 offen sc1
    buffer_load_dwordx4 a[16:19], v22, s[8:11], s81 offen sc1
    buffer_load_dwordx4 a[20:23], v23, s[8:11], s81 offen sc1
    buffer_load_dwordx4 a[24:27], v24, s[8:11], s81 offen sc1
    buffer_load_dwordx4 a[28:31], v25, s[8:11], s81 offen sc1
    buffer_load_dwordx4 a[40:43], v19, s[8:11], s82 offen sc1
    buffer_load_dwordx4 a[44:47], v20, s[8:11], s82 offen sc1
    buffer_load_dwordx4 a[48:51], v21, s[8:11], s82 offen sc1
    buffer_load_dwordx4 a[52:55], v22, s[8:11], s82 offen sc1
    buffer_load_dwordx4 a[56:59], v23, s[8:11], s82 offen sc1
    buffer_load_dwordx4 a[60:63], v24, s[8:11], s82 offen sc1
    buffer_load_dwordx4 a[64:67], v25, s[8:11], s82 offen sc1
    buffer_load_dwordx4 a[68:71], v18, s[8:11], s82 offen sc1
    buffer_load_dwordx4 a[80:83], v20, s[8:11], s83 offen sc1
    buffer_load_dwordx4 a[84:87], v21, s[8:11], s83 offen sc1
    buffer_load_dwordx4 a[88:91], v22, s[8:11], s83 offen sc1
    buffer_load_dwordx4 a[92:95], v23, s[8:11], s83 offen sc1
    buffer_load_dwordx4 a[96:99], v24, s[8:11], s83 offen sc1
    buffer_load_dwordx4 a[100:103], v25, s[8:11], s83 offen sc1
    buffer_load_dwordx4 a[104:107], v18, s[8:11], s83 offen sc1
    buffer_load_dwordx4 a[108:111], v19, s[8:11], s83 offen sc1
    buffer_load_dwordx4 a[120:123], v21, s[8:11], s84 offen sc1
    buffer_load_dwordx4 a[124:127], v22, s[8:11], s84 offen sc1
    buffer_load_dwordx4 a[128:131], v23, s[8:11], s84 offen sc1
    buffer_load_dwordx4 a[132:135], v24, s[8:11], s84 offen sc1
    buffer_load_dwordx4 a[136:139], v25, s[8:11], s84 offen sc1
    buffer_load_dwordx4 a[140:143], v18, s[8:11], s84 offen sc1
    buffer_load_dwordx4 a[144:147], v19, s[8:11], s84 offen sc1
    buffer_load_dwordx4 a[148:151], v20, s[8:11], s84 offen sc1
    buffer_load_dwordx4 a[160:163], v22, s[8:11], s85 offen sc1
    buffer_load_dwordx4 a[164:167], v23, s[8:11], s85 offen sc1
    buffer_load_dwordx4 a[168:171], v24, s[8:11], s85 offen sc1
    buffer_load_dwordx4 a[172:175], v25, s[8:11], s85 offen sc1
    buffer_load_dwordx4 a[176:179], v18, s[8:11], s85 offen sc1
    buffer_load_dwordx4 a[180:183], v19, s[8:11], s85 offen sc1
    buffer_load_dwordx4 a[184:187], v20, s[8:11], s85 offen sc1
    buffer_load_dwordx4 a[188:191], v21, s[8:11], s85 offen sc1
    v_mov_b32 v14, 0
    v_not_b32 v16, s4
L_f_seg:
    s_lshl_b32 s30, s35, 13
    s_lshl_b32 s37, s42, 22
    s_add_u32 s37, s37, s30
    s_and_b32 s37, s37, 134217727
    s_add_u32 s30, s40, 4
    s_lshl_b32 s30, s30, 14
    s_add_u32 s36, s37, s30
    s_lshl_b32 s30, s3, 11
    s_add_u32 s46, s37, 737280
    s_add_u32 s48, s46, s30
    s_add_u32 s48, s48, 65536
    s_add_u32 s49, s48, 81920
    s_lshl_b32 s30, s3, 14
    s_add_u32 s46, s46, s30
    s_add_u32 s47, s46, 81920
    s_mov_b64 s[38:39], -1
    s_add_u32 s44, s42, 1
    s_add_u32 s45, s44, s4
    s_add_u32 s56, s42, 2
    s_add_u32 s57, s42, 3
    s_min_u32 s57, s57, 64
    s_add_u32 s52, s36, 16384
    s_add_u32 s53, s36, 32768
    s_add_u32 s54, s36, 49152
    s_add_u32 s55, s36, 65536
    s_mov_b32 s51, s36
    s_branch L_f_tk1
L_f_tk:
    s_sleep 1
L_f_tk1:
    buffer_load_dword v16, v7, s[8:11], s37 offen sc1
    s_add_u32 s7, s7, 1
    s_bitcmp1_b32 s7, 22
    s_cbranch_scc1 L_abort
    s_waitcnt vmcnt(0)
    buffer_store_dwordx2 v[14:15], v8, s[8:11], s58 offen sc1
    s_mov_b32 s58, 2130706432
    v_cmp_ne_u32 vcc, s45, v16
    s_cbranch_vccnz L_f_tk
    v_cmp_ne_u32 vcc, s4, v13
    v_cmp_gt_u32 s[28:29], s57, v12
    s_or_b64 vcc, vcc, s[28:29]
    s_cbranch_scc0 L_fe_74
L_fw_73:
    buffer_load_dwordx2 v[12:13], v6, s[8:11], 0 offen sc1
    s_add_u32 s7, s7, 1
    s_bitcmp1_b32 s7, 22
    s_cbranch_scc1 L_abort
    s_waitcnt vmcnt(0)
    v_cmp_ne_u32 vcc, s4, v13
    v_cmp_gt_u32 s[28:29], s57, v12
    s_or_b64 vcc, vcc, s[28:29]
    s_cbranch_scc1 L_fw_73
L_fe_74:
L_f_go:
    s_lshl_b32 s43, s56, 22
    s_and_b32 s43, s43, 134217727
    s_cmp_gt_u32 s56, 60
    s_cselect_b32 s43, 2130706432, s43
    s_add_u32 s81, s43, s76
    s_add_u32 s82, s43, s77
    s_add_u32 s83, s43, s78
    s_add_u32 s84, s43, s79
    s_add_u32 s85, s43, s80
    buffer_load_dwordx4 v[32:35], v4, s[8:11], s46 offen offset:0 sc1
    buffer_load_dwordx4 v[36:39], v4, s[8:11], s47 offen offset:0 sc1
    buffer_load_dwordx4 v[40:43], v4, s[8:11], s46 offen offset:1024 sc1
    buffer_load_dwordx4 v[44:47], v4, s[8:11], s47 offen offset:1024 sc1
    buffer_load_dwordx4 v[48:51], v4, s[8:11], s46 offen offset:2048 sc1
    buffer_load_dwordx4 v[52:55], v4, s[8:11], s47 offen offset:2048 sc1
    s_waitcnt vmcnt(5)
    v_mfma_f32_16x16x32_bf16 v[112:115], a[0:3], v[32:35], 0
    buffer_load_dwordx4 v[56:59], v4, s[8:11], s46 offen offset:3072 sc1
    v_mfma_f32_16x16x32_bf16 v[120:123], a[40:43], v[32:35], 0
    v_mfma_f32_16x16x32_bf16 v[128:131], a[80:83], v[32:35], 0
    v_mfma_f32_16x16x32_bf16 v[136:139], a[120:123], v[32:35], 0
    buffer_load_dwordx4 v[60:63], v4, s[8:11], s47 offen offset:3072 sc1
    v_mfma_f32_16x16x32_bf16 v[144:147], a[160:163], v[32:35], 0
    s_waitcnt vmcnt(6)
    v_mfma_f32_16x16x32_bf16 v[116:119], a[0:3], v[36:39], 0
    buffer_load_dwordx4 a[32:35], v152, s[8:11], s51 offen sc1
    v_mfma_f32_16x16x32_bf16 v[124:127], a[40:43], v[36:39], 0
    v_mfma_f32_16x16x32_bf16 v[132:135], a[80:83], v[36:39], 0
    v_mfma_f32_16x16x32_bf16 v[140:143], a[120:123], v[36:39], 0
    buffer_load_dwordx4 a[72:75], v153, s[8:11], s52 offen sc1
    v_mfma_f32_16x16x32_bf16 v[148:151], a[160:163], v[36:39], 0
    s_waitcnt vmcnt(7)
    v_mfma_f32_16x16x32_bf16 v[112:115], a[4:7], v[40:43], v[112:115]
    buffer_load_dwordx4 v[64:67], v5, s[8:11], s46 offen offset:0 sc1
    v_mfma_f32_16x16x32_bf16 v[120:123], a[44:47], v[40:43], v[120:123]
    v_mfma_f32_16x16x32_bf16 v[128:131], a[84:87], v[40:43], v[128:131]
    v_mfma_f32_16x16x32_bf16 v[136:139], a[124:127], v[40:43], v[136:139]
    buffer_load_dwordx4 v[68:71], v5, s[8:11], s47 offen offset:0 sc1
    v_mfma_f32_16x16x32_bf16 v[144:147], a[164:167], v[40:43], v[144:147]
    s_waitcnt vmcnt(8)
    v_mfma_f32_16x16x32_bf16 v[116:119], a[4:7], v[44:47], v[116:119]
    buffer_load_dwordx4 a[112:115], v154, s[8:11], s53 offen sc1
    v_mfma_f32_16x16x32_bf16 v[124:127], a[44:47], v[44:47], v[124:127]
    v_mfma_f32_16x16x32_bf16 v[132:135], a[84:87], v[44:47], v[132:135]
    v_mfma_f32_16x16x32_bf16 v[140:143], a[124:127], v[44:47], v[140:143]
    buffer_load_dwordx4 a[152:155], v155, s[8:11], s54 offen sc1
    v_mfma_f32_16x16x32_bf16 v[148:151], a[164:167], v[44:47], v[148:151]
    s_waitcnt vmcnt(9)
    v_mfma_f32_16x16x32_bf16 v[112:115], a[8:11], v[48:51], v[112:115]
    buffer_load_dwordx4 v[72:75], v5, s[8:11], s46 offen offset:1024 sc1
    v_mfma_f32_16x16x32_bf16 v[120:123], a[48:51], v[48:51], v[120:123]
    v_mfma_f32_16x16x32_bf16 v[128:131], a[88:91], v[48:51], v[128:131]
    v_mfma_f32_16x16x32_bf16 v[136:139], a[128:131], v[48:51], v[136:139]
    buffer_load_dwordx4 v[76:79], v5, s[8:11], s47 offen offset:1024 sc1
    v_mfma_f32_16x16x32_bf16 v[144:147], a[168:171], v[48:51], v[144:147]
    s_waitcnt vmcnt(10)
    v_mfma_f32_16x16x32_bf16 v[116:119], a[8:11], v[52:55], v[116:119]
    buffer_load_dwordx4 a[192:195], v156, s[8:11], s55 offen sc1
    v_mfma_f32_16x16x32_bf16 v[124:127], a[48:51], v[52:55], v[124:127]
    v_mfma_f32_16x16x32_bf16 v[132:135], a[88:91], v[52:55], v[132:135]
    v_mfma_f32_16x16x32_bf16 v[140:143], a[128:131], v[52:55], v[140:143]
    buffer_load_dwordx4 a[36:39], v153, s[8:11], s51 offen sc1
    v_mfma_f32_16x16x32_bf16 v[148:151], a[168:171], v[52:55], v[148:151]
    s_waitcnt vmcnt(11)
    v_mfma_f32_16x16x32_bf16 v[112:115], a[12:15], v[56:59], v[112:115]
    buffer_load_dwordx4 v[80:83], v5, s[8:11], s46 offen offset:2048 sc1
    v_mfma_f32_16x16x32_bf16 v[120:123], a[52:55], v[56:59], v[120:123]
    v_mfma_f32_16x16x32_bf16 v[128:131], a[92:95], v[56:59], v[128:131]
    v_mfma_f32_16x16x32_bf16 v[136:139], a[132:135], v[56:59], v[136:139]
    buffer_load_dwordx4 v[84:87], v5, s[8:11], s47 offen offset:2048 sc1
    v_mfma_f32_16x16x32_bf16 v[144:147], a[172:175], v[56:59], v[144:147]
    s_waitcnt vmcnt(12)
    v_mfma_f32_16x16x32_bf16 v[116:119], a[12:15], v[60:63], v[116:119]
    buffer_load_dwordx4 a[76:79], v154, s[8:11], s52 offen sc1
    v_mfma_f32_16x16x32_bf16 v[124:127], a[52:55], v[60:63], v[124:127]
    v_mfma_f32_16x16x32_bf16 v[132:135], a[92:95], v[60:63], v[132:135]
    v_mfma_f32_16x16x32_bf16 v[140:143], a[132:135], v[60:63], v[140:143]
    buffer_load_dwordx4 a[116:119], v155, s[8:11], s53 offen sc1
    v_mfma_f32_16x16x32_bf16 v[148:151], a[172:175], v[60:63], v[148:151]
    s_waitcnt vmcnt(11)
    v_mfma_f32_16x16x32_bf16 v[112:115], a[16:19], v[64:67], v[112:115]
    buffer_load_dwordx4 v[88:91], v5, s[8:11], s46 offen offset:3072 sc1
    v_mfma_f32_16x16x32_bf16 v[120:123], a[56:59], v[64:67], v[120:123]
    v_mfma_f32_16x16x32_bf16 v[128:131], a[96:99], v[64:67], v[128:131]
    v_mfma_f32_16x16x32_bf16 v[136:139], a[136:139], v[64:67], v[136:139]
    buffer_load_dwordx4 v[92:95], v5, s[8:11], s47 offen offset:3072 sc1
    v_mfma_f32_16x16x32_bf16 v[144:147], a[176:179], v[64:67], v[144:147]
    s_waitcnt vmcnt(12)
    v_mfma_f32_16x16x32_bf16 v[116:119], a[16:19], v[68:71], v[116:119]
    buffer_load_dwordx4 a[156:159], v156, s[8:11], s54 offen sc1
    v_mfma_f32_16x16x32_bf16 v[124:127], a[56:59], v[68:71], v[124:127]
    v_mfma_f32_16x16x32_bf16 v[132:135], a[96:99], v[68:71], v[132:135]
    v_mfma_f32_16x16x32_bf16 v[140:143], a[136:139], v[68:71], v[140:143]
    buffer_load_dwordx4 a[196:199], v157, s[8:11], s55 offen sc1
    v_mfma_f32_16x16x32_bf16 v[148:151], a[176:179], v[68:71], v[148:151]
    s_waitcnt vmcnt(11)
    v_mfma_f32_16x16x32_bf16 v[112:115], a[20:23], v[72:75], v[112:115]
    buffer_load_dwordx4 v[96:99], v4, s[8:11], s48 offen offset:0 sc1
    v_mfma_f32_16x16x32_bf16 v[120:123], a[60:63], v[72:75], v[120:123]
    v_mfma_f32_16x16x32_bf16 v[128:131], a[100:103], v[72:75], v[128:131]
    v_mfma_f32_16x16x32_bf16 v[136:139], a[140:143], v[72:75], v[136:139]
    buffer_load_dwordx4 v[100:103], v4, s[8:11], s49 offen offset:0 sc1
    v_mfma_f32_16x16x32_bf16 v[144:147], a[180:183], v[72:75], v[144:147]
    s_waitcnt vmcnt(12)
    v_mfma_f32_16x16x32_bf16 v[116:119], a[20:23], v[76:79], v[116:119]
    buffer_load_dwordx4 v[104:107], v4, s[8:11], s48 offen offset:1024 sc1
    v_mfma_f32_16x16x32_bf16 v[124:127], a[60:63], v[76:79], v[124:127]
    v_mfma_f32_16x16x32_bf16 v[132:135], a[100:103], v[76:79], v[132:135]
    v_mfma_f32_16x16x32_bf16 v[140:143], a[140:143], v[76:79], v[140:143]
    buffer_load_dwordx4 v[108:111], v4, s[8:11], s49 offen offset:1024 sc1
    v_mfma_f32_16x16x32_bf16 v[148:151], a[180:183], v[76:79], v[148:151]
    s_waitcnt vmcnt(11)
    v_mfma_f32_16x16x32_bf16 v[112:115], a[24:27], v[80:83], v[112:115]
    v_mfma_f32_16x16x32_bf16 v[120:123], a[64:67], v[80:83], v[120:123]
    buffer_load_dwordx4 a[0:3], v18, s[8:11], s81 offen sc1
    v_mfma_f32_16x16x32_bf16 v[128:131], a[104:107], v[80:83], v[128:131]
    v_mfma_f32_16x16x32_bf16 v[136:139], a[144:147], v[80:83], v[136:139]
    v_mfma_f32_16x16x32_bf16 v[144:147], a[184:187], v[80:83], v[144:147]
    s_waitcnt vmcnt(11)
    v_mfma_f32_16x16x32_bf16 v[116:119], a[24:27], v[84:87], v[116:119]
    v_mfma_f32_16x16x32_bf16 v[124:127], a[64:67], v[84:87], v[124:127]
    buffer_load_dwordx4 a[40:43], v19, s[8:11], s82 offen sc1
    v_mfma_f32_16x16x32_bf16 v[132:135], a[104:107], v[84:87], v[132:135]
    v_mfma_f32_16x16x32_bf16 v[140:143], a[144:147], v[84:87], v[140:143]
    v_mfma_f32_16x16x32_bf16 v[148:151], a[184:187], v[84:87], v[148:151]
    s_waitcnt vmcnt(9)
    v_mfma_f32_16x16x32_bf16 v[112:115], a[28:31], v[88:91], v[112:115]
    v_mfma_f32_16x16x32_bf16 v[120:123], a[68:71], v[88:91], v[120:123]
    buffer_load_dwordx4 a[80:83], v20, s[8:11], s83 offen sc1
    v_mfma_f32_16x16x32_bf16 v[128:131], a[108:111], v[88:91], v[128:131]
    v_mfma_f32_16x16x32_bf16 v[136:139], a[148:151], v[88:91], v[136:139]
    v_mfma_f32_16x16x32_bf16 v[144:147], a[188:191], v[88:91], v[144:147]
    s_waitcnt vmcnt(9)
    v_mfma_f32_16x16x32_bf16 v[116:119], a[28:31], v[92:95], v[116:119]
    v_mfma_f32_16x16x32_bf16 v[124:127], a[68:71], v[92:95], v[124:127]
    buffer_load_dwordx4 a[120:123], v21, s[8:11], s84 offen sc1
    v_mfma_f32_16x16x32_bf16 v[132:135], a[108:111], v[92:95], v[132:135]
    v_mfma_f32_16x16x32_bf16 v[140:143], a[148:151], v[92:95], v[140:143]
    v_mfma_f32_16x16x32_bf16 v[148:151], a[188:191], v[92:95], v[148:151]
    s_waitcnt vmcnt(7)
    v_mfma_f32_16x16x32_bf16 v[112:115], a[32:35], v[96:99], v[112:115]
    v_mfma_f32_16x16x32_bf16 v[120:123], a[72:75], v[96:99], v[120:123]
    buffer_load_dwordx4 a[160:163], v22, s[8:11], s85 offen sc1
    v_mfma_f32_16x16x32_bf16 v[128:131], a[112:115], v[96:99], v[128:131]
    v_mfma_f32_16x16x32_bf16 v[136:139], a[152:155], v[96:99], v[136:139]
    v_mfma_f32_16x16x32_bf16 v[144:147], a[192:195], v[96:99], v[144:147]
    s_waitcnt vmcnt(7)
    v_mfma_f32_16x16x32_bf16 v[116:119], a[32:35], v[100:103], v[116:119]
    v_mfma_f32_16x16x32_bf16 v[124:127], a[72:75], v[100:103], v[124:127]
    buffer_load_dwordx4 a[4:7], v19, s[8:11], s81 offen sc1
    v_mfma_f32_16x16x32_bf16 v[132:135], a[112:115], v[100:103], v[132:135]
    v_mfma_f32_16x16x32_bf16 v[140:143], a[152:155], v[100:103], v[140:143]
    v_mfma_f32_16x16x32_bf16 v[148:151], a[192:195], v[100:103], v[148:151]
    s_waitcnt vmcnt(7)
    v_mfma_f32_16x16x32_bf16 v[112:115], a[36:39], v[104:107], v[112:115]
    v_mfma_f32_16x16x32_bf16 v[120:123], a[76:79], v[104:107], v[120:123]
    buffer_load_dwordx4 a[44:47], v20, s[8:11], s82 offen sc1
    v_mfma_f32_16x16x32_bf16 v[128:131], a[116:119], v[104:107], v[128:131]
    v_mfma_f32_16x16x32_bf16 v[136:139], a[156:159], v[104:107], v[136:139]
    v_mfma_f32_16x16x32_bf16 v[144:147], a[196:199], v[104:107], v[144:147]
    s_waitcnt vmcnt(7)
    v_mfma_f32_16x16x32_bf16 v[116:119], a[36:39], v[108:111], v[116:119]
    v_mfma_f32_16x16x32_bf16 v[124:127], a[76:79], v[108:111], v[124:127]
    buffer_load_dwordx4 a[84:87], v21, s[8:11], s83 offen sc1
    v_mfma_f32_16x16x32_bf16 v[132:135], a[116:119], v[108:111], v[132:135]
    v_mfma_f32_16x16x32_bf16 v[140:143], a[156:159], v[108:111], v[140:143]
    v_mfma_f32_16x16x32_bf16 v[148:151], a[196:199], v[108:111], v[148:151]
    s_mov_b64 s[28:29], 0
    v_cmp_u_f32 vcc, v112, v113
    s_or_b64 s[28:29], s[28:29], vcc
    v_cmp_u_f32 vcc, v114, v115
    s_or_b64 s[28:29], s[28:29], vcc
    v_cmp_u_f32 vcc, v120, v121
    s_or_b64 s[28:29], s[28:29], vcc
    v_cmp_u_f32 vcc, v122, v123
    s_or_b64 s[28:29], s[28:29], vcc
    v_cmp_u_f32 vcc, v128, v129
    s_or_b64 s[28:29], s[28:29], vcc
    v_cmp_u_f32 vcc, v130, v131
    s_or_b64 s[28:29], s[28:29], vcc
    v_cmp_u_f32 vcc, v136, v137
    s_or_b64 s[28:29], s[28:29], vcc
    v_cmp_u_f32 vcc, v138, v139
    s_or_b64 s[28:29], s[28:29], vcc
    v_cmp_u_f32 vcc, v144, v145
    s_or_b64 s[28:29], s[28:29], vcc
    v_cmp_u_f32 vcc, v146, v147
    s_or_b64 s[28:29], s[28:29], vcc
    v_cmp_u_f32 vcc, v116, v116
    s_or_b64 s[28:29], s[28:29], vcc
    s_and_b64 s[28:29], s[28:29], s[38:39]
    s_cbranch_scc1 L_f_slow
    ds_write_b128 v9, v[112:115] offset:0
    buffer_load_dwordx4 a[124:127], v22, s[8:11], s84 offen sc1
    ds_write_b128 v9, v[116:119] offset:1024
    buffer_load_dwordx4 a[164:167], v23, s[8:11], s85 offen sc1
    ds_write_b128 v9, v[120:123] offset:2048
    buffer_load_dwordx4 a[8:11], v20, s[8:11], s81 offen sc1
    ds_write_b128 v9, v[124:127] offset:3072
    buffer_load_dwordx4 a[48:51], v21, s[8:11], s82 offen sc1
    ds_write_b128 v9, v[128:131] offset:4096
    buffer_load_dwordx4 a[88:91], v22, s[8:11], s83 offen sc1
    ds_write_b128 v9, v[132:135] offset:5120
    buffer_load_dwordx4 a[128:131], v23, s[8:11], s84 offen sc1
    ds_write_b128 v9, v[136:139] offset:6144
    buffer_load_dwordx4 a[168:171], v24, s[8:11], s85 offen sc1
    ds_write_b128 v9, v[140:143] offset:7168
    buffer_load_dwordx4 a[12:15], v21, s[8:11], s81 offen sc1
    ds_write_b128 v9, v[144:147] offset:8192
    buffer_load_dwordx4 a[52:55], v22, s[8:11], s82 offen sc1
    ds_write_b128 v9, v[148:151] offset:9216
    buffer_load_dwordx4 a[92:95], v23, s[8:11], s83 offen sc1
    s_lshl_b32 s50, s42, 12
    s_add_u32 s50, s50, s40
    s_lshl_b32 s50, s50, 10
    s_add_u32 s50, s50, 3932160
    s_waitcnt lgkmcnt(0)
    s_barrier
    ds_read_b128 v[32:35], v10 offset:0
    ds_read_b128 v[36:39], v10 offset:10240
    ds_read_b128 v[40:43], v10 offset:20480
    ds_read_b128 v[44:47], v10 offset:30720
    ds_read_b128 v[48:51], v10 offset:4096
    ds_read_b128 v[52:55], v10 offset:14336
    ds_read_b128 v[56:59], v10 offset:24576
    ds_read_b128 v[60:63], v10 offset:34816
    ds_read_b128 v[64:67], v10 offset:8192
    ds_read_b128 v[68:71], v10 offset:18432
    ds_read_b128 v[72:75], v10 offset:28672
    ds_read_b128 v[76:79], v10 offset:38912
    s_cmp_lt_u32 s3, 2
    s_cselect_b32 s59, s50, 2130706432
    s_add_u32 s59, s59, 4096
    buffer_load_dwordx4 a[132:135], v24, s[8:11], s84 offen sc1
    buffer_load_dwordx4 a[172:175], v25, s[8:11], s85 offen sc1
    s_waitcnt lgkmcnt(8)
    v_pk_add_f32 v[32:33], v[32:33], v[36:37]
    v_pk_add_f32 v[34:35], v[34:35], v[38:39]
    v_pk_add_f32 v[40:41], v[40:41], v[44:45]
    v_pk_add_f32 v[42:43], v[42:43], v[46:47]
    v_pk_add_f32 v[32:33], v[32:33], v[40:41]
    v_pk_add_f32 v[34:35], v[34:35], v[42:43]
    v_cvt_pk_bf16_f32 v32, v32, v33
    v_cvt_pk_bf16_f32 v33, v34, v35
    buffer_store_dwordx2 v[32:33], v11, s[8:11], s50 offen offset:0 sc1
    s_waitcnt lgkmcnt(4)
    v_pk_add_f32 v[48:49], v[48:49], v[52:53]
    v_pk_add_f32 v[50:51], v[50:51], v[54:55]
    v_pk_add_f32 v[56:57], v[56:57], v[60:61]
    v_pk_add_f32 v[58:59], v[58:59], v[62:63]
    v_pk_add_f32 v[48:49], v[48:49], v[56:57]
    v_pk_add_f32 v[50:51], v[50:51], v[58:59]
    v_cvt_pk_bf16_f32 v48, v48, v49
    v_cvt_pk_bf16_f32 v49, v50, v51
    buffer_store_dwordx2 v[48:49], v11, s[8:11], s50 offen offset:2048 sc1
    s_waitcnt lgkmcnt(0)
    v_pk_add_f32 v[64:65], v[64:65], v[68:69]
    v_pk_add_f32 v[66:67], v[66:67], v[70:71]
    v_pk_add_f32 v[72:73], v[72:73], v[76:77]
    v_pk_add_f32 v[74:75], v[74:75], v[78:79]
    v_pk_add_f32 v[64:65], v[64:65], v[72:73]
    v_pk_add_f32 v[66:67], v[66:67], v[74:75]
    v_cvt_pk_bf16_f32 v64, v64, v65
    v_cvt_pk_bf16_f32 v65, v66, v67
    buffer_store_dwordx2 v[64:65], v11, s[8:11], s59 offen sc1
    s_barrier
    v_mov_b32 v14, s44
    s_mov_b32 s58, 0
    s_cmp_gt_u32 s56, 60
    s_cbranch_scc1 L_f_done
    buffer_load_dwordx2 v[12:13], v6, s[8:11], 0 offen sc1
    buffer_load_dwordx4 a[16:19], v22, s[8:11], s81 offen sc1
    buffer_load_dwordx4 a[56:59], v23, s[8:11], s82 offen sc1
    buffer_load_dwordx4 a[96:99], v24, s[8:11], s83 offen sc1
    buffer_load_dwordx4 a[136:139], v25, s[8:11], s84 offen sc1
    buffer_load_dwordx4 a[176:179], v18, s[8:11], s85 offen sc1
    buffer_load_dwordx4 a[20:23], v23, s[8:11], s81 offen sc1
    buffer_load_dwordx4 a[60:63], v24, s[8:11], s82 offen sc1
    buffer_load_dwordx4 a[100:103], v25, s[8:11], s83 offen sc1
    buffer_load_dwordx4 a[140:143], v18, s[8:11], s84 offen sc1
    buffer_load_dwordx4 a[180:183], v19, s[8:11], s85 offen sc1
    buffer_load_dwordx4 a[24:27], v24, s[8:11], s81 offen sc1
    buffer_load_dwordx4 a[64:67], v25, s[8:11], s82 offen sc1
    buffer_load_dwordx4 a[104:107], v18, s[8:11], s83 offen sc1
    buffer_load_dwordx4 a[144:147], v19, s[8:11], s84 offen sc1
    buffer_load_dwordx4 a[184:187], v20, s[8:11], s85 offen sc1
    buffer_load_dwordx4 a[28:31], v25, s[8:11], s81 offen sc1
    buffer_load_dwordx4 a[68:71], v18, s[8:11], s82 offen sc1
    buffer_load_dwordx4 a[108:111], v19, s[8:11], s83 offen sc1
    buffer_load_dwordx4 a[148:151], v20, s[8:11], s84 offen sc1
    buffer_load_dwordx4 a[188:191], v21, s[8:11], s85 offen sc1
    s_mov_b32 s42, s56
    s_branch L_f_seg
L_f_done:
    s_waitcnt vmcnt(0)
    v_mov_b32 v14, s44
    buffer_store_dwordx2 v[14:15], v8, s[8:11], 0 offen sc1
    s_endpgm
L_f_slow:
    s_waitcnt vmcnt(0)
    s_lshl_b32 s43, s42, 22
    s_and_b32 s43, s43, 134217727
    s_cmp_gt_u32 s42, 60
    s_cselect_b32 s43, 2130706432, s43
    s_add_u32 s81, s43, s76
    s_add_u32 s82, s43, s77
    s_add_u32 s83, s43, s78
    s_add_u32 s84, s43, s79
    s_add_u32 s85, s43, s80
    buffer_load_dwordx4 a[0:3], v18, s[8:11], s81 offen sc1
    buffer_load_dwordx4 a[4:7], v19, s[8:11], s81 offen sc1
    buffer_load_dwordx4 a[8:11], v20, s[8:11], s81 offen sc1
    buffer_load_dwordx4 a[12:15], v21, s[8:11], s81 offen sc1
    buffer_load_dwordx4 a[16:19], v22, s[8:11], s81 offen sc1
    buffer_load_dwordx4 a[20:23], v23, s[8:11], s81 offen sc1
    buffer_load_dwordx4 a[24:27], v24, s[8:11], s81 offen sc1
    buffer_load_dwordx4 a[28:31], v25, s[8:11], s81 offen sc1
    buffer_load_dwordx4 a[40:43], v19, s[8:11], s82 offen sc1
    buffer_load_dwordx4 a[44:47], v20, s[8:11], s82 offen sc1
    buffer_load_dwordx4 a[48:51], v21, s[8:11], s82 offen sc1
    buffer_load_dwordx4 a[52:55], v22, s[8:11], s82 offen sc1
    buffer_load_dwordx4 a[56:59], v23, s[8:11], s82 offen sc1
    buffer_load_dwordx4 a[60:63], v24, s[8:11], s82 offen sc1
    buffer_load_dwordx4 a[64:67], v25, s[8:11], s82 offen sc1
    buffer_load_dwordx4 a[68:71], v18, s[8:11], s82 offen sc1
    buffer_load_dwordx4 a[80:83], v20, s[8:11], s83 offen sc1
    buffer_load_dwordx4 a[84:87], v21, s[8:11], s83 offen sc1
    buffer_load_dwordx4 a[88:91], v22, s[8:11], s83 offen sc1
    buffer_load_dwordx4 a[92:95], v23, s[8:11], s83 offen sc1
    buffer_load_dwordx4 a[96:99], v24, s[8:11], s83 offen sc1
    buffer_load_dwordx4 a[100:103], v25, s[8:11], s83 offen sc1
    buffer_load_dwordx4 a[104:107], v18, s[8:11], s83 offen sc1
    buffer_load_dwordx4 a[108:111], v19, s[8:11], s83 offen sc1
    buffer_load_dwordx4 a[120:123], v21, s[8:11], s84 offen sc1
    buffer_load_dwordx4 a[124:127], v22, s[8:11], s84 offen sc1
    buffer_load_dwordx4 a[128:131], v23, s[8:11], s84 offen sc1
    buffer_load_dwordx4 a[132:135], v24, s[8:11], s84 offen sc1
    buffer_load_dwordx4 a[136:139], v25, s[8:11], s84 offen sc1
    buffer_load_dwordx4 a[140:143], v18, s[8:11], s84 offen sc1
    buffer_load_dwordx4 a[144:147], v19, s[8:11], s84 offen sc1
    buffer_load_dwordx4 a[148:151], v20, s[8:11], s84 offen sc1
    buffer_load_dwordx4 a[160:163], v22, s[8:11], s85 offen sc1
    buffer_load_dwordx4 a[164:167], v23, s[8:11], s85 offen sc1
    buffer_load_dwordx4 a[168:171], v24, s[8:11], s85 offen sc1
    buffer_load_dwordx4 a[172:175], v25, s[8:11], s85 offen sc1
    buffer_load_dwordx4 a[176:179], v18, s[8:11], s85 offen sc1
    buffer_load_dwordx4 a[180:183], v19, s[8:11], s85 offen sc1
    buffer_load_dwordx4 a[184:187], v20, s[8:11], s85 offen sc1
    buffer_load_dwordx4 a[188:191], v21, s[8:11], s85 offen sc1
    s_waitcnt vmcnt(0)
L_f_sp:
    buffer_load_dwordx4 v[32:35], v4, s[8:11], s46 offen offset:0 sc1
    buffer_load_dwordx4 v[36:39], v4, s[8:11], s47 offen offset:0 sc1
    buffer_load_dwordx4 v[40:43], v4, s[8:11], s46 offen offset:1024 sc1
    buffer_load_dwordx4 v[44:47], v4, s[8:11], s47 offen offset:1024 sc1
    buffer_load_dwordx4 v[48:51], v4, s[8:11], s46 offen offset:2048 sc1
    buffer_load_dwordx4 v[52:55], v4, s[8:11], s47 offen offset:2048 sc1
    buffer_load_dwordx4 v[56:59], v4, s[8:11], s46 offen offset:3072 sc1
    buffer_load_dwordx4 v[60:63], v4, s[8:11], s47 offen offset:3072 sc1
    buffer_load_dwordx4 a[32:35], v152, s[8:11], s51 offen sc1
    buffer_load_dwordx4 a[72:75], v153, s[8:11], s52 offen sc1
    buffer_load_dwordx4 v[64:67], v5, s[8:11], s46 offen offset:0 sc1
    buffer_load_dwordx4 v[68:71], v5, s[8:11], s47 offen offset:0 sc1
    buffer_load_dwordx4 a[112:115], v154, s[8:11], s53 offen sc1
    buffer_load_dwordx4 a[152:155], v155, s[8:11], s54 offen sc1
    buffer_load_dwordx4 v[72:75], v5, s[8:11], s46 offen offset:1024 sc1
    buffer_load_dwordx4 v[76:79], v5, s[8:11], s47 offen offset:1024 sc1
    buffer_load_dwordx4 a[192:195], v156, s[8:11], s55 offen sc1
    buffer_load_dwordx4 a[36:39], v153, s[8:11], s51 offen sc1
    buffer_load_dwordx4 v[80:83], v5, s[8:11], s46 offen offset:2048 sc1
    buffer_load_dwordx4 v[84:87], v5, s[8:11], s47 offen offset:2048 sc1
    buffer_load_dwordx4 a[76:79], v154, s[8:11], s52 offen sc1
    buffer_load_dwordx4 a[116:119], v155, s[8:11], s53 offen sc1
    buffer_load_dwordx4 v[88:91], v5, s[8:11], s46 offen offset:3072 sc1
    buffer_load_dwordx4 v[92:95], v5, s[8:11], s47 offen offset:3072 sc1
    buffer_load_dwordx4 a[156:159], v156, s[8:11], s54 offen sc1
    buffer_load_dwordx4 a[196:199], v157, s[8:11], s55 offen sc1
    buffer_load_dwordx4 v[96:99], v4, s[8:11], s48 offen offset:0 sc1
    buffer_load_dwordx4 v[100:103], v4, s[8:11], s49 offen offset:0 sc1
    buffer_load_dwordx4 v[104:107], v4, s[8:11], s48 offen offset:1024 sc1
    buffer_load_dwordx4 v[108:111], v4, s[8:11], s49 offen offset:1024 sc1
    s_add_u32 s7, s7, 1
    s_bitcmp1_b32 s7, 22
    s_cbranch_scc1 L_abort
    s_waitcnt vmcnt(0)
    v_mov_b32 v1, 0
    v_accvgpr_read_b32 v2, a32
    v_max_u32 v1, v1, v2
    v_accvgpr_read_b32 v2, a33
    v_max_u32 v1, v1, v2
    v_accvgpr_read_b32 v2, a34
    v_max_u32 v1, v1, v2
    v_accvgpr_read_b32 v2, a35
    v_max_u32 v1, v1, v2
    v_accvgpr_read_b32 v2, a36
    v_max_u32 v1, v1, v2
    v_accvgpr_read_b32 v2, a37
    v_max_u32 v1, v1, v2
    v_accvgpr_read_b32 v2, a38
    v_max_u32 v1, v1, v2
    v_accvgpr_read_b32 v2, a39
    v_max_u32 v1, v1, v2
    v_accvgpr_read_b32 v2, a72
    v_max_u32 v1, v1, v2
    v_accvgpr_read_b32 v2, a73
    v_max_u32 v1, v1, v2
    v_accvgpr_read_b32 v2, a74
    v_max_u32 v1, v1, v2
    v_accvgpr_read_b32 v2, a75
    v_max_u32 v1, v1, v2
    v_accvgpr_read_b32 v2, a76
    v_max_u32 v1, v1, v2
    v_accvgpr_read_b32 v2, a77
    v_max_u32 v1, v1, v2
    v_accvgpr_read_b32 v2, a78
    v_max_u32 v1, v1, v2
    v_accvgpr_read_b32 v2, a79
    v_max_u32 v1, v1, v2
    v_accvgpr_read_b32 v2, a112
    v_max_u32 v1, v1, v2
    v_accvgpr_read_b32 v2, a113
    v_max_u32 v1, v1, v2
    v_accvgpr_read_b32 v2, a114
    v_max_u32 v1, v1, v2
    v_accvgpr_read_b32 v2, a115
    v_max_u32 v1, v1, v2
    v_accvgpr_read_b32 v2, a116
    v_max_u32 v1, v1, v2
    v_accvgpr_read_b32 v2, a117
    v_max_u32 v1, v1, v2
    v_accvgpr_read_b32 v2, a118
    v_max_u32 v1, v1, v2
    v_accvgpr_read_b32 v2, a119
    v_max_u32 v1, v1, v2
    v_accvgpr_read_b32 v2, a152
    v_max_u32 v1, v1, v2
    v_accvgpr_read_b32 v2, a153
    v_max_u32 v1, v1, v2
    v_accvgpr_read_b32 v2, a154
    v_max_u32 v1, v1, v2
    v_accvgpr_read_b32 v2, a155
    v_max_u32 v1, v1, v2
    v_accvgpr_read_b32 v2, a156
    v_max_u32 v1, v1, v2
    v_accvgpr_read_b32 v2, a157
    v_max_u32 v1, v1, v2
    v_accvgpr_read_b32 v2, a158
    v_max_u32 v1, v1, v2
    v_accvgpr_read_b32 v2, a159
    v_max_u32 v1, v1, v2
    v_accvgpr_read_b32 v2, a192
    v_max_u32 v1, v1, v2
    v_accvgpr_read_b32 v2, a193
    v_max_u32 v1, v1, v2
    v_accvgpr_read_b32 v2, a194
    v_max_u32 v1, v1, v2
    v_accvgpr_read_b32 v2, a195
    v_max_u32 v1, v1, v2
    v_accvgpr_read_b32 v2, a196
    v_max_u32 v1, v1, v2
    v_accvgpr_read_b32 v2, a197
    v_max_u32 v1, v1, v2
    v_accvgpr_read_b32 v2, a198
    v_max_u32 v1, v1, v2
    v_accvgpr_read_b32 v2, a199
    v_max_u32 v1, v1, v2
    v_max_u32 v1, v1, v32
    v_max_u32 v1, v1, v33
    v_max_u32 v1, v1, v34
    v_max_u32 v1, v1, v35
    v_max_u32 v1, v1, v36
    v_max_u32 v1, v1, v37
    v_max_u32 v1, v1, v38
    v_max_u32 v1, v1, v39
    v_max_u32 v1, v1, v40
    v_max_u32 v1, v1, v41
    v_max_u32 v1, v1, v42
    v_max_u32 v1, v1, v43
    v_max_u32 v1, v1, v44
    v_max_u32 v1, v1, v45
    v_max_u32 v1, v1, v46
    v_max_u32 v1, v1, v47
    v_max_u32 v1, v1, v48
    v_max_u32 v1, v1, v49
    v_max_u32 v1, v1, v50
    v_max_u32 v1, v1, v51
    v_max_u32 v1, v1, v52
    v_max_u32 v1, v1, v53
    v_max_u32 v1, v1, v54
    v_max_u32 v1, v1, v55
    v_max_u32 v1, v1, v56
    v_max_u32 v1, v1, v57
    v_max_u32 v1, v1, v58
    v_max_u32 v1, v1, v59
    v_max_u32 v1, v1, v60
    v_max_u32 v1, v1, v61
    v_max_u32 v1, v1, v62
    v_max_u32 v1, v1, v63
    v_max_u32 v1, v1, v64
    v_max_u32 v1, v1, v65
    v_max_u32 v1, v1, v66
    v_max_u32 v1, v1, v67
    v_max_u32 v1, v1, v68
    v_max_u32 v1, v1, v69
    v_max_u32 v1, v1, v70
    v_max_u32 v1, v1, v71
    v_max_u32 v1, v1, v72
    v_max_u32 v1, v1, v73
    v_max_u32 v1, v1, v74
    v_max_u32 v1, v1, v75
    v_max_u32 v1, v1, v76
    v_max_u32 v1, v1, v77
    v_max_u32 v1, v1, v78
    v_max_u32 v1, v1, v79
    v_max_u32 v1, v1, v80
    v_max_u32 v1, v1, v81
    v_max_u32 v1, v1, v82
    v_max_u32 v1, v1, v83
    v_max_u32 v1, v1, v84
    v_max_u32 v1, v1, v85
    v_max_u32 v1, v1, v86
    v_max_u32 v1, v1, v87
    v_max_u32 v1, v1, v88
    v_max_u32 v1, v1, v89
    v_max_u32 v1, v1, v90
    v_max_u32 v1, v1, v91
    v_max_u32 v1, v1, v92
    v_max_u32 v1, v1, v93
    v_max_u32 v1, v1, v94
    v_max_u32 v1, v1, v95
    v_max_u32 v1, v1, v96
    v_max_u32 v1, v1, v97
    v_max_u32 v1, v1, v98
    v_max_u32 v1, v1, v99
    v_max_u32 v1, v1, v100
    v_max_u32 v1, v1, v101
    v_max_u32 v1, v1, v102
    v_max_u32 v1, v1, v103
    v_max_u32 v1, v1, v104
    v_max_u32 v1, v1, v105
    v_max_u32 v1, v1, v106
    v_max_u32 v1, v1, v107
    v_max_u32 v1, v1, v108
    v_max_u32 v1, v1, v109
    v_max_u32 v1, v1, v110
    v_max_u32 v1, v1, v111
    v_cmp_eq_u32 vcc, -1, v1
    s_cbranch_vccnz L_f_sp
    s_mov_b64 s[38:39], 0
    s_branch L_f_go
L_a1:
    s_lshl_b32 s40, s5, 1
    s_add_u32 s40, s40, s6
    s_sub_u32 s40, s40, 30
    s_mov_b32 s60, 1069066811
    s_mov_b32 s61, 897988541
    s_mov_b32 s12, s66
    s_mov_b32 s13, s67
    s_mov_b32 s14, 2457600
    s_mov_b32 s15, 0x20000
    s_sleep 100
    s_sleep 100
    s_sleep 100
    s_sleep 75
    v_lshrrev_b32 v1, 3, v0
    s_lshl_b32 s30, s3, 3
    v_add_u32 v1, s30, v1
    v_bfe_u32 v2, v1, 1, 3
    v_and_b32 v3, 7, v0
    v_xor_b32 v2, v2, v3
    v_mul_u32_u24 v1, 1280, v1
    v_lshl_add_u32 v8, v2, 4, v1
    v_and_b32 v1, 15, v0
    v_lshrrev_b32 v2, 1, v1
    v_lshrrev_b32 v3, 4, v0
    v_xor_b32 v2, v2, v3
    v_lshlrev_b32 v1, 7, v1
    v_lshl_add_u32 v16, v2, 4, v1
    v_xor_b32 v17, 64, v16
    s_lshl_b32 s34, s3, 10
    s_mov_b32 s44, 0
    s_mov_b32 s48, s34
    s_add_u32 m0, s48, 0
    s_nop 0
    buffer_load_dwordx4 v8, s[20:23], s44 offen offset:0 lds
    s_add_u32 m0, s48, 3968
    s_nop 0
    buffer_load_dwordx4 v8, s[20:23], s44 offen offset:128 lds
    s_add_u32 m0, s48, 7936
    s_nop 0
    buffer_load_dwordx4 v8, s[20:23], s44 offen offset:256 lds
    s_add_u32 m0, s48, 11904
    s_nop 0
    buffer_load_dwordx4 v8, s[20:23], s44 offen offset:384 lds
    s_add_u32 m0, s48, 15872
    s_nop 0
    buffer_load_dwordx4 v8, s[20:23], s44 offen offset:512 lds
    s_add_u32 m0, s48, 19840
    s_nop 0
    buffer_load_dwordx4 v8, s[20:23], s44 offen offset:640 lds
    s_add_u32 m0, s48, 23808
    s_nop 0
    buffer_load_dwordx4 v8, s[20:23], s44 offen offset:768 lds
    s_add_u32 m0, s48, 27776
    s_nop 0
    buffer_load_dwordx4 v8, s[20:23], s44 offen offset:896 lds
    s_add_u32 m0, s48, 31744
    s_nop 0
    buffer_load_dwordx4 v8, s[20:23], s44 offen offset:1024 lds
    s_add_u32 m0, s48, 35712
    s_nop 0
    buffer_load_dwordx4 v8, s[20:23], s44 offen offset:1152 lds
    s_add_u32 s44, s44, 40960
    s_add_u32 s48, s48, 40960
    s_add_u32 m0, s48, 0
    s_nop 0
    buffer_load_dwordx4 v8, s[20:23], s44 offen offset:0 lds
    s_add_u32 m0, s48, 3968
    s_nop 0
    buffer_load_dwordx4 v8, s[20:23], s44 offen offset:128 lds
    s_add_u32 m0, s48, 7936
    s_nop 0
    buffer_load_dwordx4 v8, s[20:23], s44 offen offset:256 lds
    s_add_u32 m0, s48, 11904
    s_nop 0
    buffer_load_dwordx4 v8, s[20:23], s44 offen offset:384 lds
    s_add_u32 m0, s48, 15872
    s_nop 0
    buffer_load_dwordx4 v8, s[20:23], s44 offen offset:512 lds
    s_add_u32 m0, s48, 19840
    s_nop 0
    buffer_load_dwordx4 v8, s[20:23], s44 offen offset:640 lds
    s_add_u32 m0, s48, 23808
    s_nop 0
    buffer_load_dwordx4 v8, s[20:23], s44 offen offset:768 lds
    s_add_u32 m0, s48, 27776
    s_nop 0
    buffer_load_dwordx4 v8, s[20:23], s44 offen offset:896 lds
    s_add_u32 m0, s48, 31744
    s_nop 0
    buffer_load_dwordx4 v8, s[20:23], s44 offen offset:1024 lds
    s_add_u32 m0, s48, 35712
    s_nop 0
    buffer_load_dwordx4 v8, s[20:23], s44 offen offset:1152 lds
    s_mul_i32 s32, s3, 15360
    s_add_u32 s32, s32, 81920
    s_mul_i32 s43, s40, 160
    s_add_u32 s43, s43, 1280
    v_add_u32 v1, 0, v0
    v_mul_u32_u24 v2, 10923, v1
    v_lshrrev_b32 v2, 16, v2
    v_mul_u32_u24 v3, 6, v2
    v_sub_u32 v3, v1, v3
    v_mul_u32_u24 v2, 3840, v2
    v_lshl_add_u32 v2, v3, 4, v2
    s_mul_i32 s30, s3, 40
    v_add_u32 v4, s30, v2
    v_add_u32 v1, 64, v0
    v_mul_u32_u24 v2, 10923, v1
    v_lshrrev_b32 v2, 16, v2
    v_mul_u32_u24 v3, 6, v2
    v_sub_u32 v3, v1, v3
    v_mul_u32_u24 v2, 3840, v2
    v_lshl_add_u32 v2, v3, 4, v2
    s_mul_i32 s30, s3, 40
    v_add_u32 v5, s30, v2
    v_add_u32 v1, 128, v0
    v_mul_u32_u24 v2, 10923, v1
    v_lshrrev_b32 v2, 16, v2
    v_mul_u32_u24 v3, 6, v2
    v_sub_u32 v3, v1, v3
    v_mul_u32_u24 v2, 3840, v2
    v_lshl_add_u32 v2, v3, 4, v2
    s_mul_i32 s30, s3, 40
    v_add_u32 v6, s30, v2
    v_lshrrev_b32 v1, 4, v0
    v_lshlrev_b32 v1, 3, v1
    v_bfe_u32 v2, v0, 2, 2
    v_add_u32 v1, v1, v2
    v_mul_u32_u24 v1, 96, v1
    v_and_b32 v2, 3, v0
    v_lshl_add_u32 v1, v2, 3, v1
    v_add_u32 v7, s32, v1
    v_add_u32 v1, 0, v0
    v_mul_u32_u24 v2, 10923, v1
    v_lshrrev_b32 v2, 16, v2
    v_mul_u32_u24 v3, 6, v2
    v_sub_u32 v3, v1, v3
    v_add_u32 v1, 1232, v4
    v_cmp_lt_u32 vcc, 2, v3
    s_nop 1
    v_cndmask_b32 v4, v4, v1, vcc
    v_add_u32 v1, 64, v0
    v_mul_u32_u24 v2, 10923, v1
    v_lshrrev_b32 v2, 16, v2
    v_mul_u32_u24 v3, 6, v2
    v_sub_u32 v3, v1, v3
    v_add_u32 v1, 1232, v5
    v_cmp_lt_u32 vcc, 2, v3
    s_nop 1
    v_cndmask_b32 v5, v5, v1, vcc
    v_add_u32 v1, 128, v0
    v_mul_u32_u24 v2, 10923, v1
    v_lshrrev_b32 v2, 16, v2
    v_mul_u32_u24 v3, 6, v2
    v_sub_u32 v3, v1, v3
    v_add_u32 v1, 1232, v6
    v_cmp_lt_u32 vcc, 2, v3
    s_nop 1
    v_cndmask_b32 v6, v6, v1, vcc
    v_add_u32 v9, 40, v7
    v_add_u32 v1, 32, v7
    v_and_b32 v2, 3, v0
    v_cmp_eq_u32 vcc, 0, v2
    s_nop 1
    v_cndmask_b32 v9, v9, v1, vcc
    s_add_u32 s33, s43, 0
    s_add_u32 m0, s32, 0
    s_nop 0
    buffer_load_dwordx4 v4, s[12:15], s33 offen lds
    s_add_u32 m0, s32, 1024
    s_nop 0
    buffer_load_dwordx4 v5, s[12:15], s33 offen lds
    s_add_u32 m0, s32, 2048
    s_nop 0
    buffer_load_dwordx4 v6, s[12:15], s33 offen lds
    s_add_u32 s33, s43, 122880
    s_add_u32 m0, s32, 3072
    s_nop 0
    buffer_load_dwordx4 v4, s[12:15], s33 offen lds
    s_add_u32 m0, s32, 4096
    s_nop 0
    buffer_load_dwordx4 v5, s[12:15], s33 offen lds
    s_add_u32 m0, s32, 5120
    s_nop 0
    buffer_load_dwordx4 v6, s[12:15], s33 offen lds
    s_add_u32 s33, s43, 245760
    s_add_u32 m0, s32, 6144
    s_nop 0
    buffer_load_dwordx4 v4, s[12:15], s33 offen lds
    s_add_u32 m0, s32, 7168
    s_nop 0
    buffer_load_dwordx4 v5, s[12:15], s33 offen lds
    s_add_u32 m0, s32, 8192
    s_nop 0
    buffer_load_dwordx4 v6, s[12:15], s33 offen lds
    s_add_u32 s33, s43, 368640
    s_add_u32 m0, s32, 9216
    s_nop 0
    buffer_load_dwordx4 v4, s[12:15], s33 offen lds
    s_add_u32 m0, s32, 10240
    s_nop 0
    buffer_load_dwordx4 v5, s[12:15], s33 offen lds
    s_add_u32 m0, s32, 11264
    s_nop 0
    buffer_load_dwordx4 v6, s[12:15], s33 offen lds
    s_add_u32 s33, s43, 491520
    s_add_u32 m0, s32, 12288
    s_nop 0
    buffer_load_dwordx4 v4, s[12:15], s33 offen lds
    s_add_u32 m0, s32, 13312
    s_nop 0
    buffer_load_dwordx4 v5, s[12:15], s33 offen lds
    s_add_u32 m0, s32, 14336
    s_nop 0
    buffer_load_dwordx4 v6, s[12:15], s33 offen lds
    s_waitcnt vmcnt(12)
    ds_read_b64_tr_b16 a[0:1], v7 offset:0
    ds_read_b64_tr_b16 a[2:3], v7 offset:384
    ds_read_b64_tr_b16 a[4:5], v9 offset:0
    ds_read_b64_tr_b16 a[6:7], v9 offset:384
    ds_read_b64_tr_b16 a[8:9], v7 offset:72
    ds_read_b64_tr_b16 a[10:11], v7 offset:456
    s_waitcnt lgkmcnt(0)
    s_add_u32 s33, s43, 614400
    s_add_u32 m0, s32, 0
    s_nop 0
    buffer_load_dwordx4 v4, s[12:15], s33 offen lds
    s_add_u32 m0, s32, 1024
    s_nop 0
    buffer_load_dwordx4 v5, s[12:15], s33 offen lds
    s_add_u32 m0, s32, 2048
    s_nop 0
    buffer_load_dwordx4 v6, s[12:15], s33 offen lds
    s_waitcnt vmcnt(12)
    ds_read_b64_tr_b16 a[12:13], v7 offset:3072
    ds_read_b64_tr_b16 a[14:15], v7 offset:3456
    ds_read_b64_tr_b16 a[16:17], v9 offset:3072
    ds_read_b64_tr_b16 a[18:19], v9 offset:3456
    ds_read_b64_tr_b16 a[20:21], v7 offset:3144
    ds_read_b64_tr_b16 a[22:23], v7 offset:3528
    s_waitcnt lgkmcnt(0)
    s_add_u32 s33, s43, 737280
    s_add_u32 m0, s32, 3072
    s_nop 0
    buffer_load_dwordx4 v4, s[12:15], s33 offen lds
    s_add_u32 m0, s32, 4096
    s_nop 0
    buffer_load_dwordx4 v5, s[12:15], s33 offen lds
    s_add_u32 m0, s32, 5120
    s_nop 0
    buffer_load_dwordx4 v6, s[12:15], s33 offen lds
    s_waitcnt vmcnt(12)
    ds_read_b64_tr_b16 a[24:25], v7 offset:6144
    ds_read_b64_tr_b16 a[26:27], v7 offset:6528
    ds_read_b64_tr_b16 a[28:29], v9 offset:6144
    ds_read_b64_tr_b16 a[30:31], v9 offset:6528
    ds_read_b64_tr_b16 a[32:33], v7 offset:6216
    ds_read_b64_tr_b16 a[34:35], v7 offset:6600
    s_waitcnt lgkmcnt(0)
    s_add_u32 s33, s43, 860160
    s_add_u32 m0, s32, 6144
    s_nop 0
    buffer_load_dwordx4 v4, s[12:15], s33 offen lds
    s_add_u32 m0, s32, 7168
    s_nop 0
    buffer_load_dwordx4 v5, s[12:15], s33 offen lds
    s_add_u32 m0, s32, 8192
    s_nop 0
    buffer_load_dwordx4 v6, s[12:15], s33 offen lds
    s_waitcnt vmcnt(12)
    ds_read_b64_tr_b16 a[36:37], v7 offset:9216
    ds_read_b64_tr_b16 a[38:39], v7 offset:9600
    ds_read_b64_tr_b16 a[40:41], v9 offset:9216
    ds_read_b64_tr_b16 a[42:43], v9 offset:9600
    ds_read_b64_tr_b16 a[44:45], v7 offset:9288
    ds_read_b64_tr_b16 a[46:47], v7 offset:9672
    s_waitcnt lgkmcnt(0)
    s_add_u32 s33, s43, 983040
    s_add_u32 m0, s32, 9216
    s_nop 0
    buffer_load_dwordx4 v4, s[12:15], s33 offen lds
    s_add_u32 m0, s32, 10240
    s_nop 0
    buffer_load_dwordx4 v5, s[12:15], s33 offen lds
    s_add_u32 m0, s32, 11264
    s_nop 0
    buffer_load_dwordx4 v6, s[12:15], s33 offen lds
    s_waitcnt vmcnt(12)
    ds_read_b64_tr_b16 a[48:49], v7 offset:12288
    ds_read_b64_tr_b16 a[50:51], v7 offset:12672
    ds_read_b64_tr_b16 a[52:53], v9 offset:12288
    ds_read_b64_tr_b16 a[54:55], v9 offset:12672
    ds_read_b64_tr_b16 a[56:57], v7 offset:12360
    ds_read_b64_tr_b16 a[58:59], v7 offset:12744
    s_waitcnt lgkmcnt(0)
    s_add_u32 s33, s43, 1105920
    s_add_u32 m0, s32, 12288
    s_nop 0
    buffer_load_dwordx4 v4, s[12:15], s33 offen lds
    s_add_u32 m0, s32, 13312
    s_nop 0
    buffer_load_dwordx4 v5, s[12:15], s33 offen lds
    s_add_u32 m0, s32, 14336
    s_nop 0
    buffer_load_dwordx4 v6, s[12:15], s33 offen lds
    s_waitcnt vmcnt(12)
    ds_read_b64_tr_b16 a[60:61], v7 offset:0
    ds_read_b64_tr_b16 a[62:63], v7 offset:384
    ds_read_b64_tr_b16 a[64:65], v9 offset:0
    ds_read_b64_tr_b16 a[66:67], v9 offset:384
    ds_read_b64_tr_b16 a[68:69], v7 offset:72
    ds_read_b64_tr_b16 a[70:71], v7 offset:456
    s_waitcnt lgkmcnt(0)
    s_add_u32 s33, s43, 1228800
    s_add_u32 m0, s32, 0
    s_nop 0
    buffer_load_dwordx4 v4, s[12:15], s33 offen lds
    s_add_u32 m0, s32, 1024
    s_nop 0
    buffer_load_dwordx4 v5, s[12:15], s33 offen lds
    s_add_u32 m0, s32, 2048
    s_nop 0
    buffer_load_dwordx4 v6, s[12:15], s33 offen lds
    s_waitcnt vmcnt(12)
    ds_read_b64_tr_b16 a[72:73], v7 offset:3072
    ds_read_b64_tr_b16 a[74:75], v7 offset:3456
    ds_read_b64_tr_b16 a[76:77], v9 offset:3072
    ds_read_b64_tr_b16 a[78:79], v9 offset:3456
    ds_read_b64_tr_b16 a[80:81], v7 offset:3144
    ds_read_b64_tr_b16 a[82:83], v7 offset:3528
    s_waitcnt lgkmcnt(0)
    s_add_u32 s33, s43, 1351680
    s_add_u32 m0, s32, 3072
    s_nop 0
    buffer_load_dwordx4 v4, s[12:15], s33 offen lds
    s_add_u32 m0, s32, 4096
    s_nop 0
    buffer_load_dwordx4 v5, s[12:15], s33 offen lds
    s_add_u32 m0, s32, 5120
    s_nop 0
    buffer_load_dwordx4 v6, s[12:15], s33 offen lds
    s_waitcnt vmcnt(12)
    ds_read_b64_tr_b16 a[84:85], v7 offset:6144
    ds_read_b64_tr_b16 a[86:87], v7 offset:6528
    ds_read_b64_tr_b16 a[88:89], v9 offset:6144
    ds_read_b64_tr_b16 a[90:91], v9 offset:6528
    ds_read_b64_tr_b16 a[92:93], v7 offset:6216
    ds_read_b64_tr_b16 a[94:95], v7 offset:6600
    s_waitcnt lgkmcnt(0)
    s_add_u32 s33, s43, 1474560
    s_add_u32 m0, s32, 6144
    s_nop 0
    buffer_load_dwordx4 v4, s[12:15], s33 offen lds
    s_add_u32 m0, s32, 7168
    s_nop 0
    buffer_load_dwordx4 v5, s[12:15], s33 offen lds
    s_add_u32 m0, s32, 8192
    s_nop 0
    buffer_load_dwordx4 v6, s[12:15], s33 offen lds
    s_waitcnt vmcnt(12)
    ds_read_b64_tr_b16 a[96:97], v7 offset:9216
    ds_read_b64_tr_b16 a[98:99], v7 offset:9600
    ds_read_b64_tr_b16 a[100:101], v9 offset:9216
    ds_read_b64_tr_b16 a[102:103], v9 offset:9600
    ds_read_b64_tr_b16 a[104:105], v7 offset:9288
    ds_read_b64_tr_b16 a[106:107], v7 offset:9672
    s_waitcnt lgkmcnt(0)
    s_add_u32 s33, s43, 1597440
    s_add_u32 m0, s32, 9216
    s_nop 0
    buffer_load_dwordx4 v4, s[12:15], s33 offen lds
    s_add_u32 m0, s32, 10240
    s_nop 0
    buffer_load_dwordx4 v5, s[12:15], s33 offen lds
    s_add_u32 m0, s32, 11264
    s_nop 0
    buffer_load_dwordx4 v6, s[12:15], s33 offen lds
    s_waitcnt vmcnt(12)
    ds_read_b64_tr_b16 a[108:109], v7 offset:12288
    ds_read_b64_tr_b16 a[110:111], v7 offset:12672
    ds_read_b64_tr_b16 a[112:113], v9 offset:12288
    ds_read_b64_tr_b16 a[114:115], v9 offset:12672
    ds_read_b64_tr_b16 a[116:117], v7 offset:12360
    ds_read_b64_tr_b16 a[118:119], v7 offset:12744
    s_waitcnt lgkmcnt(0)
    s_add_u32 s33, s43, 1720320
    s_add_u32 m0, s32, 12288
    s_nop 0
    buffer_load_dwordx4 v4, s[12:15], s33 offen lds
    s_add_u32 m0, s32, 13312
    s_nop 0
    buffer_load_dwordx4 v5, s[12:15], s33 offen lds
    s_add_u32 m0, s32, 14336
    s_nop 0
    buffer_load_dwordx4 v6, s[12:15], s33 offen lds
    s_waitcnt vmcnt(12)
    ds_read_b64_tr_b16 a[120:121], v7 offset:0
    ds_read_b64_tr_b16 a[122:123], v7 offset:384
    ds_read_b64_tr_b16 a[124:125], v9 offset:0
    ds_read_b64_tr_b16 a[126:127], v9 offset:384
    ds_read_b64_tr_b16 a[128:129], v7 offset:72
    ds_read_b64_tr_b16 a[130:131], v7 offset:456
    s_waitcnt lgkmcnt(0)
    s_add_u32 s33, s43, 1843200
    s_add_u32 m0, s32, 0
    s_nop 0
    buffer_load_dwordx4 v4, s[12:15], s33 offen lds
    s_add_u32 m0, s32, 1024
    s_nop 0
    buffer_load_dwordx4 v5, s[12:15], s33 offen lds
    s_add_u32 m0, s32, 2048
    s_nop 0
    buffer_load_dwordx4 v6, s[12:15], s33 offen lds
    s_waitcnt vmcnt(12)
    ds_read_b64_tr_b16 a[132:133], v7 offset:3072
    ds_read_b64_tr_b16 a[134:135], v7 offset:3456
    ds_read_b64_tr_b16 a[136:137], v9 offset:3072
    ds_read_b64_tr_b16 a[138:139], v9 offset:3456
    ds_read_b64_tr_b16 a[140:141], v7 offset:3144
    ds_read_b64_tr_b16 a[142:143], v7 offset:3528
    s_waitcnt lgkmcnt(0)
    s_add_u32 s33, s43, 1966080
    s_add_u32 m0, s32, 3072
    s_nop 0
    buffer_load_dwordx4 v4, s[12:15], s33 offen lds
    s_add_u32 m0, s32, 4096
    s_nop 0
    buffer_load_dwordx4 v5, s[12:15], s33 offen lds
    s_add_u32 m0, s32, 5120
    s_nop 0
    buffer_load_dwordx4 v6, s[12:15], s33 offen lds
    s_waitcnt vmcnt(12)
    ds_read_b64_tr_b16 a[144:145], v7 offset:6144
    ds_read_b64_tr_b16 a[146:147], v7 offset:6528
    ds_read_b64_tr_b16 a[148:149], v9 offset:6144
    ds_read_b64_tr_b16 a[150:151], v9 offset:6528
    ds_read_b64_tr_b16 a[152:153], v7 offset:6216
    ds_read_b64_tr_b16 a[154:155], v7 offset:6600
    s_waitcnt lgkmcnt(0)
    s_add_u32 s33, s43, 2088960
    s_add_u32 m0, s32, 6144
    s_nop 0
    buffer_load_dwordx4 v4, s[12:15], s33 offen lds
    s_add_u32 m0, s32, 7168
    s_nop 0
    buffer_load_dwordx4 v5, s[12:15], s33 offen lds
    s_add_u32 m0, s32, 8192
    s_nop 0
    buffer_load_dwordx4 v6, s[12:15], s33 offen lds
    s_waitcnt vmcnt(12)
    ds_read_b64_tr_b16 a[156:157], v7 offset:9216
    ds_read_b64_tr_b16 a[158:159], v7 offset:9600
    ds_read_b64_tr_b16 a[160:161], v9 offset:9216
    ds_read_b64_tr_b16 a[162:163], v9 offset:9600
    ds_read_b64_tr_b16 a[164:165], v7 offset:9288
    ds_read_b64_tr_b16 a[166:167], v7 offset:9672
    s_waitcnt lgkmcnt(0)
    s_add_u32 s33, s43, 2211840
    s_add_u32 m0, s32, 9216
    s_nop 0
    buffer_load_dwordx4 v4, s[12:15], s33 offen lds
    s_add_u32 m0, s32, 10240
    s_nop 0
    buffer_load_dwordx4 v5, s[12:15], s33 offen lds
    s_add_u32 m0, s32, 11264
    s_nop 0
    buffer_load_dwordx4 v6, s[12:15], s33 offen lds
    s_waitcnt vmcnt(12)
    ds_read_b64_tr_b16 a[168:169], v7 offset:12288
    ds_read_b64_tr_b16 a[170:171], v7 offset:12672
    ds_read_b64_tr_b16 a[172:173], v9 offset:12288
    ds_read_b64_tr_b16 a[174:175], v9 offset:12672
    ds_read_b64_tr_b16 a[176:177], v7 offset:12360
    ds_read_b64_tr_b16 a[178:179], v7 offset:12744
    s_waitcnt lgkmcnt(0)
    s_add_u32 s33, s43, 2334720
    s_add_u32 m0, s32, 12288
    s_nop 0
    buffer_load_dwordx4 v4, s[12:15], s33 offen lds
    s_add_u32 m0, s32, 13312
    s_nop 0
    buffer_load_dwordx4 v5, s[12:15], s33 offen lds
    s_add_u32 m0, s32, 14336
    s_nop 0
    buffer_load_dwordx4 v6, s[12:15], s33 offen lds
    s_waitcnt vmcnt(12)
    ds_read_b64_tr_b16 a[180:181], v7 offset:0
    ds_read_b64_tr_b16 a[182:183], v7 offset:384
    ds_read_b64_tr_b16 a[184:185], v9 offset:0
    ds_read_b64_tr_b16 a[186:187], v9 offset:384
    ds_read_b64_tr_b16 a[188:189], v7 offset:72
    ds_read_b64_tr_b16 a[190:191], v7 offset:456
    s_waitcnt lgkmcnt(0)
    s_waitcnt vmcnt(9)
    ds_read_b64_tr_b16 a[192:193], v7 offset:3072
    ds_read_b64_tr_b16 a[194:195], v7 offset:3456
    ds_read_b64_tr_b16 a[196:197], v9 offset:3072
    ds_read_b64_tr_b16 a[198:199], v9 offset:3456
    ds_read_b64_tr_b16 a[200:201], v7 offset:3144
    ds_read_b64_tr_b16 a[202:203], v7 offset:3528
    s_waitcnt lgkmcnt(0)
    s_waitcnt vmcnt(6)
    ds_read_b64_tr_b16 a[204:205], v7 offset:6144
    ds_read_b64_tr_b16 a[206:207], v7 offset:6528
    ds_read_b64_tr_b16 a[208:209], v9 offset:6144
    ds_read_b64_tr_b16 a[210:211], v9 offset:6528
    ds_read_b64_tr_b16 a[212:213], v7 offset:6216
    ds_read_b64_tr_b16 a[214:215], v7 offset:6600
    s_waitcnt lgkmcnt(0)
    s_waitcnt vmcnt(3)
    ds_read_b64_tr_b16 a[216:217], v7 offset:9216
    ds_read_b64_tr_b16 a[218:219], v7 offset:9600
    ds_read_b64_tr_b16 a[220:221], v9 offset:9216
    ds_read_b64_tr_b16 a[222:223], v9 offset:9600
    ds_read_b64_tr_b16 a[224:225], v7 offset:9288
    ds_read_b64_tr_b16 a[226:227], v7 offset:9672
    s_waitcnt lgkmcnt(0)
    s_waitcnt vmcnt(0)
    ds_read_b64_tr_b16 a[228:229], v7 offset:12288
    ds_read_b64_tr_b16 a[230:231], v7 offset:12672
    ds_read_b64_tr_b16 a[232:233], v9 offset:12288
    ds_read_b64_tr_b16 a[234:235], v9 offset:12672
    ds_read_b64_tr_b16 a[236:237], v7 offset:12360
    ds_read_b64_tr_b16 a[238:239], v7 offset:12744
    s_waitcnt lgkmcnt(0)
    v_mov_b32 v128, 0
    v_mov_b32 v129, 0
    v_mov_b32 v130, 0
    v_mov_b32 v131, 0
    v_mov_b32 v132, 0
    v_mov_b32 v133, 0
    v_mov_b32 v134, 0
    v_mov_b32 v135, 0
    v_mov_b32 v136, 0
    v_mov_b32 v137, 0
    v_mov_b32 v138, 0
    v_mov_b32 v139, 0
    v_mov_b32 v140, 0
    v_mov_b32 v141, 0
    v_mov_b32 v142, 0
    v_mov_b32 v143, 0
    v_mov_b32 v144, 0
    v_mov_b32 v145, 0
    v_mov_b32 v146, 0
    v_mov_b32 v147, 0
    v_mov_b32 v148, 0
    v_mov_b32 v149, 0
    v_mov_b32 v150, 0
    v_mov_b32 v151, 0
    v_mov_b32 v184, 0x3f803f80
    v_mov_b32 v185, 0x3f803f80
    v_mov_b32 v186, 0x3f803f80
    v_mov_b32 v187, 0x3f803f80
    s_mov_b32 s46, 0
    s_waitcnt vmcnt(0)
    s_barrier
    v_mov_b32 v18, v16
    v_mov_b32 v19, v17
    s_mov_b32 s49, 40960
    ds_read_b128 v[96:99], v18 offset:0
    ds_read_b128 v[100:103], v18 offset:2048
    ds_read_b128 v[104:107], v19 offset:0
    ds_read_b128 v[108:111], v19 offset:2048
    s_waitcnt lgkmcnt(2)
    v_mfma_f32_16x16x32_bf16 v[32:35], v[96:99], a[0:3], 0
    ds_read_b128 v[112:115], v18 offset:4096
    v_mfma_f32_16x16x32_bf16 v[40:43], v[96:99], a[4:7], 0
    s_add_u32 m0, s48, 15872
    v_mfma_f32_16x16x32_bf16 v[48:51], v[96:99], a[8:11], 0
    buffer_load_dwordx4 v8, s[20:23], s44 offen offset:512 lds
    v_mfma_f32_16x16x32_bf16 v[36:39], v[100:103], a[0:3], 0
    ds_read_b128 v[116:119], v18 offset:6144
    v_mfma_f32_16x16x32_bf16 v[44:47], v[100:103], a[4:7], 0
    v_mfma_f32_16x16x32_bf16 v[52:55], v[100:103], a[8:11], 0
    s_add_u32 m0, s48, 19840
    s_waitcnt lgkmcnt(2)
    v_mfma_f32_16x16x32_bf16 v[32:35], v[104:107], a[12:15], v[32:35]
    ds_read_b128 v[120:123], v19 offset:4096
    buffer_load_dwordx4 v8, s[20:23], s44 offen offset:640 lds
    v_mfma_f32_16x16x32_bf16 v[40:43], v[104:107], a[16:19], v[40:43]
    v_mfma_f32_16x16x32_bf16 v[48:51], v[104:107], a[20:23], v[48:51]
    v_mfma_f32_16x16x32_bf16 v[36:39], v[108:111], a[12:15], v[36:39]
    ds_read_b128 v[124:127], v19 offset:6144
    s_add_u32 m0, s48, 23808
    v_mfma_f32_16x16x32_bf16 v[44:47], v[108:111], a[16:19], v[44:47]
    buffer_load_dwordx4 v8, s[20:23], s44 offen offset:768 lds
    v_mfma_f32_16x16x32_bf16 v[52:55], v[108:111], a[20:23], v[52:55]
    s_waitcnt lgkmcnt(2)
    v_mfma_f32_16x16x32_bf16 v[32:35], v[112:115], a[24:27], v[32:35]
    ds_read_b128 v[96:99], v18 offset:8192
    v_mfma_f32_16x16x32_bf16 v[40:43], v[112:115], a[28:31], v[40:43]
    s_add_u32 m0, s48, 27776
    v_mfma_f32_16x16x32_bf16 v[48:51], v[112:115], a[32:35], v[48:51]
    buffer_load_dwordx4 v8, s[20:23], s44 offen offset:896 lds
    v_mfma_f32_16x16x32_bf16 v[36:39], v[116:119], a[24:27], v[36:39]
    ds_read_b128 v[100:103], v18 offset:10240
    v_mfma_f32_16x16x32_bf16 v[44:47], v[116:119], a[28:31], v[44:47]
    v_mfma_f32_16x16x32_bf16 v[52:55], v[116:119], a[32:35], v[52:55]
    s_add_u32 m0, s48, 31744
    s_waitcnt lgkmcnt(2)
    v_mfma_f32_16x16x32_bf16 v[32:35], v[120:123], a[36:39], v[32:35]
    ds_read_b128 v[104:107], v19 offset:8192
    buffer_load_dwordx4 v8, s[20:23], s44 offen offset:1024 lds
    v_mfma_f32_16x16x32_bf16 v[40:43], v[120:123], a[40:43], v[40:43]
    v_mfma_f32_16x16x32_bf16 v[48:51], v[120:123], a[44:47], v[48:51]
    v_mfma_f32_16x16x32_bf16 v[36:39], v[124:127], a[36:39], v[36:39]
    ds_read_b128 v[108:111], v19 offset:10240
    s_add_u32 m0, s48, 35712
    v_mfma_f32_16x16x32_bf16 v[44:47], v[124:127], a[40:43], v[44:47]
    buffer_load_dwordx4 v8, s[20:23], s44 offen offset:1152 lds
    v_mfma_f32_16x16x32_bf16 v[52:55], v[124:127], a[44:47], v[52:55]
    s_waitcnt lgkmcnt(2)
    v_mfma_f32_16x16x32_bf16 v[32:35], v[96:99], a[48:51], v[32:35]
    ds_read_b128 v[112:115], v18 offset:12288
    v_mfma_f32_16x16x32_bf16 v[40:43], v[96:99], a[52:55], v[40:43]
    v_mfma_f32_16x16x32_bf16 v[48:51], v[96:99], a[56:59], v[48:51]
    v_mfma_f32_16x16x32_bf16 v[36:39], v[100:103], a[48:51], v[36:39]
    ds_read_b128 v[116:119], v18 offset:14336
    v_mfma_f32_16x16x32_bf16 v[44:47], v[100:103], a[52:55], v[44:47]
    v_mfma_f32_16x16x32_bf16 v[52:55], v[100:103], a[56:59], v[52:55]
    s_waitcnt lgkmcnt(2)
    v_mfma_f32_16x16x32_bf16 v[32:35], v[104:107], a[60:63], v[32:35]
    ds_read_b128 v[120:123], v19 offset:12288
    v_mfma_f32_16x16x32_bf16 v[40:43], v[104:107], a[64:67], v[40:43]
    v_mfma_f32_16x16x32_bf16 v[48:51], v[104:107], a[68:71], v[48:51]
    v_mfma_f32_16x16x32_bf16 v[36:39], v[108:111], a[60:63], v[36:39]
    ds_read_b128 v[124:127], v19 offset:14336
    v_mfma_f32_16x16x32_bf16 v[44:47], v[108:111], a[64:67], v[44:47]
    v_mfma_f32_16x16x32_bf16 v[52:55], v[108:111], a[68:71], v[52:55]
    s_waitcnt lgkmcnt(2)
    v_mfma_f32_16x16x32_bf16 v[32:35], v[112:115], a[72:75], v[32:35]
    ds_read_b128 v[96:99], v18 offset:16384
    v_mfma_f32_16x16x32_bf16 v[40:43], v[112:115], a[76:79], v[40:43]
    v_mfma_f32_16x16x32_bf16 v[48:51], v[112:115], a[80:83], v[48:51]
    v_mfma_f32_16x16x32_bf16 v[36:39], v[116:119], a[72:75], v[36:39]
    ds_read_b128 v[100:103], v18 offset:18432
    v_mfma_f32_16x16x32_bf16 v[44:47], v[116:119], a[76:79], v[44:47]
    v_mfma_f32_16x16x32_bf16 v[52:55], v[116:119], a[80:83], v[52:55]
    s_waitcnt lgkmcnt(2)
    v_mfma_f32_16x16x32_bf16 v[32:35], v[120:123], a[84:87], v[32:35]
    ds_read_b128 v[104:107], v19 offset:16384
    v_mfma_f32_16x16x32_bf16 v[40:43], v[120:123], a[88:91], v[40:43]
    v_mfma_f32_16x16x32_bf16 v[48:51], v[120:123], a[92:95], v[48:51]
    v_mfma_f32_16x16x32_bf16 v[36:39], v[124:127], a[84:87], v[36:39]
    ds_read_b128 v[108:111], v19 offset:18432
    v_mfma_f32_16x16x32_bf16 v[44:47], v[124:127], a[88:91], v[44:47]
    v_mfma_f32_16x16x32_bf16 v[52:55], v[124:127], a[92:95], v[52:55]
    s_waitcnt lgkmcnt(2)
    v_mfma_f32_16x16x32_bf16 v[32:35], v[96:99], a[96:99], v[32:35]
    ds_read_b128 v[112:115], v18 offset:20480
    v_mfma_f32_16x16x32_bf16 v[40:43], v[96:99], a[100:103], v[40:43]
    v_mfma_f32_16x16x32_bf16 v[48:51], v[96:99], a[104:107], v[48:51]
    v_mfma_f32_16x16x32_bf16 v[36:39], v[100:103], a[96:99], v[36:39]
    ds_read_b128 v[116:119], v18 offset:22528
    v_mfma_f32_16x16x32_bf16 v[44:47], v[100:103], a[100:103], v[44:47]
    v_mfma_f32_16x16x32_bf16 v[52:55], v[100:103], a[104:107], v[52:55]
    s_waitcnt lgkmcnt(2)
    v_mfma_f32_16x16x32_bf16 v[32:35], v[104:107], a[108:111], v[32:35]
    ds_read_b128 v[120:123], v19 offset:20480
    v_mfma_f32_16x16x32_bf16 v[40:43], v[104:107], a[112:115], v[40:43]
    v_mfma_f32_16x16x32_bf16 v[48:51], v[104:107], a[116:119], v[48:51]
    v_mfma_f32_16x16x32_bf16 v[36:39], v[108:111], a[108:111], v[36:39]
    ds_read_b128 v[124:127], v19 offset:22528
    v_mfma_f32_16x16x32_bf16 v[44:47], v[108:111], a[112:115], v[44:47]
    v_mfma_f32_16x16x32_bf16 v[52:55], v[108:111], a[116:119], v[52:55]
    s_waitcnt lgkmcnt(2)
    v_mfma_f32_16x16x32_bf16 v[32:35], v[112:115], a[120:123], v[32:35]
    ds_read_b128 v[96:99], v18 offset:24576
    v_mfma_f32_16x16x32_bf16 v[40:43], v[112:115], a[124:127], v[40:43]
    v_mfma_f32_16x16x32_bf16 v[48:51], v[112:115], a[128:131], v[48:51]
    v_mfma_f32_16x16x32_bf16 v[36:39], v[116:119], a[120:123], v[36:39]
    ds_read_b128 v[100:103], v18 offset:26624
    v_mfma_f32_16x16x32_bf16 v[44:47], v[116:119], a[124:127], v[44:47]
    v_mfma_f32_16x16x32_bf16 v[52:55], v[116:119], a[128:131], v[52:55]
    s_waitcnt lgkmcnt(2)
    v_mfma_f32_16x16x32_bf16 v[32:35], v[120:123], a[132:135], v[32:35]
    ds_read_b128 v[104:107], v19 offset:24576
    v_mfma_f32_16x16x32_bf16 v[40:43], v[120:123], a[136:139], v[40:43]
    v_mfma_f32_16x16x32_bf16 v[48:51], v[120:123], a[140:143], v[48:51]
    v_mfma_f32_16x16x32_bf16 v[36:39], v[124:127], a[132:135], v[36:39]
    ds_read_b128 v[108:111], v19 offset:26624
    v_mfma_f32_16x16x32_bf16 v[44:47], v[124:127], a[136:139], v[44:47]
    v_mfma_f32_16x16x32_bf16 v[52:55], v[124:127], a[140:143], v[52:55]
    s_waitcnt lgkmcnt(2)
    v_mfma_f32_16x16x32_bf16 v[32:35], v[96:99], a[144:147], v[32:35]
    ds_read_b128 v[112:115], v18 offset:28672
    v_mfma_f32_16x16x32_bf16 v[40:43], v[96:99], a[148:151], v[40:43]
    v_mfma_f32_16x16x32_bf16 v[48:51], v[96:99], a[152:155], v[48:51]
    v_mfma_f32_16x16x32_bf16 v[36:39], v[100:103], a[144:147], v[36:39]
    ds_read_b128 v[116:119], v18 offset:30720
    v_mfma_f32_16x16x32_bf16 v[44:47], v[100:103], a[148:151], v[44:47]
    v_mfma_f32_16x16x32_bf16 v[52:55], v[100:103], a[152:155], v[52:55]
    s_waitcnt lgkmcnt(2)
    v_mfma_f32_16x16x32_bf16 v[32:35], v[104:107], a[156:159], v[32:35]
    ds_read_b128 v[120:123], v19 offset:28672
    v_mfma_f32_16x16x32_bf16 v[40:43], v[104:107], a[160:163], v[40:43]
    v_mfma_f32_16x16x32_bf16 v[48:51], v[104:107], a[164:167], v[48:51]
    v_mfma_f32_16x16x32_bf16 v[36:39], v[108:111], a[156:159], v[36:39]
    ds_read_b128 v[124:127], v19 offset:30720
    v_mfma_f32_16x16x32_bf16 v[44:47], v[108:111], a[160:163], v[44:47]
    v_mfma_f32_16x16x32_bf16 v[52:55], v[108:111], a[164:167], v[52:55]
    s_waitcnt lgkmcnt(2)
    v_mfma_f32_16x16x32_bf16 v[32:35], v[112:115], a[168:171], v[32:35]
    ds_read_b128 v[96:99], v18 offset:32768
    v_mfma_f32_16x16x32_bf16 v[40:43], v[112:115], a[172:175], v[40:43]
    v_mfma_f32_16x16x32_bf16 v[48:51], v[112:115], a[176:179], v[48:51]
    v_mfma_f32_16x16x32_bf16 v[36:39], v[116:119], a[168:171], v[36:39]
    ds_read_b128 v[100:103], v18 offset:34816
    v_mfma_f32_16x16x32_bf16 v[44:47], v[116:119], a[172:175], v[44:47]
    v_mfma_f32_16x16x32_bf16 v[52:55], v[116:119], a[176:179], v[52:55]
    s_waitcnt lgkmcnt(2)
    v_mfma_f32_16x16x32_bf16 v[32:35], v[120:123], a[180:183], v[32:35]
    ds_read_b128 v[104:107], v19 offset:32768
    v_mfma_f32_16x16x32_bf16 v[40:43], v[120:123], a[184:187], v[40:43]
    v_mfma_f32_16x16x32_bf16 v[48:51], v[120:123], a[188:191], v[48:51]
    v_mfma_f32_16x16x32_bf16 v[36:39], v[124:127], a[180:183], v[36:39]
    ds_read_b128 v[108:111], v19 offset:34816
    v_mfma_f32_16x16x32_bf16 v[44:47], v[124:127], a[184:187], v[44:47]
    v_mfma_f32_16x16x32_bf16 v[52:55], v[124:127], a[188:191], v[52:55]
    s_waitcnt lgkmcnt(2)
    v_mfma_f32_16x16x32_bf16 v[32:35], v[96:99], a[192:195], v[32:35]
    ds_read_b128 v[112:115], v18 offset:36864
    v_mfma_f32_16x16x32_bf16 v[40:43], v[96:99], a[196:199], v[40:43]
    v_mfma_f32_16x16x32_bf16 v[48:51], v[96:99], a[200:203], v[48:51]
    v_add_u32 v20, s49, v16
    v_add_u32 v21, s49, v17
    v_mfma_f32_16x16x32_bf16 v[36:39], v[100:103], a[192:195], v[36:39]
    ds_read_b128 v[116:119], v18 offset:38912
    s_add_u32 s49, s49, 40960
    s_cmp_eq_u32 s49, 122880
    v_mfma_f32_16x16x32_bf16 v[44:47], v[100:103], a[196:199], v[44:47]
    s_cselect_b32 s49, 0, s49
    v_mfma_f32_16x16x32_bf16 v[52:55], v[100:103], a[200:203], v[52:55]
    s_add_u32 s48, s49, s34
    s_add_u32 s44, s44, 40960
    s_waitcnt lgkmcnt(2)
    v_mfma_f32_16x16x32_bf16 v[32:35], v[104:107], a[204:207], v[32:35]
    ds_read_b128 v[120:123], v19 offset:36864
    v_mfma_f32_16x16x32_bf16 v[40:43], v[104:107], a[208:211], v[40:43]
    v_mfma_f32_16x16x32_bf16 v[48:51], v[104:107], a[212:215], v[48:51]
    s_waitcnt vmcnt(0)
    s_barrier
    v_mfma_f32_16x16x32_bf16 v[36:39], v[108:111], a[204:207], v[36:39]
    ds_read_b128 v[124:127], v19 offset:38912
    s_add_u32 m0, s48, 0
    v_mfma_f32_16x16x32_bf16 v[44:47], v[108:111], a[208:211], v[44:47]
    buffer_load_dwordx4 v8, s[20:23], s44 offen offset:0 lds
    v_mfma_f32_16x16x32_bf16 v[52:55], v[108:111], a[212:215], v[52:55]
    s_waitcnt lgkmcnt(2)
    v_mfma_f32_16x16x32_bf16 v[32:35], v[112:115], a[216:219], v[32:35]
    ds_read_b128 v[96:99], v20 offset:0
    v_mfma_f32_16x16x32_bf16 v[40:43], v[112:115], a[220:223], v[40:43]
    s_add_u32 m0, s48, 3968
    v_mfma_f32_16x16x32_bf16 v[48:51], v[112:115], a[224:227], v[48:51]
    buffer_load_dwordx4 v8, s[20:23], s44 offen offset:128 lds
    v_mfma_f32_16x16x32_bf16 v[36:39], v[116:119], a[216:219], v[36:39]
    ds_read_b128 v[100:103], v20 offset:2048
    v_mfma_f32_16x16x32_bf16 v[44:47], v[116:119], a[220:223], v[44:47]
    v_mfma_f32_16x16x32_bf16 v[52:55], v[116:119], a[224:227], v[52:55]
    s_add_u32 m0, s48, 7936
    s_waitcnt lgkmcnt(2)
    v_mfma_f32_16x16x32_bf16 v[32:35], v[120:123], a[228:231], v[32:35]
    ds_read_b128 v[104:107], v21 offset:0
    buffer_load_dwordx4 v8, s[20:23], s44 offen offset:256 lds
    v_mfma_f32_16x16x32_bf16 v[40:43], v[120:123], a[232:235], v[40:43]
    v_mfma_f32_16x16x32_bf16 v[48:51], v[120:123], a[236:239], v[48:51]
    v_mfma_f32_16x16x32_bf16 v[36:39], v[124:127], a[228:231], v[36:39]
    ds_read_b128 v[108:111], v21 offset:2048
    s_add_u32 m0, s48, 11904
    v_mfma_f32_16x16x32_bf16 v[44:47], v[124:127], a[232:235], v[44:47]
    buffer_load_dwordx4 v8, s[20:23], s44 offen offset:384 lds
    v_mfma_f32_16x16x32_bf16 v[52:55], v[124:127], a[236:239], v[52:55]
    s_branch L_a1_odd
L_a1_loop:
    s_waitcnt lgkmcnt(2)
    v_mfma_f32_16x16x32_bf16 v[32:35], v[96:99], a[0:3], 0
    ds_read_b128 v[112:115], v18 offset:4096
    v_mfma_f32_16x16x32_bf16 v[40:43], v[96:99], a[4:7], 0
    s_add_u32 m0, s48, 15872
    v_mfma_f32_16x16x32_bf16 v[48:51], v[96:99], a[8:11], 0
    buffer_load_dwordx4 v8, s[20:23], s44 offen offset:512 lds
    v_mfma_f32_16x16x32_bf16 v[36:39], v[100:103], a[0:3], 0
    ds_read_b128 v[116:119], v18 offset:6144
    v_cvt_pk_bf16_f32 v176, v64, v65
    v_mfma_f32_16x16x32_bf16 v[44:47], v[100:103], a[4:7], 0
    v_cvt_pk_bf16_f32 v177, v66, v67
    v_cvt_pk_bf16_f32 v178, v68, v69
    v_mfma_f32_16x16x32_bf16 v[52:55], v[100:103], a[8:11], 0
    v_cvt_pk_bf16_f32 v179, v70, v71
    s_add_u32 m0, s48, 19840
    s_waitcnt lgkmcnt(2)
    v_mfma_f32_16x16x32_bf16 v[32:35], v[104:107], a[12:15], v[32:35]
    ds_read_b128 v[120:123], v19 offset:4096
    v_cvt_pk_bf16_f32 v180, v72, v73
    buffer_load_dwordx4 v8, s[20:23], s44 offen offset:640 lds
    v_mfma_f32_16x16x32_bf16 v[40:43], v[104:107], a[16:19], v[40:43]
    v_cvt_pk_bf16_f32 v181, v74, v75
    v_cvt_pk_bf16_f32 v182, v76, v77
    v_mfma_f32_16x16x32_bf16 v[48:51], v[104:107], a[20:23], v[48:51]
    v_cvt_pk_bf16_f32 v183, v78, v79
    v_mul_f32 v152, s60, v56
    v_mfma_f32_16x16x32_bf16 v[36:39], v[108:111], a[12:15], v[36:39]
    ds_read_b128 v[124:127], v19 offset:6144
    v_mul_f32 v153, s60, v57
    s_add_u32 m0, s48, 23808
    v_mfma_f32_16x16x32_bf16 v[44:47], v[108:111], a[16:19], v[44:47]
    v_mul_f32 v154, s60, v58
    buffer_load_dwordx4 v8, s[20:23], s44 offen offset:768 lds
    v_mfma_f32_16x16x32_bf16 v[52:55], v[108:111], a[20:23], v[52:55]
    v_mul_f32 v155, s60, v59
    s_waitcnt lgkmcnt(2)
    v_mfma_f32_16x16x32_bf16 v[32:35], v[112:115], a[24:27], v[32:35]
    ds_read_b128 v[96:99], v18 offset:8192
    v_mul_f32 v156, s60, v60
    v_mfma_f32_16x16x32_bf16 v[40:43], v[112:115], a[28:31], v[40:43]
    v_mul_f32 v157, s60, v61
    s_add_u32 m0, s48, 27776
    v_mfma_f32_16x16x32_bf16 v[48:51], v[112:115], a[32:35], v[48:51]
    v_mul_f32 v158, s60, v62
    buffer_load_dwordx4 v8, s[20:23], s44 offen offset:896 lds
    v_mfma_f32_16x16x32_bf16 v[36:39], v[116:119], a[24:27], v[36:39]
    ds_read_b128 v[100:103], v18 offset:10240
    v_mul_f32 v159, s60, v63
    v_mfma_f32_16x16x32_bf16 v[44:47], v[116:119], a[28:31], v[44:47]
    v_mul_f32 v160, s60, v64
    v_mul_f32 v161, s60, v65
    v_mfma_f32_16x16x32_bf16 v[52:55], v[116:119], a[32:35], v[52:55]
    v_mul_f32 v162, s60, v66
    s_add_u32 m0, s48, 31744
    s_waitcnt lgkmcnt(2)
    v_mfma_f32_16x16x32_bf16 v[32:35], v[120:123], a[36:39], v[32:35]
    ds_read_b128 v[104:107], v19 offset:8192
    v_mul_f32 v163, s60, v67
    buffer_load_dwordx4 v8, s[20:23], s44 offen offset:1024 lds
    v_mfma_f32_16x16x32_bf16 v[40:43], v[120:123], a[40:43], v[40:43]
    v_mul_f32 v164, s60, v68
    v_mul_f32 v165, s60, v69
    v_mfma_f32_16x16x32_bf16 v[48:51], v[120:123], a[44:47], v[48:51]
    v_mul_f32 v166, s60, v70
    v_mul_f32 v167, s60, v71
    v_mfma_f32_16x16x32_bf16 v[36:39], v[124:127], a[36:39], v[36:39]
    ds_read_b128 v[108:111], v19 offset:10240
    v_exp_f32 v152, v152 clamp
    s_add_u32 m0, s48, 35712
    v_mfma_f32_16x16x32_bf16 v[44:47], v[124:127], a[40:43], v[44:47]
    v_exp_f32 v153, v153 clamp
    buffer_load_dwordx4 v8, s[20:23], s44 offen offset:1152 lds
    v_mfma_f32_16x16x32_bf16 v[52:55], v[124:127], a[44:47], v[52:55]
    v_exp_f32 v154, v154 clamp
    s_waitcnt lgkmcnt(2)
    v_mfma_f32_16x16x32_bf16 v[32:35], v[96:99], a[48:51], v[32:35]
    ds_read_b128 v[112:115], v18 offset:12288
    v_exp_f32 v155, v155 clamp
    v_mfma_f32_16x16x32_bf16 v[40:43], v[96:99], a[52:55], v[40:43]
    v_exp_f32 v156, v156 clamp
    v_mfma_f32_16x16x32_bf16 v[48:51], v[96:99], a[56:59], v[48:51]
    v_exp_f32 v157, v157 clamp
    v_mfma_f32_16x16x32_bf16 v[36:39], v[100:103], a[48:51], v[36:39]
    ds_read_b128 v[116:119], v18 offset:14336
    v_exp_f32 v158, v158 clamp
    v_mfma_f32_16x16x32_bf16 v[44:47], v[100:103], a[52:55], v[44:47]
    v_exp_f32 v159, v159 clamp
    v_mfma_f32_16x16x32_bf16 v[52:55], v[100:103], a[56:59], v[52:55]
    v_exp_f32 v160, v160 clamp
    s_waitcnt lgkmcnt(2)
    v_mfma_f32_16x16x32_bf16 v[32:35], v[104:107], a[60:63], v[32:35]
    ds_read_b128 v[120:123], v19 offset:12288
    v_exp_f32 v161, v161 clamp
    v_mfma_f32_16x16x32_bf16 v[40:43], v[104:107], a[64:67], v[40:43]
    v_exp_f32 v162, v162 clamp
    v_mfma_f32_16x16x32_bf16 v[48:51], v[104:107], a[68:71], v[48:51]
    v_exp_f32 v163, v163 clamp
    v_mfma_f32_16x16x32_bf16 v[36:39], v[108:111], a[60:63], v[36:39]
    ds_read_b128 v[124:127], v19 offset:14336
    v_exp_f32 v164, v164 clamp
    v_mfma_f32_16x16x32_bf16 v[44:47], v[108:111], a[64:67], v[44:47]
    v_exp_f32 v165, v165 clamp
    v_mfma_f32_16x16x32_bf16 v[52:55], v[108:111], a[68:71], v[52:55]
    v_exp_f32 v166, v166 clamp
    s_waitcnt lgkmcnt(2)
    v_mfma_f32_16x16x32_bf16 v[32:35], v[112:115], a[72:75], v[32:35]
    ds_read_b128 v[96:99], v18 offset:16384
    v_exp_f32 v167, v167 clamp
    v_mfma_f32_16x16x32_bf16 v[40:43], v[112:115], a[76:79], v[40:43]
    v_max_f32 v56, 0, v56
    v_max_f32 v57, 0, v57
    v_mfma_f32_16x16x32_bf16 v[48:51], v[112:115], a[80:83], v[48:51]
    v_max_f32 v58, 0, v58
    v_max_f32 v59, 0, v59
    v_mfma_f32_16x16x32_bf16 v[36:39], v[116:119], a[72:75], v[36:39]
    ds_read_b128 v[100:103], v18 offset:18432
    v_max_f32 v60, 0, v60
    v_mfma_f32_16x16x32_bf16 v[44:47], v[116:119], a[76:79], v[44:47]
    v_max_f32 v61, 0, v61
    v_max_f32 v62, 0, v62
    v_mfma_f32_16x16x32_bf16 v[52:55], v[116:119], a[80:83], v[52:55]
    v_max_f32 v63, 0, v63
    s_waitcnt lgkmcnt(2)
    v_mfma_f32_16x16x32_bf16 v[32:35], v[120:123], a[84:87], v[32:35]
    ds_read_b128 v[104:107], v19 offset:16384
    v_max_f32 v64, 0, v64
    v_mfma_f32_16x16x32_bf16 v[40:43], v[120:123], a[88:91], v[40:43]
    v_max_f32 v65, 0, v65
    v_max_f32 v66, 0, v66
    v_mfma_f32_16x16x32_bf16 v[48:51], v[120:123], a[92:95], v[48:51]
    v_max_f32 v67, 0, v67
    v_max_f32 v68, 0, v68
    v_mfma_f32_16x16x32_bf16 v[36:39], v[124:127], a[84:87], v[36:39]
    ds_read_b128 v[108:111], v19 offset:18432
    v_max_f32 v69, 0, v69
    v_mfma_f32_16x16x32_bf16 v[44:47], v[124:127], a[88:91], v[44:47]
    v_max_f32 v70, 0, v70
    v_max_f32 v71, 0, v71
    v_mfma_f32_16x16x32_bf16 v[52:55], v[124:127], a[92:95], v[52:55]
    v_add_f32 v152, v152, v56
    s_waitcnt lgkmcnt(2)
    v_mfma_f32_16x16x32_bf16 v[32:35], v[96:99], a[96:99], v[32:35]
    ds_read_b128 v[112:115], v18 offset:20480
    v_add_f32 v153, v153, v57
    v_mfma_f32_16x16x32_bf16 v[40:43], v[96:99], a[100:103], v[40:43]
    v_add_f32 v154, v154, v58
    v_add_f32 v155, v155, v59
    v_mfma_f32_16x16x32_bf16 v[48:51], v[96:99], a[104:107], v[48:51]
    v_add_f32 v156, v156, v60
    v_add_f32 v157, v157, v61
    v_mfma_f32_16x16x32_bf16 v[36:39], v[100:103], a[96:99], v[36:39]
    ds_read_b128 v[116:119], v18 offset:22528
    v_add_f32 v158, v158, v62
    v_mfma_f32_16x16x32_bf16 v[44:47], v[100:103], a[100:103], v[44:47]
    v_add_f32 v159, v159, v63
    v_add_f32 v160, v160, v64
    v_mfma_f32_16x16x32_bf16 v[52:55], v[100:103], a[104:107], v[52:55]
    v_add_f32 v161, v161, v65
    s_waitcnt lgkmcnt(2)
    v_mfma_f32_16x16x32_bf16 v[32:35], v[104:107], a[108:111], v[32:35]
    ds_read_b128 v[120:123], v19 offset:20480
    v_add_f32 v162, v162, v66
    v_mfma_f32_16x16x32_bf16 v[40:43], v[104:107], a[112:115], v[40:43]
    v_add_f32 v163, v163, v67
    v_add_f32 v164, v164, v68
    v_mfma_f32_16x16x32_bf16 v[48:51], v[104:107], a[116:119], v[48:51]
    v_add_f32 v165, v165, v69
    v_add_f32 v166, v166, v70
    v_mfma_f32_16x16x32_bf16 v[36:39], v[108:111], a[108:111], v[36:39]
    ds_read_b128 v[124:127], v19 offset:22528
    v_add_f32 v167, v167, v71
    v_mfma_f32_16x16x32_bf16 v[44:47], v[108:111], a[112:115], v[44:47]
    v_add_f32 v152, s61, v152
    v_add_f32 v153, s61, v153
    v_mfma_f32_16x16x32_bf16 v[52:55], v[108:111], a[116:119], v[52:55]
    v_add_f32 v154, s61, v154
    s_waitcnt lgkmcnt(2)
    v_mfma_f32_16x16x32_bf16 v[32:35], v[112:115], a[120:123], v[32:35]
    ds_read_b128 v[96:99], v18 offset:24576
    v_add_f32 v155, s61, v155
    v_mfma_f32_16x16x32_bf16 v[40:43], v[112:115], a[124:127], v[40:43]
    v_add_f32 v156, s61, v156
    v_add_f32 v157, s61, v157
    v_mfma_f32_16x16x32_bf16 v[48:51], v[112:115], a[128:131], v[48:51]
    v_add_f32 v158, s61, v158
    v_add_f32 v159, s61, v159
    v_mfma_f32_16x16x32_bf16 v[36:39], v[116:119], a[120:123], v[36:39]
    ds_read_b128 v[100:103], v18 offset:26624
    v_add_f32 v160, s61, v160
    v_mfma_f32_16x16x32_bf16 v[44:47], v[116:119], a[124:127], v[44:47]
    v_add_f32 v161, s61, v161
    v_add_f32 v162, s61, v162
    v_mfma_f32_16x16x32_bf16 v[52:55], v[116:119], a[128:131], v[52:55]
    v_add_f32 v163, s61, v163
    s_waitcnt lgkmcnt(2)
    v_mfma_f32_16x16x32_bf16 v[32:35], v[120:123], a[132:135], v[32:35]
    ds_read_b128 v[104:107], v19 offset:24576
    v_add_f32 v164, s61, v164
    v_mfma_f32_16x16x32_bf16 v[40:43], v[120:123], a[136:139], v[40:43]
    v_add_f32 v165, s61, v165
    v_add_f32 v166, s61, v166
    v_mfma_f32_16x16x32_bf16 v[48:51], v[120:123], a[140:143], v[48:51]
    v_add_f32 v167, s61, v167
    v_cvt_pk_bf16_f32 v168, v152, v153
    v_mfma_f32_16x16x32_bf16 v[36:39], v[124:127], a[132:135], v[36:39]
    ds_read_b128 v[108:111], v19 offset:26624
    v_cvt_pk_bf16_f32 v169, v154, v155
    v_mfma_f32_16x16x32_bf16 v[44:47], v[124:127], a[136:139], v[44:47]
    v_cvt_pk_bf16_f32 v170, v156, v157
    v_cvt_pk_bf16_f32 v171, v158, v159
    v_mfma_f32_16x16x32_bf16 v[52:55], v[124:127], a[140:143], v[52:55]
    v_cvt_pk_bf16_f32 v172, v160, v161
    s_waitcnt lgkmcnt(2)
    v_mfma_f32_16x16x32_bf16 v[32:35], v[96:99], a[144:147], v[32:35]
    ds_read_b128 v[112:115], v18 offset:28672
    v_cvt_pk_bf16_f32 v173, v162, v163
    v_mfma_f32_16x16x32_bf16 v[40:43], v[96:99], a[148:151], v[40:43]
    v_cvt_pk_bf16_f32 v174, v164, v165
    v_cvt_pk_bf16_f32 v175, v166, v167
    v_mfma_f32_16x16x32_bf16 v[48:51], v[96:99], a[152:155], v[48:51]
    v_mfma_f32_16x16x32_bf16 v[36:39], v[100:103], a[144:147], v[36:39]
    ds_read_b128 v[116:119], v18 offset:30720
    v_mfma_f32_16x16x32_bf16 v[128:131], v[168:171], v[176:179], v[128:131]
    v_mfma_f32_16x16x32_bf16 v[44:47], v[100:103], a[148:151], v[44:47]
    v_mfma_f32_16x16x32_bf16 v[132:135], v[168:171], v[180:183], v[132:135]
    v_mfma_f32_16x16x32_bf16 v[52:55], v[100:103], a[152:155], v[52:55]
    v_mfma_f32_16x16x32_bf16 v[136:139], v[168:171], v[184:187], v[136:139]
    s_waitcnt lgkmcnt(2)
    v_mfma_f32_16x16x32_bf16 v[32:35], v[104:107], a[156:159], v[32:35]
    ds_read_b128 v[120:123], v19 offset:28672
    v_mfma_f32_16x16x32_bf16 v[140:143], v[172:175], v[176:179], v[140:143]
    v_mfma_f32_16x16x32_bf16 v[40:43], v[104:107], a[160:163], v[40:43]
    v_mfma_f32_16x16x32_bf16 v[144:147], v[172:175], v[180:183], v[144:147]
    v_mfma_f32_16x16x32_bf16 v[48:51], v[104:107], a[164:167], v[48:51]
    v_mfma_f32_16x16x32_bf16 v[148:151], v[172:175], v[184:187], v[148:151]
    v_mfma_f32_16x16x32_bf16 v[36:39], v[108:111], a[156:159], v[36:39]
    ds_read_b128 v[124:127], v19 offset:30720
    v_mfma_f32_16x16x32_bf16 v[44:47], v[108:111], a[160:163], v[44:47]
    v_mfma_f32_16x16x32_bf16 v[52:55], v[108:111], a[164:167], v[52:55]
    s_waitcnt lgkmcnt(2)
    v_mfma_f32_16x16x32_bf16 v[32:35], v[112:115], a[168:171], v[32:35]
    ds_read_b128 v[96:99], v18 offset:32768
    v_mfma_f32_16x16x32_bf16 v[40:43], v[112:115], a[172:175], v[40:43]
    v_mfma_f32_16x16x32_bf16 v[48:51], v[112:115], a[176:179], v[48:51]
    v_mfma_f32_16x16x32_bf16 v[36:39], v[116:119], a[168:171], v[36:39]
    ds_read_b128 v[100:103], v18 offset:34816
    v_mfma_f32_16x16x32_bf16 v[44:47], v[116:119], a[172:175], v[44:47]
    v_mfma_f32_16x16x32_bf16 v[52:55], v[116:119], a[176:179], v[52:55]
    s_waitcnt lgkmcnt(2)
    v_mfma_f32_16x16x32_bf16 v[32:35], v[120:123], a[180:183], v[32:35]
    ds_read_b128 v[104:107], v19 offset:32768
    v_mfma_f32_16x16x32_bf16 v[40:43], v[120:123], a[184:187], v[40:43]
    v_mfma_f32_16x16x32_bf16 v[48:51], v[120:123], a[188:191], v[48:51]
    v_mfma_f32_16x16x32_bf16 v[36:39], v[124:127], a[180:183], v[36:39]
    ds_read_b128 v[108:111], v19 offset:34816
    v_mfma_f32_16x16x32_bf16 v[44:47], v[124:127], a[184:187], v[44:47]
    v_mfma_f32_16x16x32_bf16 v[52:55], v[124:127], a[188:191], v[52:55]
    s_waitcnt lgkmcnt(2)
    v_mfma_f32_16x16x32_bf16 v[32:35], v[96:99], a[192:195], v[32:35]
    ds_read_b128 v[112:115], v18 offset:36864
    v_mfma_f32_16x16x32_bf16 v[40:43], v[96:99], a[196:199], v[40:43]
    v_mfma_f32_16x16x32_bf16 v[48:51], v[96:99], a[200:203], v[48:51]
    v_add_u32 v20, s49, v16
    v_add_u32 v21, s49, v17
    v_mfma_f32_16x16x32_bf16 v[36:39], v[100:103], a[192:195], v[36:39]
    ds_read_b128 v[116:119], v18 offset:38912
    s_add_u32 s49, s49, 40960
    s_cmp_eq_u32 s49, 122880
    v_mfma_f32_16x16x32_bf16 v[44:47], v[100:103], a[196:199], v[44:47]
    s_cselect_b32 s49, 0, s49
    v_mfma_f32_16x16x32_bf16 v[52:55], v[100:103], a[200:203], v[52:55]
    s_add_u32 s48, s49, s34
    s_add_u32 s44, s44, 40960
    s_waitcnt lgkmcnt(2)
    v_mfma_f32_16x16x32_bf16 v[32:35], v[104:107], a[204:207], v[32:35]
    ds_read_b128 v[120:123], v19 offset:36864
    v_mfma_f32_16x16x32_bf16 v[40:43], v[104:107], a[208:211], v[40:43]
    v_mfma_f32_16x16x32_bf16 v[48:51], v[104:107], a[212:215], v[48:51]
    s_waitcnt vmcnt(0)
    s_barrier
    v_mfma_f32_16x16x32_bf16 v[36:39], v[108:111], a[204:207], v[36:39]
    ds_read_b128 v[124:127], v19 offset:38912
    s_add_u32 m0, s48, 0
    v_mfma_f32_16x16x32_bf16 v[44:47], v[108:111], a[208:211], v[44:47]
    buffer_load_dwordx4 v8, s[20:23], s44 offen offset:0 lds
    v_mfma_f32_16x16x32_bf16 v[52:55], v[108:111], a[212:215], v[52:55]
    s_waitcnt lgkmcnt(2)
    v_mfma_f32_16x16x32_bf16 v[32:35], v[112:115], a[216:219], v[32:35]
    ds_read_b128 v[96:99], v20 offset:0
    v_mfma_f32_16x16x32_bf16 v[40:43], v[112:115], a[220:223], v[40:43]
    s_add_u32 m0, s48, 3968
    v_mfma_f32_16x16x32_bf16 v[48:51], v[112:115], a[224:227], v[48:51]
    s_add_u32 s46, s46, 1
    buffer_load_dwordx4 v8, s[20:23], s44 offen offset:128 lds
    v_mfma_f32_16x16x32_bf16 v[36:39], v[116:119], a[216:219], v[36:39]
    ds_read_b128 v[100:103], v20 offset:2048
    v_mfma_f32_16x16x32_bf16 v[44:47], v[116:119], a[220:223], v[44:47]
    v_mfma_f32_16x16x32_bf16 v[52:55], v[116:119], a[224:227], v[52:55]
    s_add_u32 m0, s48, 7936
    s_waitcnt lgkmcnt(2)
    v_mfma_f32_16x16x32_bf16 v[32:35], v[120:123], a[228:231], v[32:35]
    ds_read_b128 v[104:107], v21 offset:0
    buffer_load_dwordx4 v8, s[20:23], s44 offen offset:256 lds
    v_mfma_f32_16x16x32_bf16 v[40:43], v[120:123], a[232:235], v[40:43]
    v_mfma_f32_16x16x32_bf16 v[48:51], v[120:123], a[236:239], v[48:51]
    v_mfma_f32_16x16x32_bf16 v[36:39], v[124:127], a[228:231], v[36:39]
    ds_read_b128 v[108:111], v21 offset:2048
    s_add_u32 m0, s48, 11904
    v_mfma_f32_16x16x32_bf16 v[44:47], v[124:127], a[232:235], v[44:47]
    buffer_load_dwordx4 v8, s[20:23], s44 offen offset:384 lds
    v_mfma_f32_16x16x32_bf16 v[52:55], v[124:127], a[236:239], v[52:55]
L_a1_odd:
    s_waitcnt lgkmcnt(2)
    v_mfma_f32_16x16x32_bf16 v[56:59], v[96:99], a[0:3], 0
    ds_read_b128 v[112:115], v20 offset:4096
    v_mfma_f32_16x16x32_bf16 v[64:67], v[96:99], a[4:7], 0
    s_add_u32 m0, s48, 15872
    v_mfma_f32_16x16x32_bf16 v[72:75], v[96:99], a[8:11], 0
    buffer_load_dwordx4 v8, s[20:23], s44 offen offset:512 lds
    v_mfma_f32_16x16x32_bf16 v[60:63], v[100:103], a[0:3], 0
    ds_read_b128 v[116:119], v20 offset:6144
    v_cvt_pk_bf16_f32 v176, v40, v41
    v_mfma_f32_16x16x32_bf16 v[68:71], v[100:103], a[4:7], 0
    v_cvt_pk_bf16_f32 v177, v42, v43
    v_cvt_pk_bf16_f32 v178, v44, v45
    v_mfma_f32_16x16x32_bf16 v[76:79], v[100:103], a[8:11], 0
    v_cvt_pk_bf16_f32 v179, v46, v47
    s_add_u32 m0, s48, 19840
    s_waitcnt lgkmcnt(2)
    v_mfma_f32_16x16x32_bf16 v[56:59], v[104:107], a[12:15], v[56:59]
    ds_read_b128 v[120:123], v21 offset:4096
    v_cvt_pk_bf16_f32 v180, v48, v49
    buffer_load_dwordx4 v8, s[20:23], s44 offen offset:640 lds
    v_mfma_f32_16x16x32_bf16 v[64:67], v[104:107], a[16:19], v[64:67]
    v_cvt_pk_bf16_f32 v181, v50, v51
    v_cvt_pk_bf16_f32 v182, v52, v53
    v_mfma_f32_16x16x32_bf16 v[72:75], v[104:107], a[20:23], v[72:75]
    v_cvt_pk_bf16_f32 v183, v54, v55
    v_mul_f32 v152, s60, v32
    v_mfma_f32_16x16x32_bf16 v[60:63], v[108:111], a[12:15], v[60:63]
    ds_read_b128 v[124:127], v21 offset:6144
    v_mul_f32 v153, s60, v33
    s_add_u32 m0, s48, 23808
    v_mfma_f32_16x16x32_bf16 v[68:71], v[108:111], a[16:19], v[68:71]
    v_mul_f32 v154, s60, v34
    buffer_load_dwordx4 v8, s[20:23], s44 offen offset:768 lds
    v_mfma_f32_16x16x32_bf16 v[76:79], v[108:111], a[20:23], v[76:79]
    v_mul_f32 v155, s60, v35
    s_waitcnt lgkmcnt(2)
    v_mfma_f32_16x16x32_bf16 v[56:59], v[112:115], a[24:27], v[56:59]
    ds_read_b128 v[96:99], v20 offset:8192
    v_mul_f32 v156, s60, v36
    v_mfma_f32_16x16x32_bf16 v[64:67], v[112:115], a[28:31], v[64:67]
    v_mul_f32 v157, s60, v37
    s_add_u32 m0, s48, 27776
    v_mfma_f32_16x16x32_bf16 v[72:75], v[112:115], a[32:35], v[72:75]
    v_mul_f32 v158, s60, v38
    buffer_load_dwordx4 v8, s[20:23], s44 offen offset:896 lds
    v_mfma_f32_16x16x32_bf16 v[60:63], v[116:119], a[24:27], v[60:63]
    ds_read_b128 v[100:103], v20 offset:10240
    v_mul_f32 v159, s60, v39
    v_mfma_f32_16x16x32_bf16 v[68:71], v[116:119], a[28:31], v[68:71]
    v_mul_f32 v160, s60, v40
    v_mul_f32 v161, s60, v41
    v_mfma_f32_16x16x32_bf16 v[76:79], v[116:119], a[32:35], v[76:79]
    v_mul_f32 v162, s60, v42
    s_add_u32 m0, s48, 31744
    s_waitcnt lgkmcnt(2)
    v_mfma_f32_16x16x32_bf16 v[56:59], v[120:123], a[36:39], v[56:59]
    ds_read_b128 v[104:107], v21 offset:8192
    v_mul_f32 v163, s60, v43
    buffer_load_dwordx4 v8, s[20:23], s44 offen offset:1024 lds
    v_mfma_f32_16x16x32_bf16 v[64:67], v[120:123], a[40:43], v[64:67]
    v_mul_f32 v164, s60, v44
    v_mul_f32 v165, s60, v45
    v_mfma_f32_16x16x32_bf16 v[72:75], v[120:123], a[44:47], v[72:75]
    v_mul_f32 v166, s60, v46
    v_mul_f32 v167, s60, v47
    v_mfma_f32_16x16x32_bf16 v[60:63], v[124:127], a[36:39], v[60:63]
    ds_read_b128 v[108:111], v21 offset:10240
    v_exp_f32 v152, v152 clamp
    s_add_u32 m0, s48, 35712
    v_mfma_f32_16x16x32_bf16 v[68:71], v[124:127], a[40:43], v[68:71]
    v_exp_f32 v153, v153 clamp
    buffer_load_dwordx4 v8, s[20:23], s44 offen offset:1152 lds
    v_mfma_f32_16x16x32_bf16 v[76:79], v[124:127], a[44:47], v[76:79]
    v_exp_f32 v154, v154 clamp
    s_waitcnt lgkmcnt(2)
    v_mfma_f32_16x16x32_bf16 v[56:59], v[96:99], a[48:51], v[56:59]
    ds_read_b128 v[112:115], v20 offset:12288
    v_exp_f32 v155, v155 clamp
    v_mfma_f32_16x16x32_bf16 v[64:67], v[96:99], a[52:55], v[64:67]
    v_exp_f32 v156, v156 clamp
    v_mfma_f32_16x16x32_bf16 v[72:75], v[96:99], a[56:59], v[72:75]
    v_exp_f32 v157, v157 clamp
    v_mfma_f32_16x16x32_bf16 v[60:63], v[100:103], a[48:51], v[60:63]
    ds_read_b128 v[116:119], v20 offset:14336
    v_exp_f32 v158, v158 clamp
    v_mfma_f32_16x16x32_bf16 v[68:71], v[100:103], a[52:55], v[68:71]
    v_exp_f32 v159, v159 clamp
    v_mfma_f32_16x16x32_bf16 v[76:79], v[100:103], a[56:59], v[76:79]
    v_exp_f32 v160, v160 clamp
    s_waitcnt lgkmcnt(2)
    v_mfma_f32_16x16x32_bf16 v[56:59], v[104:107], a[60:63], v[56:59]
    ds_read_b128 v[120:123], v21 offset:12288
    v_exp_f32 v161, v161 clamp
    v_mfma_f32_16x16x32_bf16 v[64:67], v[104:107], a[64:67], v[64:67]
    v_exp_f32 v162, v162 clamp
    v_mfma_f32_16x16x32_bf16 v[72:75], v[104:107], a[68:71], v[72:75]
    v_exp_f32 v163, v163 clamp
    v_mfma_f32_16x16x32_bf16 v[60:63], v[108:111], a[60:63], v[60:63]
    ds_read_b128 v[124:127], v21 offset:14336
    v_exp_f32 v164, v164 clamp
    v_mfma_f32_16x16x32_bf16 v[68:71], v[108:111], a[64:67], v[68:71]
    v_exp_f32 v165, v165 clamp
    v_mfma_f32_16x16x32_bf16 v[76:79], v[108:111], a[68:71], v[76:79]
    v_exp_f32 v166, v166 clamp
    s_waitcnt lgkmcnt(2)
    v_mfma_f32_16x16x32_bf16 v[56:59], v[112:115], a[72:75], v[56:59]
    ds_read_b128 v[96:99], v20 offset:16384
    v_exp_f32 v167, v167 clamp
    v_mfma_f32_16x16x32_bf16 v[64:67], v[112:115], a[76:79], v[64:67]
    v_max_f32 v32, 0, v32
    v_max_f32 v33, 0, v33
    v_mfma_f32_16x16x32_bf16 v[72:75], v[112:115], a[80:83], v[72:75]
    v_max_f32 v34, 0, v34
    v_max_f32 v35, 0, v35
    v_mfma_f32_16x16x32_bf16 v[60:63], v[116:119], a[72:75], v[60:63]
    ds_read_b128 v[100:103], v20 offset:18432
    v_max_f32 v36, 0, v36
    v_mfma_f32_16x16x32_bf16 v[68:71], v[116:119], a[76:79], v[68:71]
    v_max_f32 v37, 0, v37
    v_max_f32 v38, 0, v38
    v_mfma_f32_16x16x32_bf16 v[76:79], v[116:119], a[80:83], v[76:79]
    v_max_f32 v39, 0, v39
    s_waitcnt lgkmcnt(2)
    v_mfma_f32_16x16x32_bf16 v[56:59], v[120:123], a[84:87], v[56:59]
    ds_read_b128 v[104:107], v21 offset:16384
    v_max_f32 v40, 0, v40
    v_mfma_f32_16x16x32_bf16 v[64:67], v[120:123], a[88:91], v[64:67]
    v_max_f32 v41, 0, v41
    v_max_f32 v42, 0, v42
    v_mfma_f32_16x16x32_bf16 v[72:75], v[120:123], a[92:95], v[72:75]
    v_max_f32 v43, 0, v43
    v_max_f32 v44, 0, v44
    v_mfma_f32_16x16x32_bf16 v[60:63], v[124:127], a[84:87], v[60:63]
    ds_read_b128 v[108:111], v21 offset:18432
    v_max_f32 v45, 0, v45
    v_mfma_f32_16x16x32_bf16 v[68:71], v[124:127], a[88:91], v[68:71]
    v_max_f32 v46, 0, v46
    v_max_f32 v47, 0, v47
    v_mfma_f32_16x16x32_bf16 v[76:79], v[124:127], a[92:95], v[76:79]
    v_add_f32 v152, v152, v32
    s_waitcnt lgkmcnt(2)
    v_mfma_f32_16x16x32_bf16 v[56:59], v[96:99], a[96:99], v[56:59]
    ds_read_b128 v[112:115], v20 offset:20480
    v_add_f32 v153, v153, v33
    v_mfma_f32_16x16x32_bf16 v[64:67], v[96:99], a[100:103], v[64:67]
    v_add_f32 v154, v154, v34
    v_add_f32 v155, v155, v35
    v_mfma_f32_16x16x32_bf16 v[72:75], v[96:99], a[104:107], v[72:75]
    v_add_f32 v156, v156, v36
    v_add_f32 v157, v157, v37
    v_mfma_f32_16x16x32_bf16 v[60:63], v[100:103], a[96:99], v[60:63]
    ds_read_b128 v[116:119], v20 offset:22528
    v_add_f32 v158, v158, v38
    v_mfma_f32_16x16x32_bf16 v[68:71], v[100:103], a[100:103], v[68:71]
    v_add_f32 v159, v159, v39
    v_add_f32 v160, v160, v40
    v_mfma_f32_16x16x32_bf16 v[76:79], v[100:103], a[104:107], v[76:79]
    v_add_f32 v161, v161, v41
    s_waitcnt lgkmcnt(2)
    v_mfma_f32_16x16x32_bf16 v[56:59], v[104:107], a[108:111], v[56:59]
    ds_read_b128 v[120:123], v21 offset:20480
    v_add_f32 v162, v162, v42
    v_mfma_f32_16x16x32_bf16 v[64:67], v[104:107], a[112:115], v[64:67]
    v_add_f32 v163, v163, v43
    v_add_f32 v164, v164, v44
    v_mfma_f32_16x16x32_bf16 v[72:75], v[104:107], a[116:119], v[72:75]
    v_add_f32 v165, v165, v45
    v_add_f32 v166, v166, v46
    v_mfma_f32_16x16x32_bf16 v[60:63], v[108:111], a[108:111], v[60:63]
    ds_read_b128 v[124:127], v21 offset:22528
    v_add_f32 v167, v167, v47
    v_mfma_f32_16x16x32_bf16 v[68:71], v[108:111], a[112:115], v[68:71]
    v_add_f32 v152, s61, v152
    v_add_f32 v153, s61, v153
    v_mfma_f32_16x16x32_bf16 v[76:79], v[108:111], a[116:119], v[76:79]
    v_add_f32 v154, s61, v154
    s_waitcnt lgkmcnt(2)
    v_mfma_f32_16x16x32_bf16 v[56:59], v[112:115], a[120:123], v[56:59]
    ds_read_b128 v[96:99], v20 offset:24576
    v_add_f32 v155, s61, v155
    v_mfma_f32_16x16x32_bf16 v[64:67], v[112:115], a[124:127], v[64:67]
    v_add_f32 v156, s61, v156
    v_add_f32 v157, s61, v157
    v_mfma_f32_16x16x32_bf16 v[72:75], v[112:115], a[128:131], v[72:75]
    v_add_f32 v158, s61, v158
    v_add_f32 v159, s61, v159
    v_mfma_f32_16x16x32_bf16 v[60:63], v[116:119], a[120:123], v[60:63]
    ds_read_b128 v[100:103], v20 offset:26624
    v_add_f32 v160, s61, v160
    v_mfma_f32_16x16x32_bf16 v[68:71], v[116:119], a[124:127], v[68:71]
    v_add_f32 v161, s61, v161
    v_add_f32 v162, s61, v162
    v_mfma_f32_16x16x32_bf16 v[76:79], v[116:119], a[128:131], v[76:79]
    v_add_f32 v163, s61, v163
    s_waitcnt lgkmcnt(2)
    v_mfma_f32_16x16x32_bf16 v[56:59], v[120:123], a[132:135], v[56:59]
    ds_read_b128 v[104:107], v21 offset:24576
    v_add_f32 v164, s61, v164
    v_mfma_f32_16x16x32_bf16 v[64:67], v[120:123], a[136:139], v[64:67]
    v_add_f32 v165, s61, v165
    v_add_f32 v166, s61, v166
    v_mfma_f32_16x16x32_bf16 v[72:75], v[120:123], a[140:143], v[72:75]
    v_add_f32 v167, s61, v167
    v_cvt_pk_bf16_f32 v168, v152, v153
    v_mfma_f32_16x16x32_bf16 v[60:63], v[124:127], a[132:135], v[60:63]
    ds_read_b128 v[108:111], v21 offset:26624
    v_cvt_pk_bf16_f32 v169, v154, v155
    v_mfma_f32_16x16x32_bf16 v[68:71], v[124:127], a[136:139], v[68:71]
    v_cvt_pk_bf16_f32 v170, v156, v157
    v_cvt_pk_bf16_f32 v171, v158, v159
    v_mfma_f32_16x16x32_bf16 v[76:79], v[124:127], a[140:143], v[76:79]
    v_cvt_pk_bf16_f32 v172, v160, v161
    s_waitcnt lgkmcnt(2)
    v_mfma_f32_16x16x32_bf16 v[56:59], v[96:99], a[144:147], v[56:59]
    ds_read_b128 v[112:115], v20 offset:28672
    v_cvt_pk_bf16_f32 v173, v162, v163
    v_mfma_f32_16x16x32_bf16 v[64:67], v[96:99], a[148:151], v[64:67]
    v_cvt_pk_bf16_f32 v174, v164, v165
    v_cvt_pk_bf16_f32 v175, v166, v167
    v_mfma_f32_16x16x32_bf16 v[72:75], v[96:99], a[152:155], v[72:75]
    v_mfma_f32_16x16x32_bf16 v[60:63], v[100:103], a[144:147], v[60:63]
    ds_read_b128 v[116:119], v20 offset:30720
    v_mfma_f32_16x16x32_bf16 v[128:131], v[168:171], v[176:179], v[128:131]
    v_mfma_f32_16x16x32_bf16 v[68:71], v[100:103], a[148:151], v[68:71]
    v_mfma_f32_16x16x32_bf16 v[132:135], v[168:171], v[180:183], v[132:135]
    v_mfma_f32_16x16x32_bf16 v[76:79], v[100:103], a[152:155], v[76:79]
    v_mfma_f32_16x16x32_bf16 v[136:139], v[168:171], v[184:187], v[136:139]
    s_waitcnt lgkmcnt(2)
    v_mfma_f32_16x16x32_bf16 v[56:59], v[104:107], a[156:159], v[56:59]
    ds_read_b128 v[120:123], v21 offset:28672
    v_mfma_f32_16x16x32_bf16 v[140:143], v[172:175], v[176:179], v[140:143]
    v_mfma_f32_16x16x32_bf16 v[64:67], v[104:107], a[160:163], v[64:67]
    v_mfma_f32_16x16x32_bf16 v[144:147], v[172:175], v[180:183], v[144:147]
    v_mfma_f32_16x16x32_bf16 v[72:75], v[104:107], a[164:167], v[72:75]
    v_mfma_f32_16x16x32_bf16 v[148:151], v[172:175], v[184:187], v[148:151]
    v_mfma_f32_16x16x32_bf16 v[60:63], v[108:111], a[156:159], v[60:63]
    ds_read_b128 v[124:127], v21 offset:30720
    v_mfma_f32_16x16x32_bf16 v[68:71], v[108:111], a[160:163], v[68:71]
    v_mfma_f32_16x16x32_bf16 v[76:79], v[108:111], a[164:167], v[76:79]
    s_waitcnt lgkmcnt(2)
    v_mfma_f32_16x16x32_bf16 v[56:59], v[112:115], a[168:171], v[56:59]
    ds_read_b128 v[96:99], v20 offset:32768
    v_mfma_f32_16x16x32_bf16 v[64:67], v[112:115], a[172:175], v[64:67]
    v_mfma_f32_16x16x32_bf16 v[72:75], v[112:115], a[176:179], v[72:75]
    v_mfma_f32_16x16x32_bf16 v[60:63], v[116:119], a[168:171], v[60:63]
    ds_read_b128 v[100:103], v20 offset:34816
    v_mfma_f32_16x16x32_bf16 v[68:71], v[116:119], a[172:175], v[68:71]
    v_mfma_f32_16x16x32_bf16 v[76:79], v[116:119], a[176:179], v[76:79]
    s_waitcnt lgkmcnt(2)
    v_mfma_f32_16x16x32_bf16 v[56:59], v[120:123], a[180:183], v[56:59]
    ds_read_b128 v[104:107], v21 offset:32768
    v_mfma_f32_16x16x32_bf16 v[64:67], v[120:123], a[184:187], v[64:67]
    v_mfma_f32_16x16x32_bf16 v[72:75], v[120:123], a[188:191], v[72:75]
    v_mfma_f32_16x16x32_bf16 v[60:63], v[124:127], a[180:183], v[60:63]
    ds_read_b128 v[108:111], v21 offset:34816
    v_mfma_f32_16x16x32_bf16 v[68:71], v[124:127], a[184:187], v[68:71]
    v_mfma_f32_16x16x32_bf16 v[76:79], v[124:127], a[188:191], v[76:79]
    s_waitcnt lgkmcnt(2)
    v_mfma_f32_16x16x32_bf16 v[56:59], v[96:99], a[192:195], v[56:59]
    ds_read_b128 v[112:115], v20 offset:36864
    v_mfma_f32_16x16x32_bf16 v[64:67], v[96:99], a[196:199], v[64:67]
    v_mfma_f32_16x16x32_bf16 v[72:75], v[96:99], a[200:203], v[72:75]
    v_add_u32 v18, s49, v16
    v_add_u32 v19, s49, v17
    v_mfma_f32_16x16x32_bf16 v[60:63], v[100:103], a[192:195], v[60:63]
    ds_read_b128 v[116:119], v20 offset:38912
    s_add_u32 s49, s49, 40960
    s_cmp_eq_u32 s49, 122880
    v_mfma_f32_16x16x32_bf16 v[68:71], v[100:103], a[196:199], v[68:71]
    s_cselect_b32 s49, 0, s49
    v_mfma_f32_16x16x32_bf16 v[76:79], v[100:103], a[200:203], v[76:79]
    s_add_u32 s48, s49, s34
    s_add_u32 s44, s44, 40960
    s_waitcnt lgkmcnt(2)
    v_mfma_f32_16x16x32_bf16 v[56:59], v[104:107], a[204:207], v[56:59]
    ds_read_b128 v[120:123], v21 offset:36864
    v_mfma_f32_16x16x32_bf16 v[64:67], v[104:107], a[208:211], v[64:67]
    v_mfma_f32_16x16x32_bf16 v[72:75], v[104:107], a[212:215], v[72:75]
    s_waitcnt vmcnt(0)
    s_barrier
    v_mfma_f32_16x16x32_bf16 v[60:63], v[108:111], a[204:207], v[60:63]
    ds_read_b128 v[124:127], v21 offset:38912
    s_add_u32 m0, s48, 0
    v_mfma_f32_16x16x32_bf16 v[68:71], v[108:111], a[208:211], v[68:71]
    buffer_load_dwordx4 v8, s[20:23], s44 offen offset:0 lds
    v_mfma_f32_16x16x32_bf16 v[76:79], v[108:111], a[212:215], v[76:79]
    s_waitcnt lgkmcnt(2)
    v_mfma_f32_16x16x32_bf16 v[56:59], v[112:115], a[216:219], v[56:59]
    ds_read_b128 v[96:99], v18 offset:0
    v_mfma_f32_16x16x32_bf16 v[64:67], v[112:115], a[220:223], v[64:67]
    s_add_u32 m0, s48, 3968
    v_mfma_f32_16x16x32_bf16 v[72:75], v[112:115], a[224:227], v[72:75]
    s_add_u32 s46, s46, 1
    buffer_load_dwordx4 v8, s[20:23], s44 offen offset:128 lds
    v_mfma_f32_16x16x32_bf16 v[60:63], v[116:119], a[216:219], v[60:63]
    ds_read_b128 v[100:103], v18 offset:2048
    v_mfma_f32_16x16x32_bf16 v[68:71], v[116:119], a[220:223], v[68:71]
    v_mfma_f32_16x16x32_bf16 v[76:79], v[116:119], a[224:227], v[76:79]
    s_add_u32 m0, s48, 7936
    s_waitcnt lgkmcnt(2)
    v_mfma_f32_16x16x32_bf16 v[56:59], v[120:123], a[228:231], v[56:59]
    ds_read_b128 v[104:107], v19 offset:0
    buffer_load_dwordx4 v8, s[20:23], s44 offen offset:256 lds
    v_mfma_f32_16x16x32_bf16 v[64:67], v[120:123], a[232:235], v[64:67]
    v_mfma_f32_16x16x32_bf16 v[72:75], v[120:123], a[236:239], v[72:75]
    v_mfma_f32_16x16x32_bf16 v[60:63], v[124:127], a[228:231], v[60:63]
    ds_read_b128 v[108:111], v19 offset:2048
    s_add_u32 m0, s48, 11904
    v_mfma_f32_16x16x32_bf16 v[68:71], v[124:127], a[232:235], v[68:71]
    buffer_load_dwordx4 v8, s[20:23], s44 offen offset:384 lds
    v_mfma_f32_16x16x32_bf16 v[76:79], v[124:127], a[236:239], v[76:79]
    s_cmp_lt_u32 s46, 63
    s_cbranch_scc1 L_a1_loop
    s_nop 5
    v_cvt_pk_bf16_f32 v176, v64, v65
    v_cvt_pk_bf16_f32 v177, v66, v67
    v_cvt_pk_bf16_f32 v178, v68, v69
    v_cvt_pk_bf16_f32 v179, v70, v71
    v_cvt_pk_bf16_f32 v180, v72, v73
    v_cvt_pk_bf16_f32 v181, v74, v75
    v_cvt_pk_bf16_f32 v182, v76, v77
    v_cvt_pk_bf16_f32 v183, v78, v79
    v_mul_f32 v152, s60, v56
    v_mul_f32 v153, s60, v57
    v_mul_f32 v154, s60, v58
    v_mul_f32 v155, s60, v59
    v_mul_f32 v156, s60, v60
    v_mul_f32 v157, s60, v61
    v_mul_f32 v158, s60, v62
    v_mul_f32 v159, s60, v63
    v_mul_f32 v160, s60, v64
    v_mul_f32 v161, s60, v65
    v_mul_f32 v162, s60, v66
    v_mul_f32 v163, s60, v67
    v_mul_f32 v164, s60, v68
    v_mul_f32 v165, s60, v69
    v_mul_f32 v166, s60, v70
    v_mul_f32 v167, s60, v71
    v_exp_f32 v152, v152 clamp
    v_exp_f32 v153, v153 clamp
    v_exp_f32 v154, v154 clamp
    v_exp_f32 v155, v155 clamp
    v_exp_f32 v156, v156 clamp
    v_exp_f32 v157, v157 clamp
    v_exp_f32 v158, v158 clamp
    v_exp_f32 v159, v159 clamp
    v_exp_f32 v160, v160 clamp
    v_exp_f32 v161, v161 clamp
    v_exp_f32 v162, v162 clamp
    v_exp_f32 v163, v163 clamp
    v_exp_f32 v164, v164 clamp
    v_exp_f32 v165, v165 clamp
    v_exp_f32 v166, v166 clamp
    v_exp_f32 v167, v167 clamp
    v_max_f32 v56, 0, v56
    v_max_f32 v57, 0, v57
    v_max_f32 v58, 0, v58
    v_max_f32 v59, 0, v59
    v_max_f32 v60, 0, v60
    v_max_f32 v61, 0, v61
    v_max_f32 v62, 0, v62
    v_max_f32 v63, 0, v63
    v_max_f32 v64, 0, v64
    v_max_f32 v65, 0, v65
    v_max_f32 v66, 0, v66
    v_max_f32 v67, 0, v67
    v_max_f32 v68, 0, v68
    v_max_f32 v69, 0, v69
    v_max_f32 v70, 0, v70
    v_max_f32 v71, 0, v71
    v_add_f32 v152, v152, v56
    v_add_f32 v153, v153, v57
    v_add_f32 v154, v154, v58
    v_add_f32 v155, v155, v59
    v_add_f32 v156, v156, v60
    v_add_f32 v157, v157, v61
    v_add_f32 v158, v158, v62
    v_add_f32 v159, v159, v63
    v_add_f32 v160, v160, v64
    v_add_f32 v161, v161, v65
    v_add_f32 v162, v162, v66
    v_add_f32 v163, v163, v67
    v_add_f32 v164, v164, v68
    v_add_f32 v165, v165, v69
    v_add_f32 v166, v166, v70
    v_add_f32 v167, v167, v71
    v_add_f32 v152, s61, v152
    v_add_f32 v153, s61, v153
    v_add_f32 v154, s61, v154
    v_add_f32 v155, s61, v155
    v_add_f32 v156, s61, v156
    v_add_f32 v157, s61, v157
    v_add_f32 v158, s61, v158
    v_add_f32 v159, s61, v159
    v_add_f32 v160, s61, v160
    v_add_f32 v161, s61, v161
    v_add_f32 v162, s61, v162
    v_add_f32 v163, s61, v163
    v_add_f32 v164, s61, v164
    v_add_f32 v165, s61, v165
    v_add_f32 v166, s61, v166
    v_add_f32 v167, s61, v167
    v_cvt_pk_bf16_f32 v168, v152, v153
    v_cvt_pk_bf16_f32 v169, v154, v155
    v_cvt_pk_bf16_f32 v170, v156, v157
    v_cvt_pk_bf16_f32 v171, v158, v159
    v_cvt_pk_bf16_f32 v172, v160, v161
    v_cvt_pk_bf16_f32 v173, v162, v163
    v_cvt_pk_bf16_f32 v174, v164, v165
    v_cvt_pk_bf16_f32 v175, v166, v167
    s_nop 1
    v_mfma_f32_16x16x32_bf16 v[128:131], v[168:171], v[176:179], v[128:131]
    v_mfma_f32_16x16x32_bf16 v[132:135], v[168:171], v[180:183], v[132:135]
    v_mfma_f32_16x16x32_bf16 v[136:139], v[168:171], v[184:187], v[136:139]
    v_mfma_f32_16x16x32_bf16 v[140:143], v[172:175], v[176:179], v[140:143]
    v_mfma_f32_16x16x32_bf16 v[144:147], v[172:175], v[180:183], v[144:147]
    v_mfma_f32_16x16x32_bf16 v[148:151], v[172:175], v[184:187], v[148:151]
    s_waitcnt vmcnt(0) lgkmcnt(0)
    s_barrier
    v_mov_b32 v32, 0
    v_mov_b32 v33, 0
    v_mov_b32 v34, 0
    v_mov_b32 v35, 0
    v_lshlrev_b32 v10, 4, v0
    s_mul_i32 s30, s3, 9216
    v_add_u32 v1, s30, v10
    ds_write_b128 v1, v[32:35] offset:0
    ds_write_b128 v1, v[32:35] offset:1024
    ds_write_b128 v1, v[32:35] offset:2048
    ds_write_b128 v1, v[32:35] offset:3072
    ds_write_b128 v1, v[32:35] offset:4096
    ds_write_b128 v1, v[32:35] offset:5120
    ds_write_b128 v1, v[32:35] offset:6144
    ds_write_b128 v1, v[32:35] offset:7168
    ds_write_b128 v1, v[32:35] offset:8192
    s_waitcnt lgkmcnt(0)
    s_barrier
    v_and_b32 v1, 15, v0
    v_lshrrev_b32 v2, 4, v0
    s_mul_i32 s30, s3, 4200
    v_mul_u32_u24 v3, 208, v1
    v_lshl_add_u32 v3, v2, 3, v3
    v_add_u32 v3, s30, v3
    v_mov_b32 v36, 40960
    v_cmp_le_u32 s[50:51], 4, v1
    v_cmp_gt_u32 s[52:53], 8, v1
    v_cmp_eq_u32 s[54:55], 0, v2
    v_subrev_u32 v32, 832, v3
    v_add_u32 v33, 2496, v3
    v_cndmask_b32 v32, v36, v32, s[50:51]
    v_cndmask_b32 v33, v36, v33, s[52:53]
    v_cndmask_b32 v34, v36, v32, s[54:55]
    v_cndmask_b32 v35, v36, v33, s[54:55]
    v_cvt_pk_bf16_f32 v152, v128, v129
    v_cvt_pk_bf16_f32 v153, v130, v131
    v_cvt_pk_bf16_f32 v154, v132, v133
    v_cvt_pk_bf16_f32 v155, v134, v135
    v_cvt_pk_bf16_f32 v156, v136, v137
    v_cvt_pk_bf16_f32 v157, v138, v139
    v_cvt_pk_bf16_f32 v158, v140, v141
    v_cvt_pk_bf16_f32 v159, v142, v143
    v_cvt_pk_bf16_f32 v160, v144, v145
    v_cvt_pk_bf16_f32 v161, v146, v147
    v_cvt_pk_bf16_f32 v162, v148, v149
    v_cvt_pk_bf16_f32 v163, v150, v151
    ds_write_b64 v32, v[152:153] offset:0
    ds_write_b64 v32, v[156:157] offset:16640
    ds_write_b64 v33, v[154:155] offset:0
    ds_write_b64 v33, v[156:157] offset:16640
    ds_write_b64 v34, v[158:159] offset:32
    ds_write_b64 v34, v[162:163] offset:16672
    ds_write_b64 v35, v[160:161] offset:32
    ds_write_b64 v35, v[162:163] offset:16672
    v_mul_u32_u24 v3, 208, v1
    v_lshl_add_u32 v3, v2, 3, v3
    s_lshr_b32 s30, s3, 1
    s_mul_i32 s31, s30, 16640
    v_add_u32 v3, s31, v3
    s_lshl_b32 s31, s40, 1
    s_add_u32 s30, s30, s31
    s_mul_i32 s45, s30, 9216
    s_add_u32 s45, s45, 8175616
    s_waitcnt lgkmcnt(0)
    s_barrier
    ds_read_b64 v[40:41], v3 offset:0
    ds_read_b64 v[42:43], v3 offset:32
    ds_read_b64 v[44:45], v3 offset:3328
    ds_read_b64 v[46:47], v3 offset:3360
    ds_read_b64 v[48:49], v3 offset:3392
    ds_read_b64 v[50:51], v3 offset:3424
    ds_read_b64 v[52:53], v3 offset:6656
    ds_read_b64 v[54:55], v3 offset:6688
    ds_read_b64 v[56:57], v3 offset:6720
    ds_read_b64 v[58:59], v3 offset:6752
    ds_read_b64 v[60:61], v3 offset:10048
    ds_read_b64 v[62:63], v3 offset:10080
    ds_read_b64 v[64:65], v3 offset:10112
    ds_read_b64 v[66:67], v3 offset:10144
    ds_read_b64 v[68:69], v3 offset:13376
    ds_read_b64 v[70:71], v3 offset:13408
    ds_read_b64 v[72:73], v3 offset:13440
    ds_read_b64 v[74:75], v3 offset:13472
    s_waitcnt lgkmcnt(0)
    buffer_store_dwordx4 v[40:43], v10, s[8:11], s45 offen offset:0 sc1
    buffer_store_dwordx4 v[44:47], v10, s[8:11], s45 offen offset:1024 sc1
    buffer_store_dwordx4 v[48:51], v10, s[8:11], s45 offen offset:2048 sc1
    buffer_store_dwordx4 v[52:55], v10, s[8:11], s45 offen offset:3072 sc1
    s_add_u32 s45, s45, 4096
    buffer_store_dwordx4 v[56:59], v10, s[8:11], s45 offen offset:0 sc1
    buffer_store_dwordx4 v[60:63], v10, s[8:11], s45 offen offset:1024 sc1
    buffer_store_dwordx4 v[64:67], v10, s[8:11], s45 offen offset:2048 sc1
    buffer_store_dwordx4 v[68:71], v10, s[8:11], s45 offen offset:3072 sc1
    s_add_u32 s45, s45, 4096
    buffer_store_dwordx4 v[72:75], v10, s[8:11], s45 offen offset:0 sc1
    s_barrier
    s_lshr_b32 s41, s40, 2
    s_and_b32 s42, s40, 3
    s_cmp_eq_u32 s41, 0
    s_cselect_b32 s12, s66, s68
    s_cselect_b32 s13, s67, s69
    s_mov_b32 s14, 819200
    s_cselect_b32 s14, 2457600, s14
    s_mov_b32 s15, 0x20000
    s_movk_i32 s44, 1280
    s_cselect_b32 s44, 3840, s44
    s_cselect_b32 s46, 3, 2
    s_movk_i32 s47, 5120
    s_cselect_b32 s47, 1280, s47
    s_mul_i32 s32, s3, 40960
    s_mul_i32 s43, s42, 160
    s_mul_i32 s43, s43, s44
    s_lshl_b32 s48, s44, 5
    v_add_u32 v1, 0, v0
    v_mul_u32_u24 v2, 3277, v1
    v_lshrrev_b32 v2, 16, v2
    v_mul_u32_u24 v3, 20, v2
    v_sub_u32 v3, v1, v3
    v_mul_lo_u32 v2, s44, v2
    v_lshl_add_u32 v2, v3, 4, v2
    s_mul_i32 s30, s3, 320
    v_add_u32 v20, s30, v2
    v_add_u32 v1, 64, v0
    v_mul_u32_u24 v2, 3277, v1
    v_lshrrev_b32 v2, 16, v2
    v_mul_u32_u24 v3, 20, v2
    v_sub_u32 v3, v1, v3
    v_mul_lo_u32 v2, s44, v2
    v_lshl_add_u32 v2, v3, 4, v2
    s_mul_i32 s30, s3, 320
    v_add_u32 v21, s30, v2
    v_add_u32 v1, 128, v0
    v_mul_u32_u24 v2, 3277, v1
    v_lshrrev_b32 v2, 16, v2
    v_mul_u32_u24 v3, 20, v2
    v_sub_u32 v3, v1, v3
    v_mul_lo_u32 v2, s44, v2
    v_lshl_add_u32 v2, v3, 4, v2
    s_mul_i32 s30, s3, 320
    v_add_u32 v22, s30, v2
    v_add_u32 v1, 192, v0
    v_mul_u32_u24 v2, 3277, v1
    v_lshrrev_b32 v2, 16, v2
    v_mul_u32_u24 v3, 20, v2
    v_sub_u32 v3, v1, v3
    v_mul_lo_u32 v2, s44, v2
    v_lshl_add_u32 v2, v3, 4, v2
    s_mul_i32 s30, s3, 320
    v_add_u32 v23, s30, v2
    v_add_u32 v1, 256, v0
    v_mul_u32_u24 v2, 3277, v1
    v_lshrrev_b32 v2, 16, v2
    v_mul_u32_u24 v3, 20, v2
    v_sub_u32 v3, v1, v3
    v_mul_lo_u32 v2, s44, v2
    v_lshl_add_u32 v2, v3, 4, v2
    s_mul_i32 s30, s3, 320
    v_add_u32 v24, s30, v2
    v_add_u32 v1, 320, v0
    v_mul_u32_u24 v2, 3277, v1
    v_lshrrev_b32 v2, 16, v2
    v_mul_u32_u24 v3, 20, v2
    v_sub_u32 v3, v1, v3
    v_mul_lo_u32 v2, s44, v2
    v_lshl_add_u32 v2, v3, 4, v2
    s_mul_i32 s30, s3, 320
    v_add_u32 v25, s30, v2
    v_add_u32 v1, 384, v0
    v_mul_u32_u24 v2, 3277, v1
    v_lshrrev_b32 v2, 16, v2
    v_mul_u32_u24 v3, 20, v2
    v_sub_u32 v3, v1, v3
    v_mul_lo_u32 v2, s44, v2
    v_lshl_add_u32 v2, v3, 4, v2
    s_mul_i32 s30, s3, 320
    v_add_u32 v26, s30, v2
    v_add_u32 v1, 448, v0
    v_mul_u32_u24 v2, 3277, v1
    v_lshrrev_b32 v2, 16, v2
    v_mul_u32_u24 v3, 20, v2
    v_sub_u32 v3, v1, v3
    v_mul_lo_u32 v2, s44, v2
    v_lshl_add_u32 v2, v3, 4, v2
    s_mul_i32 s30, s3, 320
    v_add_u32 v27, s30, v2
    v_add_u32 v1, 512, v0
    v_mul_u32_u24 v2, 3277, v1
    v_lshrrev_b32 v2, 16, v2
    v_mul_u32_u24 v3, 20, v2
    v_sub_u32 v3, v1, v3
    v_mul_lo_u32 v2, s44, v2
    v_lshl_add_u32 v2, v3, 4, v2
    s_mul_i32 s30, s3, 320
    v_add_u32 v28, s30, v2
    v_add_u32 v1, 576, v0
    v_mul_u32_u24 v2, 3277, v1
    v_lshrrev_b32 v2, 16, v2
    v_mul_u32_u24 v3, 20, v2
    v_sub_u32 v3, v1, v3
    v_mul_lo_u32 v2, s44, v2
    v_lshl_add_u32 v2, v3, 4, v2
    s_mul_i32 s30, s3, 320
    v_add_u32 v29, s30, v2
    v_lshrrev_b32 v1, 4, v0
    v_lshlrev_b32 v1, s46, v1
    v_bfe_u32 v2, v0, 2, 2
    v_add_u32 v1, v1, v2
    v_mul_u32_u24 v1, 320, v1
    v_and_b32 v2, 3, v0
    v_lshl_add_u32 v1, v2, 3, v1
    v_add_u32 v30, s32, v1
    v_add_u32 v31, s47, v30
    s_lshl_b32 s45, s41, 2
    s_add_u32 s45, s45, s3
    s_lshl_b32 s45, s45, 22
    s_mul_i32 s30, s42, 51200
    s_add_u32 s45, s45, s30
    s_add_u32 s45, s45, 12369920
    s_mov_b32 s33, s43
    s_add_u32 s43, s43, s48
    s_add_u32 m0, s32, 0
    s_nop 0
    buffer_load_dwordx4 v20, s[12:15], s33 offen lds
    s_add_u32 m0, s32, 1024
    s_nop 0
    buffer_load_dwordx4 v21, s[12:15], s33 offen lds
    s_add_u32 m0, s32, 2048
    s_nop 0
    buffer_load_dwordx4 v22, s[12:15], s33 offen lds
    s_add_u32 m0, s32, 3072
    s_nop 0
    buffer_load_dwordx4 v23, s[12:15], s33 offen lds
    s_add_u32 m0, s32, 4096
    s_nop 0
    buffer_load_dwordx4 v24, s[12:15], s33 offen lds
    s_add_u32 m0, s32, 5120
    s_nop 0
    buffer_load_dwordx4 v25, s[12:15], s33 offen lds
    s_add_u32 m0, s32, 6144
    s_nop 0
    buffer_load_dwordx4 v26, s[12:15], s33 offen lds
    s_add_u32 m0, s32, 7168
    s_nop 0
    buffer_load_dwordx4 v27, s[12:15], s33 offen lds
    s_add_u32 m0, s32, 8192
    s_nop 0
    buffer_load_dwordx4 v28, s[12:15], s33 offen lds
    s_add_u32 m0, s32, 9216
    s_nop 0
    buffer_load_dwordx4 v29, s[12:15], s33 offen lds
    s_mov_b32 s33, s43
    s_add_u32 s43, s43, s48
    s_add_u32 m0, s32, 10240
    s_nop 0
    buffer_load_dwordx4 v20, s[12:15], s33 offen lds
    s_add_u32 m0, s32, 11264
    s_nop 0
    buffer_load_dwordx4 v21, s[12:15], s33 offen lds
    s_add_u32 m0, s32, 12288
    s_nop 0
    buffer_load_dwordx4 v22, s[12:15], s33 offen lds
    s_add_u32 m0, s32, 13312
    s_nop 0
    buffer_load_dwordx4 v23, s[12:15], s33 offen lds
    s_add_u32 m0, s32, 14336
    s_nop 0
    buffer_load_dwordx4 v24, s[12:15], s33 offen lds
    s_add_u32 m0, s32, 15360
    s_nop 0
    buffer_load_dwordx4 v25, s[12:15], s33 offen lds
    s_add_u32 m0, s32, 16384
    s_nop 0
    buffer_load_dwordx4 v26, s[12:15], s33 offen lds
    s_add_u32 m0, s32, 17408
    s_nop 0
    buffer_load_dwordx4 v27, s[12:15], s33 offen lds
    s_add_u32 m0, s32, 18432
    s_nop 0
    buffer_load_dwordx4 v28, s[12:15], s33 offen lds
    s_add_u32 m0, s32, 19456
    s_nop 0
    buffer_load_dwordx4 v29, s[12:15], s33 offen lds
    s_mov_b32 s33, s43
    s_add_u32 s43, s43, s48
    s_add_u32 m0, s32, 20480
    s_nop 0
    buffer_load_dwordx4 v20, s[12:15], s33 offen lds
    s_add_u32 m0, s32, 21504
    s_nop 0
    buffer_load_dwordx4 v21, s[12:15], s33 offen lds
    s_add_u32 m0, s32, 22528
    s_nop 0
    buffer_load_dwordx4 v22, s[12:15], s33 offen lds
    s_add_u32 m0, s32, 23552
    s_nop 0
    buffer_load_dwordx4 v23, s[12:15], s33 offen lds
    s_add_u32 m0, s32, 24576
    s_nop 0
    buffer_load_dwordx4 v24, s[12:15], s33 offen lds
    s_add_u32 m0, s32, 25600
    s_nop 0
    buffer_load_dwordx4 v25, s[12:15], s33 offen lds
    s_add_u32 m0, s32, 26624
    s_nop 0
    buffer_load_dwordx4 v26, s[12:15], s33 offen lds
    s_add_u32 m0, s32, 27648
    s_nop 0
    buffer_load_dwordx4 v27, s[12:15], s33 offen lds
    s_add_u32 m0, s32, 28672
    s_nop 0
    buffer_load_dwordx4 v28, s[12:15], s33 offen lds
    s_add_u32 m0, s32, 29696
    s_nop 0
    buffer_load_dwordx4 v29, s[12:15], s33 offen lds
    s_mov_b32 s33, s43
    s_add_u32 s43, s43, s48
    s_add_u32 m0, s32, 30720
    s_nop 0
    buffer_load_dwordx4 v20, s[12:15], s33 offen lds
    s_add_u32 m0, s32, 31744
    s_nop 0
    buffer_load_dwordx4 v21, s[12:15], s33 offen lds
    s_add_u32 m0, s32, 32768
    s_nop 0
    buffer_load_dwordx4 v22, s[12:15], s33 offen lds
    s_add_u32 m0, s32, 33792
    s_nop 0
    buffer_load_dwordx4 v23, s[12:15], s33 offen lds
    s_add_u32 m0, s32, 34816
    s_nop 0
    buffer_load_dwordx4 v24, s[12:15], s33 offen lds
    s_add_u32 m0, s32, 35840
    s_nop 0
    buffer_load_dwordx4 v25, s[12:15], s33 offen lds
    s_add_u32 m0, s32, 36864
    s_nop 0
    buffer_load_dwordx4 v26, s[12:15], s33 offen lds
    s_add_u32 m0, s32, 37888
    s_nop 0
    buffer_load_dwordx4 v27, s[12:15], s33 offen lds
    s_add_u32 m0, s32, 38912
    s_nop 0
    buffer_load_dwordx4 v28, s[12:15], s33 offen lds
    s_add_u32 m0, s32, 39936
    s_nop 0
    buffer_load_dwordx4 v29, s[12:15], s33 offen lds
    s_waitcnt vmcnt(0)
    ds_read_b64_tr_b16 v[40:41], v30 offset:0
    ds_read_b64_tr_b16 v[42:43], v31 offset:0
    ds_read_b64_tr_b16 v[44:45], v30 offset:32
    ds_read_b64_tr_b16 v[46:47], v31 offset:32
    ds_read_b64_tr_b16 v[48:49], v30 offset:64
    ds_read_b64_tr_b16 v[50:51], v31 offset:64
    ds_read_b64_tr_b16 v[52:53], v30 offset:96
    ds_read_b64_tr_b16 v[54:55], v31 offset:96
    ds_read_b64_tr_b16 v[56:57], v30 offset:128
    ds_read_b64_tr_b16 v[58:59], v31 offset:128
    ds_read_b64_tr_b16 v[60:61], v30 offset:160
    ds_read_b64_tr_b16 v[62:63], v31 offset:160
    ds_read_b64_tr_b16 v[64:65], v30 offset:192
    ds_read_b64_tr_b16 v[66:67], v31 offset:192
    ds_read_b64_tr_b16 v[68:69], v30 offset:224
    ds_read_b64_tr_b16 v[70:71], v31 offset:224
    ds_read_b64_tr_b16 v[72:73], v30 offset:256
    ds_read_b64_tr_b16 v[74:75], v31 offset:256
    ds_read_b64_tr_b16 v[76:77], v30 offset:288
    ds_read_b64_tr_b16 v[78:79], v31 offset:288
    s_waitcnt lgkmcnt(0)
    buffer_store_dwordx4 v[40:43], v10, s[8:11], s45 offen offset:0 sc1
    buffer_store_dwordx4 v[44:47], v10, s[8:11], s45 offen offset:1024 sc1
    buffer_store_dwordx4 v[48:51], v10, s[8:11], s45 offen offset:2048 sc1
    buffer_store_dwordx4 v[52:55], v10, s[8:11], s45 offen offset:3072 sc1
    s_add_u32 s45, s45, 4096
    buffer_store_dwordx4 v[56:59], v10, s[8:11], s45 offen offset:0 sc1
    buffer_store_dwordx4 v[60:63], v10, s[8:11], s45 offen offset:1024 sc1
    buffer_store_dwordx4 v[64:67], v10, s[8:11], s45 offen offset:2048 sc1
    buffer_store_dwordx4 v[68:71], v10, s[8:11], s45 offen offset:3072 sc1
    s_add_u32 s45, s45, 4096
    buffer_store_dwordx4 v[72:75], v10, s[8:11], s45 offen offset:0 sc1
    buffer_store_dwordx4 v[76:79], v10, s[8:11], s45 offen offset:1024 sc1
    s_add_u32 s45, s45, 2048
    s_mov_b32 s33, s43
    s_add_u32 s43, s43, s48
    s_add_u32 m0, s32, 0
    s_nop 0
    buffer_load_dwordx4 v20, s[12:15], s33 offen lds
    s_add_u32 m0, s32, 1024
    s_nop 0
    buffer_load_dwordx4 v21, s[12:15], s33 offen lds
    s_add_u32 m0, s32, 2048
    s_nop 0
    buffer_load_dwordx4 v22, s[12:15], s33 offen lds
    s_add_u32 m0, s32, 3072
    s_nop 0
    buffer_load_dwordx4 v23, s[12:15], s33 offen lds
    s_add_u32 m0, s32, 4096
    s_nop 0
    buffer_load_dwordx4 v24, s[12:15], s33 offen lds
    s_add_u32 m0, s32, 5120
    s_nop 0
    buffer_load_dwordx4 v25, s[12:15], s33 offen lds
    s_add_u32 m0, s32, 6144
    s_nop 0
    buffer_load_dwordx4 v26, s[12:15], s33 offen lds
    s_add_u32 m0, s32, 7168
    s_nop 0
    buffer_load_dwordx4 v27, s[12:15], s33 offen lds
    s_add_u32 m0, s32, 8192
    s_nop 0
    buffer_load_dwordx4 v28, s[12:15], s33 offen lds
    s_add_u32 m0, s32, 9216
    s_nop 0
    buffer_load_dwordx4 v29, s[12:15], s33 offen lds
    s_waitcnt vmcnt(0)
    ds_read_b64_tr_b16 v[40:41], v30 offset:10240
    ds_read_b64_tr_b16 v[42:43], v31 offset:10240
    ds_read_b64_tr_b16 v[44:45], v30 offset:10272
    ds_read_b64_tr_b16 v[46:47], v31 offset:10272
    ds_read_b64_tr_b16 v[48:49], v30 offset:10304
    ds_read_b64_tr_b16 v[50:51], v31 offset:10304
    ds_read_b64_tr_b16 v[52:53], v30 offset:10336
    ds_read_b64_tr_b16 v[54:55], v31 offset:10336
    ds_read_b64_tr_b16 v[56:57], v30 offset:10368
    ds_read_b64_tr_b16 v[58:59], v31 offset:10368
    ds_read_b64_tr_b16 v[60:61], v30 offset:10400
    ds_read_b64_tr_b16 v[62:63], v31 offset:10400
    ds_read_b64_tr_b16 v[64:65], v30 offset:10432
    ds_read_b64_tr_b16 v[66:67], v31 offset:10432
    ds_read_b64_tr_b16 v[68:69], v30 offset:10464
    ds_read_b64_tr_b16 v[70:71], v31 offset:10464
    ds_read_b64_tr_b16 v[72:73], v30 offset:10496
    ds_read_b64_tr_b16 v[74:75], v31 offset:10496
    ds_read_b64_tr_b16 v[76:77], v30 offset:10528
    ds_read_b64_tr_b16 v[78:79], v31 offset:10528
    s_waitcnt lgkmcnt(0)
    buffer_store_dwordx4 v[40:43], v10, s[8:11], s45 offen offset:0 sc1
    buffer_store_dwordx4 v[44:47], v10, s[8:11], s45 offen offset:1024 sc1
    buffer_store_dwordx4 v[48:51], v10, s[8:11], s45 offen offset:2048 sc1
    buffer_store_dwordx4 v[52:55], v10, s[8:11], s45 offen offset:3072 sc1
    s_add_u32 s45, s45, 4096
    buffer_store_dwordx4 v[56:59], v10, s[8:11], s45 offen offset:0 sc1
    buffer_store_dwordx4 v[60:63], v10, s[8:11], s45 offen offset:1024 sc1
    buffer_store_dwordx4 v[64:67], v10, s[8:11], s45 offen offset:2048 sc1
    buffer_store_dwordx4 v[68:71], v10, s[8:11], s45 offen offset:3072 sc1
    s_add_u32 s45, s45, 4096
    buffer_store_dwordx4 v[72:75], v10, s[8:11], s45 offen offset:0 sc1
    buffer_store_dwordx4 v[76:79], v10, s[8:11], s45 offen offset:1024 sc1
    s_add_u32 s45, s45, 2048
    s_waitcnt vmcnt(0)
    ds_read_b64_tr_b16 v[40:41], v30 offset:20480
    ds_read_b64_tr_b16 v[42:43], v31 offset:20480
    ds_read_b64_tr_b16 v[44:45], v30 offset:20512
    ds_read_b64_tr_b16 v[46:47], v31 offset:20512
    ds_read_b64_tr_b16 v[48:49], v30 offset:20544
    ds_read_b64_tr_b16 v[50:51], v31 offset:20544
    ds_read_b64_tr_b16 v[52:53], v30 offset:20576
    ds_read_b64_tr_b16 v[54:55], v31 offset:20576
    ds_read_b64_tr_b16 v[56:57], v30 offset:20608
    ds_read_b64_tr_b16 v[58:59], v31 offset:20608
    ds_read_b64_tr_b16 v[60:61], v30 offset:20640
    ds_read_b64_tr_b16 v[62:63], v31 offset:20640
    ds_read_b64_tr_b16 v[64:65], v30 offset:20672
    ds_read_b64_tr_b16 v[66:67], v31 offset:20672
    ds_read_b64_tr_b16 v[68:69], v30 offset:20704
    ds_read_b64_tr_b16 v[70:71], v31 offset:20704
    ds_read_b64_tr_b16 v[72:73], v30 offset:20736
    ds_read_b64_tr_b16 v[74:75], v31 offset:20736
    ds_read_b64_tr_b16 v[76:77], v30 offset:20768
    ds_read_b64_tr_b16 v[78:79], v31 offset:20768
    s_waitcnt lgkmcnt(0)
    buffer_store_dwordx4 v[40:43], v10, s[8:11], s45 offen offset:0 sc1
    buffer_store_dwordx4 v[44:47], v10, s[8:11], s45 offen offset:1024 sc1
    buffer_store_dwordx4 v[48:51], v10, s[8:11], s45 offen offset:2048 sc1
    buffer_store_dwordx4 v[52:55], v10, s[8:11], s45 offen offset:3072 sc1
    s_add_u32 s45, s45, 4096
    buffer_store_dwordx4 v[56:59], v10, s[8:11], s45 offen offset:0 sc1
    buffer_store_dwordx4 v[60:63], v10, s[8:11], s45 offen offset:1024 sc1
    buffer_store_dwordx4 v[64:67], v10, s[8:11], s45 offen offset:2048 sc1
    buffer_store_dwordx4 v[68:71], v10, s[8:11], s45 offen offset:3072 sc1
    s_add_u32 s45, s45, 4096
    buffer_store_dwordx4 v[72:75], v10, s[8:11], s45 offen offset:0 sc1
    buffer_store_dwordx4 v[76:79], v10, s[8:11], s45 offen offset:1024 sc1
    s_add_u32 s45, s45, 2048
    s_waitcnt vmcnt(0)
    ds_read_b64_tr_b16 v[40:41], v30 offset:30720
    ds_read_b64_tr_b16 v[42:43], v31 offset:30720
    ds_read_b64_tr_b16 v[44:45], v30 offset:30752
    ds_read_b64_tr_b16 v[46:47], v31 offset:30752
    ds_read_b64_tr_b16 v[48:49], v30 offset:30784
    ds_read_b64_tr_b16 v[50:51], v31 offset:30784
    ds_read_b64_tr_b16 v[52:53], v30 offset:30816
    ds_read_b64_tr_b16 v[54:55], v31 offset:30816
    ds_read_b64_tr_b16 v[56:57], v30 offset:30848
    ds_read_b64_tr_b16 v[58:59], v31 offset:30848
    ds_read_b64_tr_b16 v[60:61], v30 offset:30880
    ds_read_b64_tr_b16 v[62:63], v31 offset:30880
    ds_read_b64_tr_b16 v[64:65], v30 offset:30912
    ds_read_b64_tr_b16 v[66:67], v31 offset:30912
    ds_read_b64_tr_b16 v[68:69], v30 offset:30944
    ds_read_b64_tr_b16 v[70:71], v31 offset:30944
    ds_read_b64_tr_b16 v[72:73], v30 offset:30976
    ds_read_b64_tr_b16 v[74:75], v31 offset:30976
    ds_read_b64_tr_b16 v[76:77], v30 offset:31008
    ds_read_b64_tr_b16 v[78:79], v31 offset:31008
    s_waitcnt lgkmcnt(0)
    buffer_store_dwordx4 v[40:43], v10, s[8:11], s45 offen offset:0 sc1
    buffer_store_dwordx4 v[44:47], v10, s[8:11], s45 offen offset:1024 sc1
    buffer_store_dwordx4 v[48:51], v10, s[8:11], s45 offen offset:2048 sc1
    buffer_store_dwordx4 v[52:55], v10, s[8:11], s45 offen offset:3072 sc1
    s_add_u32 s45, s45, 4096
    buffer_store_dwordx4 v[56:59], v10, s[8:11], s45 offen offset:0 sc1
    buffer_store_dwordx4 v[60:63], v10, s[8:11], s45 offen offset:1024 sc1
    buffer_store_dwordx4 v[64:67], v10, s[8:11], s45 offen offset:2048 sc1
    buffer_store_dwordx4 v[68:71], v10, s[8:11], s45 offen offset:3072 sc1
    s_add_u32 s45, s45, 4096
    buffer_store_dwordx4 v[72:75], v10, s[8:11], s45 offen offset:0 sc1
    buffer_store_dwordx4 v[76:79], v10, s[8:11], s45 offen offset:1024 sc1
    s_add_u32 s45, s45, 2048
    s_waitcnt vmcnt(0)
    ds_read_b64_tr_b16 v[40:41], v30 offset:0
    ds_read_b64_tr_b16 v[42:43], v31 offset:0
    ds_read_b64_tr_b16 v[44:45], v30 offset:32
    ds_read_b64_tr_b16 v[46:47], v31 offset:32
    ds_read_b64_tr_b16 v[48:49], v30 offset:64
    ds_read_b64_tr_b16 v[50:51], v31 offset:64
    ds_read_b64_tr_b16 v[52:53], v30 offset:96
    ds_read_b64_tr_b16 v[54:55], v31 offset:96
    ds_read_b64_tr_b16 v[56:57], v30 offset:128
    ds_read_b64_tr_b16 v[58:59], v31 offset:128
    ds_read_b64_tr_b16 v[60:61], v30 offset:160
    ds_read_b64_tr_b16 v[62:63], v31 offset:160
    ds_read_b64_tr_b16 v[64:65], v30 offset:192
    ds_read_b64_tr_b16 v[66:67], v31 offset:192
    ds_read_b64_tr_b16 v[68:69], v30 offset:224
    ds_read_b64_tr_b16 v[70:71], v31 offset:224
    ds_read_b64_tr_b16 v[72:73], v30 offset:256
    ds_read_b64_tr_b16 v[74:75], v31 offset:256
    ds_read_b64_tr_b16 v[76:77], v30 offset:288
    ds_read_b64_tr_b16 v[78:79], v31 offset:288
    s_waitcnt lgkmcnt(0)
    buffer_store_dwordx4 v[40:43], v10, s[8:11], s45 offen offset:0 sc1
    buffer_store_dwordx4 v[44:47], v10, s[8:11], s45 offen offset:1024 sc1
    buffer_store_dwordx4 v[48:51], v10, s[8:11], s45 offen offset:2048 sc1
    buffer_store_dwordx4 v[52:55], v10, s[8:11], s45 offen offset:3072 sc1
    s_add_u32 s45, s45, 4096
    buffer_store_dwordx4 v[56:59], v10, s[8:11], s45 offen offset:0 sc1
    buffer_store_dwordx4 v[60:63], v10, s[8:11], s45 offen offset:1024 sc1
    buffer_store_dwordx4 v[64:67], v10, s[8:11], s45 offen offset:2048 sc1
    buffer_store_dwordx4 v[68:71], v10, s[8:11], s45 offen offset:3072 sc1
    s_add_u32 s45, s45, 4096
    buffer_store_dwordx4 v[72:75], v10, s[8:11], s45 offen offset:0 sc1
    buffer_store_dwordx4 v[76:79], v10, s[8:11], s45 offen offset:1024 sc1
    s_add_u32 s45, s45, 2048
    s_add_u32 s30, s40, 31488
    s_lshl_b32 s30, s30, 7
    s_lshl_b32 s31, s3, 3
    s_add_u32 s30, s30, s31
    v_mov_b32 v12, s30
    v_mov_b32 v1, 2130706432
    v_cmp_eq_u32 vcc, 0, v0
    s_nop 1
    v_cndmask_b32 v12, v1, v12, vcc
    v_mov_b32 v15, s4
    s_waitcnt vmcnt(0)
    v_mov_b32 v14, 1
    buffer_store_dwordx2 v[14:15], v12, s[8:11], 0 offen sc1
    s_endpgm
L_a3:
    s_lshl_b32 s42, s41, 5
    s_add_u32 s42, s42, s40
    s_mov_b32 s60, 1069066811
    s_mov_b32 s61, 897988541
    s_barrier
    s_mul_i32 s44, s42, 40960
    s_mov_b32 s12, s84
    s_mov_b32 s13, s85
    s_mov_b32 s14, 1280
    s_mov_b32 s15, 0x20000
    s_mov_b32 s16, s86
    s_mov_b32 s17, s87
    s_mov_b32 s18, 2621440
    s_mov_b32 s19, 0x20000
    s_add_u32 m0, s34, 0
    s_nop 0
    buffer_load_dwordx4 v8, s[20:23], s44 offen offset:0 lds
    s_add_u32 m0, s34, 3968
    s_nop 0
    buffer_load_dwordx4 v8, s[20:23], s44 offen offset:128 lds
    s_add_u32 m0, s34, 7936
    s_nop 0
    buffer_load_dwordx4 v8, s[20:23], s44 offen offset:256 lds
    s_add_u32 m0, s34, 11904
    s_nop 0
    buffer_load_dwordx4 v8, s[20:23], s44 offen offset:384 lds
    s_add_u32 m0, s34, 15872
    s_nop 0
    buffer_load_dwordx4 v8, s[20:23], s44 offen offset:512 lds
    s_add_u32 m0, s34, 19840
    s_nop 0
    buffer_load_dwordx4 v8, s[20:23], s44 offen offset:640 lds
    s_add_u32 m0, s34, 23808
    s_nop 0
    buffer_load_dwordx4 v8, s[20:23], s44 offen offset:768 lds
    s_add_u32 m0, s34, 27776
    s_nop 0
    buffer_load_dwordx4 v8, s[20:23], s44 offen offset:896 lds
    s_add_u32 m0, s34, 31744
    s_nop 0
    buffer_load_dwordx4 v8, s[20:23], s44 offen offset:1024 lds
    s_add_u32 m0, s34, 35712
    s_nop 0
    buffer_load_dwordx4 v8, s[20:23], s44 offen offset:1152 lds
    v_lshlrev_b32 v4, 4, v0
    v_add_u32 v5, 4096, v4
    v_add_u32 v6, 8192, v4
    v_lshrrev_b32 v7, 4, v0
    v_lshlrev_b32 v7, 4, v7
    v_and_b32 v1, 7, v0
    v_bfe_u32 v2, v0, 3, 2
    v_lshlrev_b32 v1, 7, v1
    v_lshl_add_u32 v9, v2, 3, v1
    v_add_u32 v9, 4030464, v9
    s_lshl_b32 s45, s3, 22
    s_add_u32 s45, s45, 12369920
L_fw_76:
    buffer_load_dwordx2 v[12:13], v9, s[8:11], 0 offen sc1
    s_add_u32 s7, s7, 1
    s_bitcmp1_b32 s7, 22
    s_cbranch_scc1 L_abort
    s_waitcnt vmcnt(0)
    v_cmp_ne_u32 vcc, s4, v13
    v_cmp_gt_u32 s[28:29], 1, v12
    s_or_b64 vcc, vcc, s[28:29]
    s_cbranch_scc1 L_fw_76
L_fe_77:
    s_barrier
    buffer_load_dwordx4 a[0:3], v4, s[8:11], s45 offen offset:0 sc1
    buffer_load_dwordx4 a[4:7], v4, s[8:11], s45 offen offset:1024 sc1
    buffer_load_dwordx4 a[8:11], v4, s[8:11], s45 offen offset:2048 sc1
    buffer_load_dwordx4 a[12:15], v4, s[8:11], s45 offen offset:3072 sc1
    buffer_load_dwordx4 a[16:19], v5, s[8:11], s45 offen offset:0 sc1
    buffer_load_dwordx4 a[20:23], v5, s[8:11], s45 offen offset:1024 sc1
    buffer_load_dwordx4 a[24:27], v5, s[8:11], s45 offen offset:2048 sc1
    buffer_load_dwordx4 a[28:31], v5, s[8:11], s45 offen offset:3072 sc1
    buffer_load_dwordx4 a[32:35], v6, s[8:11], s45 offen offset:0 sc1
    buffer_load_dwordx4 a[36:39], v6, s[8:11], s45 offen offset:1024 sc1
    buffer_load_dwordx4 a[40:43], v7, s[12:15], 0 offen offset:0
    s_add_u32 s45, s45, 10240
    buffer_load_dwordx4 a[44:47], v4, s[8:11], s45 offen offset:0 sc1
    buffer_load_dwordx4 a[48:51], v4, s[8:11], s45 offen offset:1024 sc1
    buffer_load_dwordx4 a[52:55], v4, s[8:11], s45 offen offset:2048 sc1
    buffer_load_dwordx4 a[56:59], v4, s[8:11], s45 offen offset:3072 sc1
    buffer_load_dwordx4 a[60:63], v5, s[8:11], s45 offen offset:0 sc1
    buffer_load_dwordx4 a[64:67], v5, s[8:11], s45 offen offset:1024 sc1
    buffer_load_dwordx4 a[68:71], v5, s[8:11], s45 offen offset:2048 sc1
    buffer_load_dwordx4 a[72:75], v5, s[8:11], s45 offen offset:3072 sc1
    buffer_load_dwordx4 a[76:79], v6, s[8:11], s45 offen offset:0 sc1
    buffer_load_dwordx4 a[80:83], v6, s[8:11], s45 offen offset:1024 sc1
    buffer_load_dwordx4 a[84:87], v7, s[12:15], 0 offen offset:64
    s_add_u32 s45, s45, 10240
    buffer_load_dwordx4 a[88:91], v4, s[8:11], s45 offen offset:0 sc1
    buffer_load_dwordx4 a[92:95], v4, s[8:11], s45 offen offset:1024 sc1
    buffer_load_dwordx4 a[96:99], v4, s[8:11], s45 offen offset:2048 sc1
    buffer_load_dwordx4 a[100:103], v4, s[8:11], s45 offen offset:3072 sc1
    buffer_load_dwordx4 a[104:107], v5, s[8:11], s45 offen offset:0 sc1
    buffer_load_dwordx4 a[108:111], v5, s[8:11], s45 offen offset:1024 sc1
    buffer_load_dwordx4 a[112:115], v5, s[8:11], s45 offen offset:2048 sc1
    buffer_load_dwordx4 a[116:119], v5, s[8:11], s45 offen offset:3072 sc1
    buffer_load_dwordx4 a[120:123], v6, s[8:11], s45 offen offset:0 sc1
    buffer_load_dwordx4 a[124:127], v6, s[8:11], s45 offen offset:1024 sc1
    buffer_load_dwordx4 a[128:131], v7, s[12:15], 0 offen offset:128
    s_add_u32 s45, s45, 10240
    buffer_load_dwordx4 a[132:135], v4, s[8:11], s45 offen offset:0 sc1
    buffer_load_dwordx4 a[136:139], v4, s[8:11], s45 offen offset:1024 sc1
    buffer_load_dwordx4 a[140:143], v4, s[8:11], s45 offen offset:2048 sc1
    buffer_load_dwordx4 a[144:147], v4, s[8:11], s45 offen offset:3072 sc1
    buffer_load_dwordx4 a[148:151], v5, s[8:11], s45 offen offset:0 sc1
    buffer_load_dwordx4 a[152:155], v5, s[8:11], s45 offen offset:1024 sc1
    buffer_load_dwordx4 a[156:159], v5, s[8:11], s45 offen offset:2048 sc1
    buffer_load_dwordx4 a[160:163], v5, s[8:11], s45 offen offset:3072 sc1
    buffer_load_dwordx4 a[164:167], v6, s[8:11], s45 offen offset:0 sc1
    buffer_load_dwordx4 a[168:171], v6, s[8:11], s45 offen offset:1024 sc1
    buffer_load_dwordx4 a[172:175], v7, s[12:15], 0 offen offset:192
    s_add_u32 s45, s45, 10240
    ds_read_b128 v[120:123], v16 offset:0
    ds_read_b128 v[124:127], v16 offset:2048
    ds_read_b128 v[128:131], v17 offset:0
    ds_read_b128 v[132:135], v17 offset:2048
    s_waitcnt vmcnt(33)
    s_waitcnt lgkmcnt(2)
    v_mfma_f32_16x16x32_bf16 v[32:35], a[0:3], v[120:123], 0
    v_mfma_f32_16x16x32_bf16 v[36:39], a[0:3], v[124:127], 0
    buffer_load_dwordx4 a[176:179], v4, s[8:11], s45 offen offset:0 sc1
    v_mfma_f32_16x16x32_bf16 v[40:43], a[4:7], v[120:123], 0
    v_mfma_f32_16x16x32_bf16 v[44:47], a[4:7], v[124:127], 0
    buffer_load_dwordx4 a[180:183], v4, s[8:11], s45 offen offset:1024 sc1
    v_mfma_f32_16x16x32_bf16 v[48:51], a[8:11], v[120:123], 0
    v_mfma_f32_16x16x32_bf16 v[52:55], a[8:11], v[124:127], 0
    buffer_load_dwordx4 a[184:187], v4, s[8:11], s45 offen offset:2048 sc1
    v_mfma_f32_16x16x32_bf16 v[56:59], a[12:15], v[120:123], 0
    v_mfma_f32_16x16x32_bf16 v[60:63], a[12:15], v[124:127], 0
    buffer_load_dwordx4 a[188:191], v4, s[8:11], s45 offen offset:3072 sc1
    v_mfma_f32_16x16x32_bf16 v[64:67], a[16:19], v[120:123], 0
    v_mfma_f32_16x16x32_bf16 v[68:71], a[16:19], v[124:127], 0
    buffer_load_dwordx4 a[192:195], v5, s[8:11], s45 offen offset:0 sc1
    v_mfma_f32_16x16x32_bf16 v[72:75], a[20:23], v[120:123], 0
    v_mfma_f32_16x16x32_bf16 v[76:79], a[20:23], v[124:127], 0
    buffer_load_dwordx4 a[196:199], v5, s[8:11], s45 offen offset:1024 sc1
    v_mfma_f32_16x16x32_bf16 v[80:83], a[24:27], v[120:123], 0
    v_mfma_f32_16x16x32_bf16 v[84:87], a[24:27], v[124:127], 0
    buffer_load_dwordx4 a[200:203], v5, s[8:11], s45 offen offset:2048 sc1
    v_mfma_f32_16x16x32_bf16 v[88:91], a[28:31], v[120:123], 0
    v_mfma_f32_16x16x32_bf16 v[92:95], a[28:31], v[124:127], 0
    buffer_load_dwordx4 a[204:207], v5, s[8:11], s45 offen offset:3072 sc1
    v_mfma_f32_16x16x32_bf16 v[96:99], a[32:35], v[120:123], 0
    v_mfma_f32_16x16x32_bf16 v[100:103], a[32:35], v[124:127], 0
    buffer_load_dwordx4 a[208:211], v6, s[8:11], s45 offen offset:0 sc1
    v_mfma_f32_16x16x32_bf16 v[104:107], a[36:39], v[120:123], 0
    v_mfma_f32_16x16x32_bf16 v[108:111], a[36:39], v[124:127], 0
    buffer_load_dwordx4 a[212:215], v6, s[8:11], s45 offen offset:1024 sc1
    v_mfma_f32_16x16x32_bf16 v[112:115], a[40:43], v[120:123], 0
    v_mfma_f32_16x16x32_bf16 v[116:119], a[40:43], v[124:127], 0
    buffer_load_dwordx4 a[216:219], v7, s[12:15], 0 offen offset:256
    s_add_u32 s45, s45, 10240
    ds_read_b128 v[120:123], v16 offset:4096
    ds_read_b128 v[124:127], v16 offset:6144
    s_waitcnt vmcnt(33)
    s_waitcnt lgkmcnt(2)
    v_mfma_f32_16x16x32_bf16 v[32:35], a[44:47], v[128:131], v[32:35]
    v_mfma_f32_16x16x32_bf16 v[36:39], a[44:47], v[132:135], v[36:39]
    buffer_load_dwordx4 a[0:3], v4, s[8:11], s45 offen offset:0 sc1
    v_mfma_f32_16x16x32_bf16 v[40:43], a[48:51], v[128:131], v[40:43]
    v_mfma_f32_16x16x32_bf16 v[44:47], a[48:51], v[132:135], v[44:47]
    buffer_load_dwordx4 a[4:7], v4, s[8:11], s45 offen offset:1024 sc1
    v_mfma_f32_16x16x32_bf16 v[48:51], a[52:55], v[128:131], v[48:51]
    v_mfma_f32_16x16x32_bf16 v[52:55], a[52:55], v[132:135], v[52:55]
    buffer_load_dwordx4 a[8:11], v4, s[8:11], s45 offen offset:2048 sc1
    v_mfma_f32_16x16x32_bf16 v[56:59], a[56:59], v[128:131], v[56:59]
    v_mfma_f32_16x16x32_bf16 v[60:63], a[56:59], v[132:135], v[60:63]
    buffer_load_dwordx4 a[12:15], v4, s[8:11], s45 offen offset:3072 sc1
    v_mfma_f32_16x16x32_bf16 v[64:67], a[60:63], v[128:131], v[64:67]
    v_mfma_f32_16x16x32_bf16 v[68:71], a[60:63], v[132:135], v[68:71]
    buffer_load_dwordx4 a[16:19], v5, s[8:11], s45 offen offset:0 sc1
    v_mfma_f32_16x16x32_bf16 v[72:75], a[64:67], v[128:131], v[72:75]
    v_mfma_f32_16x16x32_bf16 v[76:79], a[64:67], v[132:135], v[76:79]
    buffer_load_dwordx4 a[20:23], v5, s[8:11], s45 offen offset:1024 sc1
    v_mfma_f32_16x16x32_bf16 v[80:83], a[68:71], v[128:131], v[80:83]
    v_mfma_f32_16x16x32_bf16 v[84:87], a[68:71], v[132:135], v[84:87]
    buffer_load_dwordx4 a[24:27], v5, s[8:11], s45 offen offset:2048 sc1
    v_mfma_f32_16x16x32_bf16 v[88:91], a[72:75], v[128:131], v[88:91]
    v_mfma_f32_16x16x32_bf16 v[92:95], a[72:75], v[132:135], v[92:95]
    buffer_load_dwordx4 a[28:31], v5, s[8:11], s45 offen offset:3072 sc1
    v_mfma_f32_16x16x32_bf16 v[96:99], a[76:79], v[128:131], v[96:99]
    v_mfma_f32_16x16x32_bf16 v[100:103], a[76:79], v[132:135], v[100:103]
    buffer_load_dwordx4 a[32:35], v6, s[8:11], s45 offen offset:0 sc1
    v_mfma_f32_16x16x32_bf16 v[104:107], a[80:83], v[128:131], v[104:107]
    v_mfma_f32_16x16x32_bf16 v[108:111], a[80:83], v[132:135], v[108:111]
    buffer_load_dwordx4 a[36:39], v6, s[8:11], s45 offen offset:1024 sc1
    v_mfma_f32_16x16x32_bf16 v[112:115], a[84:87], v[128:131], v[112:115]
    v_mfma_f32_16x16x32_bf16 v[116:119], a[84:87], v[132:135], v[116:119]
    buffer_load_dwordx4 a[40:43], v7, s[12:15], 0 offen offset:320
    s_add_u32 s45, s45, 10240
    ds_read_b128 v[128:131], v17 offset:4096
    ds_read_b128 v[132:135], v17 offset:6144
    s_waitcnt vmcnt(33)
    s_waitcnt lgkmcnt(2)
    v_mfma_f32_16x16x32_bf16 v[32:35], a[88:91], v[120:123], v[32:35]
    v_mfma_f32_16x16x32_bf16 v[36:39], a[88:91], v[124:127], v[36:39]
    buffer_load_dwordx4 a[44:47], v4, s[8:11], s45 offen offset:0 sc1
    v_mfma_f32_16x16x32_bf16 v[40:43], a[92:95], v[120:123], v[40:43]
    v_mfma_f32_16x16x32_bf16 v[44:47], a[92:95], v[124:127], v[44:47]
    buffer_load_dwordx4 a[48:51], v4, s[8:11], s45 offen offset:1024 sc1
    v_mfma_f32_16x16x32_bf16 v[48:51], a[96:99], v[120:123], v[48:51]
    v_mfma_f32_16x16x32_bf16 v[52:55], a[96:99], v[124:127], v[52:55]
    buffer_load_dwordx4 a[52:55], v4, s[8:11], s45 offen offset:2048 sc1
    v_mfma_f32_16x16x32_bf16 v[56:59], a[100:103], v[120:123], v[56:59]
    v_mfma_f32_16x16x32_bf16 v[60:63], a[100:103], v[124:127], v[60:63]
    buffer_load_dwordx4 a[56:59], v4, s[8:11], s45 offen offset:3072 sc1
    v_mfma_f32_16x16x32_bf16 v[64:67], a[104:107], v[120:123], v[64:67]
    v_mfma_f32_16x16x32_bf16 v[68:71], a[104:107], v[124:127], v[68:71]
    buffer_load_dwordx4 a[60:63], v5, s[8:11], s45 offen offset:0 sc1
    v_mfma_f32_16x16x32_bf16 v[72:75], a[108:111], v[120:123], v[72:75]
    v_mfma_f32_16x16x32_bf16 v[76:79], a[108:111], v[124:127], v[76:79]
    buffer_load_dwordx4 a[64:67], v5, s[8:11], s45 offen offset:1024 sc1
    v_mfma_f32_16x16x32_bf16 v[80:83], a[112:115], v[120:123], v[80:83]
    v_mfma_f32_16x16x32_bf16 v[84:87], a[112:115], v[124:127], v[84:87]
    buffer_load_dwordx4 a[68:71], v5, s[8:11], s45 offen offset:2048 sc1
    v_mfma_f32_16x16x32_bf16 v[88:91], a[116:119], v[120:123], v[88:91]
    v_mfma_f32_16x16x32_bf16 v[92:95], a[116:119], v[124:127], v[92:95]
    buffer_load_dwordx4 a[72:75], v5, s[8:11], s45 offen offset:3072 sc1
    v_mfma_f32_16x16x32_bf16 v[96:99], a[120:123], v[120:123], v[96:99]
    v_mfma_f32_16x16x32_bf16 v[100:103], a[120:123], v[124:127], v[100:103]
    buffer_load_dwordx4 a[76:79], v6, s[8:11], s45 offen offset:0 sc1
    v_mfma_f32_16x16x32_bf16 v[104:107], a[124:127], v[120:123], v[104:107]
    v_mfma_f32_16x16x32_bf16 v[108:111], a[124:127], v[124:127], v[108:111]
    buffer_load_dwordx4 a[80:83], v6, s[8:11], s45 offen offset:1024 sc1
    v_mfma_f32_16x16x32_bf16 v[112:115], a[128:131], v[120:123], v[112:115]
    v_mfma_f32_16x16x32_bf16 v[116:119], a[128:131], v[124:127], v[116:119]
    buffer_load_dwordx4 a[84:87], v7, s[12:15], 0 offen offset:384
    s_add_u32 s45, s45, 10240
    ds_read_b128 v[120:123], v16 offset:8192
    ds_read_b128 v[124:127], v16 offset:10240
    s_waitcnt vmcnt(33)
    s_waitcnt lgkmcnt(2)
    v_mfma_f32_16x16x32_bf16 v[32:35], a[132:135], v[128:131], v[32:35]
    v_mfma_f32_16x16x32_bf16 v[36:39], a[132:135], v[132:135], v[36:39]
    buffer_load_dwordx4 a[88:91], v4, s[8:11], s45 offen offset:0 sc1
    v_mfma_f32_16x16x32_bf16 v[40:43], a[136:139], v[128:131], v[40:43]
    v_mfma_f32_16x16x32_bf16 v[44:47], a[136:139], v[132:135], v[44:47]
    buffer_load_dwordx4 a[92:95], v4, s[8:11], s45 offen offset:1024 sc1
    v_mfma_f32_16x16x32_bf16 v[48:51], a[140:143], v[128:131], v[48:51]
    v_mfma_f32_16x16x32_bf16 v[52:55], a[140:143], v[132:135], v[52:55]
    buffer_load_dwordx4 a[96:99], v4, s[8:11], s45 offen offset:2048 sc1
    v_mfma_f32_16x16x32_bf16 v[56:59], a[144:147], v[128:131], v[56:59]
    v_mfma_f32_16x16x32_bf16 v[60:63], a[144:147], v[132:135], v[60:63]
    buffer_load_dwordx4 a[100:103], v4, s[8:11], s45 offen offset:3072 sc1
    v_mfma_f32_16x16x32_bf16 v[64:67], a[148:151], v[128:131], v[64:67]
    v_mfma_f32_16x16x32_bf16 v[68:71], a[148:151], v[132:135], v[68:71]
    buffer_load_dwordx4 a[104:107], v5, s[8:11], s45 offen offset:0 sc1
    v_mfma_f32_16x16x32_bf16 v[72:75], a[152:155], v[128:131], v[72:75]
    v_mfma_f32_16x16x32_bf16 v[76:79], a[152:155], v[132:135], v[76:79]
    buffer_load_dwordx4 a[108:111], v5, s[8:11], s45 offen offset:1024 sc1
    v_mfma_f32_16x16x32_bf16 v[80:83], a[156:159], v[128:131], v[80:83]
    v_mfma_f32_16x16x32_bf16 v[84:87], a[156:159], v[132:135], v[84:87]
    buffer_load_dwordx4 a[112:115], v5, s[8:11], s45 offen offset:2048 sc1
    v_mfma_f32_16x16x32_bf16 v[88:91], a[160:163], v[128:131], v[88:91]
    v_mfma_f32_16x16x32_bf16 v[92:95], a[160:163], v[132:135], v[92:95]
    buffer_load_dwordx4 a[116:119], v5, s[8:11], s45 offen offset:3072 sc1
    v_mfma_f32_16x16x32_bf16 v[96:99], a[164:167], v[128:131], v[96:99]
    v_mfma_f32_16x16x32_bf16 v[100:103], a[164:167], v[132:135], v[100:103]
    buffer_load_dwordx4 a[120:123], v6, s[8:11], s45 offen offset:0 sc1
    v_mfma_f32_16x16x32_bf16 v[104:107], a[168:171], v[128:131], v[104:107]
    v_mfma_f32_16x16x32_bf16 v[108:111], a[168:171], v[132:135], v[108:111]
    buffer_load_dwordx4 a[124:127], v6, s[8:11], s45 offen offset:1024 sc1
    v_mfma_f32_16x16x32_bf16 v[112:115], a[172:175], v[128:131], v[112:115]
    v_mfma_f32_16x16x32_bf16 v[116:119], a[172:175], v[132:135], v[116:119]
    buffer_load_dwordx4 a[128:131], v7, s[12:15], 0 offen offset:448
    s_add_u32 s45, s45, 10240
    ds_read_b128 v[128:131], v17 offset:8192
    ds_read_b128 v[132:135], v17 offset:10240
    s_waitcnt vmcnt(33)
    s_waitcnt lgkmcnt(2)
    v_mfma_f32_16x16x32_bf16 v[32:35], a[176:179], v[120:123], v[32:35]
    v_mfma_f32_16x16x32_bf16 v[36:39], a[176:179], v[124:127], v[36:39]
    buffer_load_dwordx4 a[132:135], v4, s[8:11], s45 offen offset:0 sc1
    v_mfma_f32_16x16x32_bf16 v[40:43], a[180:183], v[120:123], v[40:43]
    v_mfma_f32_16x16x32_bf16 v[44:47], a[180:183], v[124:127], v[44:47]
    buffer_load_dwordx4 a[136:139], v4, s[8:11], s45 offen offset:1024 sc1
    v_mfma_f32_16x16x32_bf16 v[48:51], a[184:187], v[120:123], v[48:51]
    v_mfma_f32_16x16x32_bf16 v[52:55], a[184:187], v[124:127], v[52:55]
    buffer_load_dwordx4 a[140:143], v4, s[8:11], s45 offen offset:2048 sc1
    v_mfma_f32_16x16x32_bf16 v[56:59], a[188:191], v[120:123], v[56:59]
    v_mfma_f32_16x16x32_bf16 v[60:63], a[188:191], v[124:127], v[60:63]
    buffer_load_dwordx4 a[144:147], v4, s[8:11], s45 offen offset:3072 sc1
    v_mfma_f32_16x16x32_bf16 v[64:67], a[192:195], v[120:123], v[64:67]
    v_mfma_f32_16x16x32_bf16 v[68:71], a[192:195], v[124:127], v[68:71]
    buffer_load_dwordx4 a[148:151], v5, s[8:11], s45 offen offset:0 sc1
    v_mfma_f32_16x16x32_bf16 v[72:75], a[196:199], v[120:123], v[72:75]
    v_mfma_f32_16x16x32_bf16 v[76:79], a[196:199], v[124:127], v[76:79]
    buffer_load_dwordx4 a[152:155], v5, s[8:11], s45 offen offset:1024 sc1
    v_mfma_f32_16x16x32_bf16 v[80:83], a[200:203], v[120:123], v[80:83]
    v_mfma_f32_16x16x32_bf16 v[84:87], a[200:203], v[124:127], v[84:87]
    buffer_load_dwordx4 a[156:159], v5, s[8:11], s45 offen offset:2048 sc1
    v_mfma_f32_16x16x32_bf16 v[88:91], a[204:207], v[120:123], v[88:91]
    v_mfma_f32_16x16x32_bf16 v[92:95], a[204:207], v[124:127], v[92:95]
    buffer_load_dwordx4 a[160:163], v5, s[8:11], s45 offen offset:3072 sc1
    v_mfma_f32_16x16x32_bf16 v[96:99], a[208:211], v[120:123], v[96:99]
    v_mfma_f32_16x16x32_bf16 v[100:103], a[208:211], v[124:127], v[100:103]
    buffer_load_dwordx4 a[164:167], v6, s[8:11], s45 offen offset:0 sc1
    v_mfma_f32_16x16x32_bf16 v[104:107], a[212:215], v[120:123], v[104:107]
    v_mfma_f32_16x16x32_bf16 v[108:111], a[212:215], v[124:127], v[108:111]
    buffer_load_dwordx4 a[168:171], v6, s[8:11], s45 offen offset:1024 sc1
    v_mfma_f32_16x16x32_bf16 v[112:115], a[216:219], v[120:123], v[112:115]
    v_mfma_f32_16x16x32_bf16 v[116:119], a[216:219], v[124:127], v[116:119]
    buffer_load_dwordx4 a[172:175], v7, s[12:15], 0 offen offset:512
    s_add_u32 s45, s45, 10240
    ds_read_b128 v[120:123], v16 offset:12288
    ds_read_b128 v[124:127], v16 offset:14336
    s_waitcnt vmcnt(33)
    s_waitcnt lgkmcnt(2)
    v_mfma_f32_16x16x32_bf16 v[32:35], a[0:3], v[128:131], v[32:35]
    v_mfma_f32_16x16x32_bf16 v[36:39], a[0:3], v[132:135], v[36:39]
    buffer_load_dwordx4 a[176:179], v4, s[8:11], s45 offen offset:0 sc1
    v_mfma_f32_16x16x32_bf16 v[40:43], a[4:7], v[128:131], v[40:43]
    v_mfma_f32_16x16x32_bf16 v[44:47], a[4:7], v[132:135], v[44:47]
    buffer_load_dwordx4 a[180:183], v4, s[8:11], s45 offen offset:1024 sc1
    v_mfma_f32_16x16x32_bf16 v[48:51], a[8:11], v[128:131], v[48:51]
    v_mfma_f32_16x16x32_bf16 v[52:55], a[8:11], v[132:135], v[52:55]
    buffer_load_dwordx4 a[184:187], v4, s[8:11], s45 offen offset:2048 sc1
    v_mfma_f32_16x16x32_bf16 v[56:59], a[12:15], v[128:131], v[56:59]
    v_mfma_f32_16x16x32_bf16 v[60:63], a[12:15], v[132:135], v[60:63]
    buffer_load_dwordx4 a[188:191], v4, s[8:11], s45 offen offset:3072 sc1
    v_mfma_f32_16x16x32_bf16 v[64:67], a[16:19], v[128:131], v[64:67]
    v_mfma_f32_16x16x32_bf16 v[68:71], a[16:19], v[132:135], v[68:71]
    buffer_load_dwordx4 a[192:195], v5, s[8:11], s45 offen offset:0 sc1
    v_mfma_f32_16x16x32_bf16 v[72:75], a[20:23], v[128:131], v[72:75]
    v_mfma_f32_16x16x32_bf16 v[76:79], a[20:23], v[132:135], v[76:79]
    buffer_load_dwordx4 a[196:199], v5, s[8:11], s45 offen offset:1024 sc1
    v_mfma_f32_16x16x32_bf16 v[80:83], a[24:27], v[128:131], v[80:83]
    v_mfma_f32_16x16x32_bf16 v[84:87], a[24:27], v[132:135], v[84:87]
    buffer_load_dwordx4 a[200:203], v5, s[8:11], s45 offen offset:2048 sc1
    v_mfma_f32_16x16x32_bf16 v[88:91], a[28:31], v[128:131], v[88:91]
    v_mfma_f32_16x16x32_bf16 v[92:95], a[28:31], v[132:135], v[92:95]
    buffer_load_dwordx4 a[204:207], v5, s[8:11], s45 offen offset:3072 sc1
    v_mfma_f32_16x16x32_bf16 v[96:99], a[32:35], v[128:131], v[96:99]
    v_mfma_f32_16x16x32_bf16 v[100:103], a[32:35], v[132:135], v[100:103]
    buffer_load_dwordx4 a[208:211], v6, s[8:11], s45 offen offset:0 sc1
    v_mfma_f32_16x16x32_bf16 v[104:107], a[36:39], v[128:131], v[104:107]
    v_mfma_f32_16x16x32_bf16 v[108:111], a[36:39], v[132:135], v[108:111]
    buffer_load_dwordx4 a[212:215], v6, s[8:11], s45 offen offset:1024 sc1
    v_mfma_f32_16x16x32_bf16 v[112:115], a[40:43], v[128:131], v[112:115]
    v_mfma_f32_16x16x32_bf16 v[116:119], a[40:43], v[132:135], v[116:119]
    buffer_load_dwordx4 a[216:219], v7, s[12:15], 0 offen offset:576
    s_add_u32 s45, s45, 10240
    ds_read_b128 v[128:131], v17 offset:12288
    ds_read_b128 v[132:135], v17 offset:14336
    s_waitcnt vmcnt(33)
    s_waitcnt lgkmcnt(2)
    v_mfma_f32_16x16x32_bf16 v[32:35], a[44:47], v[120:123], v[32:35]
    v_mfma_f32_16x16x32_bf16 v[36:39], a[44:47], v[124:127], v[36:39]
    buffer_load_dwordx4 a[0:3], v4, s[8:11], s45 offen offset:0 sc1
    v_mfma_f32_16x16x32_bf16 v[40:43], a[48:51], v[120:123], v[40:43]
    v_mfma_f32_16x16x32_bf16 v[44:47], a[48:51], v[124:127], v[44:47]
    buffer_load_dwordx4 a[4:7], v4, s[8:11], s45 offen offset:1024 sc1
    v_mfma_f32_16x16x32_bf16 v[48:51], a[52:55], v[120:123], v[48:51]
    v_mfma_f32_16x16x32_bf16 v[52:55], a[52:55], v[124:127], v[52:55]
    buffer_load_dwordx4 a[8:11], v4, s[8:11], s45 offen offset:2048 sc1
    v_mfma_f32_16x16x32_bf16 v[56:59], a[56:59], v[120:123], v[56:59]
    v_mfma_f32_16x16x32_bf16 v[60:63], a[56:59], v[124:127], v[60:63]
    buffer_load_dwordx4 a[12:15], v4, s[8:11], s45 offen offset:3072 sc1
    v_mfma_f32_16x16x32_bf16 v[64:67], a[60:63], v[120:123], v[64:67]
    v_mfma_f32_16x16x32_bf16 v[68:71], a[60:63], v[124:127], v[68:71]
    buffer_load_dwordx4 a[16:19], v5, s[8:11], s45 offen offset:0 sc1
    v_mfma_f32_16x16x32_bf16 v[72:75], a[64:67], v[120:123], v[72:75]
    v_mfma_f32_16x16x32_bf16 v[76:79], a[64:67], v[124:127], v[76:79]
    buffer_load_dwordx4 a[20:23], v5, s[8:11], s45 offen offset:1024 sc1
    v_mfma_f32_16x16x32_bf16 v[80:83], a[68:71], v[120:123], v[80:83]
    v_mfma_f32_16x16x32_bf16 v[84:87], a[68:71], v[124:127], v[84:87]
    buffer_load_dwordx4 a[24:27], v5, s[8:11], s45 offen offset:2048 sc1
    v_mfma_f32_16x16x32_bf16 v[88:91], a[72:75], v[120:123], v[88:91]
    v_mfma_f32_16x16x32_bf16 v[92:95], a[72:75], v[124:127], v[92:95]
    buffer_load_dwordx4 a[28:31], v5, s[8:11], s45 offen offset:3072 sc1
    v_mfma_f32_16x16x32_bf16 v[96:99], a[76:79], v[120:123], v[96:99]
    v_mfma_f32_16x16x32_bf16 v[100:103], a[76:79], v[124:127], v[100:103]
    buffer_load_dwordx4 a[32:35], v6, s[8:11], s45 offen offset:0 sc1
    v_mfma_f32_16x16x32_bf16 v[104:107], a[80:83], v[120:123], v[104:107]
    v_mfma_f32_16x16x32_bf16 v[108:111], a[80:83], v[124:127], v[108:111]
    buffer_load_dwordx4 a[36:39], v6, s[8:11], s45 offen offset:1024 sc1
    v_mfma_f32_16x16x32_bf16 v[112:115], a[84:87], v[120:123], v[112:115]
    v_mfma_f32_16x16x32_bf16 v[116:119], a[84:87], v[124:127], v[116:119]
    buffer_load_dwordx4 a[40:43], v7, s[12:15], 0 offen offset:640
    s_add_u32 s45, s45, 10240
    ds_read_b128 v[120:123], v16 offset:16384
    ds_read_b128 v[124:127], v16 offset:18432
    s_waitcnt vmcnt(33)
    s_waitcnt lgkmcnt(2)
    v_mfma_f32_16x16x32_bf16 v[32:35], a[88:91], v[128:131], v[32:35]
    v_mfma_f32_16x16x32_bf16 v[36:39], a[88:91], v[132:135], v[36:39]
    buffer_load_dwordx4 a[44:47], v4, s[8:11], s45 offen offset:0 sc1
    v_mfma_f32_16x16x32_bf16 v[40:43], a[92:95], v[128:131], v[40:43]
    v_mfma_f32_16x16x32_bf16 v[44:47], a[92:95], v[132:135], v[44:47]
    buffer_load_dwordx4 a[48:51], v4, s[8:11], s45 offen offset:1024 sc1
    v_mfma_f32_16x16x32_bf16 v[48:51], a[96:99], v[128:131], v[48:51]
    v_mfma_f32_16x16x32_bf16 v[52:55], a[96:99], v[132:135], v[52:55]
    buffer_load_dwordx4 a[52:55], v4, s[8:11], s45 offen offset:2048 sc1
    v_mfma_f32_16x16x32_bf16 v[56:59], a[100:103], v[128:131], v[56:59]
    v_mfma_f32_16x16x32_bf16 v[60:63], a[100:103], v[132:135], v[60:63]
    buffer_load_dwordx4 a[56:59], v4, s[8:11], s45 offen offset:3072 sc1
    v_mfma_f32_16x16x32_bf16 v[64:67], a[104:107], v[128:131], v[64:67]
    v_mfma_f32_16x16x32_bf16 v[68:71], a[104:107], v[132:135], v[68:71]
    buffer_load_dwordx4 a[60:63], v5, s[8:11], s45 offen offset:0 sc1
    v_mfma_f32_16x16x32_bf16 v[72:75], a[108:111], v[128:131], v[72:75]
    v_mfma_f32_16x16x32_bf16 v[76:79], a[108:111], v[132:135], v[76:79]
    buffer_load_dwordx4 a[64:67], v5, s[8:11], s45 offen offset:1024 sc1
    v_mfma_f32_16x16x32_bf16 v[80:83], a[112:115], v[128:131], v[80:83]
    v_mfma_f32_16x16x32_bf16 v[84:87], a[112:115], v[132:135], v[84:87]
    buffer_load_dwordx4 a[68:71], v5, s[8:11], s45 offen offset:2048 sc1
    v_mfma_f32_16x16x32_bf16 v[88:91], a[116:119], v[128:131], v[88:91]
    v_mfma_f32_16x16x32_bf16 v[92:95], a[116:119], v[132:135], v[92:95]
    buffer_load_dwordx4 a[72:75], v5, s[8:11], s45 offen offset:3072 sc1
    v_mfma_f32_16x16x32_bf16 v[96:99], a[120:123], v[128:131], v[96:99]
    v_mfma_f32_16x16x32_bf16 v[100:103], a[120:123], v[132:135], v[100:103]
    buffer_load_dwordx4 a[76:79], v6, s[8:11], s45 offen offset:0 sc1
    v_mfma_f32_16x16x32_bf16 v[104:107], a[124:127], v[128:131], v[104:107]
    v_mfma_f32_16x16x32_bf16 v[108:111], a[124:127], v[132:135], v[108:111]
    buffer_load_dwordx4 a[80:83], v6, s[8:11], s45 offen offset:1024 sc1
    v_mfma_f32_16x16x32_bf16 v[112:115], a[128:131], v[128:131], v[112:115]
    v_mfma_f32_16x16x32_bf16 v[116:119], a[128:131], v[132:135], v[116:119]
    buffer_load_dwordx4 a[84:87], v7, s[12:15], 0 offen offset:704
    s_add_u32 s45, s45, 10240
    ds_read_b128 v[128:131], v17 offset:16384
    ds_read_b128 v[132:135], v17 offset:18432
    s_waitcnt vmcnt(33)
    s_waitcnt lgkmcnt(2)
    v_mfma_f32_16x16x32_bf16 v[32:35], a[132:135], v[120:123], v[32:35]
    v_mfma_f32_16x16x32_bf16 v[36:39], a[132:135], v[124:127], v[36:39]
    buffer_load_dwordx4 a[88:91], v4, s[8:11], s45 offen offset:0 sc1
    v_mfma_f32_16x16x32_bf16 v[40:43], a[136:139], v[120:123], v[40:43]
    v_mfma_f32_16x16x32_bf16 v[44:47], a[136:139], v[124:127], v[44:47]
    buffer_load_dwordx4 a[92:95], v4, s[8:11], s45 offen offset:1024 sc1
    v_mfma_f32_16x16x32_bf16 v[48:51], a[140:143], v[120:123], v[48:51]
    v_mfma_f32_16x16x32_bf16 v[52:55], a[140:143], v[124:127], v[52:55]
    buffer_load_dwordx4 a[96:99], v4, s[8:11], s45 offen offset:2048 sc1
    v_mfma_f32_16x16x32_bf16 v[56:59], a[144:147], v[120:123], v[56:59]
    v_mfma_f32_16x16x32_bf16 v[60:63], a[144:147], v[124:127], v[60:63]
    buffer_load_dwordx4 a[100:103], v4, s[8:11], s45 offen offset:3072 sc1
    v_mfma_f32_16x16x32_bf16 v[64:67], a[148:151], v[120:123], v[64:67]
    v_mfma_f32_16x16x32_bf16 v[68:71], a[148:151], v[124:127], v[68:71]
    buffer_load_dwordx4 a[104:107], v5, s[8:11], s45 offen offset:0 sc1
    v_mfma_f32_16x16x32_bf16 v[72:75], a[152:155], v[120:123], v[72:75]
    v_mfma_f32_16x16x32_bf16 v[76:79], a[152:155], v[124:127], v[76:79]
    buffer_load_dwordx4 a[108:111], v5, s[8:11], s45 offen offset:1024 sc1
    v_mfma_f32_16x16x32_bf16 v[80:83], a[156:159], v[120:123], v[80:83]
    v_mfma_f32_16x16x32_bf16 v[84:87], a[156:159], v[124:127], v[84:87]
    buffer_load_dwordx4 a[112:115], v5, s[8:11], s45 offen offset:2048 sc1
    v_mfma_f32_16x16x32_bf16 v[88:91], a[160:163], v[120:123], v[88:91]
    v_mfma_f32_16x16x32_bf16 v[92:95], a[160:163], v[124:127], v[92:95]
    buffer_load_dwordx4 a[116:119], v5, s[8:11], s45 offen offset:3072 sc1
    v_mfma_f32_16x16x32_bf16 v[96:99], a[164:167], v[120:123], v[96:99]
    v_mfma_f32_16x16x32_bf16 v[100:103], a[164:167], v[124:127], v[100:103]
    buffer_load_dwordx4 a[120:123], v6, s[8:11], s45 offen offset:0 sc1
    v_mfma_f32_16x16x32_bf16 v[104:107], a[168:171], v[120:123], v[104:107]
    v_mfma_f32_16x16x32_bf16 v[108:111], a[168:171], v[124:127], v[108:111]
    buffer_load_dwordx4 a[124:127], v6, s[8:11], s45 offen offset:1024 sc1
    v_mfma_f32_16x16x32_bf16 v[112:115], a[172:175], v[120:123], v[112:115]
    v_mfma_f32_16x16x32_bf16 v[116:119], a[172:175], v[124:127], v[116:119]
    buffer_load_dwordx4 a[128:131], v7, s[12:15], 0 offen offset:768
    s_add_u32 s45, s45, 10240
    ds_read_b128 v[120:123], v16 offset:20480
    ds_read_b128 v[124:127], v16 offset:22528
    s_waitcnt vmcnt(33)
    s_waitcnt lgkmcnt(2)
    v_mfma_f32_16x16x32_bf16 v[32:35], a[176:179], v[128:131], v[32:35]
    v_mfma_f32_16x16x32_bf16 v[36:39], a[176:179], v[132:135], v[36:39]
    buffer_load_dwordx4 a[132:135], v4, s[8:11], s45 offen offset:0 sc1
    v_mfma_f32_16x16x32_bf16 v[40:43], a[180:183], v[128:131], v[40:43]
    v_mfma_f32_16x16x32_bf16 v[44:47], a[180:183], v[132:135], v[44:47]
    buffer_load_dwordx4 a[136:139], v4, s[8:11], s45 offen offset:1024 sc1
    v_mfma_f32_16x16x32_bf16 v[48:51], a[184:187], v[128:131], v[48:51]
    v_mfma_f32_16x16x32_bf16 v[52:55], a[184:187], v[132:135], v[52:55]
    buffer_load_dwordx4 a[140:143], v4, s[8:11], s45 offen offset:2048 sc1
    v_mfma_f32_16x16x32_bf16 v[56:59], a[188:191], v[128:131], v[56:59]
    v_mfma_f32_16x16x32_bf16 v[60:63], a[188:191], v[132:135], v[60:63]
    buffer_load_dwordx4 a[144:147], v4, s[8:11], s45 offen offset:3072 sc1
    v_mfma_f32_16x16x32_bf16 v[64:67], a[192:195], v[128:131], v[64:67]
    v_mfma_f32_16x16x32_bf16 v[68:71], a[192:195], v[132:135], v[68:71]
    buffer_load_dwordx4 a[148:151], v5, s[8:11], s45 offen offset:0 sc1
    v_mfma_f32_16x16x32_bf16 v[72:75], a[196:199], v[128:131], v[72:75]
    v_mfma_f32_16x16x32_bf16 v[76:79], a[196:199], v[132:135], v[76:79]
    buffer_load_dwordx4 a[152:155], v5, s[8:11], s45 offen offset:1024 sc1
    v_mfma_f32_16x16x32_bf16 v[80:83], a[200:203], v[128:131], v[80:83]
    v_mfma_f32_16x16x32_bf16 v[84:87], a[200:203], v[132:135], v[84:87]
    buffer_load_dwordx4 a[156:159], v5, s[8:11], s45 offen offset:2048 sc1
    v_mfma_f32_16x16x32_bf16 v[88:91], a[204:207], v[128:131], v[88:91]
    v_mfma_f32_16x16x32_bf16 v[92:95], a[204:207], v[132:135], v[92:95]
    buffer_load_dwordx4 a[160:163], v5, s[8:11], s45 offen offset:3072 sc1
    v_mfma_f32_16x16x32_bf16 v[96:99], a[208:211], v[128:131], v[96:99]
    v_mfma_f32_16x16x32_bf16 v[100:103], a[208:211], v[132:135], v[100:103]
    buffer_load_dwordx4 a[164:167], v6, s[8:11], s45 offen offset:0 sc1
    v_mfma_f32_16x16x32_bf16 v[104:107], a[212:215], v[128:131], v[104:107]
    v_mfma_f32_16x16x32_bf16 v[108:111], a[212:215], v[132:135], v[108:111]
    buffer_load_dwordx4 a[168:171], v6, s[8:11], s45 offen offset:1024 sc1
    v_mfma_f32_16x16x32_bf16 v[112:115], a[216:219], v[128:131], v[112:115]
    v_mfma_f32_16x16x32_bf16 v[116:119], a[216:219], v[132:135], v[116:119]
    buffer_load_dwordx4 a[172:175], v7, s[12:15], 0 offen offset:832
    s_add_u32 s45, s45, 10240
    ds_read_b128 v[128:131], v17 offset:20480
    ds_read_b128 v[132:135], v17 offset:22528
    s_waitcnt vmcnt(33)
    s_waitcnt lgkmcnt(2)
    v_mfma_f32_16x16x32_bf16 v[32:35], a[0:3], v[120:123], v[32:35]
    v_mfma_f32_16x16x32_bf16 v[36:39], a[0:3], v[124:127], v[36:39]
    buffer_load_dwordx4 a[176:179], v4, s[8:11], s45 offen offset:0 sc1
    v_mfma_f32_16x16x32_bf16 v[40:43], a[4:7], v[120:123], v[40:43]
    v_mfma_f32_16x16x32_bf16 v[44:47], a[4:7], v[124:127], v[44:47]
    buffer_load_dwordx4 a[180:183], v4, s[8:11], s45 offen offset:1024 sc1
    v_mfma_f32_16x16x32_bf16 v[48:51], a[8:11], v[120:123], v[48:51]
    v_mfma_f32_16x16x32_bf16 v[52:55], a[8:11], v[124:127], v[52:55]
    buffer_load_dwordx4 a[184:187], v4, s[8:11], s45 offen offset:2048 sc1
    v_mfma_f32_16x16x32_bf16 v[56:59], a[12:15], v[120:123], v[56:59]
    v_mfma_f32_16x16x32_bf16 v[60:63], a[12:15], v[124:127], v[60:63]
    buffer_load_dwordx4 a[188:191], v4, s[8:11], s45 offen offset:3072 sc1
    v_mfma_f32_16x16x32_bf16 v[64:67], a[16:19], v[120:123], v[64:67]
    v_mfma_f32_16x16x32_bf16 v[68:71], a[16:19], v[124:127], v[68:71]
    buffer_load_dwordx4 a[192:195], v5, s[8:11], s45 offen offset:0 sc1
    v_mfma_f32_16x16x32_bf16 v[72:75], a[20:23], v[120:123], v[72:75]
    v_mfma_f32_16x16x32_bf16 v[76:79], a[20:23], v[124:127], v[76:79]
    buffer_load_dwordx4 a[196:199], v5, s[8:11], s45 offen offset:1024 sc1
    v_mfma_f32_16x16x32_bf16 v[80:83], a[24:27], v[120:123], v[80:83]
    v_mfma_f32_16x16x32_bf16 v[84:87], a[24:27], v[124:127], v[84:87]
    buffer_load_dwordx4 a[200:203], v5, s[8:11], s45 offen offset:2048 sc1
    v_mfma_f32_16x16x32_bf16 v[88:91], a[28:31], v[120:123], v[88:91]
    v_mfma_f32_16x16x32_bf16 v[92:95], a[28:31], v[124:127], v[92:95]
    buffer_load_dwordx4 a[204:207], v5, s[8:11], s45 offen offset:3072 sc1
    v_mfma_f32_16x16x32_bf16 v[96:99], a[32:35], v[120:123], v[96:99]
    v_mfma_f32_16x16x32_bf16 v[100:103], a[32:35], v[124:127], v[100:103]
    buffer_load_dwordx4 a[208:211], v6, s[8:11], s45 offen offset:0 sc1
    v_mfma_f32_16x16x32_bf16 v[104:107], a[36:39], v[120:123], v[104:107]
    v_mfma_f32_16x16x32_bf16 v[108:111], a[36:39], v[124:127], v[108:111]
    buffer_load_dwordx4 a[212:215], v6, s[8:11], s45 offen offset:1024 sc1
    v_mfma_f32_16x16x32_bf16 v[112:115], a[40:43], v[120:123], v[112:115]
    v_mfma_f32_16x16x32_bf16 v[116:119], a[40:43], v[124:127], v[116:119]
    buffer_load_dwordx4 a[216:219], v7, s[12:15], 0 offen offset:896
    s_add_u32 s45, s45, 10240
    ds_read_b128 v[120:123], v16 offset:24576
    ds_read_b128 v[124:127], v16 offset:26624
    s_waitcnt vmcnt(33)
    s_waitcnt lgkmcnt(2)
    v_mfma_f32_16x16x32_bf16 v[32:35], a[44:47], v[128:131], v[32:35]
    v_mfma_f32_16x16x32_bf16 v[36:39], a[44:47], v[132:135], v[36:39]
    buffer_load_dwordx4 a[0:3], v4, s[8:11], s45 offen offset:0 sc1
    v_mfma_f32_16x16x32_bf16 v[40:43], a[48:51], v[128:131], v[40:43]
    v_mfma_f32_16x16x32_bf16 v[44:47], a[48:51], v[132:135], v[44:47]
    buffer_load_dwordx4 a[4:7], v4, s[8:11], s45 offen offset:1024 sc1
    v_mfma_f32_16x16x32_bf16 v[48:51], a[52:55], v[128:131], v[48:51]
    v_mfma_f32_16x16x32_bf16 v[52:55], a[52:55], v[132:135], v[52:55]
    buffer_load_dwordx4 a[8:11], v4, s[8:11], s45 offen offset:2048 sc1
    v_mfma_f32_16x16x32_bf16 v[56:59], a[56:59], v[128:131], v[56:59]
    v_mfma_f32_16x16x32_bf16 v[60:63], a[56:59], v[132:135], v[60:63]
    buffer_load_dwordx4 a[12:15], v4, s[8:11], s45 offen offset:3072 sc1
    v_mfma_f32_16x16x32_bf16 v[64:67], a[60:63], v[128:131], v[64:67]
    v_mfma_f32_16x16x32_bf16 v[68:71], a[60:63], v[132:135], v[68:71]
    buffer_load_dwordx4 a[16:19], v5, s[8:11], s45 offen offset:0 sc1
    v_mfma_f32_16x16x32_bf16 v[72:75], a[64:67], v[128:131], v[72:75]
    v_mfma_f32_16x16x32_bf16 v[76:79], a[64:67], v[132:135], v[76:79]
    buffer_load_dwordx4 a[20:23], v5, s[8:11], s45 offen offset:1024 sc1
    v_mfma_f32_16x16x32_bf16 v[80:83], a[68:71], v[128:131], v[80:83]
    v_mfma_f32_16x16x32_bf16 v[84:87], a[68:71], v[132:135], v[84:87]
    buffer_load_dwordx4 a[24:27], v5, s[8:11], s45 offen offset:2048 sc1
    v_mfma_f32_16x16x32_bf16 v[88:91], a[72:75], v[128:131], v[88:91]
    v_mfma_f32_16x16x32_bf16 v[92:95], a[72:75], v[132:135], v[92:95]
    buffer_load_dwordx4 a[28:31], v5, s[8:11], s45 offen offset:3072 sc1
    v_mfma_f32_16x16x32_bf16 v[96:99], a[76:79], v[128:131], v[96:99]
    v_mfma_f32_16x16x32_bf16 v[100:103], a[76:79], v[132:135], v[100:103]
    buffer_load_dwordx4 a[32:35], v6, s[8:11], s45 offen offset:0 sc1
    v_mfma_f32_16x16x32_bf16 v[104:107], a[80:83], v[128:131], v[104:107]
    v_mfma_f32_16x16x32_bf16 v[108:111], a[80:83], v[132:135], v[108:111]
    buffer_load_dwordx4 a[36:39], v6, s[8:11], s45 offen offset:1024 sc1
    v_mfma_f32_16x16x32_bf16 v[112:115], a[84:87], v[128:131], v[112:115]
    v_mfma_f32_16x16x32_bf16 v[116:119], a[84:87], v[132:135], v[116:119]
    buffer_load_dwordx4 a[40:43], v7, s[12:15], 0 offen offset:960
    s_add_u32 s45, s45, 10240
    ds_read_b128 v[128:131], v17 offset:24576
    ds_read_b128 v[132:135], v17 offset:26624
    s_waitcnt vmcnt(33)
    s_waitcnt lgkmcnt(2)
    v_mfma_f32_16x16x32_bf16 v[32:35], a[88:91], v[120:123], v[32:35]
    v_mfma_f32_16x16x32_bf16 v[36:39], a[88:91], v[124:127], v[36:39]
    buffer_load_dwordx4 a[44:47], v4, s[8:11], s45 offen offset:0 sc1
    v_mfma_f32_16x16x32_bf16 v[40:43], a[92:95], v[120:123], v[40:43]
    v_mfma_f32_16x16x32_bf16 v[44:47], a[92:95], v[124:127], v[44:47]
    buffer_load_dwordx4 a[48:51], v4, s[8:11], s45 offen offset:1024 sc1
    v_mfma_f32_16x16x32_bf16 v[48:51], a[96:99], v[120:123], v[48:51]
    v_mfma_f32_16x16x32_bf16 v[52:55], a[96:99], v[124:127], v[52:55]
    buffer_load_dwordx4 a[52:55], v4, s[8:11], s45 offen offset:2048 sc1
    v_mfma_f32_16x16x32_bf16 v[56:59], a[100:103], v[120:123], v[56:59]
    v_mfma_f32_16x16x32_bf16 v[60:63], a[100:103], v[124:127], v[60:63]
    buffer_load_dwordx4 a[56:59], v4, s[8:11], s45 offen offset:3072 sc1
    v_mfma_f32_16x16x32_bf16 v[64:67], a[104:107], v[120:123], v[64:67]
    v_mfma_f32_16x16x32_bf16 v[68:71], a[104:107], v[124:127], v[68:71]
    buffer_load_dwordx4 a[60:63], v5, s[8:11], s45 offen offset:0 sc1
    v_mfma_f32_16x16x32_bf16 v[72:75], a[108:111], v[120:123], v[72:75]
    v_mfma_f32_16x16x32_bf16 v[76:79], a[108:111], v[124:127], v[76:79]
    buffer_load_dwordx4 a[64:67], v5, s[8:11], s45 offen offset:1024 sc1
    v_mfma_f32_16x16x32_bf16 v[80:83], a[112:115], v[120:123], v[80:83]
    v_mfma_f32_16x16x32_bf16 v[84:87], a[112:115], v[124:127], v[84:87]
    buffer_load_dwordx4 a[68:71], v5, s[8:11], s45 offen offset:2048 sc1
    v_mfma_f32_16x16x32_bf16 v[88:91], a[116:119], v[120:123], v[88:91]
    v_mfma_f32_16x16x32_bf16 v[92:95], a[116:119], v[124:127], v[92:95]
    buffer_load_dwordx4 a[72:75], v5, s[8:11], s45 offen offset:3072 sc1
    v_mfma_f32_16x16x32_bf16 v[96:99], a[120:123], v[120:123], v[96:99]
    v_mfma_f32_16x16x32_bf16 v[100:103], a[120:123], v[124:127], v[100:103]
    buffer_load_dwordx4 a[76:79], v6, s[8:11], s45 offen offset:0 sc1
    v_mfma_f32_16x16x32_bf16 v[104:107], a[124:127], v[120:123], v[104:107]
    v_mfma_f32_16x16x32_bf16 v[108:111], a[124:127], v[124:127], v[108:111]
    buffer_load_dwordx4 a[80:83], v6, s[8:11], s45 offen offset:1024 sc1
    v_mfma_f32_16x16x32_bf16 v[112:115], a[128:131], v[120:123], v[112:115]
    v_mfma_f32_16x16x32_bf16 v[116:119], a[128:131], v[124:127], v[116:119]
    buffer_load_dwordx4 a[84:87], v7, s[12:15], 0 offen offset:1024
    s_add_u32 s45, s45, 10240
    ds_read_b128 v[120:123], v16 offset:28672
    ds_read_b128 v[124:127], v16 offset:30720
    s_waitcnt vmcnt(33)
    s_waitcnt lgkmcnt(2)
    v_mfma_f32_16x16x32_bf16 v[32:35], a[132:135], v[128:131], v[32:35]
    v_mfma_f32_16x16x32_bf16 v[36:39], a[132:135], v[132:135], v[36:39]
    buffer_load_dwordx4 a[88:91], v4, s[8:11], s45 offen offset:0 sc1
    v_mfma_f32_16x16x32_bf16 v[40:43], a[136:139], v[128:131], v[40:43]
    v_mfma_f32_16x16x32_bf16 v[44:47], a[136:139], v[132:135], v[44:47]
    buffer_load_dwordx4 a[92:95], v4, s[8:11], s45 offen offset:1024 sc1
    v_mfma_f32_16x16x32_bf16 v[48:51], a[140:143], v[128:131], v[48:51]
    v_mfma_f32_16x16x32_bf16 v[52:55], a[140:143], v[132:135], v[52:55]
    buffer_load_dwordx4 a[96:99], v4, s[8:11], s45 offen offset:2048 sc1
    v_mfma_f32_16x16x32_bf16 v[56:59], a[144:147], v[128:131], v[56:59]
    v_mfma_f32_16x16x32_bf16 v[60:63], a[144:147], v[132:135], v[60:63]
    buffer_load_dwordx4 a[100:103], v4, s[8:11], s45 offen offset:3072 sc1
    v_mfma_f32_16x16x32_bf16 v[64:67], a[148:151], v[128:131], v[64:67]
    v_mfma_f32_16x16x32_bf16 v[68:71], a[148:151], v[132:135], v[68:71]
    buffer_load_dwordx4 a[104:107], v5, s[8:11], s45 offen offset:0 sc1
    v_mfma_f32_16x16x32_bf16 v[72:75], a[152:155], v[128:131], v[72:75]
    v_mfma_f32_16x16x32_bf16 v[76:79], a[152:155], v[132:135], v[76:79]
    buffer_load_dwordx4 a[108:111], v5, s[8:11], s45 offen offset:1024 sc1
    v_mfma_f32_16x16x32_bf16 v[80:83], a[156:159], v[128:131], v[80:83]
    v_mfma_f32_16x16x32_bf16 v[84:87], a[156:159], v[132:135], v[84:87]
    buffer_load_dwordx4 a[112:115], v5, s[8:11], s45 offen offset:2048 sc1
    v_mfma_f32_16x16x32_bf16 v[88:91], a[160:163], v[128:131], v[88:91]
    v_mfma_f32_16x16x32_bf16 v[92:95], a[160:163], v[132:135], v[92:95]
    buffer_load_dwordx4 a[116:119], v5, s[8:11], s45 offen offset:3072 sc1
    v_mfma_f32_16x16x32_bf16 v[96:99], a[164:167], v[128:131], v[96:99]
    v_mfma_f32_16x16x32_bf16 v[100:103], a[164:167], v[132:135], v[100:103]
    buffer_load_dwordx4 a[120:123], v6, s[8:11], s45 offen offset:0 sc1
    v_mfma_f32_16x16x32_bf16 v[104:107], a[168:171], v[128:131], v[104:107]
    v_mfma_f32_16x16x32_bf16 v[108:111], a[168:171], v[132:135], v[108:111]
    buffer_load_dwordx4 a[124:127], v6, s[8:11], s45 offen offset:1024 sc1
    v_mfma_f32_16x16x32_bf16 v[112:115], a[172:175], v[128:131], v[112:115]
    v_mfma_f32_16x16x32_bf16 v[116:119], a[172:175], v[132:135], v[116:119]
    buffer_load_dwordx4 a[128:131], v7, s[12:15], 0 offen offset:1088
    s_add_u32 s45, s45, 10240
    ds_read_b128 v[128:131], v17 offset:28672
    ds_read_b128 v[132:135], v17 offset:30720
    s_waitcnt vmcnt(33)
    s_waitcnt lgkmcnt(2)
    v_mfma_f32_16x16x32_bf16 v[32:35], a[176:179], v[120:123], v[32:35]
    v_mfma_f32_16x16x32_bf16 v[36:39], a[176:179], v[124:127], v[36:39]
    buffer_load_dwordx4 a[132:135], v4, s[8:11], s45 offen offset:0 sc1
    v_mfma_f32_16x16x32_bf16 v[40:43], a[180:183], v[120:123], v[40:43]
    v_mfma_f32_16x16x32_bf16 v[44:47], a[180:183], v[124:127], v[44:47]
    buffer_load_dwordx4 a[136:139], v4, s[8:11], s45 offen offset:1024 sc1
    v_mfma_f32_16x16x32_bf16 v[48:51], a[184:187], v[120:123], v[48:51]
    v_mfma_f32_16x16x32_bf16 v[52:55], a[184:187], v[124:127], v[52:55]
    buffer_load_dwordx4 a[140:143], v4, s[8:11], s45 offen offset:2048 sc1
    v_mfma_f32_16x16x32_bf16 v[56:59], a[188:191], v[120:123], v[56:59]
    v_mfma_f32_16x16x32_bf16 v[60:63], a[188:191], v[124:127], v[60:63]
    buffer_load_dwordx4 a[144:147], v4, s[8:11], s45 offen offset:3072 sc1
    v_mfma_f32_16x16x32_bf16 v[64:67], a[192:195], v[120:123], v[64:67]
    v_mfma_f32_16x16x32_bf16 v[68:71], a[192:195], v[124:127], v[68:71]
    buffer_load_dwordx4 a[148:151], v5, s[8:11], s45 offen offset:0 sc1
    v_mfma_f32_16x16x32_bf16 v[72:75], a[196:199], v[120:123], v[72:75]
    v_mfma_f32_16x16x32_bf16 v[76:79], a[196:199], v[124:127], v[76:79]
    buffer_load_dwordx4 a[152:155], v5, s[8:11], s45 offen offset:1024 sc1
    v_mfma_f32_16x16x32_bf16 v[80:83], a[200:203], v[120:123], v[80:83]
    v_mfma_f32_16x16x32_bf16 v[84:87], a[200:203], v[124:127], v[84:87]
    buffer_load_dwordx4 a[156:159], v5, s[8:11], s45 offen offset:2048 sc1
    v_mfma_f32_16x16x32_bf16 v[88:91], a[204:207], v[120:123], v[88:91]
    v_mfma_f32_16x16x32_bf16 v[92:95], a[204:207], v[124:127], v[92:95]
    buffer_load_dwordx4 a[160:163], v5, s[8:11], s45 offen offset:3072 sc1
    v_mfma_f32_16x16x32_bf16 v[96:99], a[208:211], v[120:123], v[96:99]
    v_mfma_f32_16x16x32_bf16 v[100:103], a[208:211], v[124:127], v[100:103]
    buffer_load_dwordx4 a[164:167], v6, s[8:11], s45 offen offset:0 sc1
    v_mfma_f32_16x16x32_bf16 v[104:107], a[212:215], v[120:123], v[104:107]
    v_mfma_f32_16x16x32_bf16 v[108:111], a[212:215], v[124:127], v[108:111]
    buffer_load_dwordx4 a[168:171], v6, s[8:11], s45 offen offset:1024 sc1
    v_mfma_f32_16x16x32_bf16 v[112:115], a[216:219], v[120:123], v[112:115]
    v_mfma_f32_16x16x32_bf16 v[116:119], a[216:219], v[124:127], v[116:119]
    buffer_load_dwordx4 a[172:175], v7, s[12:15], 0 offen offset:1152
    s_add_u32 s45, s45, 10240
    ds_read_b128 v[120:123], v16 offset:32768
    ds_read_b128 v[124:127], v16 offset:34816
    s_waitcnt vmcnt(33)
    s_waitcnt lgkmcnt(2)
    v_mfma_f32_16x16x32_bf16 v[32:35], a[0:3], v[128:131], v[32:35]
    v_mfma_f32_16x16x32_bf16 v[36:39], a[0:3], v[132:135], v[36:39]
    buffer_load_dwordx4 a[176:179], v4, s[8:11], s45 offen offset:0 sc1
    v_mfma_f32_16x16x32_bf16 v[40:43], a[4:7], v[128:131], v[40:43]
    v_mfma_f32_16x16x32_bf16 v[44:47], a[4:7], v[132:135], v[44:47]
    buffer_load_dwordx4 a[180:183], v4, s[8:11], s45 offen offset:1024 sc1
    v_mfma_f32_16x16x32_bf16 v[48:51], a[8:11], v[128:131], v[48:51]
    v_mfma_f32_16x16x32_bf16 v[52:55], a[8:11], v[132:135], v[52:55]
    buffer_load_dwordx4 a[184:187], v4, s[8:11], s45 offen offset:2048 sc1
    v_mfma_f32_16x16x32_bf16 v[56:59], a[12:15], v[128:131], v[56:59]
    v_mfma_f32_16x16x32_bf16 v[60:63], a[12:15], v[132:135], v[60:63]
    buffer_load_dwordx4 a[188:191], v4, s[8:11], s45 offen offset:3072 sc1
    v_mfma_f32_16x16x32_bf16 v[64:67], a[16:19], v[128:131], v[64:67]
    v_mfma_f32_16x16x32_bf16 v[68:71], a[16:19], v[132:135], v[68:71]
    buffer_load_dwordx4 a[192:195], v5, s[8:11], s45 offen offset:0 sc1
    v_mfma_f32_16x16x32_bf16 v[72:75], a[20:23], v[128:131], v[72:75]
    v_mfma_f32_16x16x32_bf16 v[76:79], a[20:23], v[132:135], v[76:79]
    buffer_load_dwordx4 a[196:199], v5, s[8:11], s45 offen offset:1024 sc1
    v_mfma_f32_16x16x32_bf16 v[80:83], a[24:27], v[128:131], v[80:83]
    v_mfma_f32_16x16x32_bf16 v[84:87], a[24:27], v[132:135], v[84:87]
    buffer_load_dwordx4 a[200:203], v5, s[8:11], s45 offen offset:2048 sc1
    v_mfma_f32_16x16x32_bf16 v[88:91], a[28:31], v[128:131], v[88:91]
    v_mfma_f32_16x16x32_bf16 v[92:95], a[28:31], v[132:135], v[92:95]
    buffer_load_dwordx4 a[204:207], v5, s[8:11], s45 offen offset:3072 sc1
    v_mfma_f32_16x16x32_bf16 v[96:99], a[32:35], v[128:131], v[96:99]
    v_mfma_f32_16x16x32_bf16 v[100:103], a[32:35], v[132:135], v[100:103]
    buffer_load_dwordx4 a[208:211], v6, s[8:11], s45 offen offset:0 sc1
    v_mfma_f32_16x16x32_bf16 v[104:107], a[36:39], v[128:131], v[104:107]
    v_mfma_f32_16x16x32_bf16 v[108:111], a[36:39], v[132:135], v[108:111]
    buffer_load_dwordx4 a[212:215], v6, s[8:11], s45 offen offset:1024 sc1
    v_mfma_f32_16x16x32_bf16 v[112:115], a[40:43], v[128:131], v[112:115]
    v_mfma_f32_16x16x32_bf16 v[116:119], a[40:43], v[132:135], v[116:119]
    buffer_load_dwordx4 a[216:219], v7, s[12:15], 0 offen offset:1216
    s_add_u32 s45, s45, 16582656
    ds_read_b128 v[128:131], v17 offset:32768
    ds_read_b128 v[132:135], v17 offset:34816
    s_waitcnt vmcnt(33)
    s_waitcnt lgkmcnt(2)
    v_mfma_f32_16x16x32_bf16 v[32:35], a[44:47], v[120:123], v[32:35]
    v_mfma_f32_16x16x32_bf16 v[36:39], a[44:47], v[124:127], v[36:39]
    buffer_load_dwordx4 a[0:3], v4, s[8:11], s45 offen offset:0 sc1
    v_mfma_f32_16x16x32_bf16 v[40:43], a[48:51], v[120:123], v[40:43]
    v_mfma_f32_16x16x32_bf16 v[44:47], a[48:51], v[124:127], v[44:47]
    buffer_load_dwordx4 a[4:7], v4, s[8:11], s45 offen offset:1024 sc1
    v_mfma_f32_16x16x32_bf16 v[48:51], a[52:55], v[120:123], v[48:51]
    v_mfma_f32_16x16x32_bf16 v[52:55], a[52:55], v[124:127], v[52:55]
    buffer_load_dwordx4 a[8:11], v4, s[8:11], s45 offen offset:2048 sc1
    v_mfma_f32_16x16x32_bf16 v[56:59], a[56:59], v[120:123], v[56:59]
    v_mfma_f32_16x16x32_bf16 v[60:63], a[56:59], v[124:127], v[60:63]
    buffer_load_dwordx4 a[12:15], v4, s[8:11], s45 offen offset:3072 sc1
    v_mfma_f32_16x16x32_bf16 v[64:67], a[60:63], v[120:123], v[64:67]
    v_mfma_f32_16x16x32_bf16 v[68:71], a[60:63], v[124:127], v[68:71]
    buffer_load_dwordx4 a[16:19], v5, s[8:11], s45 offen offset:0 sc1
    v_mfma_f32_16x16x32_bf16 v[72:75], a[64:67], v[120:123], v[72:75]
    v_mfma_f32_16x16x32_bf16 v[76:79], a[64:67], v[124:127], v[76:79]
    buffer_load_dwordx4 a[20:23], v5, s[8:11], s45 offen offset:1024 sc1
    v_mfma_f32_16x16x32_bf16 v[80:83], a[68:71], v[120:123], v[80:83]
    v_mfma_f32_16x16x32_bf16 v[84:87], a[68:71], v[124:127], v[84:87]
    buffer_load_dwordx4 a[24:27], v5, s[8:11], s45 offen offset:2048 sc1
    v_mfma_f32_16x16x32_bf16 v[88:91], a[72:75], v[120:123], v[88:91]
    v_mfma_f32_16x16x32_bf16 v[92:95], a[72:75], v[124:127], v[92:95]
    buffer_load_dwordx4 a[28:31], v5, s[8:11], s45 offen offset:3072 sc1
    v_mfma_f32_16x16x32_bf16 v[96:99], a[76:79], v[120:123], v[96:99]
    v_mfma_f32_16x16x32_bf16 v[100:103], a[76:79], v[124:127], v[100:103]
    buffer_load_dwordx4 a[32:35], v6, s[8:11], s45 offen offset:0 sc1
    v_mfma_f32_16x16x32_bf16 v[104:107], a[80:83], v[120:123], v[104:107]
    v_mfma_f32_16x16x32_bf16 v[108:111], a[80:83], v[124:127], v[108:111]
    buffer_load_dwordx4 a[36:39], v6, s[8:11], s45 offen offset:1024 sc1
    v_mfma_f32_16x16x32_bf16 v[112:115], a[84:87], v[120:123], v[112:115]
    v_mfma_f32_16x16x32_bf16 v[116:119], a[84:87], v[124:127], v[116:119]
    s_add_u32 s45, s45, 10240
    ds_read_b128 v[120:123], v16 offset:36864
    ds_read_b128 v[124:127], v16 offset:38912
    s_waitcnt vmcnt(32)
    s_waitcnt lgkmcnt(2)
    v_mfma_f32_16x16x32_bf16 v[32:35], a[88:91], v[128:131], v[32:35]
    v_mfma_f32_16x16x32_bf16 v[36:39], a[88:91], v[132:135], v[36:39]
    buffer_load_dwordx4 a[44:47], v4, s[8:11], s45 offen offset:0 sc1
    v_mfma_f32_16x16x32_bf16 v[40:43], a[92:95], v[128:131], v[40:43]
    v_mfma_f32_16x16x32_bf16 v[44:47], a[92:95], v[132:135], v[44:47]
    buffer_load_dwordx4 a[48:51], v4, s[8:11], s45 offen offset:1024 sc1
    v_mfma_f32_16x16x32_bf16 v[48:51], a[96:99], v[128:131], v[48:51]
    v_mfma_f32_16x16x32_bf16 v[52:55], a[96:99], v[132:135], v[52:55]
    buffer_load_dwordx4 a[52:55], v4, s[8:11], s45 offen offset:2048 sc1
    v_mfma_f32_16x16x32_bf16 v[56:59], a[100:103], v[128:131], v[56:59]
    v_mfma_f32_16x16x32_bf16 v[60:63], a[100:103], v[132:135], v[60:63]
    buffer_load_dwordx4 a[56:59], v4, s[8:11], s45 offen offset:3072 sc1
    v_mfma_f32_16x16x32_bf16 v[64:67], a[104:107], v[128:131], v[64:67]
    v_mfma_f32_16x16x32_bf16 v[68:71], a[104:107], v[132:135], v[68:71]
    buffer_load_dwordx4 a[60:63], v5, s[8:11], s45 offen offset:0 sc1
    v_mfma_f32_16x16x32_bf16 v[72:75], a[108:111], v[128:131], v[72:75]
    v_mfma_f32_16x16x32_bf16 v[76:79], a[108:111], v[132:135], v[76:79]
    buffer_load_dwordx4 a[64:67], v5, s[8:11], s45 offen offset:1024 sc1
    v_mfma_f32_16x16x32_bf16 v[80:83], a[112:115], v[128:131], v[80:83]
    v_mfma_f32_16x16x32_bf16 v[84:87], a[112:115], v[132:135], v[84:87]
    buffer_load_dwordx4 a[68:71], v5, s[8:11], s45 offen offset:2048 sc1
    v_mfma_f32_16x16x32_bf16 v[88:91], a[116:119], v[128:131], v[88:91]
    v_mfma_f32_16x16x32_bf16 v[92:95], a[116:119], v[132:135], v[92:95]
    buffer_load_dwordx4 a[72:75], v5, s[8:11], s45 offen offset:3072 sc1
    v_mfma_f32_16x16x32_bf16 v[96:99], a[120:123], v[128:131], v[96:99]
    v_mfma_f32_16x16x32_bf16 v[100:103], a[120:123], v[132:135], v[100:103]
    buffer_load_dwordx4 a[76:79], v6, s[8:11], s45 offen offset:0 sc1
    v_mfma_f32_16x16x32_bf16 v[104:107], a[124:127], v[128:131], v[104:107]
    v_mfma_f32_16x16x32_bf16 v[108:111], a[124:127], v[132:135], v[108:111]
    buffer_load_dwordx4 a[80:83], v6, s[8:11], s45 offen offset:1024 sc1
    v_mfma_f32_16x16x32_bf16 v[112:115], a[128:131], v[128:131], v[112:115]
    v_mfma_f32_16x16x32_bf16 v[116:119], a[128:131], v[132:135], v[116:119]
    s_add_u32 s45, s45, 10240
    ds_read_b128 v[128:131], v17 offset:36864
    ds_read_b128 v[132:135], v17 offset:38912
    s_waitcnt vmcnt(31)
    s_waitcnt lgkmcnt(2)
    v_mfma_f32_16x16x32_bf16 v[32:35], a[132:135], v[120:123], v[32:35]
    v_mfma_f32_16x16x32_bf16 v[36:39], a[132:135], v[124:127], v[36:39]
    buffer_load_dwordx4 a[88:91], v4, s[8:11], s45 offen offset:0 sc1
    v_mfma_f32_16x16x32_bf16 v[40:43], a[136:139], v[120:123], v[40:43]
    v_mfma_f32_16x16x32_bf16 v[44:47], a[136:139], v[124:127], v[44:47]
    buffer_load_dwordx4 a[92:95], v4, s[8:11], s45 offen offset:1024 sc1
    v_mfma_f32_16x16x32_bf16 v[48:51], a[140:143], v[120:123], v[48:51]
    v_mfma_f32_16x16x32_bf16 v[52:55], a[140:143], v[124:127], v[52:55]
    buffer_load_dwordx4 a[96:99], v4, s[8:11], s45 offen offset:2048 sc1
    v_mfma_f32_16x16x32_bf16 v[56:59], a[144:147], v[120:123], v[56:59]
    v_mfma_f32_16x16x32_bf16 v[60:63], a[144:147], v[124:127], v[60:63]
    buffer_load_dwordx4 a[100:103], v4, s[8:11], s45 offen offset:3072 sc1
    v_mfma_f32_16x16x32_bf16 v[64:67], a[148:151], v[120:123], v[64:67]
    v_mfma_f32_16x16x32_bf16 v[68:71], a[148:151], v[124:127], v[68:71]
    buffer_load_dwordx4 a[104:107], v5, s[8:11], s45 offen offset:0 sc1
    v_mfma_f32_16x16x32_bf16 v[72:75], a[152:155], v[120:123], v[72:75]
    v_mfma_f32_16x16x32_bf16 v[76:79], a[152:155], v[124:127], v[76:79]
    buffer_load_dwordx4 a[108:111], v5, s[8:11], s45 offen offset:1024 sc1
    v_mfma_f32_16x16x32_bf16 v[80:83], a[156:159], v[120:123], v[80:83]
    v_mfma_f32_16x16x32_bf16 v[84:87], a[156:159], v[124:127], v[84:87]
    buffer_load_dwordx4 a[112:115], v5, s[8:11], s45 offen offset:2048 sc1
    v_mfma_f32_16x16x32_bf16 v[88:91], a[160:163], v[120:123], v[88:91]
    v_mfma_f32_16x16x32_bf16 v[92:95], a[160:163], v[124:127], v[92:95]
    buffer_load_dwordx4 a[116:119], v5, s[8:11], s45 offen offset:3072 sc1
    v_mfma_f32_16x16x32_bf16 v[96:99], a[164:167], v[120:123], v[96:99]
    v_mfma_f32_16x16x32_bf16 v[100:103], a[164:167], v[124:127], v[100:103]
    buffer_load_dwordx4 a[120:123], v6, s[8:11], s45 offen offset:0 sc1
    v_mfma_f32_16x16x32_bf16 v[104:107], a[168:171], v[120:123], v[104:107]
    v_mfma_f32_16x16x32_bf16 v[108:111], a[168:171], v[124:127], v[108:111]
    buffer_load_dwordx4 a[124:127], v6, s[8:11], s45 offen offset:1024 sc1
    v_mfma_f32_16x16x32_bf16 v[112:115], a[172:175], v[120:123], v[112:115]
    v_mfma_f32_16x16x32_bf16 v[116:119], a[172:175], v[124:127], v[116:119]
    s_add_u32 s45, s45, 10240
    s_waitcnt vmcnt(30)
    s_waitcnt lgkmcnt(0)
    v_mfma_f32_16x16x32_bf16 v[32:35], a[176:179], v[128:131], v[32:35]
    v_mfma_f32_16x16x32_bf16 v[36:39], a[176:179], v[132:135], v[36:39]
    buffer_load_dwordx4 a[132:135], v4, s[8:11], s45 offen offset:0 sc1
    v_mfma_f32_16x16x32_bf16 v[40:43], a[180:183], v[128:131], v[40:43]
    v_mfma_f32_16x16x32_bf16 v[44:47], a[180:183], v[132:135], v[44:47]
    buffer_load_dwordx4 a[136:139], v4, s[8:11], s45 offen offset:1024 sc1
    v_mfma_f32_16x16x32_bf16 v[48:51], a[184:187], v[128:131], v[48:51]
    v_mfma_f32_16x16x32_bf16 v[52:55], a[184:187], v[132:135], v[52:55]
    buffer_load_dwordx4 a[140:143], v4, s[8:11], s45 offen offset:2048 sc1
    v_mfma_f32_16x16x32_bf16 v[56:59], a[188:191], v[128:131], v[56:59]
    v_mfma_f32_16x16x32_bf16 v[60:63], a[188:191], v[132:135], v[60:63]
    buffer_load_dwordx4 a[144:147], v4, s[8:11], s45 offen offset:3072 sc1
    v_mfma_f32_16x16x32_bf16 v[64:67], a[192:195], v[128:131], v[64:67]
    v_mfma_f32_16x16x32_bf16 v[68:71], a[192:195], v[132:135], v[68:71]
    buffer_load_dwordx4 a[148:151], v5, s[8:11], s45 offen offset:0 sc1
    v_mfma_f32_16x16x32_bf16 v[72:75], a[196:199], v[128:131], v[72:75]
    v_mfma_f32_16x16x32_bf16 v[76:79], a[196:199], v[132:135], v[76:79]
    buffer_load_dwordx4 a[152:155], v5, s[8:11], s45 offen offset:1024 sc1
    v_mfma_f32_16x16x32_bf16 v[80:83], a[200:203], v[128:131], v[80:83]
    v_mfma_f32_16x16x32_bf16 v[84:87], a[200:203], v[132:135], v[84:87]
    buffer_load_dwordx4 a[156:159], v5, s[8:11], s45 offen offset:2048 sc1
    v_mfma_f32_16x16x32_bf16 v[88:91], a[204:207], v[128:131], v[88:91]
    v_mfma_f32_16x16x32_bf16 v[92:95], a[204:207], v[132:135], v[92:95]
    buffer_load_dwordx4 a[160:163], v5, s[8:11], s45 offen offset:3072 sc1
    v_mfma_f32_16x16x32_bf16 v[96:99], a[208:211], v[128:131], v[96:99]
    v_mfma_f32_16x16x32_bf16 v[100:103], a[208:211], v[132:135], v[100:103]
    buffer_load_dwordx4 a[164:167], v6, s[8:11], s45 offen offset:0 sc1
    v_mfma_f32_16x16x32_bf16 v[104:107], a[212:215], v[128:131], v[104:107]
    v_mfma_f32_16x16x32_bf16 v[108:111], a[212:215], v[132:135], v[108:111]
    buffer_load_dwordx4 a[168:171], v6, s[8:11], s45 offen offset:1024 sc1
    v_mfma_f32_16x16x32_bf16 v[112:115], a[216:219], v[128:131], v[112:115]
    v_mfma_f32_16x16x32_bf16 v[116:119], a[216:219], v[132:135], v[116:119]
    s_add_u32 s45, s45, 10240
    s_mul_i32 s46, s3, 36864
    s_add_u32 s46, s46, 8175616
    s_mul_i32 s30, s3, 10240
    s_add_u32 s30, s30, 40960
    v_add_u32 v10, s30, v4
    v_add_u32 v11, 40960, v4
    v_mov_b32 v226, 0
    v_mov_b32 v227, 0
    v_mov_b32 v230, 0
    v_mov_b32 v231, 0
    buffer_load_dwordx4 v[136:139], v4, s[8:11], s46 offen offset:0 sc1
    buffer_load_dwordx4 v[140:143], v4, s[8:11], s46 offen offset:1024 sc1
    buffer_load_dwordx4 v[144:147], v4, s[8:11], s46 offen offset:2048 sc1
    buffer_load_dwordx4 v[148:151], v4, s[8:11], s46 offen offset:3072 sc1
    s_add_u32 s46, s46, 4096
    buffer_load_dwordx4 v[152:155], v4, s[8:11], s46 offen offset:0 sc1
    buffer_load_dwordx4 v[156:159], v4, s[8:11], s46 offen offset:1024 sc1
    buffer_load_dwordx4 v[160:163], v4, s[8:11], s46 offen offset:2048 sc1
    buffer_load_dwordx4 v[164:167], v4, s[8:11], s46 offen offset:3072 sc1
    s_add_u32 s46, s46, 4096
    buffer_load_dwordx4 v[168:171], v4, s[8:11], s46 offen offset:0 sc1
    buffer_load_dwordx4 v[172:175], v4, s[8:11], s46 offen offset:1024 sc1
    buffer_load_dwordx4 v[176:179], v4, s[8:11], s46 offen offset:2048 sc1
    buffer_load_dwordx4 v[180:183], v4, s[8:11], s46 offen offset:3072 sc1
    s_add_u32 s46, s46, 4096
    buffer_load_dwordx4 v[184:187], v4, s[8:11], s46 offen offset:0 sc1
    buffer_load_dwordx4 v[188:191], v4, s[8:11], s46 offen offset:1024 sc1
    buffer_load_dwordx4 v[192:195], v4, s[8:11], s46 offen offset:2048 sc1
    buffer_load_dwordx4 v[196:199], v4, s[8:11], s46 offen offset:3072 sc1
    s_add_u32 s46, s46, 4096
    buffer_load_dwordx4 v[200:203], v4, s[8:11], s46 offen offset:0 sc1
    buffer_load_dwordx4 v[204:207], v4, s[8:11], s46 offen offset:1024 sc1
    s_add_u32 s46, s46, 2048
    v_mul_f32 v232, s60, v32
    v_mul_f32 v233, s60, v33
    v_mul_f32 v234, s60, v34
    v_mul_f32 v235, s60, v35
    v_mul_f32 v236, s60, v36
    v_mul_f32 v237, s60, v37
    v_mul_f32 v238, s60, v38
    v_mul_f32 v239, s60, v39
    v_exp_f32 v232, v232 clamp
    v_exp_f32 v233, v233 clamp
    v_exp_f32 v234, v234 clamp
    v_exp_f32 v235, v235 clamp
    v_exp_f32 v236, v236 clamp
    v_exp_f32 v237, v237 clamp
    v_exp_f32 v238, v238 clamp
    v_exp_f32 v239, v239 clamp
    v_max_f32 v32, 0, v32
    v_max_f32 v33, 0, v33
    v_max_f32 v34, 0, v34
    v_max_f32 v35, 0, v35
    v_max_f32 v36, 0, v36
    v_max_f32 v37, 0, v37
    v_max_f32 v38, 0, v38
    v_max_f32 v39, 0, v39
    v_add_f32 v232, v232, v32
    v_add_f32 v233, v233, v33
    v_add_f32 v234, v234, v34
    v_add_f32 v235, v235, v35
    v_add_f32 v236, v236, v36
    v_add_f32 v237, v237, v37
    v_add_f32 v238, v238, v38
    v_add_f32 v239, v239, v39
    v_add_f32 v232, s61, v232
    v_add_f32 v233, s61, v233
    v_add_f32 v234, s61, v234
    v_add_f32 v235, s61, v235
    v_add_f32 v236, s61, v236
    v_add_f32 v237, s61, v237
    v_add_f32 v238, s61, v238
    v_add_f32 v239, s61, v239
    v_cvt_pk_bf16_f32 v208, v232, v233
    v_cvt_pk_bf16_f32 v209, v234, v235
    v_cvt_pk_bf16_f32 v212, v236, v237
    v_cvt_pk_bf16_f32 v213, v238, v239
    v_mul_f32 v232, s60, v40
    v_mul_f32 v233, s60, v41
    v_mul_f32 v234, s60, v42
    v_mul_f32 v235, s60, v43
    v_mul_f32 v236, s60, v44
    v_mul_f32 v237, s60, v45
    v_mul_f32 v238, s60, v46
    v_mul_f32 v239, s60, v47
    v_exp_f32 v232, v232 clamp
    v_exp_f32 v233, v233 clamp
    v_exp_f32 v234, v234 clamp
    v_exp_f32 v235, v235 clamp
    v_exp_f32 v236, v236 clamp
    v_exp_f32 v237, v237 clamp
    v_exp_f32 v238, v238 clamp
    v_exp_f32 v239, v239 clamp
    v_max_f32 v40, 0, v40
    v_max_f32 v41, 0, v41
    v_max_f32 v42, 0, v42
    v_max_f32 v43, 0, v43
    v_max_f32 v44, 0, v44
    v_max_f32 v45, 0, v45
    v_max_f32 v46, 0, v46
    v_max_f32 v47, 0, v47
    v_add_f32 v232, v232, v40
    v_add_f32 v233, v233, v41
    v_add_f32 v234, v234, v42
    v_add_f32 v235, v235, v43
    v_add_f32 v236, v236, v44
    v_add_f32 v237, v237, v45
    v_add_f32 v238, v238, v46
    v_add_f32 v239, v239, v47
    v_add_f32 v232, s61, v232
    v_add_f32 v233, s61, v233
    v_add_f32 v234, s61, v234
    v_add_f32 v235, s61, v235
    v_add_f32 v236, s61, v236
    v_add_f32 v237, s61, v237
    v_add_f32 v238, s61, v238
    v_add_f32 v239, s61, v239
    v_cvt_pk_bf16_f32 v210, v232, v233
    v_cvt_pk_bf16_f32 v211, v234, v235
    v_cvt_pk_bf16_f32 v214, v236, v237
    v_cvt_pk_bf16_f32 v215, v238, v239
    v_mul_f32 v232, s60, v48
    v_mul_f32 v233, s60, v49
    v_mul_f32 v234, s60, v50
    v_mul_f32 v235, s60, v51
    v_mul_f32 v236, s60, v52
    v_mul_f32 v237, s60, v53
    v_mul_f32 v238, s60, v54
    v_mul_f32 v239, s60, v55
    v_exp_f32 v232, v232 clamp
    v_exp_f32 v233, v233 clamp
    v_exp_f32 v234, v234 clamp
    v_exp_f32 v235, v235 clamp
    v_exp_f32 v236, v236 clamp
    v_exp_f32 v237, v237 clamp
    v_exp_f32 v238, v238 clamp
    v_exp_f32 v239, v239 clamp
    v_max_f32 v48, 0, v48
    v_max_f32 v49, 0, v49
    v_max_f32 v50, 0, v50
    v_max_f32 v51, 0, v51
    v_max_f32 v52, 0, v52
    v_max_f32 v53, 0, v53
    v_max_f32 v54, 0, v54
    v_max_f32 v55, 0, v55
    v_add_f32 v232, v232, v48
    v_add_f32 v233, v233, v49
    v_add_f32 v234, v234, v50
    v_add_f32 v235, v235, v51
    v_add_f32 v236, v236, v52
    v_add_f32 v237, v237, v53
    v_add_f32 v238, v238, v54
    v_add_f32 v239, v239, v55
    v_add_f32 v232, s61, v232
    v_add_f32 v233, s61, v233
    v_add_f32 v234, s61, v234
    v_add_f32 v235, s61, v235
    v_add_f32 v236, s61, v236
    v_add_f32 v237, s61, v237
    v_add_f32 v238, s61, v238
    v_add_f32 v239, s61, v239
    v_cvt_pk_bf16_f32 v216, v232, v233
    v_cvt_pk_bf16_f32 v217, v234, v235
    v_cvt_pk_bf16_f32 v220, v236, v237
    v_cvt_pk_bf16_f32 v221, v238, v239
    v_mul_f32 v232, s60, v56
    v_mul_f32 v233, s60, v57
    v_mul_f32 v234, s60, v58
    v_mul_f32 v235, s60, v59
    v_mul_f32 v236, s60, v60
    v_mul_f32 v237, s60, v61
    v_mul_f32 v238, s60, v62
    v_mul_f32 v239, s60, v63
    v_exp_f32 v232, v232 clamp
    v_exp_f32 v233, v233 clamp
    v_exp_f32 v234, v234 clamp
    v_exp_f32 v235, v235 clamp
    v_exp_f32 v236, v236 clamp
    v_exp_f32 v237, v237 clamp
    v_exp_f32 v238, v238 clamp
    v_exp_f32 v239, v239 clamp
    v_max_f32 v56, 0, v56
    v_max_f32 v57, 0, v57
    v_max_f32 v58, 0, v58
    v_max_f32 v59, 0, v59
    v_max_f32 v60, 0, v60
    v_max_f32 v61, 0, v61
    v_max_f32 v62, 0, v62
    v_max_f32 v63, 0, v63
    v_add_f32 v232, v232, v56
    v_add_f32 v233, v233, v57
    v_add_f32 v234, v234, v58
    v_add_f32 v235, v235, v59
    v_add_f32 v236, v236, v60
    v_add_f32 v237, v237, v61
    v_add_f32 v238, v238, v62
    v_add_f32 v239, v239, v63
    v_add_f32 v232, s61, v232
    v_add_f32 v233, s61, v233
    v_add_f32 v234, s61, v234
    v_add_f32 v235, s61, v235
    v_add_f32 v236, s61, v236
    v_add_f32 v237, s61, v237
    v_add_f32 v238, s61, v238
    v_add_f32 v239, s61, v239
    v_cvt_pk_bf16_f32 v218, v232, v233
    v_cvt_pk_bf16_f32 v219, v234, v235
    v_cvt_pk_bf16_f32 v222, v236, v237
    v_cvt_pk_bf16_f32 v223, v238, v239
    v_mul_f32 v232, s60, v64
    v_mul_f32 v233, s60, v65
    v_mul_f32 v234, s60, v66
    v_mul_f32 v235, s60, v67
    v_mul_f32 v236, s60, v68
    v_mul_f32 v237, s60, v69
    v_mul_f32 v238, s60, v70
    v_mul_f32 v239, s60, v71
    v_exp_f32 v232, v232 clamp
    v_exp_f32 v233, v233 clamp
    v_exp_f32 v234, v234 clamp
    v_exp_f32 v235, v235 clamp
    v_exp_f32 v236, v236 clamp
    v_exp_f32 v237, v237 clamp
    v_exp_f32 v238, v238 clamp
    v_exp_f32 v239, v239 clamp
    v_max_f32 v64, 0, v64
    v_max_f32 v65, 0, v65
    v_max_f32 v66, 0, v66
    v_max_f32 v67, 0, v67
    v_max_f32 v68, 0, v68
    v_max_f32 v69, 0, v69
    v_max_f32 v70, 0, v70
    v_max_f32 v71, 0, v71
    v_add_f32 v232, v232, v64
    v_add_f32 v233, v233, v65
    v_add_f32 v234, v234, v66
    v_add_f32 v235, v235, v67
    v_add_f32 v236, v236, v68
    v_add_f32 v237, v237, v69
    v_add_f32 v238, v238, v70
    v_add_f32 v239, v239, v71
    v_add_f32 v232, s61, v232
    v_add_f32 v233, s61, v233
    v_add_f32 v234, s61, v234
    v_add_f32 v235, s61, v235
    v_add_f32 v236, s61, v236
    v_add_f32 v237, s61, v237
    v_add_f32 v238, s61, v238
    v_add_f32 v239, s61, v239
    v_cvt_pk_bf16_f32 v224, v232, v233
    v_cvt_pk_bf16_f32 v225, v234, v235
    v_cvt_pk_bf16_f32 v228, v236, v237
    v_cvt_pk_bf16_f32 v229, v238, v239
    s_waitcnt vmcnt(0)
    v_mfma_f32_16x16x32_bf16 v[120:123], v[136:139], v[208:211], 0
    v_mfma_f32_16x16x32_bf16 v[124:127], v[136:139], v[212:215], 0
    v_mfma_f32_16x16x32_bf16 v[128:131], v[172:175], v[208:211], 0
    v_mfma_f32_16x16x32_bf16 v[132:135], v[172:175], v[212:215], 0
    s_nop 7
    v_add_f32 v232, s61, v128
    v_add_f32 v233, s61, v129
    v_add_f32 v234, s61, v130
    v_add_f32 v235, s61, v131
    v_add_f32 v236, s61, v132
    v_add_f32 v237, s61, v133
    v_add_f32 v238, s61, v134
    v_add_f32 v239, s61, v135
    v_rcp_f32 v232, v232
    v_rcp_f32 v233, v233
    v_rcp_f32 v234, v234
    v_rcp_f32 v235, v235
    v_rcp_f32 v236, v236
    v_rcp_f32 v237, v237
    v_rcp_f32 v238, v238
    v_rcp_f32 v239, v239
    v_mul_f32 v232, v120, v232
    v_mul_f32 v233, v121, v233
    v_mul_f32 v234, v122, v234
    v_mul_f32 v235, v123, v235
    v_mul_f32 v236, v124, v236
    v_mul_f32 v237, v125, v237
    v_mul_f32 v238, v126, v238
    v_mul_f32 v239, v127, v239
    v_cvt_pk_bf16_f32 v240, v232, v233
    v_cvt_pk_bf16_f32 v241, v234, v235
    ds_write_b64 v10, v[240:241] offset:0
    v_cvt_pk_bf16_f32 v242, v236, v237
    v_cvt_pk_bf16_f32 v243, v238, v239
    ds_write_b64 v10, v[242:243] offset:1024
    v_mfma_f32_16x16x32_bf16 v[120:123], v[140:143], v[208:211], 0
    v_mfma_f32_16x16x32_bf16 v[124:127], v[140:143], v[212:215], 0
    v_mfma_f32_16x16x32_bf16 v[128:131], v[176:179], v[208:211], 0
    v_mfma_f32_16x16x32_bf16 v[132:135], v[176:179], v[212:215], 0
    v_mfma_f32_16x16x32_bf16 v[120:123], v[144:147], v[216:219], v[120:123]
    v_mfma_f32_16x16x32_bf16 v[124:127], v[144:147], v[220:223], v[124:127]
    v_mfma_f32_16x16x32_bf16 v[128:131], v[180:183], v[216:219], v[128:131]
    v_mfma_f32_16x16x32_bf16 v[132:135], v[180:183], v[220:223], v[132:135]
    s_nop 7
    v_add_f32 v232, s61, v128
    v_add_f32 v233, s61, v129
    v_add_f32 v234, s61, v130
    v_add_f32 v235, s61, v131
    v_add_f32 v236, s61, v132
    v_add_f32 v237, s61, v133
    v_add_f32 v238, s61, v134
    v_add_f32 v239, s61, v135
    v_rcp_f32 v232, v232
    v_rcp_f32 v233, v233
    v_rcp_f32 v234, v234
    v_rcp_f32 v235, v235
    v_rcp_f32 v236, v236
    v_rcp_f32 v237, v237
    v_rcp_f32 v238, v238
    v_rcp_f32 v239, v239
    v_mul_f32 v232, v120, v232
    v_mul_f32 v233, v121, v233
    v_mul_f32 v234, v122, v234
    v_mul_f32 v235, v123, v235
    v_mul_f32 v236, v124, v236
    v_mul_f32 v237, v125, v237
    v_mul_f32 v238, v126, v238
    v_mul_f32 v239, v127, v239
    v_cvt_pk_bf16_f32 v240, v232, v233
    v_cvt_pk_bf16_f32 v241, v234, v235
    ds_write_b64 v10, v[240:241] offset:8
    v_cvt_pk_bf16_f32 v242, v236, v237
    v_cvt_pk_bf16_f32 v243, v238, v239
    ds_write_b64 v10, v[242:243] offset:1032
    v_mfma_f32_16x16x32_bf16 v[120:123], v[148:151], v[208:211], 0
    v_mfma_f32_16x16x32_bf16 v[124:127], v[148:151], v[212:215], 0
    v_mfma_f32_16x16x32_bf16 v[128:131], v[184:187], v[208:211], 0
    v_mfma_f32_16x16x32_bf16 v[132:135], v[184:187], v[212:215], 0
    v_mfma_f32_16x16x32_bf16 v[120:123], v[152:155], v[216:219], v[120:123]
    v_mfma_f32_16x16x32_bf16 v[124:127], v[152:155], v[220:223], v[124:127]
    v_mfma_f32_16x16x32_bf16 v[128:131], v[188:191], v[216:219], v[128:131]
    v_mfma_f32_16x16x32_bf16 v[132:135], v[188:191], v[220:223], v[132:135]
    s_nop 7
    v_add_f32 v232, s61, v128
    v_add_f32 v233, s61, v129
    v_add_f32 v234, s61, v130
    v_add_f32 v235, s61, v131
    v_add_f32 v236, s61, v132
    v_add_f32 v237, s61, v133
    v_add_f32 v238, s61, v134
    v_add_f32 v239, s61, v135
    v_rcp_f32 v232, v232
    v_rcp_f32 v233, v233
    v_rcp_f32 v234, v234
    v_rcp_f32 v235, v235
    v_rcp_f32 v236, v236
    v_rcp_f32 v237, v237
    v_rcp_f32 v238, v238
    v_rcp_f32 v239, v239
    v_mul_f32 v232, v120, v232
    v_mul_f32 v233, v121, v233
    v_mul_f32 v234, v122, v234
    v_mul_f32 v235, v123, v235
    v_mul_f32 v236, v124, v236
    v_mul_f32 v237, v125, v237
    v_mul_f32 v238, v126, v238
    v_mul_f32 v239, v127, v239
    v_cvt_pk_bf16_f32 v240, v232, v233
    v_cvt_pk_bf16_f32 v241, v234, v235
    ds_write_b64 v10, v[240:241] offset:2048
    v_cvt_pk_bf16_f32 v242, v236, v237
    v_cvt_pk_bf16_f32 v243, v238, v239
    ds_write_b64 v10, v[242:243] offset:3072
    v_mfma_f32_16x16x32_bf16 v[120:123], v[156:159], v[216:219], 0
    v_mfma_f32_16x16x32_bf16 v[124:127], v[156:159], v[220:223], 0
    v_mfma_f32_16x16x32_bf16 v[128:131], v[192:195], v[216:219], 0
    v_mfma_f32_16x16x32_bf16 v[132:135], v[192:195], v[220:223], 0
    v_mfma_f32_16x16x32_bf16 v[120:123], v[160:163], v[224:227], v[120:123]
    v_mfma_f32_16x16x32_bf16 v[124:127], v[160:163], v[228:231], v[124:127]
    v_mfma_f32_16x16x32_bf16 v[128:131], v[196:199], v[224:227], v[128:131]
    v_mfma_f32_16x16x32_bf16 v[132:135], v[196:199], v[228:231], v[132:135]
    s_nop 7
    v_add_f32 v232, s61, v128
    v_add_f32 v233, s61, v129
    v_add_f32 v234, s61, v130
    v_add_f32 v235, s61, v131
    v_add_f32 v236, s61, v132
    v_add_f32 v237, s61, v133
    v_add_f32 v238, s61, v134
    v_add_f32 v239, s61, v135
    v_rcp_f32 v232, v232
    v_rcp_f32 v233, v233
    v_rcp_f32 v234, v234
    v_rcp_f32 v235, v235
    v_rcp_f32 v236, v236
    v_rcp_f32 v237, v237
    v_rcp_f32 v238, v238
    v_rcp_f32 v239, v239
    v_mul_f32 v232, v120, v232
    v_mul_f32 v233, v121, v233
    v_mul_f32 v234, v122, v234
    v_mul_f32 v235, v123, v235
    v_mul_f32 v236, v124, v236
    v_mul_f32 v237, v125, v237
    v_mul_f32 v238, v126, v238
    v_mul_f32 v239, v127, v239
    v_cvt_pk_bf16_f32 v240, v232, v233
    v_cvt_pk_bf16_f32 v241, v234, v235
    ds_write_b64 v10, v[240:241] offset:2056
    v_cvt_pk_bf16_f32 v242, v236, v237
    v_cvt_pk_bf16_f32 v243, v238, v239
    ds_write_b64 v10, v[242:243] offset:3080
    v_mfma_f32_16x16x32_bf16 v[120:123], v[164:167], v[216:219], 0
    v_mfma_f32_16x16x32_bf16 v[124:127], v[164:167], v[220:223], 0
    v_mfma_f32_16x16x32_bf16 v[128:131], v[200:203], v[216:219], 0
    v_mfma_f32_16x16x32_bf16 v[132:135], v[200:203], v[220:223], 0
    v_mfma_f32_16x16x32_bf16 v[120:123], v[168:171], v[224:227], v[120:123]
    v_mfma_f32_16x16x32_bf16 v[124:127], v[168:171], v[228:231], v[124:127]
    v_mfma_f32_16x16x32_bf16 v[128:131], v[204:207], v[224:227], v[128:131]
    v_mfma_f32_16x16x32_bf16 v[132:135], v[204:207], v[228:231], v[132:135]
    s_nop 7
    v_add_f32 v232, s61, v128
    v_add_f32 v233, s61, v129
    v_add_f32 v234, s61, v130
    v_add_f32 v235, s61, v131
    v_add_f32 v236, s61, v132
    v_add_f32 v237, s61, v133
    v_add_f32 v238, s61, v134
    v_add_f32 v239, s61, v135
    v_rcp_f32 v232, v232
    v_rcp_f32 v233, v233
    v_rcp_f32 v234, v234
    v_rcp_f32 v235, v235
    v_rcp_f32 v236, v236
    v_rcp_f32 v237, v237
    v_rcp_f32 v238, v238
    v_rcp_f32 v239, v239
    v_mul_f32 v232, v120, v232
    v_mul_f32 v233, v121, v233
    v_mul_f32 v234, v122, v234
    v_mul_f32 v235, v123, v235
    v_mul_f32 v236, v124, v236
    v_mul_f32 v237, v125, v237
    v_mul_f32 v238, v126, v238
    v_mul_f32 v239, v127, v239
    v_cvt_pk_bf16_f32 v240, v232, v233
    v_cvt_pk_bf16_f32 v241, v234, v235
    ds_write_b64 v10, v[240:241] offset:4096
    v_cvt_pk_bf16_f32 v242, v236, v237
    v_cvt_pk_bf16_f32 v243, v238, v239
    ds_write_b64 v10, v[242:243] offset:5120
    buffer_load_dwordx4 v[136:139], v4, s[8:11], s46 offen offset:0 sc1
    buffer_load_dwordx4 v[140:143], v4, s[8:11], s46 offen offset:1024 sc1
    buffer_load_dwordx4 v[144:147], v4, s[8:11], s46 offen offset:2048 sc1
    buffer_load_dwordx4 v[148:151], v4, s[8:11], s46 offen offset:3072 sc1
    s_add_u32 s46, s46, 4096
    buffer_load_dwordx4 v[152:155], v4, s[8:11], s46 offen offset:0 sc1
    buffer_load_dwordx4 v[156:159], v4, s[8:11], s46 offen offset:1024 sc1
    buffer_load_dwordx4 v[160:163], v4, s[8:11], s46 offen offset:2048 sc1
    buffer_load_dwordx4 v[164:167], v4, s[8:11], s46 offen offset:3072 sc1
    s_add_u32 s46, s46, 4096
    buffer_load_dwordx4 v[168:171], v4, s[8:11], s46 offen offset:0 sc1
    buffer_load_dwordx4 v[172:175], v4, s[8:11], s46 offen offset:1024 sc1
    buffer_load_dwordx4 v[176:179], v4, s[8:11], s46 offen offset:2048 sc1
    buffer_load_dwordx4 v[180:183], v4, s[8:11], s46 offen offset:3072 sc1
    s_add_u32 s46, s46, 4096
    buffer_load_dwordx4 v[184:187], v4, s[8:11], s46 offen offset:0 sc1
    buffer_load_dwordx4 v[188:191], v4, s[8:11], s46 offen offset:1024 sc1
    buffer_load_dwordx4 v[192:195], v4, s[8:11], s46 offen offset:2048 sc1
    buffer_load_dwordx4 v[196:199], v4, s[8:11], s46 offen offset:3072 sc1
    s_add_u32 s46, s46, 4096
    buffer_load_dwordx4 v[200:203], v4, s[8:11], s46 offen offset:0 sc1
    buffer_load_dwordx4 v[204:207], v4, s[8:11], s46 offen offset:1024 sc1
    s_add_u32 s46, s46, 2048
    v_mul_f32 v232, s60, v72
    v_mul_f32 v233, s60, v73
    v_mul_f32 v234, s60, v74
    v_mul_f32 v235, s60, v75
    v_mul_f32 v236, s60, v76
    v_mul_f32 v237, s60, v77
    v_mul_f32 v238, s60, v78
    v_mul_f32 v239, s60, v79
    v_exp_f32 v232, v232 clamp
    v_exp_f32 v233, v233 clamp
    v_exp_f32 v234, v234 clamp
    v_exp_f32 v235, v235 clamp
    v_exp_f32 v236, v236 clamp
    v_exp_f32 v237, v237 clamp
    v_exp_f32 v238, v238 clamp
    v_exp_f32 v239, v239 clamp
    v_max_f32 v72, 0, v72
    v_max_f32 v73, 0, v73
    v_max_f32 v74, 0, v74
    v_max_f32 v75, 0, v75
    v_max_f32 v76, 0, v76
    v_max_f32 v77, 0, v77
    v_max_f32 v78, 0, v78
    v_max_f32 v79, 0, v79
    v_add_f32 v232, v232, v72
    v_add_f32 v233, v233, v73
    v_add_f32 v234, v234, v74
    v_add_f32 v235, v235, v75
    v_add_f32 v236, v236, v76
    v_add_f32 v237, v237, v77
    v_add_f32 v238, v238, v78
    v_add_f32 v239, v239, v79
    v_add_f32 v232, s61, v232
    v_add_f32 v233, s61, v233
    v_add_f32 v234, s61, v234
    v_add_f32 v235, s61, v235
    v_add_f32 v236, s61, v236
    v_add_f32 v237, s61, v237
    v_add_f32 v238, s61, v238
    v_add_f32 v239, s61, v239
    v_cvt_pk_bf16_f32 v208, v232, v233
    v_cvt_pk_bf16_f32 v209, v234, v235
    v_cvt_pk_bf16_f32 v212, v236, v237
    v_cvt_pk_bf16_f32 v213, v238, v239
    v_mul_f32 v232, s60, v80
    v_mul_f32 v233, s60, v81
    v_mul_f32 v234, s60, v82
    v_mul_f32 v235, s60, v83
    v_mul_f32 v236, s60, v84
    v_mul_f32 v237, s60, v85
    v_mul_f32 v238, s60, v86
    v_mul_f32 v239, s60, v87
    v_exp_f32 v232, v232 clamp
    v_exp_f32 v233, v233 clamp
    v_exp_f32 v234, v234 clamp
    v_exp_f32 v235, v235 clamp
    v_exp_f32 v236, v236 clamp
    v_exp_f32 v237, v237 clamp
    v_exp_f32 v238, v238 clamp
    v_exp_f32 v239, v239 clamp
    v_max_f32 v80, 0, v80
    v_max_f32 v81, 0, v81
    v_max_f32 v82, 0, v82
    v_max_f32 v83, 0, v83
    v_max_f32 v84, 0, v84
    v_max_f32 v85, 0, v85
    v_max_f32 v86, 0, v86
    v_max_f32 v87, 0, v87
    v_add_f32 v232, v232, v80
    v_add_f32 v233, v233, v81
    v_add_f32 v234, v234, v82
    v_add_f32 v235, v235, v83
    v_add_f32 v236, v236, v84
    v_add_f32 v237, v237, v85
    v_add_f32 v238, v238, v86
    v_add_f32 v239, v239, v87
    v_add_f32 v232, s61, v232
    v_add_f32 v233, s61, v233
    v_add_f32 v234, s61, v234
    v_add_f32 v235, s61, v235
    v_add_f32 v236, s61, v236
    v_add_f32 v237, s61, v237
    v_add_f32 v238, s61, v238
    v_add_f32 v239, s61, v239
    v_cvt_pk_bf16_f32 v210, v232, v233
    v_cvt_pk_bf16_f32 v211, v234, v235
    v_cvt_pk_bf16_f32 v214, v236, v237
    v_cvt_pk_bf16_f32 v215, v238, v239
    v_mul_f32 v232, s60, v88
    v_mul_f32 v233, s60, v89
    v_mul_f32 v234, s60, v90
    v_mul_f32 v235, s60, v91
    v_mul_f32 v236, s60, v92
    v_mul_f32 v237, s60, v93
    v_mul_f32 v238, s60, v94
    v_mul_f32 v239, s60, v95
    v_exp_f32 v232, v232 clamp
    v_exp_f32 v233, v233 clamp
    v_exp_f32 v234, v234 clamp
    v_exp_f32 v235, v235 clamp
    v_exp_f32 v236, v236 clamp
    v_exp_f32 v237, v237 clamp
    v_exp_f32 v238, v238 clamp
    v_exp_f32 v239, v239 clamp
    v_max_f32 v88, 0, v88
    v_max_f32 v89, 0, v89
    v_max_f32 v90, 0, v90
    v_max_f32 v91, 0, v91
    v_max_f32 v92, 0, v92
    v_max_f32 v93, 0, v93
    v_max_f32 v94, 0, v94
    v_max_f32 v95, 0, v95
    v_add_f32 v232, v232, v88
    v_add_f32 v233, v233, v89
    v_add_f32 v234, v234, v90
    v_add_f32 v235, v235, v91
    v_add_f32 v236, v236, v92
    v_add_f32 v237, v237, v93
    v_add_f32 v238, v238, v94
    v_add_f32 v239, v239, v95
    v_add_f32 v232, s61, v232
    v_add_f32 v233, s61, v233
    v_add_f32 v234, s61, v234
    v_add_f32 v235, s61, v235
    v_add_f32 v236, s61, v236
    v_add_f32 v237, s61, v237
    v_add_f32 v238, s61, v238
    v_add_f32 v239, s61, v239
    v_cvt_pk_bf16_f32 v216, v232, v233
    v_cvt_pk_bf16_f32 v217, v234, v235
    v_cvt_pk_bf16_f32 v220, v236, v237
    v_cvt_pk_bf16_f32 v221, v238, v239
    v_mul_f32 v232, s60, v96
    v_mul_f32 v233, s60, v97
    v_mul_f32 v234, s60, v98
    v_mul_f32 v235, s60, v99
    v_mul_f32 v236, s60, v100
    v_mul_f32 v237, s60, v101
    v_mul_f32 v238, s60, v102
    v_mul_f32 v239, s60, v103
    v_exp_f32 v232, v232 clamp
    v_exp_f32 v233, v233 clamp
    v_exp_f32 v234, v234 clamp
    v_exp_f32 v235, v235 clamp
    v_exp_f32 v236, v236 clamp
    v_exp_f32 v237, v237 clamp
    v_exp_f32 v238, v238 clamp
    v_exp_f32 v239, v239 clamp
    v_max_f32 v96, 0, v96
    v_max_f32 v97, 0, v97
    v_max_f32 v98, 0, v98
    v_max_f32 v99, 0, v99
    v_max_f32 v100, 0, v100
    v_max_f32 v101, 0, v101
    v_max_f32 v102, 0, v102
    v_max_f32 v103, 0, v103
    v_add_f32 v232, v232, v96
    v_add_f32 v233, v233, v97
    v_add_f32 v234, v234, v98
    v_add_f32 v235, v235, v99
    v_add_f32 v236, v236, v100
    v_add_f32 v237, v237, v101
    v_add_f32 v238, v238, v102
    v_add_f32 v239, v239, v103
    v_add_f32 v232, s61, v232
    v_add_f32 v233, s61, v233
    v_add_f32 v234, s61, v234
    v_add_f32 v235, s61, v235
    v_add_f32 v236, s61, v236
    v_add_f32 v237, s61, v237
    v_add_f32 v238, s61, v238
    v_add_f32 v239, s61, v239
    v_cvt_pk_bf16_f32 v218, v232, v233
    v_cvt_pk_bf16_f32 v219, v234, v235
    v_cvt_pk_bf16_f32 v222, v236, v237
    v_cvt_pk_bf16_f32 v223, v238, v239
    v_mul_f32 v232, s60, v104
    v_mul_f32 v233, s60, v105
    v_mul_f32 v234, s60, v106
    v_mul_f32 v235, s60, v107
    v_mul_f32 v236, s60, v108
    v_mul_f32 v237, s60, v109
    v_mul_f32 v238, s60, v110
    v_mul_f32 v239, s60, v111
    v_exp_f32 v232, v232 clamp
    v_exp_f32 v233, v233 clamp
    v_exp_f32 v234, v234 clamp
    v_exp_f32 v235, v235 clamp
    v_exp_f32 v236, v236 clamp
    v_exp_f32 v237, v237 clamp
    v_exp_f32 v238, v238 clamp
    v_exp_f32 v239, v239 clamp
    v_max_f32 v104, 0, v104
    v_max_f32 v105, 0, v105
    v_max_f32 v106, 0, v106
    v_max_f32 v107, 0, v107
    v_max_f32 v108, 0, v108
    v_max_f32 v109, 0, v109
    v_max_f32 v110, 0, v110
    v_max_f32 v111, 0, v111
    v_add_f32 v232, v232, v104
    v_add_f32 v233, v233, v105
    v_add_f32 v234, v234, v106
    v_add_f32 v235, v235, v107
    v_add_f32 v236, v236, v108
    v_add_f32 v237, v237, v109
    v_add_f32 v238, v238, v110
    v_add_f32 v239, v239, v111
    v_add_f32 v232, s61, v232
    v_add_f32 v233, s61, v233
    v_add_f32 v234, s61, v234
    v_add_f32 v235, s61, v235
    v_add_f32 v236, s61, v236
    v_add_f32 v237, s61, v237
    v_add_f32 v238, s61, v238
    v_add_f32 v239, s61, v239
    v_cvt_pk_bf16_f32 v224, v232, v233
    v_cvt_pk_bf16_f32 v225, v234, v235
    v_cvt_pk_bf16_f32 v228, v236, v237
    v_cvt_pk_bf16_f32 v229, v238, v239
    s_waitcnt vmcnt(0)
    v_mfma_f32_16x16x32_bf16 v[120:123], v[136:139], v[208:211], 0
    v_mfma_f32_16x16x32_bf16 v[124:127], v[136:139], v[212:215], 0
    v_mfma_f32_16x16x32_bf16 v[128:131], v[172:175], v[208:211], 0
    v_mfma_f32_16x16x32_bf16 v[132:135], v[172:175], v[212:215], 0
    s_nop 7
    v_add_f32 v232, s61, v128
    v_add_f32 v233, s61, v129
    v_add_f32 v234, s61, v130
    v_add_f32 v235, s61, v131
    v_add_f32 v236, s61, v132
    v_add_f32 v237, s61, v133
    v_add_f32 v238, s61, v134
    v_add_f32 v239, s61, v135
    v_rcp_f32 v232, v232
    v_rcp_f32 v233, v233
    v_rcp_f32 v234, v234
    v_rcp_f32 v235, v235
    v_rcp_f32 v236, v236
    v_rcp_f32 v237, v237
    v_rcp_f32 v238, v238
    v_rcp_f32 v239, v239
    v_mul_f32 v232, v120, v232
    v_mul_f32 v233, v121, v233
    v_mul_f32 v234, v122, v234
    v_mul_f32 v235, v123, v235
    v_mul_f32 v236, v124, v236
    v_mul_f32 v237, v125, v237
    v_mul_f32 v238, v126, v238
    v_mul_f32 v239, v127, v239
    v_cvt_pk_bf16_f32 v240, v232, v233
    v_cvt_pk_bf16_f32 v241, v234, v235
    ds_write_b64 v10, v[240:241] offset:4104
    v_cvt_pk_bf16_f32 v242, v236, v237
    v_cvt_pk_bf16_f32 v243, v238, v239
    ds_write_b64 v10, v[242:243] offset:5128
    v_mfma_f32_16x16x32_bf16 v[120:123], v[140:143], v[208:211], 0
    v_mfma_f32_16x16x32_bf16 v[124:127], v[140:143], v[212:215], 0
    v_mfma_f32_16x16x32_bf16 v[128:131], v[176:179], v[208:211], 0
    v_mfma_f32_16x16x32_bf16 v[132:135], v[176:179], v[212:215], 0
    v_mfma_f32_16x16x32_bf16 v[120:123], v[144:147], v[216:219], v[120:123]
    v_mfma_f32_16x16x32_bf16 v[124:127], v[144:147], v[220:223], v[124:127]
    v_mfma_f32_16x16x32_bf16 v[128:131], v[180:183], v[216:219], v[128:131]
    v_mfma_f32_16x16x32_bf16 v[132:135], v[180:183], v[220:223], v[132:135]
    s_nop 7
    v_add_f32 v232, s61, v128
    v_add_f32 v233, s61, v129
    v_add_f32 v234, s61, v130
    v_add_f32 v235, s61, v131
    v_add_f32 v236, s61, v132
    v_add_f32 v237, s61, v133
    v_add_f32 v238, s61, v134
    v_add_f32 v239, s61, v135
    v_rcp_f32 v232, v232
    v_rcp_f32 v233, v233
    v_rcp_f32 v234, v234
    v_rcp_f32 v235, v235
    v_rcp_f32 v236, v236
    v_rcp_f32 v237, v237
    v_rcp_f32 v238, v238
    v_rcp_f32 v239, v239
    v_mul_f32 v232, v120, v232
    v_mul_f32 v233, v121, v233
    v_mul_f32 v234, v122, v234
    v_mul_f32 v235, v123, v235
    v_mul_f32 v236, v124, v236
    v_mul_f32 v237, v125, v237
    v_mul_f32 v238, v126, v238
    v_mul_f32 v239, v127, v239
    v_cvt_pk_bf16_f32 v240, v232, v233
    v_cvt_pk_bf16_f32 v241, v234, v235
    ds_write_b64 v10, v[240:241] offset:6144
    v_cvt_pk_bf16_f32 v242, v236, v237
    v_cvt_pk_bf16_f32 v243, v238, v239
    ds_write_b64 v10, v[242:243] offset:7168
    v_mfma_f32_16x16x32_bf16 v[120:123], v[148:151], v[208:211], 0
    v_mfma_f32_16x16x32_bf16 v[124:127], v[148:151], v[212:215], 0
    v_mfma_f32_16x16x32_bf16 v[128:131], v[184:187], v[208:211], 0
    v_mfma_f32_16x16x32_bf16 v[132:135], v[184:187], v[212:215], 0
    v_mfma_f32_16x16x32_bf16 v[120:123], v[152:155], v[216:219], v[120:123]
    v_mfma_f32_16x16x32_bf16 v[124:127], v[152:155], v[220:223], v[124:127]
    v_mfma_f32_16x16x32_bf16 v[128:131], v[188:191], v[216:219], v[128:131]
    v_mfma_f32_16x16x32_bf16 v[132:135], v[188:191], v[220:223], v[132:135]
    s_nop 7
    v_add_f32 v232, s61, v128
    v_add_f32 v233, s61, v129
    v_add_f32 v234, s61, v130
    v_add_f32 v235, s61, v131
    v_add_f32 v236, s61, v132
    v_add_f32 v237, s61, v133
    v_add_f32 v238, s61, v134
    v_add_f32 v239, s61, v135
    v_rcp_f32 v232, v232
    v_rcp_f32 v233, v233
    v_rcp_f32 v234, v234
    v_rcp_f32 v235, v235
    v_rcp_f32 v236, v236
    v_rcp_f32 v237, v237
    v_rcp_f32 v238, v238
    v_rcp_f32 v239, v239
    v_mul_f32 v232, v120, v232
    v_mul_f32 v233, v121, v233
    v_mul_f32 v234, v122, v234
    v_mul_f32 v235, v123, v235
    v_mul_f32 v236, v124, v236
    v_mul_f32 v237, v125, v237
    v_mul_f32 v238, v126, v238
    v_mul_f32 v239, v127, v239
    v_cvt_pk_bf16_f32 v240, v232, v233
    v_cvt_pk_bf16_f32 v241, v234, v235
    ds_write_b64 v10, v[240:241] offset:6152
    v_cvt_pk_bf16_f32 v242, v236, v237
    v_cvt_pk_bf16_f32 v243, v238, v239
    ds_write_b64 v10, v[242:243] offset:7176
    v_mfma_f32_16x16x32_bf16 v[120:123], v[156:159], v[216:219], 0
    v_mfma_f32_16x16x32_bf16 v[124:127], v[156:159], v[220:223], 0
    v_mfma_f32_16x16x32_bf16 v[128:131], v[192:195], v[216:219], 0
    v_mfma_f32_16x16x32_bf16 v[132:135], v[192:195], v[220:223], 0
    v_mfma_f32_16x16x32_bf16 v[120:123], v[160:163], v[224:227], v[120:123]
    v_mfma_f32_16x16x32_bf16 v[124:127], v[160:163], v[228:231], v[124:127]
    v_mfma_f32_16x16x32_bf16 v[128:131], v[196:199], v[224:227], v[128:131]
    v_mfma_f32_16x16x32_bf16 v[132:135], v[196:199], v[228:231], v[132:135]
    s_nop 7
    v_add_f32 v232, s61, v128
    v_add_f32 v233, s61, v129
    v_add_f32 v234, s61, v130
    v_add_f32 v235, s61, v131
    v_add_f32 v236, s61, v132
    v_add_f32 v237, s61, v133
    v_add_f32 v238, s61, v134
    v_add_f32 v239, s61, v135
    v_rcp_f32 v232, v232
    v_rcp_f32 v233, v233
    v_rcp_f32 v234, v234
    v_rcp_f32 v235, v235
    v_rcp_f32 v236, v236
    v_rcp_f32 v237, v237
    v_rcp_f32 v238, v238
    v_rcp_f32 v239, v239
    v_mul_f32 v232, v120, v232
    v_mul_f32 v233, v121, v233
    v_mul_f32 v234, v122, v234
    v_mul_f32 v235, v123, v235
    v_mul_f32 v236, v124, v236
    v_mul_f32 v237, v125, v237
    v_mul_f32 v238, v126, v238
    v_mul_f32 v239, v127, v239
    v_cvt_pk_bf16_f32 v240, v232, v233
    v_cvt_pk_bf16_f32 v241, v234, v235
    ds_write_b64 v10, v[240:241] offset:8192
    v_cvt_pk_bf16_f32 v242, v236, v237
    v_cvt_pk_bf16_f32 v243, v238, v239
    ds_write_b64 v10, v[242:243] offset:9216
    v_mfma_f32_16x16x32_bf16 v[120:123], v[164:167], v[216:219], 0
    v_mfma_f32_16x16x32_bf16 v[124:127], v[164:167], v[220:223], 0
    v_mfma_f32_16x16x32_bf16 v[128:131], v[200:203], v[216:219], 0
    v_mfma_f32_16x16x32_bf16 v[132:135], v[200:203], v[220:223], 0
    v_mfma_f32_16x16x32_bf16 v[120:123], v[168:171], v[224:227], v[120:123]
    v_mfma_f32_16x16x32_bf16 v[124:127], v[168:171], v[228:231], v[124:127]
    v_mfma_f32_16x16x32_bf16 v[128:131], v[204:207], v[224:227], v[128:131]
    v_mfma_f32_16x16x32_bf16 v[132:135], v[204:207], v[228:231], v[132:135]
    s_nop 7
    v_add_f32 v232, s61, v128
    v_add_f32 v233, s61, v129
    v_add_f32 v234, s61, v130
    v_add_f32 v235, s61, v131
    v_add_f32 v236, s61, v132
    v_add_f32 v237, s61, v133
    v_add_f32 v238, s61, v134
    v_add_f32 v239, s61, v135
    v_rcp_f32 v232, v232
    v_rcp_f32 v233, v233
    v_rcp_f32 v234, v234
    v_rcp_f32 v235, v235
    v_rcp_f32 v236, v236
    v_rcp_f32 v237, v237
    v_rcp_f32 v238, v238
    v_rcp_f32 v239, v239
    v_mul_f32 v232, v120, v232
    v_mul_f32 v233, v121, v233
    v_mul_f32 v234, v122, v234
    v_mul_f32 v235, v123, v235
    v_mul_f32 v236, v124, v236
    v_mul_f32 v237, v125, v237
    v_mul_f32 v238, v126, v238
    v_mul_f32 v239, v127, v239
    v_cvt_pk_bf16_f32 v240, v232, v233
    v_cvt_pk_bf16_f32 v241, v234, v235
    ds_write_b64 v10, v[240:241] offset:8200
    v_cvt_pk_bf16_f32 v242, v236, v237
    v_cvt_pk_bf16_f32 v243, v238, v239
    ds_write_b64 v10, v[242:243] offset:9224
    v_mul_f32 v20, s60, v112
    v_exp_f32 v20, -v20
    s_nop 0
    v_add_f32 v20, 1.0, v20
    v_rcp_f32 v20, v20
    s_nop 0
    v_sub_f32 v22, 1.0, v20
    v_mul_f32 v21, s60, v116
    v_exp_f32 v21, -v21
    s_nop 0
    v_add_f32 v21, 1.0, v21
    v_rcp_f32 v21, v21
    s_nop 0
    v_sub_f32 v23, 1.0, v21
    s_waitcnt lgkmcnt(0)
    s_barrier
    ds_read_b128 v[120:123], v11 offset:0
    ds_read_b128 v[124:127], v11 offset:1024
    ds_read_b128 v[128:131], v11 offset:2048
    ds_read_b128 v[132:135], v11 offset:3072
    s_waitcnt vmcnt(63)
    s_waitcnt lgkmcnt(2)
    v_mfma_f32_16x16x32_bf16 v[32:35], a[0:3], v[120:123], 0
    v_mfma_f32_16x16x32_bf16 v[36:39], a[0:3], v[124:127], 0
    buffer_load_dwordx4 a[176:179], v4, s[8:11], s45 offen offset:0 sc1
    v_mfma_f32_16x16x32_bf16 v[40:43], a[4:7], v[120:123], 0
    v_mfma_f32_16x16x32_bf16 v[44:47], a[4:7], v[124:127], 0
    buffer_load_dwordx4 a[180:183], v4, s[8:11], s45 offen offset:1024 sc1
    v_mfma_f32_16x16x32_bf16 v[48:51], a[8:11], v[120:123], 0
    v_mfma_f32_16x16x32_bf16 v[52:55], a[8:11], v[124:127], 0
    buffer_load_dwordx4 a[184:187], v4, s[8:11], s45 offen offset:2048 sc1
    v_mfma_f32_16x16x32_bf16 v[56:59], a[12:15], v[120:123], 0
    v_mfma_f32_16x16x32_bf16 v[60:63], a[12:15], v[124:127], 0
    buffer_load_dwordx4 a[188:191], v4, s[8:11], s45 offen offset:3072 sc1
    v_mfma_f32_16x16x32_bf16 v[64:67], a[16:19], v[120:123], 0
    v_mfma_f32_16x16x32_bf16 v[68:71], a[16:19], v[124:127], 0
    buffer_load_dwordx4 a[192:195], v5, s[8:11], s45 offen offset:0 sc1
    v_mfma_f32_16x16x32_bf16 v[72:75], a[20:23], v[120:123], 0
    v_mfma_f32_16x16x32_bf16 v[76:79], a[20:23], v[124:127], 0
    buffer_load_dwordx4 a[196:199], v5, s[8:11], s45 offen offset:1024 sc1
    v_mfma_f32_16x16x32_bf16 v[80:83], a[24:27], v[120:123], 0
    v_mfma_f32_16x16x32_bf16 v[84:87], a[24:27], v[124:127], 0
    buffer_load_dwordx4 a[200:203], v5, s[8:11], s45 offen offset:2048 sc1
    v_mfma_f32_16x16x32_bf16 v[88:91], a[28:31], v[120:123], 0
    v_mfma_f32_16x16x32_bf16 v[92:95], a[28:31], v[124:127], 0
    buffer_load_dwordx4 a[204:207], v5, s[8:11], s45 offen offset:3072 sc1
    v_mfma_f32_16x16x32_bf16 v[96:99], a[32:35], v[120:123], 0
    v_mfma_f32_16x16x32_bf16 v[100:103], a[32:35], v[124:127], 0
    buffer_load_dwordx4 a[208:211], v6, s[8:11], s45 offen offset:0 sc1
    v_mfma_f32_16x16x32_bf16 v[104:107], a[36:39], v[120:123], 0
    v_mfma_f32_16x16x32_bf16 v[108:111], a[36:39], v[124:127], 0
    buffer_load_dwordx4 a[212:215], v6, s[8:11], s45 offen offset:1024 sc1
    s_add_u32 s45, s45, 10240
    ds_read_b128 v[120:123], v11 offset:4096
    ds_read_b128 v[124:127], v11 offset:5120
    s_waitcnt vmcnt(63)
    s_waitcnt lgkmcnt(2)
    v_mfma_f32_16x16x32_bf16 v[32:35], a[44:47], v[128:131], v[32:35]
    v_mfma_f32_16x16x32_bf16 v[36:39], a[44:47], v[132:135], v[36:39]
    buffer_load_dwordx4 a[0:3], v4, s[8:11], s45 offen offset:0 sc1
    v_mfma_f32_16x16x32_bf16 v[40:43], a[48:51], v[128:131], v[40:43]
    v_mfma_f32_16x16x32_bf16 v[44:47], a[48:51], v[132:135], v[44:47]
    buffer_load_dwordx4 a[4:7], v4, s[8:11], s45 offen offset:1024 sc1
    v_mfma_f32_16x16x32_bf16 v[48:51], a[52:55], v[128:131], v[48:51]
    v_mfma_f32_16x16x32_bf16 v[52:55], a[52:55], v[132:135], v[52:55]
    buffer_load_dwordx4 a[8:11], v4, s[8:11], s45 offen offset:2048 sc1
    v_mfma_f32_16x16x32_bf16 v[56:59], a[56:59], v[128:131], v[56:59]
    v_mfma_f32_16x16x32_bf16 v[60:63], a[56:59], v[132:135], v[60:63]
    buffer_load_dwordx4 a[12:15], v4, s[8:11], s45 offen offset:3072 sc1
    v_mfma_f32_16x16x32_bf16 v[64:67], a[60:63], v[128:131], v[64:67]
    v_mfma_f32_16x16x32_bf16 v[68:71], a[60:63], v[132:135], v[68:71]
    buffer_load_dwordx4 a[16:19], v5, s[8:11], s45 offen offset:0 sc1
    v_mfma_f32_16x16x32_bf16 v[72:75], a[64:67], v[128:131], v[72:75]
    v_mfma_f32_16x16x32_bf16 v[76:79], a[64:67], v[132:135], v[76:79]
    buffer_load_dwordx4 a[20:23], v5, s[8:11], s45 offen offset:1024 sc1
    v_mfma_f32_16x16x32_bf16 v[80:83], a[68:71], v[128:131], v[80:83]
    v_mfma_f32_16x16x32_bf16 v[84:87], a[68:71], v[132:135], v[84:87]
    buffer_load_dwordx4 a[24:27], v5, s[8:11], s45 offen offset:2048 sc1
    v_mfma_f32_16x16x32_bf16 v[88:91], a[72:75], v[128:131], v[88:91]
    v_mfma_f32_16x16x32_bf16 v[92:95], a[72:75], v[132:135], v[92:95]
    buffer_load_dwordx4 a[28:31], v5, s[8:11], s45 offen offset:3072 sc1
    v_mfma_f32_16x16x32_bf16 v[96:99], a[76:79], v[128:131], v[96:99]
    v_mfma_f32_16x16x32_bf16 v[100:103], a[76:79], v[132:135], v[100:103]
    buffer_load_dwordx4 a[32:35], v6, s[8:11], s45 offen offset:0 sc1
    v_mfma_f32_16x16x32_bf16 v[104:107], a[80:83], v[128:131], v[104:107]
    v_mfma_f32_16x16x32_bf16 v[108:111], a[80:83], v[132:135], v[108:111]
    buffer_load_dwordx4 a[36:39], v6, s[8:11], s45 offen offset:1024 sc1
    s_add_u32 s45, s45, 10240
    ds_read_b128 v[128:131], v11 offset:6144
    ds_read_b128 v[132:135], v11 offset:7168
    s_waitcnt vmcnt(63)
    s_waitcnt lgkmcnt(2)
    v_mfma_f32_16x16x32_bf16 v[32:35], a[88:91], v[120:123], v[32:35]
    v_mfma_f32_16x16x32_bf16 v[36:39], a[88:91], v[124:127], v[36:39]
    buffer_load_dwordx4 a[44:47], v4, s[8:11], s45 offen offset:0 sc1
    v_mfma_f32_16x16x32_bf16 v[40:43], a[92:95], v[120:123], v[40:43]
    v_mfma_f32_16x16x32_bf16 v[44:47], a[92:95], v[124:127], v[44:47]
    buffer_load_dwordx4 a[48:51], v4, s[8:11], s45 offen offset:1024 sc1
    v_mfma_f32_16x16x32_bf16 v[48:51], a[96:99], v[120:123], v[48:51]
    v_mfma_f32_16x16x32_bf16 v[52:55], a[96:99], v[124:127], v[52:55]
    buffer_load_dwordx4 a[52:55], v4, s[8:11], s45 offen offset:2048 sc1
    v_mfma_f32_16x16x32_bf16 v[56:59], a[100:103], v[120:123], v[56:59]
    v_mfma_f32_16x16x32_bf16 v[60:63], a[100:103], v[124:127], v[60:63]
    buffer_load_dwordx4 a[56:59], v4, s[8:11], s45 offen offset:3072 sc1
    v_mfma_f32_16x16x32_bf16 v[64:67], a[104:107], v[120:123], v[64:67]
    v_mfma_f32_16x16x32_bf16 v[68:71], a[104:107], v[124:127], v[68:71]
    buffer_load_dwordx4 a[60:63], v5, s[8:11], s45 offen offset:0 sc1
    v_mfma_f32_16x16x32_bf16 v[72:75], a[108:111], v[120:123], v[72:75]
    v_mfma_f32_16x16x32_bf16 v[76:79], a[108:111], v[124:127], v[76:79]
    buffer_load_dwordx4 a[64:67], v5, s[8:11], s45 offen offset:1024 sc1
    v_mfma_f32_16x16x32_bf16 v[80:83], a[112:115], v[120:123], v[80:83]
    v_mfma_f32_16x16x32_bf16 v[84:87], a[112:115], v[124:127], v[84:87]
    buffer_load_dwordx4 a[68:71], v5, s[8:11], s45 offen offset:2048 sc1
    v_mfma_f32_16x16x32_bf16 v[88:91], a[116:119], v[120:123], v[88:91]
    v_mfma_f32_16x16x32_bf16 v[92:95], a[116:119], v[124:127], v[92:95]
    buffer_load_dwordx4 a[72:75], v5, s[8:11], s45 offen offset:3072 sc1
    v_mfma_f32_16x16x32_bf16 v[96:99], a[120:123], v[120:123], v[96:99]
    v_mfma_f32_16x16x32_bf16 v[100:103], a[120:123], v[124:127], v[100:103]
    buffer_load_dwordx4 a[76:79], v6, s[8:11], s45 offen offset:0 sc1
    v_mfma_f32_16x16x32_bf16 v[104:107], a[124:127], v[120:123], v[104:107]
    v_mfma_f32_16x16x32_bf16 v[108:111], a[124:127], v[124:127], v[108:111]
    buffer_load_dwordx4 a[80:83], v6, s[8:11], s45 offen offset:1024 sc1
    s_add_u32 s45, s45, 10240
    ds_read_b128 v[120:123], v11 offset:8192
    ds_read_b128 v[124:127], v11 offset:9216
    s_waitcnt vmcnt(63)
    s_waitcnt lgkmcnt(2)
    v_mfma_f32_16x16x32_bf16 v[32:35], a[132:135], v[128:131], v[32:35]
    v_mfma_f32_16x16x32_bf16 v[36:39], a[132:135], v[132:135], v[36:39]
    buffer_load_dwordx4 a[88:91], v4, s[8:11], s45 offen offset:0 sc1
    v_mfma_f32_16x16x32_bf16 v[40:43], a[136:139], v[128:131], v[40:43]
    v_mfma_f32_16x16x32_bf16 v[44:47], a[136:139], v[132:135], v[44:47]
    buffer_load_dwordx4 a[92:95], v4, s[8:11], s45 offen offset:1024 sc1
    v_mfma_f32_16x16x32_bf16 v[48:51], a[140:143], v[128:131], v[48:51]
    v_mfma_f32_16x16x32_bf16 v[52:55], a[140:143], v[132:135], v[52:55]
    buffer_load_dwordx4 a[96:99], v4, s[8:11], s45 offen offset:2048 sc1
    v_mfma_f32_16x16x32_bf16 v[56:59], a[144:147], v[128:131], v[56:59]
    v_mfma_f32_16x16x32_bf16 v[60:63], a[144:147], v[132:135], v[60:63]
    buffer_load_dwordx4 a[100:103], v4, s[8:11], s45 offen offset:3072 sc1
    v_mfma_f32_16x16x32_bf16 v[64:67], a[148:151], v[128:131], v[64:67]
    v_mfma_f32_16x16x32_bf16 v[68:71], a[148:151], v[132:135], v[68:71]
    buffer_load_dwordx4 a[104:107], v5, s[8:11], s45 offen offset:0 sc1
    v_mfma_f32_16x16x32_bf16 v[72:75], a[152:155], v[128:131], v[72:75]
    v_mfma_f32_16x16x32_bf16 v[76:79], a[152:155], v[132:135], v[76:79]
    buffer_load_dwordx4 a[108:111], v5, s[8:11], s45 offen offset:1024 sc1
    v_mfma_f32_16x16x32_bf16 v[80:83], a[156:159], v[128:131], v[80:83]
    v_mfma_f32_16x16x32_bf16 v[84:87], a[156:159], v[132:135], v[84:87]
    buffer_load_dwordx4 a[112:115], v5, s[8:11], s45 offen offset:2048 sc1
    v_mfma_f32_16x16x32_bf16 v[88:91], a[160:163], v[128:131], v[88:91]
    v_mfma_f32_16x16x32_bf16 v[92:95], a[160:163], v[132:135], v[92:95]
    buffer_load_dwordx4 a[116:119], v5, s[8:11], s45 offen offset:3072 sc1
    v_mfma_f32_16x16x32_bf16 v[96:99], a[164:167], v[128:131], v[96:99]
    v_mfma_f32_16x16x32_bf16 v[100:103], a[164:167], v[132:135], v[100:103]
    buffer_load_dwordx4 a[120:123], v6, s[8:11], s45 offen offset:0 sc1
    v_mfma_f32_16x16x32_bf16 v[104:107], a[168:171], v[128:131], v[104:107]
    v_mfma_f32_16x16x32_bf16 v[108:111], a[168:171], v[132:135], v[108:111]
    buffer_load_dwordx4 a[124:127], v6, s[8:11], s45 offen offset:1024 sc1
    s_add_u32 s45, s45, 10240
    ds_read_b128 v[128:131], v11 offset:10240
    ds_read_b128 v[132:135], v11 offset:11264
    s_waitcnt vmcnt(30)
    s_waitcnt lgkmcnt(2)
    v_mfma_f32_16x16x32_bf16 v[32:35], a[176:179], v[120:123], v[32:35]
    v_mfma_f32_16x16x32_bf16 v[36:39], a[176:179], v[124:127], v[36:39]
    buffer_load_dwordx4 a[132:135], v4, s[8:11], s45 offen offset:0 sc1
    v_mfma_f32_16x16x32_bf16 v[40:43], a[180:183], v[120:123], v[40:43]
    v_mfma_f32_16x16x32_bf16 v[44:47], a[180:183], v[124:127], v[44:47]
    buffer_load_dwordx4 a[136:139], v4, s[8:11], s45 offen offset:1024 sc1
    v_mfma_f32_16x16x32_bf16 v[48:51], a[184:187], v[120:123], v[48:51]
    v_mfma_f32_16x16x32_bf16 v[52:55], a[184:187], v[124:127], v[52:55]
    buffer_load_dwordx4 a[140:143], v4, s[8:11], s45 offen offset:2048 sc1
    v_mfma_f32_16x16x32_bf16 v[56:59], a[188:191], v[120:123], v[56:59]
    v_mfma_f32_16x16x32_bf16 v[60:63], a[188:191], v[124:127], v[60:63]
    buffer_load_dwordx4 a[144:147], v4, s[8:11], s45 offen offset:3072 sc1
    v_mfma_f32_16x16x32_bf16 v[64:67], a[192:195], v[120:123], v[64:67]
    v_mfma_f32_16x16x32_bf16 v[68:71], a[192:195], v[124:127], v[68:71]
    buffer_load_dwordx4 a[148:151], v5, s[8:11], s45 offen offset:0 sc1
    v_mfma_f32_16x16x32_bf16 v[72:75], a[196:199], v[120:123], v[72:75]
    v_mfma_f32_16x16x32_bf16 v[76:79], a[196:199], v[124:127], v[76:79]
    buffer_load_dwordx4 a[152:155], v5, s[8:11], s45 offen offset:1024 sc1
    v_mfma_f32_16x16x32_bf16 v[80:83], a[200:203], v[120:123], v[80:83]
    v_mfma_f32_16x16x32_bf16 v[84:87], a[200:203], v[124:127], v[84:87]
    buffer_load_dwordx4 a[156:159], v5, s[8:11], s45 offen offset:2048 sc1
    v_mfma_f32_16x16x32_bf16 v[88:91], a[204:207], v[120:123], v[88:91]
    v_mfma_f32_16x16x32_bf16 v[92:95], a[204:207], v[124:127], v[92:95]
    buffer_load_dwordx4 a[160:163], v5, s[8:11], s45 offen offset:3072 sc1
    v_mfma_f32_16x16x32_bf16 v[96:99], a[208:211], v[120:123], v[96:99]
    v_mfma_f32_16x16x32_bf16 v[100:103], a[208:211], v[124:127], v[100:103]
    buffer_load_dwordx4 a[164:167], v6, s[8:11], s45 offen offset:0 sc1
    v_mfma_f32_16x16x32_bf16 v[104:107], a[212:215], v[120:123], v[104:107]
    v_mfma_f32_16x16x32_bf16 v[108:111], a[212:215], v[124:127], v[108:111]
    buffer_load_dwordx4 a[168:171], v6, s[8:11], s45 offen offset:1024 sc1
    s_add_u32 s45, s45, 10240
    ds_read_b128 v[120:123], v11 offset:12288
    ds_read_b128 v[124:127], v11 offset:13312
    s_waitcnt vmcnt(30)
    s_waitcnt lgkmcnt(2)
    v_mfma_f32_16x16x32_bf16 v[32:35], a[0:3], v[128:131], v[32:35]
    v_mfma_f32_16x16x32_bf16 v[36:39], a[0:3], v[132:135], v[36:39]
    buffer_load_dwordx4 a[176:179], v4, s[8:11], s45 offen offset:0 sc1
    v_mfma_f32_16x16x32_bf16 v[40:43], a[4:7], v[128:131], v[40:43]
    v_mfma_f32_16x16x32_bf16 v[44:47], a[4:7], v[132:135], v[44:47]
    buffer_load_dwordx4 a[180:183], v4, s[8:11], s45 offen offset:1024 sc1
    v_mfma_f32_16x16x32_bf16 v[48:51], a[8:11], v[128:131], v[48:51]
    v_mfma_f32_16x16x32_bf16 v[52:55], a[8:11], v[132:135], v[52:55]
    buffer_load_dwordx4 a[184:187], v4, s[8:11], s45 offen offset:2048 sc1
    v_mfma_f32_16x16x32_bf16 v[56:59], a[12:15], v[128:131], v[56:59]
    v_mfma_f32_16x16x32_bf16 v[60:63], a[12:15], v[132:135], v[60:63]
    buffer_load_dwordx4 a[188:191], v4, s[8:11], s45 offen offset:3072 sc1
    v_mfma_f32_16x16x32_bf16 v[64:67], a[16:19], v[128:131], v[64:67]
    v_mfma_f32_16x16x32_bf16 v[68:71], a[16:19], v[132:135], v[68:71]
    buffer_load_dwordx4 a[192:195], v5, s[8:11], s45 offen offset:0 sc1
    v_mfma_f32_16x16x32_bf16 v[72:75], a[20:23], v[128:131], v[72:75]
    v_mfma_f32_16x16x32_bf16 v[76:79], a[20:23], v[132:135], v[76:79]
    buffer_load_dwordx4 a[196:199], v5, s[8:11], s45 offen offset:1024 sc1
    v_mfma_f32_16x16x32_bf16 v[80:83], a[24:27], v[128:131], v[80:83]
    v_mfma_f32_16x16x32_bf16 v[84:87], a[24:27], v[132:135], v[84:87]
    buffer_load_dwordx4 a[200:203], v5, s[8:11], s45 offen offset:2048 sc1
    v_mfma_f32_16x16x32_bf16 v[88:91], a[28:31], v[128:131], v[88:91]
    v_mfma_f32_16x16x32_bf16 v[92:95], a[28:31], v[132:135], v[92:95]
    buffer_load_dwordx4 a[204:207], v5, s[8:11], s45 offen offset:3072 sc1
    v_mfma_f32_16x16x32_bf16 v[96:99], a[32:35], v[128:131], v[96:99]
    v_mfma_f32_16x16x32_bf16 v[100:103], a[32:35], v[132:135], v[100:103]
    buffer_load_dwordx4 a[208:211], v6, s[8:11], s45 offen offset:0 sc1
    v_mfma_f32_16x16x32_bf16 v[104:107], a[36:39], v[128:131], v[104:107]
    v_mfma_f32_16x16x32_bf16 v[108:111], a[36:39], v[132:135], v[108:111]
    buffer_load_dwordx4 a[212:215], v6, s[8:11], s45 offen offset:1024 sc1
    s_add_u32 s45, s45, 10240
    ds_read_b128 v[128:131], v11 offset:14336
    ds_read_b128 v[132:135], v11 offset:15360
    s_waitcnt vmcnt(30)
    s_waitcnt lgkmcnt(2)
    v_mfma_f32_16x16x32_bf16 v[32:35], a[44:47], v[120:123], v[32:35]
    v_mfma_f32_16x16x32_bf16 v[36:39], a[44:47], v[124:127], v[36:39]
    buffer_load_dwordx4 a[0:3], v4, s[8:11], s45 offen offset:0 sc1
    v_mfma_f32_16x16x32_bf16 v[40:43], a[48:51], v[120:123], v[40:43]
    v_mfma_f32_16x16x32_bf16 v[44:47], a[48:51], v[124:127], v[44:47]
    buffer_load_dwordx4 a[4:7], v4, s[8:11], s45 offen offset:1024 sc1
    v_mfma_f32_16x16x32_bf16 v[48:51], a[52:55], v[120:123], v[48:51]
    v_mfma_f32_16x16x32_bf16 v[52:55], a[52:55], v[124:127], v[52:55]
    buffer_load_dwordx4 a[8:11], v4, s[8:11], s45 offen offset:2048 sc1
    v_mfma_f32_16x16x32_bf16 v[56:59], a[56:59], v[120:123], v[56:59]
    v_mfma_f32_16x16x32_bf16 v[60:63], a[56:59], v[124:127], v[60:63]
    buffer_load_dwordx4 a[12:15], v4, s[8:11], s45 offen offset:3072 sc1
    v_mfma_f32_16x16x32_bf16 v[64:67], a[60:63], v[120:123], v[64:67]
    v_mfma_f32_16x16x32_bf16 v[68:71], a[60:63], v[124:127], v[68:71]
    buffer_load_dwordx4 a[16:19], v5, s[8:11], s45 offen offset:0 sc1
    v_mfma_f32_16x16x32_bf16 v[72:75], a[64:67], v[120:123], v[72:75]
    v_mfma_f32_16x16x32_bf16 v[76:79], a[64:67], v[124:127], v[76:79]
    buffer_load_dwordx4 a[20:23], v5, s[8:11], s45 offen offset:1024 sc1
    v_mfma_f32_16x16x32_bf16 v[80:83], a[68:71], v[120:123], v[80:83]
    v_mfma_f32_16x16x32_bf16 v[84:87], a[68:71], v[124:127], v[84:87]
    buffer_load_dwordx4 a[24:27], v5, s[8:11], s45 offen offset:2048 sc1
    v_mfma_f32_16x16x32_bf16 v[88:91], a[72:75], v[120:123], v[88:91]
    v_mfma_f32_16x16x32_bf16 v[92:95], a[72:75], v[124:127], v[92:95]
    buffer_load_dwordx4 a[28:31], v5, s[8:11], s45 offen offset:3072 sc1
    v_mfma_f32_16x16x32_bf16 v[96:99], a[76:79], v[120:123], v[96:99]
    v_mfma_f32_16x16x32_bf16 v[100:103], a[76:79], v[124:127], v[100:103]
    buffer_load_dwordx4 a[32:35], v6, s[8:11], s45 offen offset:0 sc1
    v_mfma_f32_16x16x32_bf16 v[104:107], a[80:83], v[120:123], v[104:107]
    v_mfma_f32_16x16x32_bf16 v[108:111], a[80:83], v[124:127], v[108:111]
    buffer_load_dwordx4 a[36:39], v6, s[8:11], s45 offen offset:1024 sc1
    s_add_u32 s45, s45, 10240
    ds_read_b128 v[120:123], v11 offset:16384
    ds_read_b128 v[124:127], v11 offset:17408
    s_waitcnt vmcnt(30)
    s_waitcnt lgkmcnt(2)
    v_mfma_f32_16x16x32_bf16 v[32:35], a[88:91], v[128:131], v[32:35]
    v_mfma_f32_16x16x32_bf16 v[36:39], a[88:91], v[132:135], v[36:39]
    buffer_load_dwordx4 a[44:47], v4, s[8:11], s45 offen offset:0 sc1
    v_mfma_f32_16x16x32_bf16 v[40:43], a[92:95], v[128:131], v[40:43]
    v_mfma_f32_16x16x32_bf16 v[44:47], a[92:95], v[132:135], v[44:47]
    buffer_load_dwordx4 a[48:51], v4, s[8:11], s45 offen offset:1024 sc1
    v_mfma_f32_16x16x32_bf16 v[48:51], a[96:99], v[128:131], v[48:51]
    v_mfma_f32_16x16x32_bf16 v[52:55], a[96:99], v[132:135], v[52:55]
    buffer_load_dwordx4 a[52:55], v4, s[8:11], s45 offen offset:2048 sc1
    v_mfma_f32_16x16x32_bf16 v[56:59], a[100:103], v[128:131], v[56:59]
    v_mfma_f32_16x16x32_bf16 v[60:63], a[100:103], v[132:135], v[60:63]
    buffer_load_dwordx4 a[56:59], v4, s[8:11], s45 offen offset:3072 sc1
    v_mfma_f32_16x16x32_bf16 v[64:67], a[104:107], v[128:131], v[64:67]
    v_mfma_f32_16x16x32_bf16 v[68:71], a[104:107], v[132:135], v[68:71]
    buffer_load_dwordx4 a[60:63], v5, s[8:11], s45 offen offset:0 sc1
    v_mfma_f32_16x16x32_bf16 v[72:75], a[108:111], v[128:131], v[72:75]
    v_mfma_f32_16x16x32_bf16 v[76:79], a[108:111], v[132:135], v[76:79]
    buffer_load_dwordx4 a[64:67], v5, s[8:11], s45 offen offset:1024 sc1
    v_mfma_f32_16x16x32_bf16 v[80:83], a[112:115], v[128:131], v[80:83]
    v_mfma_f32_16x16x32_bf16 v[84:87], a[112:115], v[132:135], v[84:87]
    buffer_load_dwordx4 a[68:71], v5, s[8:11], s45 offen offset:2048 sc1
    v_mfma_f32_16x16x32_bf16 v[88:91], a[116:119], v[128:131], v[88:91]
    v_mfma_f32_16x16x32_bf16 v[92:95], a[116:119], v[132:135], v[92:95]
    buffer_load_dwordx4 a[72:75], v5, s[8:11], s45 offen offset:3072 sc1
    v_mfma_f32_16x16x32_bf16 v[96:99], a[120:123], v[128:131], v[96:99]
    v_mfma_f32_16x16x32_bf16 v[100:103], a[120:123], v[132:135], v[100:103]
    buffer_load_dwordx4 a[76:79], v6, s[8:11], s45 offen offset:0 sc1
    v_mfma_f32_16x16x32_bf16 v[104:107], a[124:127], v[128:131], v[104:107]
    v_mfma_f32_16x16x32_bf16 v[108:111], a[124:127], v[132:135], v[108:111]
    buffer_load_dwordx4 a[80:83], v6, s[8:11], s45 offen offset:1024 sc1
    s_add_u32 s45, s45, 10240
    ds_read_b128 v[128:131], v11 offset:18432
    ds_read_b128 v[132:135], v11 offset:19456
    s_waitcnt vmcnt(30)
    s_waitcnt lgkmcnt(2)
    v_mfma_f32_16x16x32_bf16 v[32:35], a[132:135], v[120:123], v[32:35]
    v_mfma_f32_16x16x32_bf16 v[36:39], a[132:135], v[124:127], v[36:39]
    buffer_load_dwordx4 a[88:91], v4, s[8:11], s45 offen offset:0 sc1
    v_mfma_f32_16x16x32_bf16 v[40:43], a[136:139], v[120:123], v[40:43]
    v_mfma_f32_16x16x32_bf16 v[44:47], a[136:139], v[124:127], v[44:47]
    buffer_load_dwordx4 a[92:95], v4, s[8:11], s45 offen offset:1024 sc1
    v_mfma_f32_16x16x32_bf16 v[48:51], a[140:143], v[120:123], v[48:51]
    v_mfma_f32_16x16x32_bf16 v[52:55], a[140:143], v[124:127], v[52:55]
    buffer_load_dwordx4 a[96:99], v4, s[8:11], s45 offen offset:2048 sc1
    v_mfma_f32_16x16x32_bf16 v[56:59], a[144:147], v[120:123], v[56:59]
    v_mfma_f32_16x16x32_bf16 v[60:63], a[144:147], v[124:127], v[60:63]
    buffer_load_dwordx4 a[100:103], v4, s[8:11], s45 offen offset:3072 sc1
    v_mfma_f32_16x16x32_bf16 v[64:67], a[148:151], v[120:123], v[64:67]
    v_mfma_f32_16x16x32_bf16 v[68:71], a[148:151], v[124:127], v[68:71]
    buffer_load_dwordx4 a[104:107], v5, s[8:11], s45 offen offset:0 sc1
    v_mfma_f32_16x16x32_bf16 v[72:75], a[152:155], v[120:123], v[72:75]
    v_mfma_f32_16x16x32_bf16 v[76:79], a[152:155], v[124:127], v[76:79]
    buffer_load_dwordx4 a[108:111], v5, s[8:11], s45 offen offset:1024 sc1
    v_mfma_f32_16x16x32_bf16 v[80:83], a[156:159], v[120:123], v[80:83]
    v_mfma_f32_16x16x32_bf16 v[84:87], a[156:159], v[124:127], v[84:87]
    buffer_load_dwordx4 a[112:115], v5, s[8:11], s45 offen offset:2048 sc1
    v_mfma_f32_16x16x32_bf16 v[88:91], a[160:163], v[120:123], v[88:91]
    v_mfma_f32_16x16x32_bf16 v[92:95], a[160:163], v[124:127], v[92:95]
    buffer_load_dwordx4 a[116:119], v5, s[8:11], s45 offen offset:3072 sc1
    v_mfma_f32_16x16x32_bf16 v[96:99], a[164:167], v[120:123], v[96:99]
    v_mfma_f32_16x16x32_bf16 v[100:103], a[164:167], v[124:127], v[100:103]
    buffer_load_dwordx4 a[120:123], v6, s[8:11], s45 offen offset:0 sc1
    v_mfma_f32_16x16x32_bf16 v[104:107], a[168:171], v[120:123], v[104:107]
    v_mfma_f32_16x16x32_bf16 v[108:111], a[168:171], v[124:127], v[108:111]
    buffer_load_dwordx4 a[124:127], v6, s[8:11], s45 offen offset:1024 sc1
    s_add_u32 s45, s45, 10240
    ds_read_b128 v[120:123], v11 offset:20480
    ds_read_b128 v[124:127], v11 offset:21504
    s_waitcnt vmcnt(30)
    s_waitcnt lgkmcnt(2)
    v_mfma_f32_16x16x32_bf16 v[32:35], a[176:179], v[128:131], v[32:35]
    v_mfma_f32_16x16x32_bf16 v[36:39], a[176:179], v[132:135], v[36:39]
    buffer_load_dwordx4 a[132:135], v4, s[8:11], s45 offen offset:0 sc1
    v_mfma_f32_16x16x32_bf16 v[40:43], a[180:183], v[128:131], v[40:43]
    v_mfma_f32_16x16x32_bf16 v[44:47], a[180:183], v[132:135], v[44:47]
    buffer_load_dwordx4 a[136:139], v4, s[8:11], s45 offen offset:1024 sc1
    v_mfma_f32_16x16x32_bf16 v[48:51], a[184:187], v[128:131], v[48:51]
    v_mfma_f32_16x16x32_bf16 v[52:55], a[184:187], v[132:135], v[52:55]
    buffer_load_dwordx4 a[140:143], v4, s[8:11], s45 offen offset:2048 sc1
    v_mfma_f32_16x16x32_bf16 v[56:59], a[188:191], v[128:131], v[56:59]
    v_mfma_f32_16x16x32_bf16 v[60:63], a[188:191], v[132:135], v[60:63]
    buffer_load_dwordx4 a[144:147], v4, s[8:11], s45 offen offset:3072 sc1
    v_mfma_f32_16x16x32_bf16 v[64:67], a[192:195], v[128:131], v[64:67]
    v_mfma_f32_16x16x32_bf16 v[68:71], a[192:195], v[132:135], v[68:71]
    buffer_load_dwordx4 a[148:151], v5, s[8:11], s45 offen offset:0 sc1
    v_mfma_f32_16x16x32_bf16 v[72:75], a[196:199], v[128:131], v[72:75]
    v_mfma_f32_16x16x32_bf16 v[76:79], a[196:199], v[132:135], v[76:79]
    buffer_load_dwordx4 a[152:155], v5, s[8:11], s45 offen offset:1024 sc1
    v_mfma_f32_16x16x32_bf16 v[80:83], a[200:203], v[128:131], v[80:83]
    v_mfma_f32_16x16x32_bf16 v[84:87], a[200:203], v[132:135], v[84:87]
    buffer_load_dwordx4 a[156:159], v5, s[8:11], s45 offen offset:2048 sc1
    v_mfma_f32_16x16x32_bf16 v[88:91], a[204:207], v[128:131], v[88:91]
    v_mfma_f32_16x16x32_bf16 v[92:95], a[204:207], v[132:135], v[92:95]
    buffer_load_dwordx4 a[160:163], v5, s[8:11], s45 offen offset:3072 sc1
    v_mfma_f32_16x16x32_bf16 v[96:99], a[208:211], v[128:131], v[96:99]
    v_mfma_f32_16x16x32_bf16 v[100:103], a[208:211], v[132:135], v[100:103]
    buffer_load_dwordx4 a[164:167], v6, s[8:11], s45 offen offset:0 sc1
    v_mfma_f32_16x16x32_bf16 v[104:107], a[212:215], v[128:131], v[104:107]
    v_mfma_f32_16x16x32_bf16 v[108:111], a[212:215], v[132:135], v[108:111]
    buffer_load_dwordx4 a[168:171], v6, s[8:11], s45 offen offset:1024 sc1
    s_add_u32 s45, s45, 10240
    ds_read_b128 v[128:131], v11 offset:22528
    ds_read_b128 v[132:135], v11 offset:23552
    s_waitcnt vmcnt(30)
    s_waitcnt lgkmcnt(2)
    v_mfma_f32_16x16x32_bf16 v[32:35], a[0:3], v[120:123], v[32:35]
    v_mfma_f32_16x16x32_bf16 v[36:39], a[0:3], v[124:127], v[36:39]
    buffer_load_dwordx4 a[176:179], v4, s[8:11], s45 offen offset:0 sc1
    v_mfma_f32_16x16x32_bf16 v[40:43], a[4:7], v[120:123], v[40:43]
    v_mfma_f32_16x16x32_bf16 v[44:47], a[4:7], v[124:127], v[44:47]
    buffer_load_dwordx4 a[180:183], v4, s[8:11], s45 offen offset:1024 sc1
    v_mfma_f32_16x16x32_bf16 v[48:51], a[8:11], v[120:123], v[48:51]
    v_mfma_f32_16x16x32_bf16 v[52:55], a[8:11], v[124:127], v[52:55]
    buffer_load_dwordx4 a[184:187], v4, s[8:11], s45 offen offset:2048 sc1
    v_mfma_f32_16x16x32_bf16 v[56:59], a[12:15], v[120:123], v[56:59]
    v_mfma_f32_16x16x32_bf16 v[60:63], a[12:15], v[124:127], v[60:63]
    buffer_load_dwordx4 a[188:191], v4, s[8:11], s45 offen offset:3072 sc1
    v_mfma_f32_16x16x32_bf16 v[64:67], a[16:19], v[120:123], v[64:67]
    v_mfma_f32_16x16x32_bf16 v[68:71], a[16:19], v[124:127], v[68:71]
    buffer_load_dwordx4 a[192:195], v5, s[8:11], s45 offen offset:0 sc1
    v_mfma_f32_16x16x32_bf16 v[72:75], a[20:23], v[120:123], v[72:75]
    v_mfma_f32_16x16x32_bf16 v[76:79], a[20:23], v[124:127], v[76:79]
    buffer_load_dwordx4 a[196:199], v5, s[8:11], s45 offen offset:1024 sc1
    v_mfma_f32_16x16x32_bf16 v[80:83], a[24:27], v[120:123], v[80:83]
    v_mfma_f32_16x16x32_bf16 v[84:87], a[24:27], v[124:127], v[84:87]
    buffer_load_dwordx4 a[200:203], v5, s[8:11], s45 offen offset:2048 sc1
    v_mfma_f32_16x16x32_bf16 v[88:91], a[28:31], v[120:123], v[88:91]
    v_mfma_f32_16x16x32_bf16 v[92:95], a[28:31], v[124:127], v[92:95]
    buffer_load_dwordx4 a[204:207], v5, s[8:11], s45 offen offset:3072 sc1
    v_mfma_f32_16x16x32_bf16 v[96:99], a[32:35], v[120:123], v[96:99]
    v_mfma_f32_16x16x32_bf16 v[100:103], a[32:35], v[124:127], v[100:103]
    buffer_load_dwordx4 a[208:211], v6, s[8:11], s45 offen offset:0 sc1
    v_mfma_f32_16x16x32_bf16 v[104:107], a[36:39], v[120:123], v[104:107]
    v_mfma_f32_16x16x32_bf16 v[108:111], a[36:39], v[124:127], v[108:111]
    buffer_load_dwordx4 a[212:215], v6, s[8:11], s45 offen offset:1024 sc1
    s_add_u32 s45, s45, 10240
    ds_read_b128 v[120:123], v11 offset:24576
    ds_read_b128 v[124:127], v11 offset:25600
    s_waitcnt vmcnt(30)
    s_waitcnt lgkmcnt(2)
    v_mfma_f32_16x16x32_bf16 v[32:35], a[44:47], v[128:131], v[32:35]
    v_mfma_f32_16x16x32_bf16 v[36:39], a[44:47], v[132:135], v[36:39]
    buffer_load_dwordx4 a[0:3], v4, s[8:11], s45 offen offset:0 sc1
    v_mfma_f32_16x16x32_bf16 v[40:43], a[48:51], v[128:131], v[40:43]
    v_mfma_f32_16x16x32_bf16 v[44:47], a[48:51], v[132:135], v[44:47]
    buffer_load_dwordx4 a[4:7], v4, s[8:11], s45 offen offset:1024 sc1
    v_mfma_f32_16x16x32_bf16 v[48:51], a[52:55], v[128:131], v[48:51]
    v_mfma_f32_16x16x32_bf16 v[52:55], a[52:55], v[132:135], v[52:55]
    buffer_load_dwordx4 a[8:11], v4, s[8:11], s45 offen offset:2048 sc1
    v_mfma_f32_16x16x32_bf16 v[56:59], a[56:59], v[128:131], v[56:59]
    v_mfma_f32_16x16x32_bf16 v[60:63], a[56:59], v[132:135], v[60:63]
    buffer_load_dwordx4 a[12:15], v4, s[8:11], s45 offen offset:3072 sc1
    v_mfma_f32_16x16x32_bf16 v[64:67], a[60:63], v[128:131], v[64:67]
    v_mfma_f32_16x16x32_bf16 v[68:71], a[60:63], v[132:135], v[68:71]
    buffer_load_dwordx4 a[16:19], v5, s[8:11], s45 offen offset:0 sc1
    v_mfma_f32_16x16x32_bf16 v[72:75], a[64:67], v[128:131], v[72:75]
    v_mfma_f32_16x16x32_bf16 v[76:79], a[64:67], v[132:135], v[76:79]
    buffer_load_dwordx4 a[20:23], v5, s[8:11], s45 offen offset:1024 sc1
    v_mfma_f32_16x16x32_bf16 v[80:83], a[68:71], v[128:131], v[80:83]
    v_mfma_f32_16x16x32_bf16 v[84:87], a[68:71], v[132:135], v[84:87]
    buffer_load_dwordx4 a[24:27], v5, s[8:11], s45 offen offset:2048 sc1
    v_mfma_f32_16x16x32_bf16 v[88:91], a[72:75], v[128:131], v[88:91]
    v_mfma_f32_16x16x32_bf16 v[92:95], a[72:75], v[132:135], v[92:95]
    buffer_load_dwordx4 a[28:31], v5, s[8:11], s45 offen offset:3072 sc1
    v_mfma_f32_16x16x32_bf16 v[96:99], a[76:79], v[128:131], v[96:99]
    v_mfma_f32_16x16x32_bf16 v[100:103], a[76:79], v[132:135], v[100:103]
    buffer_load_dwordx4 a[32:35], v6, s[8:11], s45 offen offset:0 sc1
    v_mfma_f32_16x16x32_bf16 v[104:107], a[80:83], v[128:131], v[104:107]
    v_mfma_f32_16x16x32_bf16 v[108:111], a[80:83], v[132:135], v[108:111]
    buffer_load_dwordx4 a[36:39], v6, s[8:11], s45 offen offset:1024 sc1
    s_add_u32 s45, s45, 10240
    ds_read_b128 v[128:131], v11 offset:26624
    ds_read_b128 v[132:135], v11 offset:27648
    s_waitcnt vmcnt(30)
    s_waitcnt lgkmcnt(2)
    v_mfma_f32_16x16x32_bf16 v[32:35], a[88:91], v[120:123], v[32:35]
    v_mfma_f32_16x16x32_bf16 v[36:39], a[88:91], v[124:127], v[36:39]
    buffer_load_dwordx4 a[44:47], v4, s[8:11], s45 offen offset:0 sc1
    v_mfma_f32_16x16x32_bf16 v[40:43], a[92:95], v[120:123], v[40:43]
    v_mfma_f32_16x16x32_bf16 v[44:47], a[92:95], v[124:127], v[44:47]
    buffer_load_dwordx4 a[48:51], v4, s[8:11], s45 offen offset:1024 sc1
    v_mfma_f32_16x16x32_bf16 v[48:51], a[96:99], v[120:123], v[48:51]
    v_mfma_f32_16x16x32_bf16 v[52:55], a[96:99], v[124:127], v[52:55]
    buffer_load_dwordx4 a[52:55], v4, s[8:11], s45 offen offset:2048 sc1
    v_mfma_f32_16x16x32_bf16 v[56:59], a[100:103], v[120:123], v[56:59]
    v_mfma_f32_16x16x32_bf16 v[60:63], a[100:103], v[124:127], v[60:63]
    buffer_load_dwordx4 a[56:59], v4, s[8:11], s45 offen offset:3072 sc1
    v_mfma_f32_16x16x32_bf16 v[64:67], a[104:107], v[120:123], v[64:67]
    v_mfma_f32_16x16x32_bf16 v[68:71], a[104:107], v[124:127], v[68:71]
    buffer_load_dwordx4 a[60:63], v5, s[8:11], s45 offen offset:0 sc1
    v_mfma_f32_16x16x32_bf16 v[72:75], a[108:111], v[120:123], v[72:75]
    v_mfma_f32_16x16x32_bf16 v[76:79], a[108:111], v[124:127], v[76:79]
    buffer_load_dwordx4 a[64:67], v5, s[8:11], s45 offen offset:1024 sc1
    v_mfma_f32_16x16x32_bf16 v[80:83], a[112:115], v[120:123], v[80:83]
    v_mfma_f32_16x16x32_bf16 v[84:87], a[112:115], v[124:127], v[84:87]
    buffer_load_dwordx4 a[68:71], v5, s[8:11], s45 offen offset:2048 sc1
    v_mfma_f32_16x16x32_bf16 v[88:91], a[116:119], v[120:123], v[88:91]
    v_mfma_f32_16x16x32_bf16 v[92:95], a[116:119], v[124:127], v[92:95]
    buffer_load_dwordx4 a[72:75], v5, s[8:11], s45 offen offset:3072 sc1
    v_mfma_f32_16x16x32_bf16 v[96:99], a[120:123], v[120:123], v[96:99]
    v_mfma_f32_16x16x32_bf16 v[100:103], a[120:123], v[124:127], v[100:103]
    buffer_load_dwordx4 a[76:79], v6, s[8:11], s45 offen offset:0 sc1
    v_mfma_f32_16x16x32_bf16 v[104:107], a[124:127], v[120:123], v[104:107]
    v_mfma_f32_16x16x32_bf16 v[108:111], a[124:127], v[124:127], v[108:111]
    buffer_load_dwordx4 a[80:83], v6, s[8:11], s45 offen offset:1024 sc1
    s_add_u32 s45, s45, 10240
    ds_read_b128 v[120:123], v11 offset:28672
    ds_read_b128 v[124:127], v11 offset:29696
    s_waitcnt vmcnt(30)
    s_waitcnt lgkmcnt(2)
    v_mfma_f32_16x16x32_bf16 v[32:35], a[132:135], v[128:131], v[32:35]
    v_mfma_f32_16x16x32_bf16 v[36:39], a[132:135], v[132:135], v[36:39]
    buffer_load_dwordx4 a[88:91], v4, s[8:11], s45 offen offset:0 sc1
    v_mfma_f32_16x16x32_bf16 v[40:43], a[136:139], v[128:131], v[40:43]
    v_mfma_f32_16x16x32_bf16 v[44:47], a[136:139], v[132:135], v[44:47]
    buffer_load_dwordx4 a[92:95], v4, s[8:11], s45 offen offset:1024 sc1
    v_mfma_f32_16x16x32_bf16 v[48:51], a[140:143], v[128:131], v[48:51]
    v_mfma_f32_16x16x32_bf16 v[52:55], a[140:143], v[132:135], v[52:55]
    buffer_load_dwordx4 a[96:99], v4, s[8:11], s45 offen offset:2048 sc1
    v_mfma_f32_16x16x32_bf16 v[56:59], a[144:147], v[128:131], v[56:59]
    v_mfma_f32_16x16x32_bf16 v[60:63], a[144:147], v[132:135], v[60:63]
    buffer_load_dwordx4 a[100:103], v4, s[8:11], s45 offen offset:3072 sc1
    v_mfma_f32_16x16x32_bf16 v[64:67], a[148:151], v[128:131], v[64:67]
    v_mfma_f32_16x16x32_bf16 v[68:71], a[148:151], v[132:135], v[68:71]
    buffer_load_dwordx4 a[104:107], v5, s[8:11], s45 offen offset:0 sc1
    v_mfma_f32_16x16x32_bf16 v[72:75], a[152:155], v[128:131], v[72:75]
    v_mfma_f32_16x16x32_bf16 v[76:79], a[152:155], v[132:135], v[76:79]
    buffer_load_dwordx4 a[108:111], v5, s[8:11], s45 offen offset:1024 sc1
    v_mfma_f32_16x16x32_bf16 v[80:83], a[156:159], v[128:131], v[80:83]
    v_mfma_f32_16x16x32_bf16 v[84:87], a[156:159], v[132:135], v[84:87]
    buffer_load_dwordx4 a[112:115], v5, s[8:11], s45 offen offset:2048 sc1
    v_mfma_f32_16x16x32_bf16 v[88:91], a[160:163], v[128:131], v[88:91]
    v_mfma_f32_16x16x32_bf16 v[92:95], a[160:163], v[132:135], v[92:95]
    buffer_load_dwordx4 a[116:119], v5, s[8:11], s45 offen offset:3072 sc1
    v_mfma_f32_16x16x32_bf16 v[96:99], a[164:167], v[128:131], v[96:99]
    v_mfma_f32_16x16x32_bf16 v[100:103], a[164:167], v[132:135], v[100:103]
    buffer_load_dwordx4 a[120:123], v6, s[8:11], s45 offen offset:0 sc1
    v_mfma_f32_16x16x32_bf16 v[104:107], a[168:171], v[128:131], v[104:107]
    v_mfma_f32_16x16x32_bf16 v[108:111], a[168:171], v[132:135], v[108:111]
    buffer_load_dwordx4 a[124:127], v6, s[8:11], s45 offen offset:1024 sc1
    s_add_u32 s45, s45, 10240
    ds_read_b128 v[128:131], v11 offset:30720
    ds_read_b128 v[132:135], v11 offset:31744
    s_waitcnt vmcnt(30)
    s_waitcnt lgkmcnt(2)
    v_mfma_f32_16x16x32_bf16 v[32:35], a[176:179], v[120:123], v[32:35]
    v_mfma_f32_16x16x32_bf16 v[36:39], a[176:179], v[124:127], v[36:39]
    buffer_load_dwordx4 a[132:135], v4, s[8:11], s45 offen offset:0 sc1
    v_mfma_f32_16x16x32_bf16 v[40:43], a[180:183], v[120:123], v[40:43]
    v_mfma_f32_16x16x32_bf16 v[44:47], a[180:183], v[124:127], v[44:47]
    buffer_load_dwordx4 a[136:139], v4, s[8:11], s45 offen offset:1024 sc1
    v_mfma_f32_16x16x32_bf16 v[48:51], a[184:187], v[120:123], v[48:51]
    v_mfma_f32_16x16x32_bf16 v[52:55], a[184:187], v[124:127], v[52:55]
    buffer_load_dwordx4 a[140:143], v4, s[8:11], s45 offen offset:2048 sc1
    v_mfma_f32_16x16x32_bf16 v[56:59], a[188:191], v[120:123], v[56:59]
    v_mfma_f32_16x16x32_bf16 v[60:63], a[188:191], v[124:127], v[60:63]
    buffer_load_dwordx4 a[144:147], v4, s[8:11], s45 offen offset:3072 sc1
    v_mfma_f32_16x16x32_bf16 v[64:67], a[192:195], v[120:123], v[64:67]
    v_mfma_f32_16x16x32_bf16 v[68:71], a[192:195], v[124:127], v[68:71]
    buffer_load_dwordx4 a[148:151], v5, s[8:11], s45 offen offset:0 sc1
    v_mfma_f32_16x16x32_bf16 v[72:75], a[196:199], v[120:123], v[72:75]
    v_mfma_f32_16x16x32_bf16 v[76:79], a[196:199], v[124:127], v[76:79]
    buffer_load_dwordx4 a[152:155], v5, s[8:11], s45 offen offset:1024 sc1
    v_mfma_f32_16x16x32_bf16 v[80:83], a[200:203], v[120:123], v[80:83]
    v_mfma_f32_16x16x32_bf16 v[84:87], a[200:203], v[124:127], v[84:87]
    buffer_load_dwordx4 a[156:159], v5, s[8:11], s45 offen offset:2048 sc1
    v_mfma_f32_16x16x32_bf16 v[88:91], a[204:207], v[120:123], v[88:91]
    v_mfma_f32_16x16x32_bf16 v[92:95], a[204:207], v[124:127], v[92:95]
    buffer_load_dwordx4 a[160:163], v5, s[8:11], s45 offen offset:3072 sc1
    v_mfma_f32_16x16x32_bf16 v[96:99], a[208:211], v[120:123], v[96:99]
    v_mfma_f32_16x16x32_bf16 v[100:103], a[208:211], v[124:127], v[100:103]
    buffer_load_dwordx4 a[164:167], v6, s[8:11], s45 offen offset:0 sc1
    v_mfma_f32_16x16x32_bf16 v[104:107], a[212:215], v[120:123], v[104:107]
    v_mfma_f32_16x16x32_bf16 v[108:111], a[212:215], v[124:127], v[108:111]
    buffer_load_dwordx4 a[168:171], v6, s[8:11], s45 offen offset:1024 sc1
    s_add_u32 s45, s45, 10240
    ds_read_b128 v[120:123], v11 offset:32768
    ds_read_b128 v[124:127], v11 offset:33792
    s_waitcnt vmcnt(30)
    s_waitcnt lgkmcnt(2)
    v_mfma_f32_16x16x32_bf16 v[32:35], a[0:3], v[128:131], v[32:35]
    v_mfma_f32_16x16x32_bf16 v[36:39], a[0:3], v[132:135], v[36:39]
    buffer_load_dwordx4 a[176:179], v4, s[8:11], s45 offen offset:0 sc1
    v_mfma_f32_16x16x32_bf16 v[40:43], a[4:7], v[128:131], v[40:43]
    v_mfma_f32_16x16x32_bf16 v[44:47], a[4:7], v[132:135], v[44:47]
    buffer_load_dwordx4 a[180:183], v4, s[8:11], s45 offen offset:1024 sc1
    v_mfma_f32_16x16x32_bf16 v[48:51], a[8:11], v[128:131], v[48:51]
    v_mfma_f32_16x16x32_bf16 v[52:55], a[8:11], v[132:135], v[52:55]
    buffer_load_dwordx4 a[184:187], v4, s[8:11], s45 offen offset:2048 sc1
    v_mfma_f32_16x16x32_bf16 v[56:59], a[12:15], v[128:131], v[56:59]
    v_mfma_f32_16x16x32_bf16 v[60:63], a[12:15], v[132:135], v[60:63]
    buffer_load_dwordx4 a[188:191], v4, s[8:11], s45 offen offset:3072 sc1
    v_mfma_f32_16x16x32_bf16 v[64:67], a[16:19], v[128:131], v[64:67]
    v_mfma_f32_16x16x32_bf16 v[68:71], a[16:19], v[132:135], v[68:71]
    buffer_load_dwordx4 a[192:195], v5, s[8:11], s45 offen offset:0 sc1
    v_mfma_f32_16x16x32_bf16 v[72:75], a[20:23], v[128:131], v[72:75]
    v_mfma_f32_16x16x32_bf16 v[76:79], a[20:23], v[132:135], v[76:79]
    buffer_load_dwordx4 a[196:199], v5, s[8:11], s45 offen offset:1024 sc1
    v_mfma_f32_16x16x32_bf16 v[80:83], a[24:27], v[128:131], v[80:83]
    v_mfma_f32_16x16x32_bf16 v[84:87], a[24:27], v[132:135], v[84:87]
    buffer_load_dwordx4 a[200:203], v5, s[8:11], s45 offen offset:2048 sc1
    v_mfma_f32_16x16x32_bf16 v[88:91], a[28:31], v[128:131], v[88:91]
    v_mfma_f32_16x16x32_bf16 v[92:95], a[28:31], v[132:135], v[92:95]
    buffer_load_dwordx4 a[204:207], v5, s[8:11], s45 offen offset:3072 sc1
    v_mfma_f32_16x16x32_bf16 v[96:99], a[32:35], v[128:131], v[96:99]
    v_mfma_f32_16x16x32_bf16 v[100:103], a[32:35], v[132:135], v[100:103]
    buffer_load_dwordx4 a[208:211], v6, s[8:11], s45 offen offset:0 sc1
    v_mfma_f32_16x16x32_bf16 v[104:107], a[36:39], v[128:131], v[104:107]
    v_mfma_f32_16x16x32_bf16 v[108:111], a[36:39], v[132:135], v[108:111]
    buffer_load_dwordx4 a[212:215], v6, s[8:11], s45 offen offset:1024 sc1
    s_add_u32 s45, s45, 10240
    ds_read_b128 v[128:131], v11 offset:34816
    ds_read_b128 v[132:135], v11 offset:35840
    s_waitcnt vmcnt(30)
    s_waitcnt lgkmcnt(2)
    v_mfma_f32_16x16x32_bf16 v[32:35], a[44:47], v[120:123], v[32:35]
    v_mfma_f32_16x16x32_bf16 v[36:39], a[44:47], v[124:127], v[36:39]
    v_mfma_f32_16x16x32_bf16 v[40:43], a[48:51], v[120:123], v[40:43]
    v_mfma_f32_16x16x32_bf16 v[44:47], a[48:51], v[124:127], v[44:47]
    v_mfma_f32_16x16x32_bf16 v[48:51], a[52:55], v[120:123], v[48:51]
    v_mfma_f32_16x16x32_bf16 v[52:55], a[52:55], v[124:127], v[52:55]
    v_mfma_f32_16x16x32_bf16 v[56:59], a[56:59], v[120:123], v[56:59]
    v_mfma_f32_16x16x32_bf16 v[60:63], a[56:59], v[124:127], v[60:63]
    v_mfma_f32_16x16x32_bf16 v[64:67], a[60:63], v[120:123], v[64:67]
    v_mfma_f32_16x16x32_bf16 v[68:71], a[60:63], v[124:127], v[68:71]
    v_mfma_f32_16x16x32_bf16 v[72:75], a[64:67], v[120:123], v[72:75]
    v_mfma_f32_16x16x32_bf16 v[76:79], a[64:67], v[124:127], v[76:79]
    v_mfma_f32_16x16x32_bf16 v[80:83], a[68:71], v[120:123], v[80:83]
    v_mfma_f32_16x16x32_bf16 v[84:87], a[68:71], v[124:127], v[84:87]
    v_mfma_f32_16x16x32_bf16 v[88:91], a[72:75], v[120:123], v[88:91]
    v_mfma_f32_16x16x32_bf16 v[92:95], a[72:75], v[124:127], v[92:95]
    v_mfma_f32_16x16x32_bf16 v[96:99], a[76:79], v[120:123], v[96:99]
    v_mfma_f32_16x16x32_bf16 v[100:103], a[76:79], v[124:127], v[100:103]
    v_mfma_f32_16x16x32_bf16 v[104:107], a[80:83], v[120:123], v[104:107]
    v_mfma_f32_16x16x32_bf16 v[108:111], a[80:83], v[124:127], v[108:111]
    ds_read_b128 v[120:123], v11 offset:36864
    ds_read_b128 v[124:127], v11 offset:37888
    s_waitcnt vmcnt(20)
    s_waitcnt lgkmcnt(2)
    v_mfma_f32_16x16x32_bf16 v[32:35], a[88:91], v[128:131], v[32:35]
    v_mfma_f32_16x16x32_bf16 v[36:39], a[88:91], v[132:135], v[36:39]
    v_mfma_f32_16x16x32_bf16 v[40:43], a[92:95], v[128:131], v[40:43]
    v_mfma_f32_16x16x32_bf16 v[44:47], a[92:95], v[132:135], v[44:47]
    v_mfma_f32_16x16x32_bf16 v[48:51], a[96:99], v[128:131], v[48:51]
    v_mfma_f32_16x16x32_bf16 v[52:55], a[96:99], v[132:135], v[52:55]
    v_mfma_f32_16x16x32_bf16 v[56:59], a[100:103], v[128:131], v[56:59]
    v_mfma_f32_16x16x32_bf16 v[60:63], a[100:103], v[132:135], v[60:63]
    v_mfma_f32_16x16x32_bf16 v[64:67], a[104:107], v[128:131], v[64:67]
    v_mfma_f32_16x16x32_bf16 v[68:71], a[104:107], v[132:135], v[68:71]
    v_mfma_f32_16x16x32_bf16 v[72:75], a[108:111], v[128:131], v[72:75]
    v_mfma_f32_16x16x32_bf16 v[76:79], a[108:111], v[132:135], v[76:79]
    v_mfma_f32_16x16x32_bf16 v[80:83], a[112:115], v[128:131], v[80:83]
    v_mfma_f32_16x16x32_bf16 v[84:87], a[112:115], v[132:135], v[84:87]
    v_mfma_f32_16x16x32_bf16 v[88:91], a[116:119], v[128:131], v[88:91]
    v_mfma_f32_16x16x32_bf16 v[92:95], a[116:119], v[132:135], v[92:95]
    v_mfma_f32_16x16x32_bf16 v[96:99], a[120:123], v[128:131], v[96:99]
    v_mfma_f32_16x16x32_bf16 v[100:103], a[120:123], v[132:135], v[100:103]
    v_mfma_f32_16x16x32_bf16 v[104:107], a[124:127], v[128:131], v[104:107]
    v_mfma_f32_16x16x32_bf16 v[108:111], a[124:127], v[132:135], v[108:111]
    ds_read_b128 v[128:131], v11 offset:38912
    ds_read_b128 v[132:135], v11 offset:39936
    s_waitcnt vmcnt(10)
    s_waitcnt lgkmcnt(2)
    v_mfma_f32_16x16x32_bf16 v[32:35], a[132:135], v[120:123], v[32:35]
    v_mfma_f32_16x16x32_bf16 v[36:39], a[132:135], v[124:127], v[36:39]
    v_mfma_f32_16x16x32_bf16 v[40:43], a[136:139], v[120:123], v[40:43]
    v_mfma_f32_16x16x32_bf16 v[44:47], a[136:139], v[124:127], v[44:47]
    v_mfma_f32_16x16x32_bf16 v[48:51], a[140:143], v[120:123], v[48:51]
    v_mfma_f32_16x16x32_bf16 v[52:55], a[140:143], v[124:127], v[52:55]
    v_mfma_f32_16x16x32_bf16 v[56:59], a[144:147], v[120:123], v[56:59]
    v_mfma_f32_16x16x32_bf16 v[60:63], a[144:147], v[124:127], v[60:63]
    v_mfma_f32_16x16x32_bf16 v[64:67], a[148:151], v[120:123], v[64:67]
    v_mfma_f32_16x16x32_bf16 v[68:71], a[148:151], v[124:127], v[68:71]
    v_mfma_f32_16x16x32_bf16 v[72:75], a[152:155], v[120:123], v[72:75]
    v_mfma_f32_16x16x32_bf16 v[76:79], a[152:155], v[124:127], v[76:79]
    v_mfma_f32_16x16x32_bf16 v[80:83], a[156:159], v[120:123], v[80:83]
    v_mfma_f32_16x16x32_bf16 v[84:87], a[156:159], v[124:127], v[84:87]
    v_mfma_f32_16x16x32_bf16 v[88:91], a[160:163], v[120:123], v[88:91]
    v_mfma_f32_16x16x32_bf16 v[92:95], a[160:163], v[124:127], v[92:95]
    v_mfma_f32_16x16x32_bf16 v[96:99], a[164:167], v[120:123], v[96:99]
    v_mfma_f32_16x16x32_bf16 v[100:103], a[164:167], v[124:127], v[100:103]
    v_mfma_f32_16x16x32_bf16 v[104:107], a[168:171], v[120:123], v[104:107]
    v_mfma_f32_16x16x32_bf16 v[108:111], a[168:171], v[124:127], v[108:111]
    s_waitcnt vmcnt(0)
    s_waitcnt lgkmcnt(0)
    v_mfma_f32_16x16x32_bf16 v[32:35], a[176:179], v[128:131], v[32:35]
    v_mfma_f32_16x16x32_bf16 v[36:39], a[176:179], v[132:135], v[36:39]
    v_mfma_f32_16x16x32_bf16 v[40:43], a[180:183], v[128:131], v[40:43]
    v_mfma_f32_16x16x32_bf16 v[44:47], a[180:183], v[132:135], v[44:47]
    v_mfma_f32_16x16x32_bf16 v[48:51], a[184:187], v[128:131], v[48:51]
    v_mfma_f32_16x16x32_bf16 v[52:55], a[184:187], v[132:135], v[52:55]
    v_mfma_f32_16x16x32_bf16 v[56:59], a[188:191], v[128:131], v[56:59]
    v_mfma_f32_16x16x32_bf16 v[60:63], a[188:191], v[132:135], v[60:63]
    v_mfma_f32_16x16x32_bf16 v[64:67], a[192:195], v[128:131], v[64:67]
    v_mfma_f32_16x16x32_bf16 v[68:71], a[192:195], v[132:135], v[68:71]
    v_mfma_f32_16x16x32_bf16 v[72:75], a[196:199], v[128:131], v[72:75]
    v_mfma_f32_16x16x32_bf16 v[76:79], a[196:199], v[132:135], v[76:79]
    v_mfma_f32_16x16x32_bf16 v[80:83], a[200:203], v[128:131], v[80:83]
    v_mfma_f32_16x16x32_bf16 v[84:87], a[200:203], v[132:135], v[84:87]
    v_mfma_f32_16x16x32_bf16 v[88:91], a[204:207], v[128:131], v[88:91]
    v_mfma_f32_16x16x32_bf16 v[92:95], a[204:207], v[132:135], v[92:95]
    v_mfma_f32_16x16x32_bf16 v[96:99], a[208:211], v[128:131], v[96:99]
    v_mfma_f32_16x16x32_bf16 v[100:103], a[208:211], v[132:135], v[100:103]
    v_mfma_f32_16x16x32_bf16 v[104:107], a[212:215], v[128:131], v[104:107]
    v_mfma_f32_16x16x32_bf16 v[108:111], a[212:215], v[132:135], v[108:111]
    s_and_b32 s30, s42, 1
    s_lshl_b32 s30, s30, 1
    s_lshl_b32 s31, s3, 2
    s_add_u32 s30, s30, s31
    s_add_u32 s30, s30, 31392
    s_lshl_b32 s30, s30, 7
    v_bfe_u32 v1, v0, 2, 1
    v_and_b32 v2, 3, v0
    v_lshlrev_b32 v1, 7, v1
    v_lshl_add_u32 v9, v2, 3, v1
    v_add_u32 v9, s30, v9
    s_add_u32 s44, s42, 1
    s_mul_i32 s46, s42, 40960
    s_mul_i32 s30, s3, 10240
    s_lshl_b32 s47, s42, 22
    s_add_u32 s47, s47, s30
    s_add_u32 s47, s47, 3932160
    v_lshlrev_b32 v4, 3, v0
    v_add_u32 v5, 4096, v4
    v_add_u32 v6, 8192, v4
    v_and_b32 v1, 15, v0
    v_mul_u32_u24 v7, 1280, v1
    v_lshrrev_b32 v2, 4, v0
    v_lshrrev_b32 v3, 1, v2
    v_and_b32 v2, 1, v2
    v_lshl_add_u32 v7, v2, 5, v7
    v_lshl_add_u32 v7, v3, 4, v7
    s_mul_i32 s30, s3, 320
    v_add_u32 v7, s30, v7
    v_add_u32 v8, 20480, v7
    v_mul_f32 v32, v20, v32
    v_mul_f32 v33, v20, v33
    v_mul_f32 v34, v20, v34
    v_mul_f32 v35, v20, v35
    v_mul_f32 v36, v21, v36
    v_mul_f32 v37, v21, v37
    v_mul_f32 v38, v21, v38
    v_mul_f32 v39, v21, v39
    v_mul_f32 v40, v20, v40
    v_mul_f32 v41, v20, v41
    v_mul_f32 v42, v20, v42
    v_mul_f32 v43, v20, v43
    v_mul_f32 v44, v21, v44
    v_mul_f32 v45, v21, v45
    v_mul_f32 v46, v21, v46
    v_mul_f32 v47, v21, v47
    v_mul_f32 v48, v20, v48
    v_mul_f32 v49, v20, v49
    v_mul_f32 v50, v20, v50
    v_mul_f32 v51, v20, v51
    v_mul_f32 v52, v21, v52
    v_mul_f32 v53, v21, v53
    v_mul_f32 v54, v21, v54
    v_mul_f32 v55, v21, v55
    v_mul_f32 v56, v20, v56
    v_mul_f32 v57, v20, v57
    v_mul_f32 v58, v20, v58
    v_mul_f32 v59, v20, v59
    v_mul_f32 v60, v21, v60
    v_mul_f32 v61, v21, v61
    v_mul_f32 v62, v21, v62
    v_mul_f32 v63, v21, v63
    v_mul_f32 v64, v20, v64
    v_mul_f32 v65, v20, v65
    v_mul_f32 v66, v20, v66
    v_mul_f32 v67, v20, v67
    v_mul_f32 v68, v21, v68
    v_mul_f32 v69, v21, v69
    v_mul_f32 v70, v21, v70
    v_mul_f32 v71, v21, v71
    v_mul_f32 v72, v20, v72
    v_mul_f32 v73, v20, v73
    v_mul_f32 v74, v20, v74
    v_mul_f32 v75, v20, v75
    v_mul_f32 v76, v21, v76
    v_mul_f32 v77, v21, v77
    v_mul_f32 v78, v21, v78
    v_mul_f32 v79, v21, v79
    v_mul_f32 v80, v20, v80
    v_mul_f32 v81, v20, v81
    v_mul_f32 v82, v20, v82
    v_mul_f32 v83, v20, v83
    v_mul_f32 v84, v21, v84
    v_mul_f32 v85, v21, v85
    v_mul_f32 v86, v21, v86
    v_mul_f32 v87, v21, v87
    v_mul_f32 v88, v20, v88
    v_mul_f32 v89, v20, v89
    v_mul_f32 v90, v20, v90
    v_mul_f32 v91, v20, v91
    v_mul_f32 v92, v21, v92
    v_mul_f32 v93, v21, v93
    v_mul_f32 v94, v21, v94
    v_mul_f32 v95, v21, v95
    v_mul_f32 v96, v20, v96
    v_mul_f32 v97, v20, v97
    v_mul_f32 v98, v20, v98
    v_mul_f32 v99, v20, v99
    v_mul_f32 v100, v21, v100
    v_mul_f32 v101, v21, v101
    v_mul_f32 v102, v21, v102
    v_mul_f32 v103, v21, v103
    v_mul_f32 v104, v20, v104
    v_mul_f32 v105, v20, v105
    v_mul_f32 v106, v20, v106
    v_mul_f32 v107, v20, v107
    v_mul_f32 v108, v21, v108
    v_mul_f32 v109, v21, v109
    v_mul_f32 v110, v21, v110
    v_mul_f32 v111, v21, v111
    s_cmp_lt_u32 s42, 61
    s_cbranch_scc1 L_a3_mix
    v_lshlrev_b32 v4, 4, v0
    v_lshlrev_b32 v5, 2, v0
    s_lshl_b32 s47, s42, 22
    s_add_u32 s48, s47, 4063232
    s_mul_i32 s30, s3, 20480
    s_add_u32 s47, s47, s30
    s_add_u32 s47, s47, 3981312
    buffer_store_dwordx4 v[32:35], v4, s[8:11], s47 offen offset:0 sc1
    buffer_store_dwordx4 v[36:39], v4, s[8:11], s47 offen offset:1024 sc1
    buffer_store_dwordx4 v[40:43], v4, s[8:11], s47 offen offset:2048 sc1
    buffer_store_dwordx4 v[44:47], v4, s[8:11], s47 offen offset:3072 sc1
    s_add_u32 s47, s47, 4096
    buffer_store_dwordx4 v[48:51], v4, s[8:11], s47 offen offset:0 sc1
    buffer_store_dwordx4 v[52:55], v4, s[8:11], s47 offen offset:1024 sc1
    buffer_store_dwordx4 v[56:59], v4, s[8:11], s47 offen offset:2048 sc1
    buffer_store_dwordx4 v[60:63], v4, s[8:11], s47 offen offset:3072 sc1
    s_add_u32 s47, s47, 4096
    buffer_store_dwordx4 v[64:67], v4, s[8:11], s47 offen offset:0 sc1
    buffer_store_dwordx4 v[68:71], v4, s[8:11], s47 offen offset:1024 sc1
    buffer_store_dwordx4 v[72:75], v4, s[8:11], s47 offen offset:2048 sc1
    buffer_store_dwordx4 v[76:79], v4, s[8:11], s47 offen offset:3072 sc1
    s_add_u32 s47, s47, 4096
    buffer_store_dwordx4 v[80:83], v4, s[8:11], s47 offen offset:0 sc1
    buffer_store_dwordx4 v[84:87], v4, s[8:11], s47 offen offset:1024 sc1
    buffer_store_dwordx4 v[88:91], v4, s[8:11], s47 offen offset:2048 sc1
    buffer_store_dwordx4 v[92:95], v4, s[8:11], s47 offen offset:3072 sc1
    s_add_u32 s47, s47, 4096
    buffer_store_dwordx4 v[96:99], v4, s[8:11], s47 offen offset:0 sc1
    buffer_store_dwordx4 v[100:103], v4, s[8:11], s47 offen offset:1024 sc1
    buffer_store_dwordx4 v[104:107], v4, s[8:11], s47 offen offset:2048 sc1
    buffer_store_dwordx4 v[108:111], v4, s[8:11], s47 offen offset:3072 sc1
    s_add_u32 s47, s47, 4096
    buffer_store_dword v22, v5, s[8:11], s48 offen offset:0 sc1
    buffer_store_dword v23, v5, s[8:11], s48 offen offset:256 sc1
    s_add_u32 s30, s42, 31491
    s_lshl_b32 s30, s30, 7
    s_lshl_b32 s31, s3, 3
    s_add_u32 s30, s30, s31
    v_mov_b32 v12, s30
    v_mov_b32 v1, 2130706432
    v_cmp_eq_u32 vcc, 0, v0
    s_nop 1
    v_cndmask_b32 v12, v1, v12, vcc
    v_mov_b32 v15, s4
    s_waitcnt vmcnt(0)
    v_mov_b32 v14, 1
    buffer_store_dwordx2 v[14:15], v12, s[8:11], 0 offen sc1
    s_endpgm
L_a3_mix:
L_fw_79:
    buffer_load_dwordx2 v[12:13], v9, s[8:11], 0 offen sc1
    s_add_u32 s7, s7, 1
    s_bitcmp1_b32 s7, 22
    s_cbranch_scc1 L_abort
    s_waitcnt vmcnt(0)
    v_cmp_ne_u32 vcc, s4, v13
    v_cmp_gt_u32 s[28:29], s44, v12
    s_or_b64 vcc, vcc, s[28:29]
    s_cbranch_scc1 L_fw_79
L_fe_80:
    buffer_load_dwordx2 v[136:137], v4, s[8:11], s47 offen offset:0 sc1
    buffer_load_dwordx2 v[138:139], v4, s[8:11], s47 offen offset:512 sc1
    buffer_load_dwordx2 v[140:141], v4, s[8:11], s47 offen offset:1024 sc1
    buffer_load_dwordx2 v[142:143], v4, s[8:11], s47 offen offset:1536 sc1
    buffer_load_dwordx2 v[144:145], v4, s[8:11], s47 offen offset:2048 sc1
    buffer_load_dwordx2 v[146:147], v4, s[8:11], s47 offen offset:2560 sc1
    buffer_load_dwordx2 v[148:149], v4, s[8:11], s47 offen offset:3072 sc1
    buffer_load_dwordx2 v[150:151], v4, s[8:11], s47 offen offset:3584 sc1
    buffer_load_dwordx2 v[152:153], v5, s[8:11], s47 offen offset:0 sc1
    buffer_load_dwordx2 v[154:155], v5, s[8:11], s47 offen offset:512 sc1
    buffer_load_dwordx2 v[156:157], v5, s[8:11], s47 offen offset:1024 sc1
    buffer_load_dwordx2 v[158:159], v5, s[8:11], s47 offen offset:1536 sc1
    buffer_load_dwordx2 v[160:161], v5, s[8:11], s47 offen offset:2048 sc1
    buffer_load_dwordx2 v[162:163], v5, s[8:11], s47 offen offset:2560 sc1
    buffer_load_dwordx2 v[164:165], v5, s[8:11], s47 offen offset:3072 sc1
    buffer_load_dwordx2 v[166:167], v5, s[8:11], s47 offen offset:3584 sc1
    buffer_load_dwordx2 v[168:169], v6, s[8:11], s47 offen offset:0 sc1
    buffer_load_dwordx2 v[170:171], v6, s[8:11], s47 offen offset:512 sc1
    buffer_load_dwordx2 v[172:173], v6, s[8:11], s47 offen offset:1024 sc1
    buffer_load_dwordx2 v[174:175], v6, s[8:11], s47 offen offset:1536 sc1
    s_waitcnt vmcnt(16)
    v_lshlrev_b32 v24, 16, v136
    v_and_b32 v25, 0xffff0000, v136
    v_lshlrev_b32 v26, 16, v137
    v_and_b32 v27, 0xffff0000, v137
    v_fmac_f32 v32, v22, v24
    v_fmac_f32 v33, v22, v25
    v_fmac_f32 v34, v22, v26
    v_fmac_f32 v35, v22, v27
    v_cvt_pk_bf16_f32 v176, v32, v33
    v_cvt_pk_bf16_f32 v177, v34, v35
    v_lshlrev_b32 v24, 16, v140
    v_and_b32 v25, 0xffff0000, v140
    v_lshlrev_b32 v26, 16, v141
    v_and_b32 v27, 0xffff0000, v141
    v_fmac_f32 v40, v22, v24
    v_fmac_f32 v41, v22, v25
    v_fmac_f32 v42, v22, v26
    v_fmac_f32 v43, v22, v27
    v_cvt_pk_bf16_f32 v178, v40, v41
    v_cvt_pk_bf16_f32 v179, v42, v43
    s_nop 1
    v_permlane16_swap_b32 v176, v178
    v_permlane16_swap_b32 v177, v179
    buffer_store_dwordx4 v[176:179], v7, s[16:19], s46 offen offset:0 sc1
    v_lshlrev_b32 v24, 16, v138
    v_and_b32 v25, 0xffff0000, v138
    v_lshlrev_b32 v26, 16, v139
    v_and_b32 v27, 0xffff0000, v139
    v_fmac_f32 v36, v23, v24
    v_fmac_f32 v37, v23, v25
    v_fmac_f32 v38, v23, v26
    v_fmac_f32 v39, v23, v27
    v_cvt_pk_bf16_f32 v180, v36, v37
    v_cvt_pk_bf16_f32 v181, v38, v39
    v_lshlrev_b32 v24, 16, v142
    v_and_b32 v25, 0xffff0000, v142
    v_lshlrev_b32 v26, 16, v143
    v_and_b32 v27, 0xffff0000, v143
    v_fmac_f32 v44, v23, v24
    v_fmac_f32 v45, v23, v25
    v_fmac_f32 v46, v23, v26
    v_fmac_f32 v47, v23, v27
    v_cvt_pk_bf16_f32 v182, v44, v45
    v_cvt_pk_bf16_f32 v183, v46, v47
    s_nop 1
    v_permlane16_swap_b32 v180, v182
    v_permlane16_swap_b32 v181, v183
    buffer_store_dwordx4 v[180:183], v8, s[16:19], s46 offen offset:0 sc1
    s_waitcnt vmcnt(14)
    v_lshlrev_b32 v24, 16, v144
    v_and_b32 v25, 0xffff0000, v144
    v_lshlrev_b32 v26, 16, v145
    v_and_b32 v27, 0xffff0000, v145
    v_fmac_f32 v48, v22, v24
    v_fmac_f32 v49, v22, v25
    v_fmac_f32 v50, v22, v26
    v_fmac_f32 v51, v22, v27
    v_cvt_pk_bf16_f32 v184, v48, v49
    v_cvt_pk_bf16_f32 v185, v50, v51
    v_lshlrev_b32 v24, 16, v148
    v_and_b32 v25, 0xffff0000, v148
    v_lshlrev_b32 v26, 16, v149
    v_and_b32 v27, 0xffff0000, v149
    v_fmac_f32 v56, v22, v24
    v_fmac_f32 v57, v22, v25
    v_fmac_f32 v58, v22, v26
    v_fmac_f32 v59, v22, v27
    v_cvt_pk_bf16_f32 v186, v56, v57
    v_cvt_pk_bf16_f32 v187, v58, v59
    s_nop 1
    v_permlane16_swap_b32 v184, v186
    v_permlane16_swap_b32 v185, v187
    buffer_store_dwordx4 v[184:187], v7, s[16:19], s46 offen offset:64 sc1
    v_lshlrev_b32 v24, 16, v146
    v_and_b32 v25, 0xffff0000, v146
    v_lshlrev_b32 v26, 16, v147
    v_and_b32 v27, 0xffff0000, v147
    v_fmac_f32 v52, v23, v24
    v_fmac_f32 v53, v23, v25
    v_fmac_f32 v54, v23, v26
    v_fmac_f32 v55, v23, v27
    v_cvt_pk_bf16_f32 v188, v52, v53
    v_cvt_pk_bf16_f32 v189, v54, v55
    v_lshlrev_b32 v24, 16, v150
    v_and_b32 v25, 0xffff0000, v150
    v_lshlrev_b32 v26, 16, v151
    v_and_b32 v27, 0xffff0000, v151
    v_fmac_f32 v60, v23, v24
    v_fmac_f32 v61, v23, v25
    v_fmac_f32 v62, v23, v26
    v_fmac_f32 v63, v23, v27
    v_cvt_pk_bf16_f32 v190, v60, v61
    v_cvt_pk_bf16_f32 v191, v62, v63
    s_nop 1
    v_permlane16_swap_b32 v188, v190
    v_permlane16_swap_b32 v189, v191
    buffer_store_dwordx4 v[188:191], v8, s[16:19], s46 offen offset:64 sc1
    s_waitcnt vmcnt(12)
    v_lshlrev_b32 v24, 16, v152
    v_and_b32 v25, 0xffff0000, v152
    v_lshlrev_b32 v26, 16, v153
    v_and_b32 v27, 0xffff0000, v153
    v_fmac_f32 v64, v22, v24
    v_fmac_f32 v65, v22, v25
    v_fmac_f32 v66, v22, v26
    v_fmac_f32 v67, v22, v27
    v_cvt_pk_bf16_f32 v192, v64, v65
    v_cvt_pk_bf16_f32 v193, v66, v67
    v_lshlrev_b32 v24, 16, v156
    v_and_b32 v25, 0xffff0000, v156
    v_lshlrev_b32 v26, 16, v157
    v_and_b32 v27, 0xffff0000, v157
    v_fmac_f32 v72, v22, v24
    v_fmac_f32 v73, v22, v25
    v_fmac_f32 v74, v22, v26
    v_fmac_f32 v75, v22, v27
    v_cvt_pk_bf16_f32 v194, v72, v73
    v_cvt_pk_bf16_f32 v195, v74, v75
    s_nop 1
    v_permlane16_swap_b32 v192, v194
    v_permlane16_swap_b32 v193, v195
    buffer_store_dwordx4 v[192:195], v7, s[16:19], s46 offen offset:128 sc1
    v_lshlrev_b32 v24, 16, v154
    v_and_b32 v25, 0xffff0000, v154
    v_lshlrev_b32 v26, 16, v155
    v_and_b32 v27, 0xffff0000, v155
    v_fmac_f32 v68, v23, v24
    v_fmac_f32 v69, v23, v25
    v_fmac_f32 v70, v23, v26
    v_fmac_f32 v71, v23, v27
    v_cvt_pk_bf16_f32 v196, v68, v69
    v_cvt_pk_bf16_f32 v197, v70, v71
    v_lshlrev_b32 v24, 16, v158
    v_and_b32 v25, 0xffff0000, v158
    v_lshlrev_b32 v26, 16, v159
    v_and_b32 v27, 0xffff0000, v159
    v_fmac_f32 v76, v23, v24
    v_fmac_f32 v77, v23, v25
    v_fmac_f32 v78, v23, v26
    v_fmac_f32 v79, v23, v27
    v_cvt_pk_bf16_f32 v198, v76, v77
    v_cvt_pk_bf16_f32 v199, v78, v79
    s_nop 1
    v_permlane16_swap_b32 v196, v198
    v_permlane16_swap_b32 v197, v199
    buffer_store_dwordx4 v[196:199], v8, s[16:19], s46 offen offset:128 sc1
    s_waitcnt vmcnt(10)
    v_lshlrev_b32 v24, 16, v160
    v_and_b32 v25, 0xffff0000, v160
    v_lshlrev_b32 v26, 16, v161
    v_and_b32 v27, 0xffff0000, v161
    v_fmac_f32 v80, v22, v24
    v_fmac_f32 v81, v22, v25
    v_fmac_f32 v82, v22, v26
    v_fmac_f32 v83, v22, v27
    v_cvt_pk_bf16_f32 v200, v80, v81
    v_cvt_pk_bf16_f32 v201, v82, v83
    v_lshlrev_b32 v24, 16, v164
    v_and_b32 v25, 0xffff0000, v164
    v_lshlrev_b32 v26, 16, v165
    v_and_b32 v27, 0xffff0000, v165
    v_fmac_f32 v88, v22, v24
    v_fmac_f32 v89, v22, v25
    v_fmac_f32 v90, v22, v26
    v_fmac_f32 v91, v22, v27
    v_cvt_pk_bf16_f32 v202, v88, v89
    v_cvt_pk_bf16_f32 v203, v90, v91
    s_nop 1
    v_permlane16_swap_b32 v200, v202
    v_permlane16_swap_b32 v201, v203
    buffer_store_dwordx4 v[200:203], v7, s[16:19], s46 offen offset:192 sc1
    v_lshlrev_b32 v24, 16, v162
    v_and_b32 v25, 0xffff0000, v162
    v_lshlrev_b32 v26, 16, v163
    v_and_b32 v27, 0xffff0000, v163
    v_fmac_f32 v84, v23, v24
    v_fmac_f32 v85, v23, v25
    v_fmac_f32 v86, v23, v26
    v_fmac_f32 v87, v23, v27
    v_cvt_pk_bf16_f32 v204, v84, v85
    v_cvt_pk_bf16_f32 v205, v86, v87
    v_lshlrev_b32 v24, 16, v166
    v_and_b32 v25, 0xffff0000, v166
    v_lshlrev_b32 v26, 16, v167
    v_and_b32 v27, 0xffff0000, v167
    v_fmac_f32 v92, v23, v24
    v_fmac_f32 v93, v23, v25
    v_fmac_f32 v94, v23, v26
    v_fmac_f32 v95, v23, v27
    v_cvt_pk_bf16_f32 v206, v92, v93
    v_cvt_pk_bf16_f32 v207, v94, v95
    s_nop 1
    v_permlane16_swap_b32 v204, v206
    v_permlane16_swap_b32 v205, v207
    buffer_store_dwordx4 v[204:207], v8, s[16:19], s46 offen offset:192 sc1
    s_waitcnt vmcnt(8)
    v_lshlrev_b32 v24, 16, v168
    v_and_b32 v25, 0xffff0000, v168
    v_lshlrev_b32 v26, 16, v169
    v_and_b32 v27, 0xffff0000, v169
    v_fmac_f32 v96, v22, v24
    v_fmac_f32 v97, v22, v25
    v_fmac_f32 v98, v22, v26
    v_fmac_f32 v99, v22, v27
    v_cvt_pk_bf16_f32 v208, v96, v97
    v_cvt_pk_bf16_f32 v209, v98, v99
    v_lshlrev_b32 v24, 16, v172
    v_and_b32 v25, 0xffff0000, v172
    v_lshlrev_b32 v26, 16, v173
    v_and_b32 v27, 0xffff0000, v173
    v_fmac_f32 v104, v22, v24
    v_fmac_f32 v105, v22, v25
    v_fmac_f32 v106, v22, v26
    v_fmac_f32 v107, v22, v27
    v_cvt_pk_bf16_f32 v210, v104, v105
    v_cvt_pk_bf16_f32 v211, v106, v107
    s_nop 1
    v_permlane16_swap_b32 v208, v210
    v_permlane16_swap_b32 v209, v211
    buffer_store_dwordx4 v[208:211], v7, s[16:19], s46 offen offset:256 sc1
    v_lshlrev_b32 v24, 16, v170
    v_and_b32 v25, 0xffff0000, v170
    v_lshlrev_b32 v26, 16, v171
    v_and_b32 v27, 0xffff0000, v171
    v_fmac_f32 v100, v23, v24
    v_fmac_f32 v101, v23, v25
    v_fmac_f32 v102, v23, v26
    v_fmac_f32 v103, v23, v27
    v_cvt_pk_bf16_f32 v212, v100, v101
    v_cvt_pk_bf16_f32 v213, v102, v103
    v_lshlrev_b32 v24, 16, v174
    v_and_b32 v25, 0xffff0000, v174
    v_lshlrev_b32 v26, 16, v175
    v_and_b32 v27, 0xffff0000, v175
    v_fmac_f32 v108, v23, v24
    v_fmac_f32 v109, v23, v25
    v_fmac_f32 v110, v23, v26
    v_fmac_f32 v111, v23, v27
    v_cvt_pk_bf16_f32 v214, v108, v109
    v_cvt_pk_bf16_f32 v215, v110, v111
    s_nop 1
    v_permlane16_swap_b32 v212, v214
    v_permlane16_swap_b32 v213, v215
    buffer_store_dwordx4 v[212:215], v8, s[16:19], s46 offen offset:256 sc1
    s_endpgm
L_g:
    s_lshr_b32 s30, s6, 3
    s_and_b32 s30, s30, 1
    s_lshl_b32 s30, s30, 5
    s_add_u32 s41, s40, s30
    s_cmp_ge_u32 s41, 60
    s_cbranch_scc1 L_end
    s_mul_i32 s42, s41, 3277
    s_lshr_b32 s42, s42, 16
    s_mul_i32 s30, s42, 20
    s_sub_u32 s41, s41, s30
    s_sub_u32 s42, 63, s42
    s_and_b32 s43, s41, 1
    s_lshr_b32 s40, s41, 1
    s_lshl_b32 s40, s40, 2
    s_mov_b32 s97, 0
    s_barrier
    v_lshlrev_b32 v4, 4, v0
    v_add_u32 v5, 4096, v4
    v_and_b32 v1, 7, v0
    s_lshl_b32 s30, s3, 3
    v_add_u32 v1, s30, v1
    v_lshlrev_b32 v1, 7, v1
    v_bfe_u32 v2, v0, 3, 2
    v_lshl_add_u32 v6, v2, 3, v1
    v_add_u32 v6, 4009984, v6
    v_and_b32 v7, 3, v0
    v_lshlrev_b32 v7, 3, v7
    s_add_u32 s30, s42, 31491
    s_lshl_b32 s30, s30, 7
    v_add_u32 v7, s30, v7
    s_lshl_b32 s30, s3, 12
    v_add_u32 v9, s30, v4
    s_lshl_b32 s30, s3, 10
    v_add_u32 v10, s30, v4
    v_mov_b32 v8, 933888
    v_and_b32 v1, 15, v0
    v_mul_u32_u24 v11, 1280, v1
    v_lshrrev_b32 v2, 4, v0
    v_lshl_add_u32 v11, v2, 3, v11
    s_lshl_b32 s30, s42, 1
    s_add_u32 s30, s30, s43
    s_mul_i32 s59, s30, 20480
    s_add_u32 s30, s40, s3
    s_lshl_b32 s30, s30, 5
    s_add_u32 s59, s59, s30
    s_mov_b32 s16, s86
    s_mov_b32 s17, s87
    s_mov_b32 s18, 2621440
    s_mov_b32 s19, 0x20000
    s_add_u32 s30, s40, 0
    s_and_b32 s30, s30, 7
    s_lshl_b32 s30, s30, 10
    v_add_u32 v18, s30, v4
    s_add_u32 s30, s40, 1
    s_and_b32 s30, s30, 7
    s_lshl_b32 s30, s30, 10
    v_add_u32 v19, s30, v4
    s_add_u32 s30, s40, 2
    s_and_b32 s30, s30, 7
    s_lshl_b32 s30, s30, 10
    v_add_u32 v20, s30, v4
    s_add_u32 s30, s40, 3
    s_and_b32 s30, s30, 7
    s_lshl_b32 s30, s30, 10
    v_add_u32 v21, s30, v4
    s_add_u32 s30, s40, 4
    s_and_b32 s30, s30, 7
    s_lshl_b32 s30, s30, 10
    v_add_u32 v22, s30, v4
    s_add_u32 s30, s40, 5
    s_and_b32 s30, s30, 7
    s_lshl_b32 s30, s30, 10
    v_add_u32 v23, s30, v4
    s_add_u32 s30, s40, 6
    s_and_b32 s30, s30, 7
    s_lshl_b32 s30, s30, 10
    v_add_u32 v24, s30, v4
    s_add_u32 s30, s40, 7
    s_and_b32 s30, s30, 7
    s_lshl_b32 s30, s30, 10
    v_add_u32 v25, s30, v4
    s_lshl_b32 s45, s3, 1
    s_add_u32 s45, s45, s40
    s_add_u32 s30, s45, 0
    s_and_b32 s30, s30, 7
    s_lshl_b32 s30, s30, 10
    v_add_u32 v152, s30, v4
    s_add_u32 s30, s45, 1
    s_and_b32 s30, s30, 7
    s_lshl_b32 s30, s30, 10
    v_add_u32 v153, s30, v4
    s_add_u32 s30, s45, 2
    s_and_b32 s30, s30, 7
    s_lshl_b32 s30, s30, 10
    v_add_u32 v154, s30, v4
    s_add_u32 s30, s45, 3
    s_and_b32 s30, s30, 7
    s_lshl_b32 s30, s30, 10
    v_add_u32 v155, s30, v4
    s_add_u32 s30, s45, 4
    s_and_b32 s30, s30, 7
    s_lshl_b32 s30, s30, 10
    v_add_u32 v156, s30, v4
    s_add_u32 s30, s45, 5
    s_and_b32 s30, s30, 7
    s_lshl_b32 s30, s30, 10
    v_add_u32 v157, s30, v4
    s_add_u32 s30, s45, 6
    s_and_b32 s30, s30, 7
    s_lshl_b32 s30, s30, 10
    v_add_u32 v158, s30, v4
    s_add_u32 s30, s45, 7
    s_and_b32 s30, s30, 7
    s_lshl_b32 s30, s30, 10
    v_add_u32 v159, s30, v4
    s_add_u32 s44, s42, 1
    s_branch L_fm_84
L_fw_82:
    s_sleep 8
L_fm_84:
    buffer_load_dwordx2 v[12:13], v6, s[8:11], 0 offen sc1
    s_add_u32 s7, s7, 1
    s_bitcmp1_b32 s7, 22
    s_cbranch_scc1 L_abort
    s_waitcnt vmcnt(0)
    v_cmp_ne_u32 vcc, s4, v13
    v_cmp_gt_u32 s[28:29], s44, v12
    s_or_b64 vcc, vcc, s[28:29]
    s_cbranch_scc1 L_fw_82
L_fe_83:
    s_lshl_b32 s46, s42, 22
    s_and_b32 s46, s46, 134217727
    s_add_u32 s45, s40, 0
    s_bfe_u32 s30, s45, 0x10003
    s_xor_b32 s30, s30, s3
    s_lshl_b32 s47, s45, 2
    s_add_u32 s30, s30, s47
    s_lshl_b32 s47, s30, 13
    s_add_u32 s47, s47, 1048576
    s_add_u32 s47, s47, s46
    buffer_load_dwordx4 a[0:3], v18, s[8:11], s47 offen sc1
    buffer_load_dwordx4 a[4:7], v19, s[8:11], s47 offen sc1
    buffer_load_dwordx4 a[8:11], v20, s[8:11], s47 offen sc1
    buffer_load_dwordx4 a[12:15], v21, s[8:11], s47 offen sc1
    buffer_load_dwordx4 a[16:19], v22, s[8:11], s47 offen sc1
    buffer_load_dwordx4 a[20:23], v23, s[8:11], s47 offen sc1
    buffer_load_dwordx4 a[24:27], v24, s[8:11], s47 offen sc1
    buffer_load_dwordx4 a[28:31], v25, s[8:11], s47 offen sc1
    s_add_u32 s45, s40, 1
    s_bfe_u32 s30, s45, 0x10003
    s_xor_b32 s30, s30, s3
    s_lshl_b32 s47, s45, 2
    s_add_u32 s30, s30, s47
    s_lshl_b32 s47, s30, 13
    s_add_u32 s47, s47, 1048576
    s_add_u32 s47, s47, s46
    buffer_load_dwordx4 a[40:43], v19, s[8:11], s47 offen sc1
    buffer_load_dwordx4 a[44:47], v20, s[8:11], s47 offen sc1
    buffer_load_dwordx4 a[48:51], v21, s[8:11], s47 offen sc1
    buffer_load_dwordx4 a[52:55], v22, s[8:11], s47 offen sc1
    buffer_load_dwordx4 a[56:59], v23, s[8:11], s47 offen sc1
    buffer_load_dwordx4 a[60:63], v24, s[8:11], s47 offen sc1
    buffer_load_dwordx4 a[64:67], v25, s[8:11], s47 offen sc1
    buffer_load_dwordx4 a[68:71], v18, s[8:11], s47 offen sc1
    s_add_u32 s45, s40, 2
    s_bfe_u32 s30, s45, 0x10003
    s_xor_b32 s30, s30, s3
    s_lshl_b32 s47, s45, 2
    s_add_u32 s30, s30, s47
    s_lshl_b32 s47, s30, 13
    s_add_u32 s47, s47, 1048576
    s_add_u32 s47, s47, s46
    buffer_load_dwordx4 a[80:83], v20, s[8:11], s47 offen sc1
    buffer_load_dwordx4 a[84:87], v21, s[8:11], s47 offen sc1
    buffer_load_dwordx4 a[88:91], v22, s[8:11], s47 offen sc1
    buffer_load_dwordx4 a[92:95], v23, s[8:11], s47 offen sc1
    buffer_load_dwordx4 a[96:99], v24, s[8:11], s47 offen sc1
    buffer_load_dwordx4 a[100:103], v25, s[8:11], s47 offen sc1
    buffer_load_dwordx4 a[104:107], v18, s[8:11], s47 offen sc1
    buffer_load_dwordx4 a[108:111], v19, s[8:11], s47 offen sc1
    s_add_u32 s45, s40, 3
    s_bfe_u32 s30, s45, 0x10003
    s_xor_b32 s30, s30, s3
    s_lshl_b32 s47, s45, 2
    s_add_u32 s30, s30, s47
    s_lshl_b32 s47, s30, 13
    s_add_u32 s47, s47, 1048576
    s_add_u32 s47, s47, s46
    buffer_load_dwordx4 a[120:123], v21, s[8:11], s47 offen sc1
    buffer_load_dwordx4 a[124:127], v22, s[8:11], s47 offen sc1
    buffer_load_dwordx4 a[128:131], v23, s[8:11], s47 offen sc1
    buffer_load_dwordx4 a[132:135], v24, s[8:11], s47 offen sc1
    buffer_load_dwordx4 a[136:139], v25, s[8:11], s47 offen sc1
    buffer_load_dwordx4 a[140:143], v18, s[8:11], s47 offen sc1
    buffer_load_dwordx4 a[144:147], v19, s[8:11], s47 offen sc1
    buffer_load_dwordx4 a[148:151], v20, s[8:11], s47 offen sc1
    s_branch L_fm_87
L_fw_85:
    s_sleep 8
L_fm_87:
    buffer_load_dwordx2 v[12:13], v7, s[8:11], 0 offen sc1
    s_add_u32 s7, s7, 1
    s_bitcmp1_b32 s7, 22
    s_cbranch_scc1 L_abort
    s_waitcnt vmcnt(0)
    v_cmp_ne_u32 vcc, s4, v13
    v_cmp_gt_u32 s[28:29], 1, v12
    s_or_b64 vcc, vcc, s[28:29]
    s_cbranch_scc1 L_fw_85
L_fe_86:
    s_lshl_b32 s47, s42, 22
    s_add_u32 s47, s47, 3981312
    s_lshl_b32 s30, s43, 8
    s_add_u32 s48, s47, s30
    s_add_u32 s48, s48, 81920
    s_add_u32 s30, s40, s3
    s_lshl_b32 s30, s30, 1
    s_add_u32 s30, s30, s43
    s_lshl_b32 s30, s30, 10
    s_add_u32 s47, s47, s30
    v_lshlrev_b32 v1, 2, v0
    buffer_load_dwordx4 v[128:131], v4, s[8:11], s47 offen sc1
    buffer_load_dword v132, v1, s[8:11], s48 offen sc1
    s_lshl_b32 s30, s35, 13
    s_lshl_b32 s37, s42, 22
    s_add_u32 s37, s37, s30
    s_and_b32 s37, s37, 134217727
    s_add_u32 s30, s40, 4
    s_lshl_b32 s30, s30, 14
    s_add_u32 s51, s37, s30
    s_mul_i32 s30, s43, 81920
    s_add_u32 s46, s37, s30
    s_add_u32 s46, s46, 737280
    s_lshl_b32 s30, s3, 11
    s_add_u32 s48, s46, s30
    s_add_u32 s48, s48, 65536
    s_lshl_b32 s30, s3, 14
    s_add_u32 s46, s46, s30
    s_min_u32 s45, s44, 63
    s_add_u32 s45, s45, s4
    s_lshl_b32 s47, s35, 13
    s_mov_b64 s[38:39], -1
    s_mov_b32 s62, -1
    s_add_u32 s52, s51, 16384
    s_add_u32 s53, s51, 32768
    s_add_u32 s54, s51, 49152
    s_cmp_lg_u32 s3, 0
    s_cbranch_scc1 L_g_tk2
L_g_tk:
    buffer_load_dword v16, v8, s[8:11], s47 offen sc1
    s_add_u32 s7, s7, 1
    s_bitcmp1_b32 s7, 22
    s_cbranch_scc1 L_abort
    s_waitcnt vmcnt(0)
    v_subrev_u32 v1, s45, v16
    v_cmp_lt_u32 vcc, 64, v1
    s_cbranch_vccnz L_g_tk
L_g_tk2:
    s_barrier
L_g_go:
    buffer_load_dwordx4 a[32:35], v152, s[8:11], s51 offen sc1
    s_nop 10
    buffer_load_dwordx4 a[72:75], v153, s[8:11], s52 offen sc1
    s_nop 10
    buffer_load_dwordx4 a[112:115], v154, s[8:11], s53 offen sc1
    s_nop 10
    buffer_load_dwordx4 a[152:155], v155, s[8:11], s54 offen sc1
    s_nop 10
    buffer_load_dwordx4 a[36:39], v153, s[8:11], s51 offen sc1
    s_nop 10
    buffer_load_dwordx4 a[76:79], v154, s[8:11], s52 offen sc1
    s_nop 10
    buffer_load_dwordx4 a[116:119], v155, s[8:11], s53 offen sc1
    s_nop 10
    buffer_load_dwordx4 a[156:159], v156, s[8:11], s54 offen sc1
    s_nop 10
    buffer_load_dwordx4 v[32:35], v4, s[8:11], s46 offen offset:0 sc1
    s_nop 10
    buffer_load_dwordx4 v[36:39], v4, s[8:11], s46 offen offset:1024 sc1
    s_nop 10
    buffer_load_dwordx4 v[40:43], v4, s[8:11], s46 offen offset:2048 sc1
    s_nop 10
    buffer_load_dwordx4 v[44:47], v4, s[8:11], s46 offen offset:3072 sc1
    s_nop 10
    buffer_load_dwordx4 v[48:51], v5, s[8:11], s46 offen offset:0 sc1
    s_nop 10
    buffer_load_dwordx4 v[52:55], v5, s[8:11], s46 offen offset:1024 sc1
    s_nop 10
    buffer_load_dwordx4 v[56:59], v5, s[8:11], s46 offen offset:2048 sc1
    s_nop 10
    buffer_load_dwordx4 v[60:63], v5, s[8:11], s46 offen offset:3072 sc1
    s_nop 10
    buffer_load_dwordx4 v[64:67], v4, s[8:11], s48 offen offset:0 sc1
    s_nop 10
    buffer_load_dwordx4 v[68:71], v4, s[8:11], s48 offen offset:1024 sc1
    s_nop 10
    s_waitcnt vmcnt(9)
    v_mfma_f32_16x16x32_bf16 v[112:115], a[0:3], v[32:35], 0
    v_mfma_f32_16x16x32_bf16 v[116:119], a[40:43], v[32:35], 0
    v_mfma_f32_16x16x32_bf16 v[120:123], a[80:83], v[32:35], 0
    v_mfma_f32_16x16x32_bf16 v[124:127], a[120:123], v[32:35], 0
    s_waitcnt vmcnt(8)
    v_mfma_f32_16x16x32_bf16 v[112:115], a[4:7], v[36:39], v[112:115]
    v_mfma_f32_16x16x32_bf16 v[116:119], a[44:47], v[36:39], v[116:119]
    v_mfma_f32_16x16x32_bf16 v[120:123], a[84:87], v[36:39], v[120:123]
    v_mfma_f32_16x16x32_bf16 v[124:127], a[124:127], v[36:39], v[124:127]
    s_waitcnt vmcnt(7)
    v_mfma_f32_16x16x32_bf16 v[112:115], a[8:11], v[40:43], v[112:115]
    v_mfma_f32_16x16x32_bf16 v[116:119], a[48:51], v[40:43], v[116:119]
    v_mfma_f32_16x16x32_bf16 v[120:123], a[88:91], v[40:43], v[120:123]
    v_mfma_f32_16x16x32_bf16 v[124:127], a[128:131], v[40:43], v[124:127]
    s_waitcnt vmcnt(6)
    v_mfma_f32_16x16x32_bf16 v[112:115], a[12:15], v[44:47], v[112:115]
    v_mfma_f32_16x16x32_bf16 v[116:119], a[52:55], v[44:47], v[116:119]
    v_mfma_f32_16x16x32_bf16 v[120:123], a[92:95], v[44:47], v[120:123]
    v_mfma_f32_16x16x32_bf16 v[124:127], a[132:135], v[44:47], v[124:127]
    s_waitcnt vmcnt(5)
    v_mfma_f32_16x16x32_bf16 v[112:115], a[16:19], v[48:51], v[112:115]
    v_mfma_f32_16x16x32_bf16 v[116:119], a[56:59], v[48:51], v[116:119]
    v_mfma_f32_16x16x32_bf16 v[120:123], a[96:99], v[48:51], v[120:123]
    v_mfma_f32_16x16x32_bf16 v[124:127], a[136:139], v[48:51], v[124:127]
    s_waitcnt vmcnt(4)
    v_mfma_f32_16x16x32_bf16 v[112:115], a[20:23], v[52:55], v[112:115]
    v_mfma_f32_16x16x32_bf16 v[116:119], a[60:63], v[52:55], v[116:119]
    v_mfma_f32_16x16x32_bf16 v[120:123], a[100:103], v[52:55], v[120:123]
    v_mfma_f32_16x16x32_bf16 v[124:127], a[140:143], v[52:55], v[124:127]
    s_waitcnt vmcnt(3)
    v_mfma_f32_16x16x32_bf16 v[112:115], a[24:27], v[56:59], v[112:115]
    v_mfma_f32_16x16x32_bf16 v[116:119], a[64:67], v[56:59], v[116:119]
    v_mfma_f32_16x16x32_bf16 v[120:123], a[104:107], v[56:59], v[120:123]
    v_mfma_f32_16x16x32_bf16 v[124:127], a[144:147], v[56:59], v[124:127]
    s_waitcnt vmcnt(2)
    v_mfma_f32_16x16x32_bf16 v[112:115], a[28:31], v[60:63], v[112:115]
    v_mfma_f32_16x16x32_bf16 v[116:119], a[68:71], v[60:63], v[116:119]
    v_mfma_f32_16x16x32_bf16 v[120:123], a[108:111], v[60:63], v[120:123]
    v_mfma_f32_16x16x32_bf16 v[124:127], a[148:151], v[60:63], v[124:127]
    s_waitcnt vmcnt(1)
    v_mfma_f32_16x16x32_bf16 v[112:115], a[32:35], v[64:67], v[112:115]
    v_mfma_f32_16x16x32_bf16 v[116:119], a[72:75], v[64:67], v[116:119]
    v_mfma_f32_16x16x32_bf16 v[120:123], a[112:115], v[64:67], v[120:123]
    v_mfma_f32_16x16x32_bf16 v[124:127], a[152:155], v[64:67], v[124:127]
    s_waitcnt vmcnt(0)
    v_mfma_f32_16x16x32_bf16 v[112:115], a[36:39], v[68:71], v[112:115]
    v_mfma_f32_16x16x32_bf16 v[116:119], a[76:79], v[68:71], v[116:119]
    v_mfma_f32_16x16x32_bf16 v[120:123], a[116:119], v[68:71], v[120:123]
    v_mfma_f32_16x16x32_bf16 v[124:127], a[156:159], v[68:71], v[124:127]
    ds_write_b128 v9, v[112:115] offset:0
    s_nop 2
    ds_write_b128 v9, v[116:119] offset:1024
    s_nop 2
    ds_write_b128 v9, v[120:123] offset:2048
    s_nop 2
    ds_write_b128 v9, v[124:127] offset:3072
    v_add_f32 v32, v112, v113
    v_add_f32 v33, v114, v115
    v_add_f32 v34, v116, v117
    v_add_f32 v35, v118, v119
    v_add_f32 v36, v120, v121
    v_add_f32 v37, v122, v123
    v_add_f32 v38, v124, v125
    v_add_f32 v39, v126, v127
    v_cmp_u_f32 s[64:65], v32, v33
    v_cmp_u_f32 s[66:67], v34, v35
    v_cmp_u_f32 s[68:69], v36, v37
    v_cmp_u_f32 s[70:71], v38, v39
    s_or_b64 s[64:65], s[64:65], s[66:67]
    s_or_b64 s[68:69], s[68:69], s[70:71]
    s_or_b64 s[64:65], s[64:65], s[68:69]
    s_and_b64 s[64:65], s[64:65], s[38:39]
    s_cbranch_scc1 L_g_slow
    s_waitcnt lgkmcnt(0)
    s_barrier
    ds_read_b128 v[32:35], v10 offset:0
    ds_read_b128 v[36:39], v10 offset:4096
    ds_read_b128 v[40:43], v10 offset:8192
    ds_read_b128 v[44:47], v10 offset:12288
    s_waitcnt lgkmcnt(0)
    v_pk_add_f32 v[32:33], v[32:33], v[36:37]
    v_pk_add_f32 v[34:35], v[34:35], v[38:39]
    v_pk_add_f32 v[40:41], v[40:41], v[44:45]
    v_pk_add_f32 v[42:43], v[42:43], v[46:47]
    v_pk_add_f32 v[32:33], v[32:33], v[40:41]
    v_pk_add_f32 v[34:35], v[34:35], v[42:43]
    v_fmac_f32 v128, v132, v32
    v_fmac_f32 v129, v132, v33
    v_fmac_f32 v130, v132, v34
    v_fmac_f32 v131, v132, v35
    v_cvt_pk_bf16_f32 v128, v128, v129
    v_cvt_pk_bf16_f32 v129, v130, v131
    buffer_store_dwordx2 v[128:129], v11, s[16:19], s59 offen sc1
    s_endpgm
L_g_slow:
    s_waitcnt lgkmcnt(0)
    s_lshl_b32 s62, s62, 4
    s_cbranch_scc1 L_g_go
L_g_sp:
    buffer_load_dwordx4 a[32:35], v152, s[8:11], s51 offen sc1
    buffer_load_dwordx4 a[72:75], v153, s[8:11], s52 offen sc1
    buffer_load_dwordx4 a[112:115], v154, s[8:11], s53 offen sc1
    buffer_load_dwordx4 a[152:155], v155, s[8:11], s54 offen sc1
    buffer_load_dwordx4 a[36:39], v153, s[8:11], s51 offen sc1
    buffer_load_dwordx4 a[76:79], v154, s[8:11], s52 offen sc1
    buffer_load_dwordx4 a[116:119], v155, s[8:11], s53 offen sc1
    buffer_load_dwordx4 a[156:159], v156, s[8:11], s54 offen sc1
    buffer_load_dwordx4 v[32:35], v4, s[8:11], s46 offen offset:0 sc1
    buffer_load_dwordx4 v[36:39], v4, s[8:11], s46 offen offset:1024 sc1
    buffer_load_dwordx4 v[40:43], v4, s[8:11], s46 offen offset:2048 sc1
    buffer_load_dwordx4 v[44:47], v4, s[8:11], s46 offen offset:3072 sc1
    buffer_load_dwordx4 v[48:51], v5, s[8:11], s46 offen offset:0 sc1
    buffer_load_dwordx4 v[52:55], v5, s[8:11], s46 offen offset:1024 sc1
    buffer_load_dwordx4 v[56:59], v5, s[8:11], s46 offen offset:2048 sc1
    buffer_load_dwordx4 v[60:63], v5, s[8:11], s46 offen offset:3072 sc1
    buffer_load_dwordx4 v[64:67], v4, s[8:11], s48 offen offset:0 sc1
    buffer_load_dwordx4 v[68:71], v4, s[8:11], s48 offen offset:1024 sc1
    s_add_u32 s7, s7, 1
    s_bitcmp1_b32 s7, 22
    s_cbranch_scc1 L_abort
    s_waitcnt vmcnt(0)
    v_mov_b32 v1, 0
    v_accvgpr_read_b32 v2, a32
    v_max_u32 v1, v1, v2
    v_accvgpr_read_b32 v2, a33
    v_max_u32 v1, v1, v2
    v_accvgpr_read_b32 v2, a34
    v_max_u32 v1, v1, v2
    v_accvgpr_read_b32 v2, a35
    v_max_u32 v1, v1, v2
    v_accvgpr_read_b32 v2, a36
    v_max_u32 v1, v1, v2
    v_accvgpr_read_b32 v2, a37
    v_max_u32 v1, v1, v2
    v_accvgpr_read_b32 v2, a38
    v_max_u32 v1, v1, v2
    v_accvgpr_read_b32 v2, a39
    v_max_u32 v1, v1, v2
    v_accvgpr_read_b32 v2, a72
    v_max_u32 v1, v1, v2
    v_accvgpr_read_b32 v2, a73
    v_max_u32 v1, v1, v2
    v_accvgpr_read_b32 v2, a74
    v_max_u32 v1, v1, v2
    v_accvgpr_read_b32 v2, a75
    v_max_u32 v1, v1, v2
    v_accvgpr_read_b32 v2, a76
    v_max_u32 v1, v1, v2
    v_accvgpr_read_b32 v2, a77
    v_max_u32 v1, v1, v2
    v_accvgpr_read_b32 v2, a78
    v_max_u32 v1, v1, v2
    v_accvgpr_read_b32 v2, a79
    v_max_u32 v1, v1, v2
    v_accvgpr_read_b32 v2, a112
    v_max_u32 v1, v1, v2
    v_accvgpr_read_b32 v2, a113
    v_max_u32 v1, v1, v2
    v_accvgpr_read_b32 v2, a114
    v_max_u32 v1, v1, v2
    v_accvgpr_read_b32 v2, a115
    v_max_u32 v1, v1, v2
    v_accvgpr_read_b32 v2, a116
    v_max_u32 v1, v1, v2
    v_accvgpr_read_b32 v2, a117
    v_max_u32 v1, v1, v2
    v_accvgpr_read_b32 v2, a118
    v_max_u32 v1, v1, v2
    v_accvgpr_read_b32 v2, a119
    v_max_u32 v1, v1, v2
    v_accvgpr_read_b32 v2, a152
    v_max_u32 v1, v1, v2
    v_accvgpr_read_b32 v2, a153
    v_max_u32 v1, v1, v2
    v_accvgpr_read_b32 v2, a154
    v_max_u32 v1, v1, v2
    v_accvgpr_read_b32 v2, a155
    v_max_u32 v1, v1, v2
    v_accvgpr_read_b32 v2, a156
    v_max_u32 v1, v1, v2
    v_accvgpr_read_b32 v2, a157
    v_max_u32 v1, v1, v2
    v_accvgpr_read_b32 v2, a158
    v_max_u32 v1, v1, v2
    v_accvgpr_read_b32 v2, a159
    v_max_u32 v1, v1, v2
    v_max_u32 v1, v1, v32
    v_max_u32 v1, v1, v33
    v_max_u32 v1, v1, v34
    v_max_u32 v1, v1, v35
    v_max_u32 v1, v1, v36
    v_max_u32 v1, v1, v37
    v_max_u32 v1, v1, v38
    v_max_u32 v1, v1, v39
    v_max_u32 v1, v1, v40
    v_max_u32 v1, v1, v41
    v_max_u32 v1, v1, v42
    v_max_u32 v1, v1, v43
    v_max_u32 v1, v1, v44
    v_max_u32 v1, v1, v45
    v_max_u32 v1, v1, v46
    v_max_u32 v1, v1, v47
    v_max_u32 v1, v1, v48
    v_max_u32 v1, v1, v49
    v_max_u32 v1, v1, v50
    v_max_u32 v1, v1, v51
    v_max_u32 v1, v1, v52
    v_max_u32 v1, v1, v53
    v_max_u32 v1, v1, v54
    v_max_u32 v1, v1, v55
    v_max_u32 v1, v1, v56
    v_max_u32 v1, v1, v57
    v_max_u32 v1, v1, v58
    v_max_u32 v1, v1, v59
    v_max_u32 v1, v1, v60
    v_max_u32 v1, v1, v61
    v_max_u32 v1, v1, v62
    v_max_u32 v1, v1, v63
    v_max_u32 v1, v1, v64
    v_max_u32 v1, v1, v65
    v_max_u32 v1, v1, v66
    v_max_u32 v1, v1, v67
    v_max_u32 v1, v1, v68
    v_max_u32 v1, v1, v69
    v_max_u32 v1, v1, v70
    v_max_u32 v1, v1, v71
    v_cmp_eq_u32 vcc, -1, v1
    s_cbranch_vccnz L_g_sp
    s_mov_b64 s[38:39], 0
    s_branch L_g_go
.section .rodata,"a"
.p2align 6
.amdhsa_kernel gated_mix__linear_attn_block__memory_aug_recurrent_mem_tr__prompt_kernel
  .amdhsa_next_free_vgpr 512
  .amdhsa_next_free_sgpr 102
  .amdhsa_accum_offset 256
  .amdhsa_group_segment_fixed_size 0
  .amdhsa_kernarg_size 112
  .amdhsa_user_sgpr_count 2
  .amdhsa_user_sgpr_kernarg_segment_ptr 1
  .amdhsa_system_sgpr_workgroup_id_x 1
  .amdhsa_float_denorm_mode_32 3
.end_amdhsa_kernel
```
